```python
import torch

def _softmax(x, axis=-1):
    return torch.softmax(x, dim=axis)

def _gelu(x):
    return torch.nn.functional.gelu(x, approximate='tanh')

def _silu(x):
    return torch.nn.functional.silu(x)

def _sigmoid(x):
    return torch.sigmoid(x)

def _layernorm(x, axis=-1, eps=1e-05):
    m = x.mean(dim=axis, keepdim=True)
    v = x.var(dim=axis, keepdim=True, unbiased=False)
    return (x - m) / torch.sqrt(v + eps)

def _scatter_add(tgt, idx, src, axis=0):
    return tgt.clone().index_add_(axis, idx, src)

def _segment_sum(src, seg, n):
    out = torch.zeros((n,) + src.shape[1:], dtype=src.dtype)
    return out.index_add_(0, seg, src)

def _pad(x, pw):
    flat = tuple((v for pair in reversed(pw) for v in pair))
    return torch.nn.functional.pad(x, flat)
kernel_name = 'sequential_preLN__memory_aug_recurrent_mem_tr__glu_gated_swiglu__prompt'

def setup_inputs():

    _w = lambda a: (lambda t: t.to(torch.bfloat16) if t.is_floating_point() else t)(torch.as_tensor(a))

    def _A_setup():
        B, S, Dm = (1, 2048, 576)
        H, Dh = (32, 128)
        M, seg = (8, 32)
        seg = min(seg, S)
        S = S // seg * seg
        return {'x': _w((lambda *s: torch.randn(*s, dtype=torch.bfloat16) * 0.05)(B, S, Dm)), 'mem0': _w((lambda *s: torch.randn(*s, dtype=torch.bfloat16) * 0.2)(B, M, Dm)), 'Wq': _w((lambda *s: torch.randn(*s, dtype=torch.bfloat16) * 1.6)(Dm, H, Dh) * Dm ** (-0.5)), 'Wk': _w((lambda *s: torch.randn(*s, dtype=torch.bfloat16) * 1.6)(Dm, H, Dh) * Dm ** (-0.5)), 'Wv': _w((lambda *s: torch.randn(*s, dtype=torch.bfloat16) * 0.2)(Dm, H, Dh) * Dm ** (-0.5)), 'Wo': _w((lambda *s: torch.randn(*s, dtype=torch.bfloat16) * 0.2)(H, Dh, Dm) * (H * Dh) ** (-0.5)), 'seg_len': seg}
    _A_in = _A_setup()

    def _B_setup():
        B, S, D, F = (1, 2048, 576, 4608)
        return {'x': _w((lambda *s: torch.randn(*s, dtype=torch.bfloat16) * 0.05)(B, S, D)), 'w1': _w((lambda *s: torch.randn(*s, dtype=torch.bfloat16) * 0.2)(D, F) * (2.0 / D) ** 0.5), 'w3': _w((lambda *s: torch.randn(*s, dtype=torch.bfloat16) * 0.2)(D, F) * (2.0 / D) ** 0.5), 'w2': _w((lambda *s: torch.randn(*s, dtype=torch.bfloat16) * 0.2)(F, D) * (2.0 / F) ** 0.5)}
    _B_in = _B_setup()
    return {'A_x': _A_in['x'], 'A_mem0': _A_in['mem0'], 'A_Wq': _A_in['Wq'], 'A_Wk': _A_in['Wk'], 'A_Wv': _A_in['Wv'], 'A_Wo': _A_in['Wo'], 'A_seg_len': _A_in['seg_len'], 'B_x': _B_in['x'], 'B_w1': _B_in['w1'], 'B_w3': _B_in['w3'], 'B_w2': _B_in['w2']}

def reference(A_x, A_mem0, A_Wq, A_Wk, A_Wv, A_Wo, A_seg_len, B_x, B_w1, B_w3, B_w2):

    def _A_ref(x, mem0, Wq, Wk, Wv, Wo, seg_len):
        B, S, Dm = x.shape
        H, Dh = (Wq.shape[1], Wq.shape[2])
        M = mem0.shape[1]
        scale = Dh ** (-0.5)
        n_seg = S // seg_len
        L = M + seg_len
        idx = torch.arange(L)
        mask = (idx[:, None] < M) | (idx[:, None] >= idx[None, :])
        mem = mem0
        outs = []
        for s in range(n_seg):
            xs = x[:, s * seg_len:(s + 1) * seg_len, :].clone()
            h = torch.concatenate([mem, xs], axis=1)
            q = torch.einsum('btd,dhe->bhte', h, Wq)
            k = torch.einsum('btd,dhe->bhte', h, Wk)
            v = torch.einsum('btd,dhe->bhte', h, Wv)
            scores = torch.einsum('bhqe,bhke->bhqk', q, k) * scale
            scores = torch.where(mask[None, None], scores, -1000000000.0)
            p = _softmax(scores, axis=-1)
            o = torch.einsum('bhqk,bhke->bhqe', p, v)
            o = torch.einsum('bhte,hed->btd', o, Wo)
            mem = o[:, :M, :].clone()
            outs.append(o[:, M:, :])
        return torch.concatenate(outs, axis=1)

    def _B_ref(x, w1, w3, w2):
        gate = torch.einsum('bsd,df->bsf', x, w1)
        up = torch.einsum('bsd,df->bsf', x, w3)
        h = _silu(gate) * up
        out = torch.einsum('bsf,fd->bsd', h, w2)
        return out
    x = A_x
    h = x + _A_ref(_layernorm(x, axis=-1), A_mem0, A_Wq, A_Wk, A_Wv, A_Wo, A_seg_len)
    h2 = h + _B_ref(_layernorm(h, axis=-1), B_w1, B_w3, B_w2)
    return h2
```

```asm
; @launch grid=(256,1,1) block=(256,1,1) lds=163840
.amdgcn_target "amdgcn-amd-amdhsa--gfx950"
.text
.globl sequential_preLN__memory_aug_recurrent_mem_tr__glu_gated_swiglu__prompt_kernel
.p2align 8
.type sequential_preLN__memory_aug_recurrent_mem_tr__glu_gated_swiglu__prompt_kernel,@function
sequential_preLN__memory_aug_recurrent_mem_tr__glu_gated_swiglu__prompt_kernel:
s_cmp_ge_u32 s2, 256
s_cbranch_scc1 K_end
s_load_dwordx2 s[48:49], s[0:1], 8
s_load_dwordx2 s[50:51], s[0:1], 16
s_load_dwordx2 s[52:53], s[0:1], 24
s_load_dwordx2 s[54:55], s[0:1], 32
s_load_dwordx2 s[56:57], s[0:1], 40
s_load_dwordx2 s[58:59], s[0:1], 104
s_load_dwordx2 s[60:61], s[0:1], 96
s_getreg_b32 s3, hwreg(HW_REG_XCC_ID)
s_and_b32 s3, s3, 0xf
v_lshrrev_b32 v1, 6, v0
s_nop 1
v_readfirstlane_b32 s13, v1
v_and_b32 v0, 63, v0
s_waitcnt lgkmcnt(0)
s_mov_b32 s8, s58
s_and_b32 s9, s59, 0xffff
s_mov_b32 s10, 230686720
s_mov_b32 s11, 0x20000
s_cmp_eq_u32 s2, 0
s_cbranch_scc0 K_noinit
s_cmp_eq_u32 s13, 0
s_cbranch_scc0 K_noinit
v_lshlrev_b32 v1, 4, v0
v_mov_b32 v4, 0
v_mov_b32 v5, 0
v_mov_b32 v6, 0
v_mov_b32 v7, 0
s_mov_b32 s25, 70270976
buffer_store_dwordx4 v[4:7], v1, s[8:11], s25 offen sc1
s_mov_b32 s25, 70272000
buffer_store_dwordx4 v[4:7], v1, s[8:11], s25 offen sc1
s_mov_b32 s25, 70273024
buffer_store_dwordx4 v[4:7], v1, s[8:11], s25 offen sc1
s_mov_b32 s25, 70274048
buffer_store_dwordx4 v[4:7], v1, s[8:11], s25 offen sc1
s_mov_b32 s25, 70275072
buffer_store_dwordx4 v[4:7], v1, s[8:11], s25 offen sc1
s_mov_b32 s25, 70276096
buffer_store_dwordx4 v[4:7], v1, s[8:11], s25 offen sc1
s_mov_b32 s25, 70277120
buffer_store_dwordx4 v[4:7], v1, s[8:11], s25 offen sc1
s_mov_b32 s25, 70278144
buffer_store_dwordx4 v[4:7], v1, s[8:11], s25 offen sc1
s_mov_b32 s25, 70279168
buffer_store_dwordx4 v[4:7], v1, s[8:11], s25 offen sc1
s_mov_b32 s25, 70280192
buffer_store_dwordx4 v[4:7], v1, s[8:11], s25 offen sc1
s_mov_b32 s25, 70281216
buffer_store_dwordx4 v[4:7], v1, s[8:11], s25 offen sc1
s_mov_b32 s25, 70282240
buffer_store_dwordx4 v[4:7], v1, s[8:11], s25 offen sc1
s_mov_b32 s25, 70283264
buffer_store_dwordx4 v[4:7], v1, s[8:11], s25 offen sc1
s_mov_b32 s25, 70284288
buffer_store_dwordx4 v[4:7], v1, s[8:11], s25 offen sc1
s_mov_b32 s25, 70285312
buffer_store_dwordx4 v[4:7], v1, s[8:11], s25 offen sc1
s_mov_b32 s25, 70286336
buffer_store_dwordx4 v[4:7], v1, s[8:11], s25 offen sc1
s_mov_b32 s25, 70287360
buffer_store_dwordx4 v[4:7], v1, s[8:11], s25 offen sc1
s_mov_b32 s25, 70288384
buffer_store_dwordx4 v[4:7], v1, s[8:11], s25 offen sc1
s_mov_b32 s25, 70289408
buffer_store_dwordx4 v[4:7], v1, s[8:11], s25 offen sc1
s_mov_b32 s25, 70290432
buffer_store_dwordx4 v[4:7], v1, s[8:11], s25 offen sc1
s_mov_b32 s25, 70385664
buffer_store_dwordx4 v[4:7], v1, s[8:11], s25 offen sc1
s_mov_b32 s25, 70386688
buffer_store_dwordx4 v[4:7], v1, s[8:11], s25 offen sc1
s_mov_b32 s25, 70387712
buffer_store_dwordx4 v[4:7], v1, s[8:11], s25 offen sc1
s_mov_b32 s25, 70388736
buffer_store_dwordx4 v[4:7], v1, s[8:11], s25 offen sc1
s_waitcnt vmcnt(0)
s_mov_b32 s26, 1
s_atomic_add s26, s[60:61], 16
s_waitcnt lgkmcnt(0)
K_noinit:
s_cmp_eq_u32 s3, 0
s_cbranch_scc0 K_worker
s_cmp_eq_u32 s13, 0
s_cbranch_scc0 K_t1
s_mov_b32 s12, 1
s_atomic_add s12, s[60:61], 0 glc
s_waitcnt lgkmcnt(0)
K_sim:
v_mov_b32 v4, 163824
v_mov_b32 v2, s12
s_mov_b64 exec, 1
ds_write_b32 v4, v2
s_waitcnt lgkmcnt(0)
s_mov_b64 exec, -1
K_t1:
s_barrier
v_mov_b32 v4, 163824
ds_read_b32 v2, v4
s_waitcnt lgkmcnt(0)
v_readfirstlane_b32 s12, v2
s_barrier
s_cmp_lt_u32 s12, 32
s_cbranch_scc0 K_worker
s_mov_b32 s30, 0
s_mov_b32 s31, 64
K_R:
v_mov_b32 v30, v0
v_and_b32 v31, 15, v30
v_lshrrev_b32 v32, 4, v30
v_and_b32 v33, 7, v30
v_bfe_u32 v34, v30, 3, 1
v_lshlrev_b32 v0, 4, v30
s_lshl_b32 s25, s13, 10
v_add_u32 v1, s25, v0
v_and_b32 v35, 1, v32
v_lshlrev_b32 v2, 7, v35
v_lshl_add_u32 v2, v33, 4, v2
s_lshr_b32 s25, s13, 1
s_lshl_b32 s25, s25, 10
s_and_b32 s26, s13, 1
s_lshl_b32 s26, s26, 7
s_add_u32 s25, s25, s26
s_add_u32 s25, s25, 14336
v_lshrrev_b32 v36, 1, v32
v_lshlrev_b32 v3, 8, v36
v_lshl_add_u32 v3, v33, 4, v3
v_lshl_add_u32 v3, v35, 3, v3
v_add_u32 v3, s25, v3
v_mov_b32 v37, 0x7ffffff0
v_cmp_eq_u32 vcc, 0, v34
s_nop 1
v_cndmask_b32 v3, v37, v3, vcc
v_mov_b32 v37, 0x80000000
v_cndmask_b32 v7, v37, v0, vcc
v_mov_b32 v38, 0x44444444
v_mov_b32 v39, 0xeeeeeeee
v_cndmask_b32 v6, v39, v38, vcc
s_lshl_b32 s24, s12, 1
s_add_u32 s24, s24, s13
s_add_u32 s25, s12, 64
s_cmp_eq_u32 s13, 2
s_cselect_b32 s24, s25, s24
s_cmp_lt_u32 s13, 2
s_cselect_b32 s23, 1, 0
s_cmp_eq_u32 s13, 2
s_cselect_b32 s25, 1, 0
s_cmp_lt_u32 s12, 8
s_cselect_b32 s26, 1, 0
s_and_b32 s25, s25, s26
s_or_b32 s23, s23, s25
s_cmp_eq_u32 s23, 0
s_cselect_b32 s24, 0, s24
s_lshr_b32 s25, s24, 2
s_and_b32 s26, s24, 3
s_cmp_gt_u32 s25, 13
s_cselect_b32 s27, 2, 0
s_cmp_gt_u32 s25, 4
s_cselect_b32 s28, 1, 0
s_cmp_gt_u32 s25, 13
s_cselect_b32 s28, 2, s28
s_sub_u32 s27, s25, s28
s_lshr_b32 s28, s27, 1
s_lshl_b32 s28, s28, 10
s_and_b32 s27, s27, 1
s_lshl_b32 s27, s27, 7
s_add_u32 s28, s28, s27
s_cmp_eq_u32 s25, 4
s_cselect_b32 s28, 8192, s28
s_cmp_eq_u32 s25, 13
s_cselect_b32 s28, 9216, s28
s_lshl_b32 s26, s26, 8
s_add_u32 s25, s28, s26
s_lshr_b32 s26, s24, 2
s_cmp_eq_u32 s26, 4
s_cselect_b32 s27, 2, s23
s_cmp_eq_u32 s26, 13
s_cselect_b32 s27, 2, s27
s_cmp_eq_u32 s23, 0
s_cselect_b32 s23, 0, s27
v_lshl_add_u32 v40, v34, 2, v32
v_mul_u32_u24 v40, 10624, v40
v_lshl_add_u32 v40, v33, 4, v40
v_add_u32 v4, s25, v40
s_cmp_eq_u32 s23, 0
s_cselect_b32 s26, 0x80000000, 0
s_cselect_b32 s45, 0x80000000, s25
v_lshlrev_b32 v40, 4, v33
v_lshl_add_u32 v40, v32, 3, v40
s_lshl_b32 s25, s24, 7
v_add_u32 v40, s25, v40
v_and_b32 v41, 40, v30
v_cmp_eq_u32 vcc, 0, v41
s_nop 1
v_cndmask_b32 v5, v37, v40, vcc
v_or_b32 v5, s26, v5
s_mov_b64 s[38:39], vcc
v_lshlrev_b32 v40, 2, v35
v_sub_u32 v40, v31, v40
v_mov_b32 v41, 0x3f80
v_mov_b32 v42, 0x3f800000
v_mov_b32 v8, 0
v_mov_b32 v9, 0
v_cmp_eq_u32 vcc, 0, v40
s_nop 1
v_cndmask_b32 v8, v8, v41, vcc
v_cmp_eq_u32 vcc, 1, v40
s_nop 1
v_cndmask_b32 v8, v8, v42, vcc
v_cmp_eq_u32 vcc, 2, v40
s_nop 1
v_cndmask_b32 v9, v9, v41, vcc
v_cmp_eq_u32 vcc, 3, v40
s_nop 1
v_cndmask_b32 v9, v9, v42, vcc
v_mov_b32 v10, 0
v_cmp_eq_u32 vcc, 0, v31
s_nop 1
v_cndmask_b32 v10, v10, v41, vcc
v_cmp_eq_u32 vcc, 1, v31
s_nop 1
v_cndmask_b32 v10, v10, v42, vcc
v_mov_b32 v11, 0
v_cmp_eq_u32 vcc, 2, v31
s_nop 1
v_cndmask_b32 v11, v11, v41, vcc
v_cmp_eq_u32 vcc, 3, v31
s_nop 1
v_cndmask_b32 v11, v11, v42, vcc
v_mov_b32 v12, 0
v_cmp_eq_u32 vcc, 4, v31
s_nop 1
v_cndmask_b32 v12, v12, v41, vcc
v_cmp_eq_u32 vcc, 5, v31
s_nop 1
v_cndmask_b32 v12, v12, v42, vcc
v_mov_b32 v13, 0
v_cmp_eq_u32 vcc, 6, v31
s_nop 1
v_cndmask_b32 v13, v13, v41, vcc
v_cmp_eq_u32 vcc, 7, v31
s_nop 1
v_cndmask_b32 v13, v13, v42, vcc
s_lshl_b32 s37, s13, 10
s_lshl_b32 s46, s12, 2
s_add_u32 s46, s46, s13
s_lshl_b32 s46, s46, 6
s_add_u32 s46, s46, 9216
s_mov_b32 s15, 0x3e0293ee
s_lshl_b32 s36, s13, 8
s_add_u32 s36, s36, 13312
s_mul_i32 s40, s13, 9
s_add_u32 s40, s40, 1
s_lshr_b32 s40, s40, 1
s_lshr_b32 s41, s13, 1
s_mul_i32 s41, s41, 9
s_add_u32 s41, s41, 4
s_lshl_b32 s25, s12, 2
s_add_u32 s25, s25, s13
s_lshl_b32 s32, s12, 7
s_add_u32 s32, s32, 70385664
s_cmp_lg_u32 s13, 0
s_cselect_b32 s32, 0x80000000, s32
L_noh2_1:
v_lshrrev_b32 v46, 4, v0
v_lshrrev_b32 v45, 2, v46
v_and_b32 v44, 3, v46
v_lshlrev_b32 v30, 13, v45
v_lshl_add_u32 v30, v44, 4, v30
v_mul_u32_u24 v32, 1152, v45
v_lshl_add_u32 v32, v44, 4, v32
v_lshrrev_b32 v43, 3, v46
v_and_b32 v42, 7, v46
v_mul_u32_u24 v31, 1152, v43
v_lshl_add_u32 v31, v42, 4, v31
s_lshl_b32 s25, s13, 12
v_add_u32 v33, s25, v0
v_lshrrev_b32 v43, 4, v46
v_bfe_u32 v42, v46, 2, 2
v_lshrrev_b32 v41, 1, v43
v_lshlrev_b32 v41, 4, v41
v_and_b32 v40, 1, v43
v_lshl_add_u32 v41, v40, 2, v41
v_lshrrev_b32 v40, 1, v42
v_lshl_add_u32 v41, v40, 3, v41
v_and_b32 v40, 1, v42
v_add_u32 v41, v41, v40
v_lshlrev_b32 v34, 6, v41
v_lshl_add_u32 v34, v44, 3, v34
v_add_u32 v34, s25, v34
v_lshl_add_u32 v41, v43, 3, v42
v_lshlrev_b32 v35, 7, v41
v_lshl_add_u32 v35, v44, 4, v35
v_add_u32 v35, s25, v35
v_lshlrev_b32 v36, 6, v41
v_lshl_add_u32 v36, v44, 4, v36
v_add_u32 v36, s25, v36
s_and_b32 s26, s13, 1
s_lshl_b32 s26, s26, 3
v_add_u32 v36, s26, v36
v_add_u32 v37, 0x10000, v1
v_add_u32 v38, 0x20000, v1
v_lshrrev_b32 v48, 4, v0
v_lshrrev_b32 v49, 4, v48
v_and_b32 v50, 15, v48
v_lshlrev_b32 v30, 13, v49
v_lshl_add_u32 v30, v50, 4, v30
s_lshl_b32 s25, s13, 12
v_add_u32 v51, 0, v49
v_xor_b32 v51, v51, v50
v_lshlrev_b32 v51, 4, v51
v_lshl_add_u32 v51, v49, 8, v51
v_add_u32 v51, 0, v51
v_add_u32 v39, s25, v51
v_add_u32 v51, 4, v49
v_xor_b32 v51, v51, v50
v_lshlrev_b32 v51, 4, v51
v_lshl_add_u32 v51, v49, 8, v51
v_add_u32 v51, 1024, v51
v_add_u32 v40, s25, v51
v_add_u32 v51, 8, v49
v_xor_b32 v51, v51, v50
v_lshlrev_b32 v51, 4, v51
v_lshl_add_u32 v51, v49, 8, v51
v_add_u32 v51, 2048, v51
v_add_u32 v41, s25, v51
v_add_u32 v51, 12, v49
v_xor_b32 v51, v51, v50
v_lshlrev_b32 v51, 4, v51
v_lshl_add_u32 v51, v49, 8, v51
v_add_u32 v51, 3072, v51
v_add_u32 v42, s25, v51
v_bfe_u32 v51, v48, 2, 2
v_lshrrev_b32 v52, 1, v49
v_lshlrev_b32 v52, 4, v52
v_and_b32 v53, 1, v49
v_lshl_add_u32 v52, v53, 2, v52
v_lshrrev_b32 v53, 1, v51
v_lshl_add_u32 v52, v53, 3, v52
v_and_b32 v53, 1, v51
v_add_u32 v52, v52, v53
v_and_b32 v54, 3, v48
v_lshrrev_b32 v55, 1, v54
v_and_b32 v54, 1, v54
v_lshlrev_b32 v54, 3, v54
s_lshl_b32 s26, s13, 2
v_add_u32 v56, 0, v52
v_and_b32 v57, 15, v56
v_add_u32 v58, s26, v55
v_add_u32 v58, 0, v58
v_xor_b32 v57, v57, v58
v_lshlrev_b32 v57, 4, v57
v_lshl_add_u32 v57, v56, 8, v57
v_add_u32 v43, v57, v54
v_add_u32 v56, 0, v52
v_and_b32 v57, 15, v56
v_add_u32 v58, s26, v55
v_add_u32 v58, 2, v58
v_xor_b32 v57, v57, v58
v_lshlrev_b32 v57, 4, v57
v_lshl_add_u32 v57, v56, 8, v57
v_add_u32 v44, v57, v54
v_add_u32 v56, 2, v52
v_and_b32 v57, 15, v56
v_add_u32 v58, s26, v55
v_add_u32 v58, 0, v58
v_xor_b32 v57, v57, v58
v_lshlrev_b32 v57, 4, v57
v_lshl_add_u32 v57, v56, 8, v57
v_add_u32 v45, v57, v54
v_add_u32 v56, 2, v52
v_and_b32 v57, 15, v56
v_add_u32 v58, s26, v55
v_add_u32 v58, 2, v58
v_xor_b32 v57, v57, v58
v_lshlrev_b32 v57, 4, v57
v_lshl_add_u32 v57, v56, 8, v57
v_add_u32 v46, v57, v54
s_mov_b32 s64, s50
s_and_b32 s65, s51, 0xffff
s_mov_b32 s66, 4718592
s_mov_b32 s67, 0x20000
s_mov_b32 s68, s52
s_and_b32 s69, s53, 0xffff
s_mov_b32 s70, 4718592
s_mov_b32 s71, 0x20000
s_mov_b32 s72, s54
s_and_b32 s73, s55, 0xffff
s_mov_b32 s74, 4718592
s_mov_b32 s75, 0x20000
s_mov_b32 s76, s56
s_and_b32 s77, s57, 0xffff
s_mov_b32 s78, 4718592
s_mov_b32 s79, 0x20000
s_lshl_b32 s80, s12, 8
s_lshl_b32 s81, s13, 17
s_add_u32 s80, s80, s81
s_mul_i32 s82, s12, 147456
s_lshl_b32 s83, s40, 6
s_add_u32 s83, s83, s82
s_lshl_b32 s84, s41, 6
s_add_u32 s84, s84, s82
s_add_u32 s85, s80, 0
buffer_load_dwordx4 v[48:51], v30, s[64:67], s85 offen
s_add_u32 s85, s80, 32768
buffer_load_dwordx4 v[52:55], v30, s[64:67], s85 offen
s_add_u32 s85, s80, 65536
buffer_load_dwordx4 v[56:59], v30, s[64:67], s85 offen
s_add_u32 s85, s80, 98304
buffer_load_dwordx4 v[60:63], v30, s[64:67], s85 offen
s_add_u32 s85, s80, 524288
buffer_load_dwordx4 v[64:67], v30, s[64:67], s85 offen
s_add_u32 s85, s80, 557056
buffer_load_dwordx4 v[68:71], v30, s[64:67], s85 offen
s_add_u32 s85, s80, 589824
buffer_load_dwordx4 v[72:75], v30, s[64:67], s85 offen
s_add_u32 s85, s80, 622592
buffer_load_dwordx4 v[76:79], v30, s[64:67], s85 offen
s_add_u32 s85, s80, 1048576
buffer_load_dwordx4 v[80:83], v30, s[64:67], s85 offen
s_add_u32 s85, s80, 1081344
buffer_load_dwordx4 v[84:87], v30, s[64:67], s85 offen
s_add_u32 s85, s80, 1114112
buffer_load_dwordx4 v[88:91], v30, s[64:67], s85 offen
s_add_u32 s85, s80, 1146880
buffer_load_dwordx4 v[92:95], v30, s[64:67], s85 offen
s_add_u32 s85, s80, 1572864
buffer_load_dwordx4 v[96:99], v30, s[64:67], s85 offen
s_add_u32 s85, s80, 1605632
buffer_load_dwordx4 v[100:103], v30, s[64:67], s85 offen
s_add_u32 s85, s80, 1638400
buffer_load_dwordx4 v[104:107], v30, s[64:67], s85 offen
s_add_u32 s85, s80, 1671168
buffer_load_dwordx4 v[108:111], v30, s[64:67], s85 offen
s_add_u32 s85, s80, 2097152
buffer_load_dwordx4 v[112:115], v30, s[64:67], s85 offen
s_add_u32 s85, s80, 2129920
buffer_load_dwordx4 v[116:119], v30, s[64:67], s85 offen
s_add_u32 s85, s80, 2162688
buffer_load_dwordx4 v[120:123], v30, s[64:67], s85 offen
s_add_u32 s85, s80, 2195456
buffer_load_dwordx4 v[124:127], v30, s[64:67], s85 offen
s_add_u32 s85, s80, 2621440
buffer_load_dwordx4 v[128:131], v30, s[64:67], s85 offen
s_add_u32 s85, s80, 2654208
buffer_load_dwordx4 v[132:135], v30, s[64:67], s85 offen
s_add_u32 s85, s80, 2686976
buffer_load_dwordx4 v[136:139], v30, s[64:67], s85 offen
s_add_u32 s85, s80, 2719744
buffer_load_dwordx4 v[140:143], v30, s[64:67], s85 offen
s_add_u32 s85, s80, 3145728
buffer_load_dwordx4 v[144:147], v30, s[64:67], s85 offen
s_add_u32 s85, s80, 3178496
buffer_load_dwordx4 v[148:151], v30, s[64:67], s85 offen
s_add_u32 s85, s80, 3211264
buffer_load_dwordx4 v[152:155], v30, s[64:67], s85 offen
s_add_u32 s85, s80, 3244032
buffer_load_dwordx4 v[156:159], v30, s[64:67], s85 offen
s_add_u32 s85, s80, 3670016
buffer_load_dwordx4 v[160:163], v30, s[64:67], s85 offen
s_add_u32 s85, s80, 3702784
buffer_load_dwordx4 v[164:167], v30, s[64:67], s85 offen
s_add_u32 s85, s80, 3735552
buffer_load_dwordx4 v[168:171], v30, s[64:67], s85 offen
s_add_u32 s85, s80, 3768320
buffer_load_dwordx4 v[172:175], v30, s[64:67], s85 offen
s_add_u32 s85, s80, 4194304
buffer_load_dwordx4 v[176:179], v30, s[64:67], s85 offen
s_add_u32 s85, s80, 4227072
buffer_load_dwordx4 v[180:183], v30, s[64:67], s85 offen
s_add_u32 s85, s80, 4259840
buffer_load_dwordx4 v[184:187], v30, s[64:67], s85 offen
s_add_u32 s85, s80, 4292608
buffer_load_dwordx4 v[188:191], v30, s[64:67], s85 offen
s_add_u32 s85, s80, 0
buffer_load_dwordx4 v[192:195], v30, s[68:71], s85 offen
s_add_u32 s85, s80, 32768
buffer_load_dwordx4 v[196:199], v30, s[68:71], s85 offen
s_add_u32 s85, s80, 65536
buffer_load_dwordx4 v[200:203], v30, s[68:71], s85 offen
s_add_u32 s85, s80, 98304
buffer_load_dwordx4 v[204:207], v30, s[68:71], s85 offen
s_add_u32 s85, s80, 524288
buffer_load_dwordx4 v[208:211], v30, s[68:71], s85 offen
s_add_u32 s85, s80, 557056
buffer_load_dwordx4 v[212:215], v30, s[68:71], s85 offen
s_add_u32 s85, s80, 589824
buffer_load_dwordx4 v[216:219], v30, s[68:71], s85 offen
s_add_u32 s85, s80, 622592
buffer_load_dwordx4 v[220:223], v30, s[68:71], s85 offen
s_add_u32 s85, s80, 1048576
buffer_load_dwordx4 v[224:227], v30, s[68:71], s85 offen
s_add_u32 s85, s80, 1081344
buffer_load_dwordx4 v[228:231], v30, s[68:71], s85 offen
s_add_u32 s85, s80, 1114112
buffer_load_dwordx4 v[232:235], v30, s[68:71], s85 offen
s_add_u32 s85, s80, 1146880
buffer_load_dwordx4 v[236:239], v30, s[68:71], s85 offen
s_add_u32 s85, s80, 1572864
buffer_load_dwordx4 v[240:243], v30, s[68:71], s85 offen
s_add_u32 s85, s80, 1605632
buffer_load_dwordx4 v[244:247], v30, s[68:71], s85 offen
s_add_u32 s85, s80, 1638400
buffer_load_dwordx4 v[248:251], v30, s[68:71], s85 offen
s_add_u32 s85, s80, 1671168
buffer_load_dwordx4 v[252:255], v30, s[68:71], s85 offen
s_waitcnt vmcnt(48)
s_waitcnt lgkmcnt(0)
s_barrier
ds_write_b128 v39, v[48:51] offset:0
ds_write_b128 v40, v[52:55] offset:0
ds_write_b128 v41, v[56:59] offset:0
ds_write_b128 v42, v[60:63] offset:0
s_waitcnt lgkmcnt(0)
s_barrier
ds_read_b64_tr_b16 a[0:1], v43 offset:0
ds_read_b64_tr_b16 a[2:3], v45 offset:0
ds_read_b64_tr_b16 a[4:5], v43 offset:8192
ds_read_b64_tr_b16 a[6:7], v45 offset:8192
ds_read_b64_tr_b16 a[72:73], v44 offset:0
ds_read_b64_tr_b16 a[74:75], v46 offset:0
ds_read_b64_tr_b16 a[76:77], v44 offset:8192
ds_read_b64_tr_b16 a[78:79], v46 offset:8192
s_waitcnt vmcnt(44)
s_waitcnt lgkmcnt(0)
s_barrier
ds_write_b128 v39, v[64:67] offset:0
ds_write_b128 v40, v[68:71] offset:0
ds_write_b128 v41, v[72:75] offset:0
ds_write_b128 v42, v[76:79] offset:0
s_waitcnt lgkmcnt(0)
s_barrier
ds_read_b64_tr_b16 a[8:9], v43 offset:0
ds_read_b64_tr_b16 a[10:11], v45 offset:0
ds_read_b64_tr_b16 a[12:13], v43 offset:8192
ds_read_b64_tr_b16 a[14:15], v45 offset:8192
ds_read_b64_tr_b16 a[80:81], v44 offset:0
ds_read_b64_tr_b16 a[82:83], v46 offset:0
ds_read_b64_tr_b16 a[84:85], v44 offset:8192
ds_read_b64_tr_b16 a[86:87], v46 offset:8192
s_add_u32 s85, s80, 2097152
buffer_load_dwordx4 v[48:51], v30, s[68:71], s85 offen
s_add_u32 s85, s80, 2129920
buffer_load_dwordx4 v[52:55], v30, s[68:71], s85 offen
s_add_u32 s85, s80, 2162688
buffer_load_dwordx4 v[56:59], v30, s[68:71], s85 offen
s_add_u32 s85, s80, 2195456
buffer_load_dwordx4 v[60:63], v30, s[68:71], s85 offen
s_waitcnt vmcnt(44)
s_waitcnt lgkmcnt(0)
s_barrier
ds_write_b128 v39, v[80:83] offset:0
ds_write_b128 v40, v[84:87] offset:0
ds_write_b128 v41, v[88:91] offset:0
ds_write_b128 v42, v[92:95] offset:0
s_waitcnt lgkmcnt(0)
s_barrier
ds_read_b64_tr_b16 a[16:17], v43 offset:0
ds_read_b64_tr_b16 a[18:19], v45 offset:0
ds_read_b64_tr_b16 a[20:21], v43 offset:8192
ds_read_b64_tr_b16 a[22:23], v45 offset:8192
ds_read_b64_tr_b16 a[88:89], v44 offset:0
ds_read_b64_tr_b16 a[90:91], v46 offset:0
ds_read_b64_tr_b16 a[92:93], v44 offset:8192
ds_read_b64_tr_b16 a[94:95], v46 offset:8192
s_add_u32 s85, s80, 2621440
buffer_load_dwordx4 v[64:67], v30, s[68:71], s85 offen
s_add_u32 s85, s80, 2654208
buffer_load_dwordx4 v[68:71], v30, s[68:71], s85 offen
s_add_u32 s85, s80, 2686976
buffer_load_dwordx4 v[72:75], v30, s[68:71], s85 offen
s_add_u32 s85, s80, 2719744
buffer_load_dwordx4 v[76:79], v30, s[68:71], s85 offen
s_waitcnt vmcnt(44)
s_waitcnt lgkmcnt(0)
s_barrier
ds_write_b128 v39, v[96:99] offset:0
ds_write_b128 v40, v[100:103] offset:0
ds_write_b128 v41, v[104:107] offset:0
ds_write_b128 v42, v[108:111] offset:0
s_waitcnt lgkmcnt(0)
s_barrier
ds_read_b64_tr_b16 a[24:25], v43 offset:0
ds_read_b64_tr_b16 a[26:27], v45 offset:0
ds_read_b64_tr_b16 a[28:29], v43 offset:8192
ds_read_b64_tr_b16 a[30:31], v45 offset:8192
ds_read_b64_tr_b16 a[96:97], v44 offset:0
ds_read_b64_tr_b16 a[98:99], v46 offset:0
ds_read_b64_tr_b16 a[100:101], v44 offset:8192
ds_read_b64_tr_b16 a[102:103], v46 offset:8192
s_waitcnt vmcnt(40)
s_waitcnt lgkmcnt(0)
s_barrier
ds_write_b128 v39, v[112:115] offset:0
ds_write_b128 v40, v[116:119] offset:0
ds_write_b128 v41, v[120:123] offset:0
ds_write_b128 v42, v[124:127] offset:0
s_waitcnt lgkmcnt(0)
s_barrier
ds_read_b64_tr_b16 a[32:33], v43 offset:0
ds_read_b64_tr_b16 a[34:35], v45 offset:0
ds_read_b64_tr_b16 a[36:37], v43 offset:8192
ds_read_b64_tr_b16 a[38:39], v45 offset:8192
ds_read_b64_tr_b16 a[104:105], v44 offset:0
ds_read_b64_tr_b16 a[106:107], v46 offset:0
ds_read_b64_tr_b16 a[108:109], v44 offset:8192
ds_read_b64_tr_b16 a[110:111], v46 offset:8192
s_add_u32 s85, s80, 3145728
buffer_load_dwordx4 v[96:99], v30, s[68:71], s85 offen
s_add_u32 s85, s80, 3178496
buffer_load_dwordx4 v[100:103], v30, s[68:71], s85 offen
s_add_u32 s85, s80, 3211264
buffer_load_dwordx4 v[104:107], v30, s[68:71], s85 offen
s_add_u32 s85, s80, 3244032
buffer_load_dwordx4 v[108:111], v30, s[68:71], s85 offen
s_waitcnt vmcnt(40)
s_waitcnt lgkmcnt(0)
s_barrier
ds_write_b128 v39, v[128:131] offset:0
ds_write_b128 v40, v[132:135] offset:0
ds_write_b128 v41, v[136:139] offset:0
ds_write_b128 v42, v[140:143] offset:0
s_waitcnt lgkmcnt(0)
s_barrier
ds_read_b64_tr_b16 a[40:41], v43 offset:0
ds_read_b64_tr_b16 a[42:43], v45 offset:0
ds_read_b64_tr_b16 a[44:45], v43 offset:8192
ds_read_b64_tr_b16 a[46:47], v45 offset:8192
ds_read_b64_tr_b16 a[112:113], v44 offset:0
ds_read_b64_tr_b16 a[114:115], v46 offset:0
ds_read_b64_tr_b16 a[116:117], v44 offset:8192
ds_read_b64_tr_b16 a[118:119], v46 offset:8192
s_add_u32 s85, s80, 3670016
buffer_load_dwordx4 v[112:115], v30, s[68:71], s85 offen
s_add_u32 s85, s80, 3702784
buffer_load_dwordx4 v[116:119], v30, s[68:71], s85 offen
s_add_u32 s85, s80, 3735552
buffer_load_dwordx4 v[120:123], v30, s[68:71], s85 offen
s_add_u32 s85, s80, 3768320
buffer_load_dwordx4 v[124:127], v30, s[68:71], s85 offen
s_waitcnt vmcnt(40)
s_waitcnt lgkmcnt(0)
s_barrier
ds_write_b128 v39, v[144:147] offset:0
ds_write_b128 v40, v[148:151] offset:0
ds_write_b128 v41, v[152:155] offset:0
ds_write_b128 v42, v[156:159] offset:0
s_waitcnt lgkmcnt(0)
s_barrier
ds_read_b64_tr_b16 a[48:49], v43 offset:0
ds_read_b64_tr_b16 a[50:51], v45 offset:0
ds_read_b64_tr_b16 a[52:53], v43 offset:8192
ds_read_b64_tr_b16 a[54:55], v45 offset:8192
ds_read_b64_tr_b16 a[120:121], v44 offset:0
ds_read_b64_tr_b16 a[122:123], v46 offset:0
ds_read_b64_tr_b16 a[124:125], v44 offset:8192
ds_read_b64_tr_b16 a[126:127], v46 offset:8192
s_add_u32 s85, s80, 4194304
buffer_load_dwordx4 v[128:131], v30, s[68:71], s85 offen
s_add_u32 s85, s80, 4227072
buffer_load_dwordx4 v[132:135], v30, s[68:71], s85 offen
s_add_u32 s85, s80, 4259840
buffer_load_dwordx4 v[136:139], v30, s[68:71], s85 offen
s_add_u32 s85, s80, 4292608
buffer_load_dwordx4 v[140:143], v30, s[68:71], s85 offen
s_waitcnt vmcnt(40)
s_waitcnt lgkmcnt(0)
s_barrier
ds_write_b128 v39, v[160:163] offset:0
ds_write_b128 v40, v[164:167] offset:0
ds_write_b128 v41, v[168:171] offset:0
ds_write_b128 v42, v[172:175] offset:0
s_waitcnt lgkmcnt(0)
s_barrier
ds_read_b64_tr_b16 a[56:57], v43 offset:0
ds_read_b64_tr_b16 a[58:59], v45 offset:0
ds_read_b64_tr_b16 a[60:61], v43 offset:8192
ds_read_b64_tr_b16 a[62:63], v45 offset:8192
ds_read_b64_tr_b16 a[128:129], v44 offset:0
ds_read_b64_tr_b16 a[130:131], v46 offset:0
ds_read_b64_tr_b16 a[132:133], v44 offset:8192
ds_read_b64_tr_b16 a[134:135], v46 offset:8192
s_add_u32 s85, s83, 0
buffer_load_dwordx4 v[144:147], v31, s[76:79], s85 offen
s_add_u32 s85, s83, 9216
buffer_load_dwordx4 v[148:151], v31, s[76:79], s85 offen
s_add_u32 s85, s83, 18432
buffer_load_dwordx4 v[152:155], v31, s[76:79], s85 offen
s_add_u32 s85, s83, 27648
buffer_load_dwordx4 v[156:159], v31, s[76:79], s85 offen
s_waitcnt vmcnt(40)
s_waitcnt lgkmcnt(0)
s_barrier
ds_write_b128 v39, v[176:179] offset:0
ds_write_b128 v40, v[180:183] offset:0
ds_write_b128 v41, v[184:187] offset:0
ds_write_b128 v42, v[188:191] offset:0
s_waitcnt lgkmcnt(0)
s_barrier
ds_read_b64_tr_b16 a[64:65], v43 offset:0
ds_read_b64_tr_b16 a[66:67], v45 offset:0
ds_read_b64_tr_b16 a[68:69], v43 offset:8192
ds_read_b64_tr_b16 a[70:71], v45 offset:8192
ds_read_b64_tr_b16 a[136:137], v44 offset:0
ds_read_b64_tr_b16 a[138:139], v46 offset:0
ds_read_b64_tr_b16 a[140:141], v44 offset:8192
ds_read_b64_tr_b16 a[142:143], v46 offset:8192
s_add_u32 s85, s83, 128
buffer_load_dwordx4 v[160:163], v31, s[76:79], s85 offen
s_add_u32 s85, s83, 9344
buffer_load_dwordx4 v[164:167], v31, s[76:79], s85 offen
s_add_u32 s85, s83, 18560
buffer_load_dwordx4 v[168:171], v31, s[76:79], s85 offen
s_add_u32 s85, s83, 27776
buffer_load_dwordx4 v[172:175], v31, s[76:79], s85 offen
s_waitcnt vmcnt(40)
s_waitcnt lgkmcnt(0)
s_barrier
ds_write_b128 v39, v[192:195] offset:0
ds_write_b128 v40, v[196:199] offset:0
ds_write_b128 v41, v[200:203] offset:0
ds_write_b128 v42, v[204:207] offset:0
s_waitcnt lgkmcnt(0)
s_barrier
ds_read_b64_tr_b16 a[144:145], v43 offset:0
ds_read_b64_tr_b16 a[146:147], v45 offset:0
ds_read_b64_tr_b16 a[148:149], v43 offset:8192
ds_read_b64_tr_b16 a[150:151], v45 offset:8192
ds_read_b64_tr_b16 a[216:217], v44 offset:0
ds_read_b64_tr_b16 a[218:219], v46 offset:0
ds_read_b64_tr_b16 a[220:221], v44 offset:8192
ds_read_b64_tr_b16 a[222:223], v46 offset:8192
s_add_u32 s85, s84, 0
buffer_load_dwordx4 v[176:179], v32, s[76:79], s85 offen
s_add_u32 s85, s84, 18432
buffer_load_dwordx4 v[180:183], v32, s[76:79], s85 offen
s_waitcnt vmcnt(38)
s_waitcnt lgkmcnt(0)
s_barrier
ds_write_b128 v39, v[208:211] offset:0
ds_write_b128 v40, v[212:215] offset:0
ds_write_b128 v41, v[216:219] offset:0
ds_write_b128 v42, v[220:223] offset:0
s_waitcnt lgkmcnt(0)
s_barrier
ds_read_b64_tr_b16 a[152:153], v43 offset:0
ds_read_b64_tr_b16 a[154:155], v45 offset:0
ds_read_b64_tr_b16 a[156:157], v43 offset:8192
ds_read_b64_tr_b16 a[158:159], v45 offset:8192
ds_read_b64_tr_b16 a[224:225], v44 offset:0
ds_read_b64_tr_b16 a[226:227], v46 offset:0
ds_read_b64_tr_b16 a[228:229], v44 offset:8192
ds_read_b64_tr_b16 a[230:231], v46 offset:8192
s_add_u32 s85, s83, 36864
buffer_load_dwordx4 v[192:195], v31, s[76:79], s85 offen
s_add_u32 s85, s83, 46080
buffer_load_dwordx4 v[196:199], v31, s[76:79], s85 offen
s_add_u32 s85, s83, 55296
buffer_load_dwordx4 v[200:203], v31, s[76:79], s85 offen
s_add_u32 s85, s83, 64512
buffer_load_dwordx4 v[204:207], v31, s[76:79], s85 offen
s_waitcnt vmcnt(38)
s_waitcnt lgkmcnt(0)
s_barrier
ds_write_b128 v39, v[224:227] offset:0
ds_write_b128 v40, v[228:231] offset:0
ds_write_b128 v41, v[232:235] offset:0
ds_write_b128 v42, v[236:239] offset:0
s_waitcnt lgkmcnt(0)
s_barrier
ds_read_b64_tr_b16 a[160:161], v43 offset:0
ds_read_b64_tr_b16 a[162:163], v45 offset:0
ds_read_b64_tr_b16 a[164:165], v43 offset:8192
ds_read_b64_tr_b16 a[166:167], v45 offset:8192
ds_read_b64_tr_b16 a[232:233], v44 offset:0
ds_read_b64_tr_b16 a[234:235], v46 offset:0
ds_read_b64_tr_b16 a[236:237], v44 offset:8192
ds_read_b64_tr_b16 a[238:239], v46 offset:8192
s_add_u32 s85, s83, 36992
buffer_load_dwordx4 v[208:211], v31, s[76:79], s85 offen
s_add_u32 s85, s83, 46208
buffer_load_dwordx4 v[212:215], v31, s[76:79], s85 offen
s_add_u32 s85, s83, 55424
buffer_load_dwordx4 v[216:219], v31, s[76:79], s85 offen
s_add_u32 s85, s83, 64640
buffer_load_dwordx4 v[220:223], v31, s[76:79], s85 offen
s_waitcnt vmcnt(38)
s_waitcnt lgkmcnt(0)
s_barrier
ds_write_b128 v39, v[240:243] offset:0
ds_write_b128 v40, v[244:247] offset:0
ds_write_b128 v41, v[248:251] offset:0
ds_write_b128 v42, v[252:255] offset:0
s_waitcnt lgkmcnt(0)
s_barrier
ds_read_b64_tr_b16 a[168:169], v43 offset:0
ds_read_b64_tr_b16 a[170:171], v45 offset:0
ds_read_b64_tr_b16 a[172:173], v43 offset:8192
ds_read_b64_tr_b16 a[174:175], v45 offset:8192
ds_read_b64_tr_b16 a[240:241], v44 offset:0
ds_read_b64_tr_b16 a[242:243], v46 offset:0
ds_read_b64_tr_b16 a[244:245], v44 offset:8192
ds_read_b64_tr_b16 a[246:247], v46 offset:8192
s_add_u32 s85, s84, 36864
buffer_load_dwordx4 v[224:227], v32, s[76:79], s85 offen
s_add_u32 s85, s84, 55296
buffer_load_dwordx4 v[228:231], v32, s[76:79], s85 offen
s_waitcnt vmcnt(36)
s_waitcnt lgkmcnt(0)
s_barrier
ds_write_b128 v39, v[48:51] offset:0
ds_write_b128 v40, v[52:55] offset:0
ds_write_b128 v41, v[56:59] offset:0
ds_write_b128 v42, v[60:63] offset:0
s_waitcnt lgkmcnt(0)
s_barrier
ds_read_b64_tr_b16 a[176:177], v43 offset:0
ds_read_b64_tr_b16 a[178:179], v45 offset:0
ds_read_b64_tr_b16 a[180:181], v43 offset:8192
ds_read_b64_tr_b16 a[182:183], v45 offset:8192
ds_read_b64_tr_b16 a[248:249], v44 offset:0
ds_read_b64_tr_b16 a[250:251], v46 offset:0
ds_read_b64_tr_b16 a[252:253], v44 offset:8192
ds_read_b64_tr_b16 a[254:255], v46 offset:8192
s_add_u32 s85, s83, 73728
buffer_load_dwordx4 v[240:243], v31, s[76:79], s85 offen
s_add_u32 s85, s83, 82944
buffer_load_dwordx4 v[244:247], v31, s[76:79], s85 offen
s_add_u32 s85, s83, 92160
buffer_load_dwordx4 v[248:251], v31, s[76:79], s85 offen
s_add_u32 s85, s83, 101376
buffer_load_dwordx4 v[252:255], v31, s[76:79], s85 offen
s_waitcnt vmcnt(36)
s_waitcnt lgkmcnt(0)
s_barrier
ds_write_b128 v39, v[64:67] offset:0
ds_write_b128 v40, v[68:71] offset:0
ds_write_b128 v41, v[72:75] offset:0
ds_write_b128 v42, v[76:79] offset:0
s_waitcnt lgkmcnt(0)
s_barrier
ds_read_b64_tr_b16 a[184:185], v43 offset:0
ds_read_b64_tr_b16 a[186:187], v45 offset:0
ds_read_b64_tr_b16 a[188:189], v43 offset:8192
ds_read_b64_tr_b16 a[190:191], v45 offset:8192
ds_read_b64_tr_b16 v[80:81], v44 offset:0
ds_read_b64_tr_b16 v[82:83], v46 offset:0
ds_read_b64_tr_b16 v[84:85], v44 offset:8192
ds_read_b64_tr_b16 v[86:87], v46 offset:8192
s_add_u32 s85, s83, 73856
buffer_load_dwordx4 v[48:51], v31, s[76:79], s85 offen
s_add_u32 s85, s83, 83072
buffer_load_dwordx4 v[52:55], v31, s[76:79], s85 offen
s_add_u32 s85, s83, 92288
buffer_load_dwordx4 v[56:59], v31, s[76:79], s85 offen
s_add_u32 s85, s83, 101504
buffer_load_dwordx4 v[60:63], v31, s[76:79], s85 offen
s_waitcnt vmcnt(36)
s_waitcnt lgkmcnt(0)
s_barrier
ds_write_b128 v39, v[96:99] offset:0
ds_write_b128 v40, v[100:103] offset:0
ds_write_b128 v41, v[104:107] offset:0
ds_write_b128 v42, v[108:111] offset:0
s_waitcnt lgkmcnt(0)
s_barrier
ds_read_b64_tr_b16 a[192:193], v43 offset:0
ds_read_b64_tr_b16 a[194:195], v45 offset:0
ds_read_b64_tr_b16 a[196:197], v43 offset:8192
ds_read_b64_tr_b16 a[198:199], v45 offset:8192
ds_read_b64_tr_b16 v[88:89], v44 offset:0
ds_read_b64_tr_b16 v[90:91], v46 offset:0
ds_read_b64_tr_b16 v[92:93], v44 offset:8192
ds_read_b64_tr_b16 v[94:95], v46 offset:8192
s_add_u32 s85, s84, 73728
buffer_load_dwordx4 v[64:67], v32, s[76:79], s85 offen
s_add_u32 s85, s84, 92160
buffer_load_dwordx4 v[68:71], v32, s[76:79], s85 offen
s_waitcnt vmcnt(34)
s_waitcnt lgkmcnt(0)
s_barrier
ds_write_b128 v39, v[112:115] offset:0
ds_write_b128 v40, v[116:119] offset:0
ds_write_b128 v41, v[120:123] offset:0
ds_write_b128 v42, v[124:127] offset:0
s_waitcnt lgkmcnt(0)
s_barrier
ds_read_b64_tr_b16 a[200:201], v43 offset:0
ds_read_b64_tr_b16 a[202:203], v45 offset:0
ds_read_b64_tr_b16 a[204:205], v43 offset:8192
ds_read_b64_tr_b16 a[206:207], v45 offset:8192
ds_read_b64_tr_b16 v[96:97], v44 offset:0
ds_read_b64_tr_b16 v[98:99], v46 offset:0
ds_read_b64_tr_b16 v[100:101], v44 offset:8192
ds_read_b64_tr_b16 v[102:103], v46 offset:8192
s_waitcnt vmcnt(30)
s_waitcnt lgkmcnt(0)
s_barrier
ds_write_b128 v39, v[128:131] offset:0
ds_write_b128 v40, v[132:135] offset:0
ds_write_b128 v41, v[136:139] offset:0
ds_write_b128 v42, v[140:143] offset:0
s_waitcnt lgkmcnt(0)
s_barrier
ds_read_b64_tr_b16 a[208:209], v43 offset:0
ds_read_b64_tr_b16 a[210:211], v45 offset:0
ds_read_b64_tr_b16 a[212:213], v43 offset:8192
ds_read_b64_tr_b16 a[214:215], v45 offset:8192
ds_read_b64_tr_b16 v[104:105], v44 offset:0
ds_read_b64_tr_b16 v[106:107], v46 offset:0
ds_read_b64_tr_b16 v[108:109], v44 offset:8192
ds_read_b64_tr_b16 v[110:111], v46 offset:8192
s_add_u32 s85, s83, 110592
buffer_load_dwordx4 v[112:115], v31, s[76:79], s85 offen
s_add_u32 s85, s83, 119808
buffer_load_dwordx4 v[116:119], v31, s[76:79], s85 offen
s_add_u32 s85, s83, 129024
buffer_load_dwordx4 v[120:123], v31, s[76:79], s85 offen
s_add_u32 s85, s83, 138240
buffer_load_dwordx4 v[124:127], v31, s[76:79], s85 offen
s_waitcnt vmcnt(30)
s_waitcnt lgkmcnt(0)
s_barrier
ds_write_b128 v33, v[144:147] offset:0
ds_write_b128 v33, v[148:151] offset:1024
ds_write_b128 v33, v[152:155] offset:2048
ds_write_b128 v33, v[156:159] offset:3072
ds_read_b64_tr_b16 v[144:145], v35 offset:0
ds_read_b64_tr_b16 v[146:147], v35 offset:512
ds_read_b64_tr_b16 v[148:149], v35 offset:8
ds_read_b64_tr_b16 v[150:151], v35 offset:520
ds_read_b64_tr_b16 v[152:153], v35 offset:64
ds_read_b64_tr_b16 v[154:155], v35 offset:576
ds_read_b64_tr_b16 v[156:157], v35 offset:72
ds_read_b64_tr_b16 v[158:159], v35 offset:584
s_waitcnt lgkmcnt(0)
ds_write_b128 v1, v[144:147] offset:16384
ds_write_b128 v1, v[148:151] offset:32768
ds_write_b128 v1, v[152:155] offset:49152
ds_write_b128 v37, v[156:159] offset:0
s_add_u32 s85, s83, 110720
buffer_load_dwordx4 v[128:131], v31, s[76:79], s85 offen
s_add_u32 s85, s83, 119936
buffer_load_dwordx4 v[132:135], v31, s[76:79], s85 offen
s_add_u32 s85, s83, 129152
buffer_load_dwordx4 v[136:139], v31, s[76:79], s85 offen
s_add_u32 s85, s83, 138368
buffer_load_dwordx4 v[140:143], v31, s[76:79], s85 offen
s_waitcnt vmcnt(30)
s_waitcnt lgkmcnt(0)
ds_write_b128 v33, v[160:163] offset:0
ds_write_b128 v33, v[164:167] offset:1024
ds_write_b128 v33, v[168:171] offset:2048
ds_write_b128 v33, v[172:175] offset:3072
ds_read_b64_tr_b16 v[160:161], v35 offset:0
ds_read_b64_tr_b16 v[162:163], v35 offset:512
ds_read_b64_tr_b16 v[164:165], v35 offset:8
ds_read_b64_tr_b16 v[166:167], v35 offset:520
ds_read_b64_tr_b16 v[168:169], v35 offset:64
ds_read_b64_tr_b16 v[170:171], v35 offset:576
ds_read_b64_tr_b16 v[172:173], v35 offset:72
ds_read_b64_tr_b16 v[174:175], v35 offset:584
s_waitcnt lgkmcnt(0)
ds_write_b128 v37, v[160:163] offset:16384
ds_write_b128 v37, v[164:167] offset:32768
ds_write_b128 v37, v[168:171] offset:49152
ds_write_b128 v38, v[172:175] offset:0
s_add_u32 s85, s84, 110592
buffer_load_dwordx4 v[144:147], v32, s[76:79], s85 offen
s_add_u32 s85, s84, 129024
buffer_load_dwordx4 v[148:151], v32, s[76:79], s85 offen
s_waitcnt vmcnt(30)
s_waitcnt lgkmcnt(0)
ds_write_b128 v33, v[176:179] offset:0
ds_write_b128 v33, v[180:183] offset:1024
ds_read_b64_tr_b16 v[176:177], v36 offset:0
ds_read_b64_tr_b16 v[178:179], v36 offset:256
s_waitcnt lgkmcnt(0)
ds_write_b128 v38, v[176:179] offset:16384
s_add_u32 s85, s80, 0
buffer_load_dwordx4 v[160:163], v30, s[72:75], s85 offen
s_add_u32 s85, s80, 32768
buffer_load_dwordx4 v[164:167], v30, s[72:75], s85 offen
s_add_u32 s85, s80, 65536
buffer_load_dwordx4 v[168:171], v30, s[72:75], s85 offen
s_add_u32 s85, s80, 98304
buffer_load_dwordx4 v[172:175], v30, s[72:75], s85 offen
s_waitcnt vmcnt(30)
s_waitcnt lgkmcnt(0)
ds_write_b128 v33, v[192:195] offset:0
ds_write_b128 v33, v[196:199] offset:1024
ds_write_b128 v33, v[200:203] offset:2048
ds_write_b128 v33, v[204:207] offset:3072
ds_read_b64_tr_b16 v[192:193], v35 offset:0
ds_read_b64_tr_b16 v[194:195], v35 offset:512
ds_read_b64_tr_b16 v[196:197], v35 offset:8
ds_read_b64_tr_b16 v[198:199], v35 offset:520
ds_read_b64_tr_b16 v[200:201], v35 offset:64
ds_read_b64_tr_b16 v[202:203], v35 offset:576
ds_read_b64_tr_b16 v[204:205], v35 offset:72
ds_read_b64_tr_b16 v[206:207], v35 offset:584
s_waitcnt lgkmcnt(0)
ds_write_b128 v1, v[192:195] offset:20480
ds_write_b128 v1, v[196:199] offset:36864
ds_write_b128 v1, v[200:203] offset:53248
ds_write_b128 v37, v[204:207] offset:4096
s_waitcnt vmcnt(26)
s_waitcnt lgkmcnt(0)
ds_write_b128 v33, v[208:211] offset:0
ds_write_b128 v33, v[212:215] offset:1024
ds_write_b128 v33, v[216:219] offset:2048
ds_write_b128 v33, v[220:223] offset:3072
ds_read_b64_tr_b16 v[208:209], v35 offset:0
ds_read_b64_tr_b16 v[210:211], v35 offset:512
ds_read_b64_tr_b16 v[212:213], v35 offset:8
ds_read_b64_tr_b16 v[214:215], v35 offset:520
ds_read_b64_tr_b16 v[216:217], v35 offset:64
ds_read_b64_tr_b16 v[218:219], v35 offset:576
ds_read_b64_tr_b16 v[220:221], v35 offset:72
ds_read_b64_tr_b16 v[222:223], v35 offset:584
s_waitcnt lgkmcnt(0)
ds_write_b128 v37, v[208:211] offset:20480
ds_write_b128 v37, v[212:215] offset:36864
ds_write_b128 v37, v[216:219] offset:53248
ds_write_b128 v38, v[220:223] offset:4096
s_add_u32 s85, s80, 524288
buffer_load_dwordx4 v[192:195], v30, s[72:75], s85 offen
s_add_u32 s85, s80, 557056
buffer_load_dwordx4 v[196:199], v30, s[72:75], s85 offen
s_add_u32 s85, s80, 589824
buffer_load_dwordx4 v[200:203], v30, s[72:75], s85 offen
s_add_u32 s85, s80, 622592
buffer_load_dwordx4 v[204:207], v30, s[72:75], s85 offen
s_waitcnt vmcnt(28)
s_waitcnt lgkmcnt(0)
ds_write_b128 v33, v[224:227] offset:0
ds_write_b128 v33, v[228:231] offset:1024
ds_read_b64_tr_b16 v[224:225], v36 offset:0
ds_read_b64_tr_b16 v[226:227], v36 offset:256
s_waitcnt lgkmcnt(0)
ds_write_b128 v38, v[224:227] offset:20480
s_add_u32 s85, s80, 1048576
buffer_load_dwordx4 v[208:211], v30, s[72:75], s85 offen
s_add_u32 s85, s80, 1081344
buffer_load_dwordx4 v[212:215], v30, s[72:75], s85 offen
s_add_u32 s85, s80, 1114112
buffer_load_dwordx4 v[216:219], v30, s[72:75], s85 offen
s_add_u32 s85, s80, 1146880
buffer_load_dwordx4 v[220:223], v30, s[72:75], s85 offen
s_waitcnt vmcnt(28)
s_waitcnt lgkmcnt(0)
ds_write_b128 v33, v[240:243] offset:0
ds_write_b128 v33, v[244:247] offset:1024
ds_write_b128 v33, v[248:251] offset:2048
ds_write_b128 v33, v[252:255] offset:3072
ds_read_b64_tr_b16 v[240:241], v35 offset:0
ds_read_b64_tr_b16 v[242:243], v35 offset:512
ds_read_b64_tr_b16 v[244:245], v35 offset:8
ds_read_b64_tr_b16 v[246:247], v35 offset:520
ds_read_b64_tr_b16 v[248:249], v35 offset:64
ds_read_b64_tr_b16 v[250:251], v35 offset:576
ds_read_b64_tr_b16 v[252:253], v35 offset:72
ds_read_b64_tr_b16 v[254:255], v35 offset:584
s_waitcnt lgkmcnt(0)
ds_write_b128 v1, v[240:243] offset:24576
ds_write_b128 v1, v[244:247] offset:40960
ds_write_b128 v1, v[248:251] offset:57344
ds_write_b128 v37, v[252:255] offset:8192
s_add_u32 s85, s80, 1572864
buffer_load_dwordx4 v[224:227], v30, s[72:75], s85 offen
s_add_u32 s85, s80, 1605632
buffer_load_dwordx4 v[228:231], v30, s[72:75], s85 offen
s_add_u32 s85, s80, 1638400
buffer_load_dwordx4 v[232:235], v30, s[72:75], s85 offen
s_add_u32 s85, s80, 1671168
buffer_load_dwordx4 v[236:239], v30, s[72:75], s85 offen
s_waitcnt vmcnt(28)
s_waitcnt lgkmcnt(0)
ds_write_b128 v33, v[48:51] offset:0
ds_write_b128 v33, v[52:55] offset:1024
ds_write_b128 v33, v[56:59] offset:2048
ds_write_b128 v33, v[60:63] offset:3072
ds_read_b64_tr_b16 v[48:49], v35 offset:0
ds_read_b64_tr_b16 v[50:51], v35 offset:512
ds_read_b64_tr_b16 v[52:53], v35 offset:8
ds_read_b64_tr_b16 v[54:55], v35 offset:520
ds_read_b64_tr_b16 v[56:57], v35 offset:64
ds_read_b64_tr_b16 v[58:59], v35 offset:576
ds_read_b64_tr_b16 v[60:61], v35 offset:72
ds_read_b64_tr_b16 v[62:63], v35 offset:584
s_waitcnt lgkmcnt(0)
ds_write_b128 v37, v[48:51] offset:24576
ds_write_b128 v37, v[52:55] offset:40960
ds_write_b128 v37, v[56:59] offset:57344
ds_write_b128 v38, v[60:63] offset:8192
s_add_u32 s85, s80, 2097152
buffer_load_dwordx4 v[240:243], v30, s[72:75], s85 offen
s_add_u32 s85, s80, 2129920
buffer_load_dwordx4 v[244:247], v30, s[72:75], s85 offen
s_add_u32 s85, s80, 2162688
buffer_load_dwordx4 v[248:251], v30, s[72:75], s85 offen
s_add_u32 s85, s80, 2195456
buffer_load_dwordx4 v[252:255], v30, s[72:75], s85 offen
s_waitcnt vmcnt(30)
s_waitcnt lgkmcnt(0)
ds_write_b128 v33, v[64:67] offset:0
ds_write_b128 v33, v[68:71] offset:1024
ds_read_b64_tr_b16 v[64:65], v36 offset:0
ds_read_b64_tr_b16 v[66:67], v36 offset:256
s_waitcnt lgkmcnt(0)
ds_write_b128 v38, v[64:67] offset:24576
s_add_u32 s85, s80, 2621440
buffer_load_dwordx4 v[48:51], v30, s[72:75], s85 offen
s_add_u32 s85, s80, 2654208
buffer_load_dwordx4 v[52:55], v30, s[72:75], s85 offen
s_add_u32 s85, s80, 2686976
buffer_load_dwordx4 v[56:59], v30, s[72:75], s85 offen
s_add_u32 s85, s80, 2719744
buffer_load_dwordx4 v[60:63], v30, s[72:75], s85 offen
s_waitcnt vmcnt(30)
s_waitcnt lgkmcnt(0)
ds_write_b128 v33, v[112:115] offset:0
ds_write_b128 v33, v[116:119] offset:1024
ds_write_b128 v33, v[120:123] offset:2048
ds_write_b128 v33, v[124:127] offset:3072
ds_read_b64_tr_b16 v[112:113], v35 offset:0
ds_read_b64_tr_b16 v[114:115], v35 offset:512
ds_read_b64_tr_b16 v[116:117], v35 offset:8
ds_read_b64_tr_b16 v[118:119], v35 offset:520
ds_read_b64_tr_b16 v[120:121], v35 offset:64
ds_read_b64_tr_b16 v[122:123], v35 offset:576
ds_read_b64_tr_b16 v[124:125], v35 offset:72
ds_read_b64_tr_b16 v[126:127], v35 offset:584
s_waitcnt lgkmcnt(0)
ds_write_b128 v1, v[112:115] offset:28672
ds_write_b128 v1, v[116:119] offset:45056
ds_write_b128 v1, v[120:123] offset:61440
ds_write_b128 v37, v[124:127] offset:12288
s_add_u32 s85, s80, 3145728
buffer_load_dwordx4 v[64:67], v30, s[72:75], s85 offen
s_add_u32 s85, s80, 3178496
buffer_load_dwordx4 v[68:71], v30, s[72:75], s85 offen
s_add_u32 s85, s80, 3211264
buffer_load_dwordx4 v[72:75], v30, s[72:75], s85 offen
s_add_u32 s85, s80, 3244032
buffer_load_dwordx4 v[76:79], v30, s[72:75], s85 offen
s_mov_b32 s24, 0
R_pi:
s_load_dword s25, s[60:61], 16 glc
s_add_u32 s24, s24, 1
s_cmp_gt_u32 s24, 1200000
s_cbranch_scc1 R_bail
s_waitcnt lgkmcnt(0)
s_cmp_ge_u32 s25, 1
s_cbranch_scc0 R_pi
s_add_u32 s62, s58, 70270976
s_addc_u32 s63, s59, 0
R_pk:
s_load_dword s26, s[62:63], 2048 glc
s_add_u32 s24, s24, 1
s_cmp_gt_u32 s24, 1200000
s_cbranch_scc1 R_bail
s_waitcnt lgkmcnt(0)
s_cmp_ge_u32 s26, 128
s_cbranch_scc0 R_pk
s_lshl_b32 s16, s12, 13
s_lshl_b32 s26, s13, 11
s_add_u32 s16, s16, s26
s_lshl_b32 s17, s12, 12
s_add_u32 s17, s17, s37
s_add_u32 s17, s17, 50331648
s_mul_i32 s26, s30, 262144
s_add_u32 s16, s16, s26
s_mul_i32 s26, s30, 131072
s_add_u32 s17, s17, s26
s_mul_i32 s20, s30, 339968
s_add_u32 s20, s20, 205520896
s_mul_i32 s26, s12, 10624
s_lshl_b32 s27, s13, 11
s_add_u32 s42, s26, s27
s_lshr_b32 s27, s13, 1
s_lshl_b32 s27, s27, 10
s_add_u32 s43, s26, s27
s_add_u32 s43, s43, 8192
s_and_b32 s27, s13, 1
s_lshl_b32 s27, s27, 3
s_add_u32 s43, s43, s27
s_add_u32 s18, s20, s42
s_add_u32 s19, s20, s43
s_mul_i32 s21, s30, 9216
s_add_u32 s21, s21, 67118080
v_bfe_u32 v47, v0, 4, 5
v_mul_u32_u24 v47, 10624, v47
v_add_u32 v47, s45, v47
buffer_load_dword v14, v47, s[8:11], s20 offen sc1
s_add_u32 s25, s21, s37
v_lshlrev_b32 v47, 3, v0
buffer_load_dword v14, v47, s[8:11], s25 offen sc1
s_add_u32 s26, s16, 16777216
buffer_load_dwordx4 v[14:17], v0, s[8:11], s16 offen
buffer_load_dwordx4 v[18:21], v0, s[8:11], s16 offen offset:1024
buffer_load_dwordx4 v[22:25], v0, s[8:11], s26 offen
buffer_load_dwordx4 v[26:29], v0, s[8:11], s26 offen offset:1024
s_waitcnt vmcnt(30)
s_waitcnt lgkmcnt(0)
ds_write_b128 v33, v[128:131] offset:0
ds_write_b128 v33, v[132:135] offset:1024
ds_write_b128 v33, v[136:139] offset:2048
ds_write_b128 v33, v[140:143] offset:3072
ds_read_b64_tr_b16 v[128:129], v35 offset:0
ds_read_b64_tr_b16 v[130:131], v35 offset:512
ds_read_b64_tr_b16 v[132:133], v35 offset:8
ds_read_b64_tr_b16 v[134:135], v35 offset:520
ds_read_b64_tr_b16 v[136:137], v35 offset:64
ds_read_b64_tr_b16 v[138:139], v35 offset:576
ds_read_b64_tr_b16 v[140:141], v35 offset:72
ds_read_b64_tr_b16 v[142:143], v35 offset:584
s_waitcnt lgkmcnt(0)
ds_write_b128 v37, v[128:131] offset:28672
ds_write_b128 v37, v[132:135] offset:45056
ds_write_b128 v37, v[136:139] offset:61440
ds_write_b128 v38, v[140:143] offset:12288
s_waitcnt vmcnt(28)
s_waitcnt lgkmcnt(0)
ds_write_b128 v33, v[144:147] offset:0
ds_write_b128 v33, v[148:151] offset:1024
ds_read_b64_tr_b16 v[144:145], v36 offset:0
ds_read_b64_tr_b16 v[146:147], v36 offset:256
s_waitcnt lgkmcnt(0)
ds_write_b128 v38, v[144:147] offset:28672
s_waitcnt vmcnt(24)
s_waitcnt lgkmcnt(0)
s_barrier
ds_write_b128 v39, v[160:163] offset:0
ds_write_b128 v40, v[164:167] offset:0
ds_write_b128 v41, v[168:171] offset:0
ds_write_b128 v42, v[172:175] offset:0
s_waitcnt lgkmcnt(0)
s_barrier
ds_read_b64_tr_b16 v[112:113], v43 offset:0
ds_read_b64_tr_b16 v[114:115], v45 offset:0
ds_read_b64_tr_b16 v[116:117], v43 offset:8192
ds_read_b64_tr_b16 v[118:119], v45 offset:8192
ds_read_b64_tr_b16 v[184:185], v44 offset:0
ds_read_b64_tr_b16 v[186:187], v46 offset:0
ds_read_b64_tr_b16 v[188:189], v44 offset:8192
ds_read_b64_tr_b16 v[190:191], v46 offset:8192
s_waitcnt vmcnt(20)
s_waitcnt lgkmcnt(0)
s_barrier
ds_write_b128 v39, v[192:195] offset:0
ds_write_b128 v40, v[196:199] offset:0
ds_write_b128 v41, v[200:203] offset:0
ds_write_b128 v42, v[204:207] offset:0
s_waitcnt lgkmcnt(0)
s_barrier
ds_read_b64_tr_b16 v[120:121], v43 offset:0
ds_read_b64_tr_b16 v[122:123], v45 offset:0
ds_read_b64_tr_b16 v[124:125], v43 offset:8192
ds_read_b64_tr_b16 v[126:127], v45 offset:8192
ds_read_b64_tr_b16 v[192:193], v44 offset:0
ds_read_b64_tr_b16 v[194:195], v46 offset:0
ds_read_b64_tr_b16 v[196:197], v44 offset:8192
ds_read_b64_tr_b16 v[198:199], v46 offset:8192
s_waitcnt vmcnt(16)
s_waitcnt lgkmcnt(0)
s_barrier
ds_write_b128 v39, v[208:211] offset:0
ds_write_b128 v40, v[212:215] offset:0
ds_write_b128 v41, v[216:219] offset:0
ds_write_b128 v42, v[220:223] offset:0
s_waitcnt lgkmcnt(0)
s_barrier
ds_read_b64_tr_b16 v[128:129], v43 offset:0
ds_read_b64_tr_b16 v[130:131], v45 offset:0
ds_read_b64_tr_b16 v[132:133], v43 offset:8192
ds_read_b64_tr_b16 v[134:135], v45 offset:8192
ds_read_b64_tr_b16 v[200:201], v44 offset:0
ds_read_b64_tr_b16 v[202:203], v46 offset:0
ds_read_b64_tr_b16 v[204:205], v44 offset:8192
ds_read_b64_tr_b16 v[206:207], v46 offset:8192
s_waitcnt vmcnt(12)
s_waitcnt lgkmcnt(0)
s_barrier
ds_write_b128 v39, v[224:227] offset:0
ds_write_b128 v40, v[228:231] offset:0
ds_write_b128 v41, v[232:235] offset:0
ds_write_b128 v42, v[236:239] offset:0
s_waitcnt lgkmcnt(0)
s_barrier
ds_read_b64_tr_b16 v[136:137], v43 offset:0
ds_read_b64_tr_b16 v[138:139], v45 offset:0
ds_read_b64_tr_b16 v[140:141], v43 offset:8192
ds_read_b64_tr_b16 v[142:143], v45 offset:8192
ds_read_b64_tr_b16 v[208:209], v44 offset:0
ds_read_b64_tr_b16 v[210:211], v46 offset:0
ds_read_b64_tr_b16 v[212:213], v44 offset:8192
ds_read_b64_tr_b16 v[214:215], v46 offset:8192
s_waitcnt vmcnt(8)
s_waitcnt lgkmcnt(0)
s_barrier
ds_write_b128 v39, v[240:243] offset:0
ds_write_b128 v40, v[244:247] offset:0
ds_write_b128 v41, v[248:251] offset:0
ds_write_b128 v42, v[252:255] offset:0
s_waitcnt lgkmcnt(0)
s_barrier
ds_read_b64_tr_b16 v[144:145], v43 offset:0
ds_read_b64_tr_b16 v[146:147], v45 offset:0
ds_read_b64_tr_b16 v[148:149], v43 offset:8192
ds_read_b64_tr_b16 v[150:151], v45 offset:8192
ds_read_b64_tr_b16 v[216:217], v44 offset:0
ds_read_b64_tr_b16 v[218:219], v46 offset:0
ds_read_b64_tr_b16 v[220:221], v44 offset:8192
ds_read_b64_tr_b16 v[222:223], v46 offset:8192
s_waitcnt vmcnt(4)
s_waitcnt lgkmcnt(0)
s_barrier
ds_write_b128 v39, v[48:51] offset:0
ds_write_b128 v40, v[52:55] offset:0
ds_write_b128 v41, v[56:59] offset:0
ds_write_b128 v42, v[60:63] offset:0
s_waitcnt lgkmcnt(0)
s_barrier
ds_read_b64_tr_b16 v[152:153], v43 offset:0
ds_read_b64_tr_b16 v[154:155], v45 offset:0
ds_read_b64_tr_b16 v[156:157], v43 offset:8192
ds_read_b64_tr_b16 v[158:159], v45 offset:8192
ds_read_b64_tr_b16 v[224:225], v44 offset:0
ds_read_b64_tr_b16 v[226:227], v46 offset:0
ds_read_b64_tr_b16 v[228:229], v44 offset:8192
ds_read_b64_tr_b16 v[230:231], v46 offset:8192
s_add_u32 s85, s80, 3670016
buffer_load_dwordx4 v[240:243], v30, s[72:75], s85 offen
s_add_u32 s85, s80, 3702784
buffer_load_dwordx4 v[244:247], v30, s[72:75], s85 offen
s_add_u32 s85, s80, 3735552
buffer_load_dwordx4 v[248:251], v30, s[72:75], s85 offen
s_add_u32 s85, s80, 3768320
buffer_load_dwordx4 v[252:255], v30, s[72:75], s85 offen
s_waitcnt vmcnt(4)
s_waitcnt lgkmcnt(0)
s_barrier
ds_write_b128 v39, v[64:67] offset:0
ds_write_b128 v40, v[68:71] offset:0
ds_write_b128 v41, v[72:75] offset:0
ds_write_b128 v42, v[76:79] offset:0
s_waitcnt lgkmcnt(0)
s_barrier
ds_read_b64_tr_b16 v[160:161], v43 offset:0
ds_read_b64_tr_b16 v[162:163], v45 offset:0
ds_read_b64_tr_b16 v[164:165], v43 offset:8192
ds_read_b64_tr_b16 v[166:167], v45 offset:8192
ds_read_b64_tr_b16 v[232:233], v44 offset:0
ds_read_b64_tr_b16 v[234:235], v46 offset:0
ds_read_b64_tr_b16 v[236:237], v44 offset:8192
ds_read_b64_tr_b16 v[238:239], v46 offset:8192
s_add_u32 s85, s80, 4194304
buffer_load_dwordx4 v[48:51], v30, s[72:75], s85 offen
s_add_u32 s85, s80, 4227072
buffer_load_dwordx4 v[52:55], v30, s[72:75], s85 offen
s_add_u32 s85, s80, 4259840
buffer_load_dwordx4 v[56:59], v30, s[72:75], s85 offen
s_add_u32 s85, s80, 4292608
buffer_load_dwordx4 v[60:63], v30, s[72:75], s85 offen
s_waitcnt vmcnt(4)
s_waitcnt lgkmcnt(0)
s_barrier
ds_write_b128 v39, v[240:243] offset:0
ds_write_b128 v40, v[244:247] offset:0
ds_write_b128 v41, v[248:251] offset:0
ds_write_b128 v42, v[252:255] offset:0
s_waitcnt lgkmcnt(0)
s_barrier
ds_read_b64_tr_b16 v[168:169], v43 offset:0
ds_read_b64_tr_b16 v[170:171], v45 offset:0
ds_read_b64_tr_b16 v[172:173], v43 offset:8192
ds_read_b64_tr_b16 v[174:175], v45 offset:8192
ds_read_b64_tr_b16 v[240:241], v44 offset:0
ds_read_b64_tr_b16 v[242:243], v46 offset:0
ds_read_b64_tr_b16 v[244:245], v44 offset:8192
ds_read_b64_tr_b16 v[246:247], v46 offset:8192
s_waitcnt vmcnt(0)
s_waitcnt lgkmcnt(0)
s_barrier
ds_write_b128 v39, v[48:51] offset:0
ds_write_b128 v40, v[52:55] offset:0
ds_write_b128 v41, v[56:59] offset:0
ds_write_b128 v42, v[60:63] offset:0
s_waitcnt lgkmcnt(0)
s_barrier
ds_read_b64_tr_b16 v[176:177], v43 offset:0
ds_read_b64_tr_b16 v[178:179], v45 offset:0
ds_read_b64_tr_b16 v[180:181], v43 offset:8192
ds_read_b64_tr_b16 v[182:183], v45 offset:8192
ds_read_b64_tr_b16 v[248:249], v44 offset:0
ds_read_b64_tr_b16 v[250:251], v46 offset:0
ds_read_b64_tr_b16 v[252:253], v44 offset:8192
ds_read_b64_tr_b16 v[254:255], v46 offset:8192
s_waitcnt lgkmcnt(0)
s_cmp_eq_u32 s13, 0
s_cbranch_scc0 R_sg
s_cmp_eq_u32 s31, 64
s_cbranch_scc0 R_sg
s_mov_b32 s25, 1
s_atomic_add s25, s[62:63], 6272
R_sg:
s_waitcnt lgkmcnt(0)
s_barrier
s_cmp_lg_u32 s30, 0
s_cbranch_scc1 L_nom0_2
s_mov_b32 s64, s48
s_and_b32 s65, s49, 0xffff
s_mov_b32 s66, 9216
s_mov_b32 s67, 0x20000
v_lshrrev_b32 v62, 4, v0
v_and_b32 v63, 7, v62
v_lshrrev_b32 v64, 3, v62
v_mul_u32_u24 v63, 1152, v63
v_lshl_add_u32 v63, v64, 4, v63
s_lshl_b32 s25, s13, 7
s_add_u32 s26, s25, 512
v_mov_b32 v53, v63
buffer_load_dwordx4 v[58:61], v53, s[64:67], s25 offen
buffer_load_dwordx4 v[62:65], v53, s[64:67], s26 offen
buffer_load_dwordx4 v[66:69], v53, s[64:67], 0 offen offset:1024
s_waitcnt vmcnt(0)
ds_write_b128 v1, v[58:61] offset:0
ds_write_b128 v1, v[62:65] offset:4096
ds_write_b128 v0, v[66:69] offset:8192
L_nom0_2:
v_mov_b32 v30, 0
v_mov_b32 v31, 0
v_mov_b32 v32, 0
v_mov_b32 v33, 0
v_mov_b32 v34, 0
v_mov_b32 v35, 0
v_mov_b32 v36, 0
v_mov_b32 v37, 0
v_mov_b32 v38, 0
v_mov_b32 v39, 0
v_mov_b32 v40, 0
v_mov_b32 v41, 0
v_mov_b32 v42, 0
v_mov_b32 v43, 0
v_mov_b32 v44, 0
v_mov_b32 v45, 0
v_mov_b32 v46, 0
v_mov_b32 v47, 0
v_mov_b32 v48, 0
v_mov_b32 v49, 0
v_mov_b32 v50, 0
v_mov_b32 v51, 0
v_mov_b32 v52, 0
v_mov_b32 v53, 0
s_mov_b32 s14, s30
s_mov_b32 s29, 0
s_mov_b32 s80, 0
s_mov_b32 s81, 0
s_waitcnt vmcnt(0) lgkmcnt(0)
v_mov_b32 v79, 128
s_barrier
s_cmp_eq_u32 s31, 64
s_cbranch_scc0 RS_entry
s_load_dword s25, s[60:61], 0 glc
s_waitcnt lgkmcnt(0)
s_cmp_ge_u32 s25, 32
s_cbranch_scc0 RS_entry
R_loop:
s_cmp_eq_u32 s30, 0
s_cbranch_scc1 R_l0
s_sub_u32 s25, s21, 9216
s_add_u32 s22, s25, s37
s_add_u32 s26, s22, 4096
s_add_u32 s27, s25, 8192
s_branch R_adisp
R_l0:
s_cmp_eq_u32 s13, 0
s_cbranch_scc1 R_qv0
s_cmp_eq_u32 s13, 1
s_cbranch_scc1 R_qv1
s_cmp_eq_u32 s13, 2
s_cbranch_scc1 R_qv2
s_branch R_qv3
R_av0:
buffer_load_dwordx4 v[58:61], v0, s[8:11], s22 offen sc1
buffer_load_dwordx4 v[62:65], v0, s[8:11], s26 offen sc1
buffer_load_dwordx4 v[66:69], v0, s[8:11], s27 offen sc1
s_add_u32 s29, s29, 1
s_cmp_gt_u32 s29, 1048576
s_cbranch_scc1 R_bail
s_waitcnt vmcnt(0)
v_max3_u32 v78, v58, v60, v62
v_max3_u32 v78, v78, v64, v66
v_max_u32 v78, v78, v68
v_cmp_eq_u32 vcc, -1, v78
s_cbranch_vccnz R_av0
ds_write_b128 v1, v[58:61] offset:0
ds_write_b128 v1, v[62:65] offset:4096
ds_write_b128 v0, v[66:69] offset:8192
R_qv0:
v_smfmac_f32_16x16x64_bf16 v[30:33], v[58:61], a[0:7], v6
s_add_u32 s26, s16, 16777216
v_smfmac_f32_16x16x64_bf16 v[34:37], v[58:61], a[72:79], v6
buffer_load_dwordx4 v[14:17], v0, s[8:11], s16 offen sc1
v_smfmac_f32_16x16x64_bf16 v[38:41], v[58:61], a[144:151], v6
v_smfmac_f32_16x16x64_bf16 v[42:45], v[58:61], a[216:223], v6
s_waitcnt lgkmcnt(0)
s_barrier
ds_read_b128 v[54:57], v0 offset:1024
ds_read_b128 v[58:61], v0 offset:2048
v_smfmac_f32_16x16x64_bf16 v[30:33], v[62:65], a[32:39], v6
buffer_load_dwordx4 v[18:21], v0, s[8:11], s16 offen offset:1024 sc1
v_smfmac_f32_16x16x64_bf16 v[34:37], v[62:65], a[104:111], v6
v_smfmac_f32_16x16x64_bf16 v[38:41], v[62:65], a[176:183], v6
v_smfmac_f32_16x16x64_bf16 v[42:45], v[62:65], a[248:255], v6
ds_read_b128 v[62:65], v0 offset:3072
v_smfmac_f32_16x16x64_bf16 v[30:33], v[66:69], a[64:71], v6
buffer_load_dwordx4 v[22:25], v0, s[8:11], s26 offen sc1
v_smfmac_f32_16x16x64_bf16 v[34:37], v[66:69], a[136:143], v6
v_smfmac_f32_16x16x64_bf16 v[38:41], v[66:69], a[208:215], v6
v_smfmac_f32_16x16x64_bf16 v[42:45], v[66:69], v[104:111], v6
s_waitcnt lgkmcnt(2)
v_smfmac_f32_16x16x64_bf16 v[30:33], v[54:57], a[8:15], v6
buffer_load_dwordx4 v[26:29], v0, s[8:11], s26 offen offset:1024 sc1
v_smfmac_f32_16x16x64_bf16 v[34:37], v[54:57], a[80:87], v6
v_smfmac_f32_16x16x64_bf16 v[38:41], v[54:57], a[152:159], v6
v_readfirstlane_b32 s25, v79
v_smfmac_f32_16x16x64_bf16 v[42:45], v[54:57], a[224:231], v6
ds_read_b128 v[54:57], v0 offset:5120
s_add_u32 s27, s14, 1
s_and_b32 s27, s27, 3
s_cmp_lg_u32 s27, 0
s_cbranch_scc1 Rw0_kv
s_cmp_ge_u32 s25, 128
s_cbranch_scc1 Rw0_kv
s_add_u32 s25, s14, 1
s_min_u32 s25, s25, 63
s_lshr_b32 s25, s25, 2
s_lshl_b32 s25, s25, 7
s_add_u32 s25, s25, 70273024
v_mov_b32 v72, s25
Rw0_kvp:
buffer_load_dword v73, v72, s[8:11], 0 offen sc1
s_waitcnt vmcnt(0)
v_readfirstlane_b32 s25, v73
s_add_u32 s29, s29, 1
s_cmp_gt_u32 s29, 1048576
s_cbranch_scc1 R_bail
s_cmp_ge_u32 s25, 128
s_cbranch_scc0 Rw0_kvp
Rw0_kv:
s_waitcnt lgkmcnt(2)
v_smfmac_f32_16x16x64_bf16 v[30:33], v[58:61], a[16:23], v6
v_bfe_u32 v72, v0, 4, 4
v_smfmac_f32_16x16x64_bf16 v[34:37], v[58:61], a[88:95], v6
v_lshlrev_b32 v72, 7, v72
v_smfmac_f32_16x16x64_bf16 v[38:41], v[58:61], a[160:167], v6
v_bfe_u32 v73, v0, 8, 1
v_smfmac_f32_16x16x64_bf16 v[42:45], v[58:61], a[232:239], v6
ds_read_b128 v[58:61], v0 offset:6144
v_lshl_add_u32 v72, v73, 24, v72
s_waitcnt lgkmcnt(2)
v_smfmac_f32_16x16x64_bf16 v[30:33], v[62:65], a[24:31], v6
s_add_u32 s16, s16, 262144
v_smfmac_f32_16x16x64_bf16 v[34:37], v[62:65], a[96:103], v6
s_mov_b32 exec_hi, 0
buffer_load_dword v79, v72, s[8:11], s16 offen
s_mov_b32 exec_hi, -1
v_smfmac_f32_16x16x64_bf16 v[38:41], v[62:65], a[168:175], v6
v_bfe_u32 v73, v0, 4, 5
v_smfmac_f32_16x16x64_bf16 v[42:45], v[62:65], a[240:247], v6
ds_read_b128 v[62:65], v0 offset:7168
v_mul_u32_u24 v73, 10624, v73
s_waitcnt lgkmcnt(2)
v_smfmac_f32_16x16x64_bf16 v[30:33], v[54:57], a[40:47], v6
v_add_u32 v73, s45, v73
v_smfmac_f32_16x16x64_bf16 v[34:37], v[54:57], a[112:119], v6
s_add_u32 s25, s20, 339968
s_mov_b32 exec_hi, 0
buffer_load_dword v79, v73, s[8:11], s25 offen
s_mov_b32 exec_hi, -1
v_smfmac_f32_16x16x64_bf16 v[38:41], v[54:57], a[184:191], v6
s_add_u32 s25, s21, s46
v_smfmac_f32_16x16x64_bf16 v[42:45], v[54:57], v[80:87], v6
v_lshlrev_b32 v72, 9, v0
s_waitcnt lgkmcnt(1)
v_smfmac_f32_16x16x64_bf16 v[30:33], v[58:61], a[48:55], v6
s_mov_b64 exec, 3
buffer_load_dword v79, v72, s[8:11], s25 offen
s_mov_b64 exec, -1
v_smfmac_f32_16x16x64_bf16 v[34:37], v[58:61], a[120:127], v6
s_add_u32 s25, s14, 2
s_min_u32 s25, s25, 63
s_lshr_b32 s25, s25, 2
s_lshl_b32 s25, s25, 7
s_add_u32 s25, s25, 70273024
s_add_u32 s27, s14, 2
s_and_b32 s27, s27, 3
s_cmp_eq_u32 s27, 0
s_cselect_b32 s25, s25, 0x80000000
v_mov_b32 v72, s25
v_smfmac_f32_16x16x64_bf16 v[38:41], v[58:61], a[192:199], v6
s_mov_b64 exec, 1
buffer_load_dword v79, v72, s[8:11], 0 offen sc1
s_mov_b64 exec, -1
v_smfmac_f32_16x16x64_bf16 v[42:45], v[58:61], v[88:95], v6
v_mov_b32 v70, s14
s_waitcnt lgkmcnt(0)
v_smfmac_f32_16x16x64_bf16 v[30:33], v[62:65], a[56:63], v6
s_cmp_eq_u32 s14, s30
s_cselect_b32 s25, 0x80000000, s32
v_mov_b32 v71, s25
v_smfmac_f32_16x16x64_bf16 v[34:37], v[62:65], a[128:135], v6
s_mov_b64 exec, 1
buffer_store_dword v70, v71, s[8:11], 0 offen sc1
s_mov_b64 exec, -1
v_add_u32 v78, s36, v2
v_smfmac_f32_16x16x64_bf16 v[38:41], v[62:65], a[200:207], v6
v_smfmac_f32_16x16x64_bf16 v[42:45], v[62:65], v[96:103], v6
v_cndmask_b32 v78, -16, v78, s[38:39]
ds_read_b128 v[54:57], v0 offset:6144
ds_read_b128 v[58:61], v0 offset:7168
ds_read_b128 v[62:65], v0 offset:8192
s_branch R_qkd
R_av1:
buffer_load_dwordx4 v[58:61], v0, s[8:11], s22 offen sc1
buffer_load_dwordx4 v[62:65], v0, s[8:11], s26 offen sc1
s_add_u32 s29, s29, 1
s_cmp_gt_u32 s29, 1048576
s_cbranch_scc1 R_bail
s_waitcnt vmcnt(0)
v_max3_u32 v78, v58, v60, v62
v_max_u32 v78, v78, v64
v_cmp_eq_u32 vcc, -1, v78
s_cbranch_vccnz R_av1
ds_write_b128 v1, v[58:61] offset:0
ds_write_b128 v1, v[62:65] offset:4096
R_qv1:
v_smfmac_f32_16x16x64_bf16 v[30:33], v[58:61], a[8:15], v6
s_add_u32 s26, s16, 16777216
v_smfmac_f32_16x16x64_bf16 v[34:37], v[58:61], a[80:87], v6
buffer_load_dwordx4 v[14:17], v0, s[8:11], s16 offen sc1
v_smfmac_f32_16x16x64_bf16 v[38:41], v[58:61], a[152:159], v6
v_smfmac_f32_16x16x64_bf16 v[42:45], v[58:61], a[224:231], v6
s_waitcnt lgkmcnt(0)
s_barrier
ds_read_b128 v[54:57], v0 offset:0
ds_read_b128 v[58:61], v0 offset:2048
v_smfmac_f32_16x16x64_bf16 v[30:33], v[62:65], a[40:47], v6
buffer_load_dwordx4 v[18:21], v0, s[8:11], s16 offen offset:1024 sc1
v_smfmac_f32_16x16x64_bf16 v[34:37], v[62:65], a[112:119], v6
v_smfmac_f32_16x16x64_bf16 v[38:41], v[62:65], a[184:191], v6
v_smfmac_f32_16x16x64_bf16 v[42:45], v[62:65], v[80:87], v6
ds_read_b128 v[62:65], v0 offset:3072
s_waitcnt lgkmcnt(2)
v_smfmac_f32_16x16x64_bf16 v[30:33], v[54:57], a[0:7], v6
buffer_load_dwordx4 v[22:25], v0, s[8:11], s26 offen sc1
v_smfmac_f32_16x16x64_bf16 v[34:37], v[54:57], a[72:79], v6
v_smfmac_f32_16x16x64_bf16 v[38:41], v[54:57], a[144:151], v6
v_smfmac_f32_16x16x64_bf16 v[42:45], v[54:57], a[216:223], v6
ds_read_b128 v[54:57], v0 offset:4096
buffer_load_dwordx4 v[26:29], v0, s[8:11], s26 offen offset:1024 sc1
s_waitcnt lgkmcnt(2)
v_smfmac_f32_16x16x64_bf16 v[30:33], v[58:61], a[16:23], v6
v_smfmac_f32_16x16x64_bf16 v[34:37], v[58:61], a[88:95], v6
v_readfirstlane_b32 s25, v79
v_smfmac_f32_16x16x64_bf16 v[38:41], v[58:61], a[160:167], v6
s_add_u32 s27, s14, 1
s_and_b32 s27, s27, 3
s_cmp_lg_u32 s27, 0
s_cbranch_scc1 Rw1_kv
s_cmp_ge_u32 s25, 128
s_cbranch_scc1 Rw1_kv
s_add_u32 s25, s14, 1
s_min_u32 s25, s25, 63
s_lshr_b32 s25, s25, 2
s_lshl_b32 s25, s25, 7
s_add_u32 s25, s25, 70273024
v_mov_b32 v72, s25
Rw1_kvp:
buffer_load_dword v73, v72, s[8:11], 0 offen sc1
s_waitcnt vmcnt(0)
v_readfirstlane_b32 s25, v73
s_add_u32 s29, s29, 1
s_cmp_gt_u32 s29, 1048576
s_cbranch_scc1 R_bail
s_cmp_ge_u32 s25, 128
s_cbranch_scc0 Rw1_kvp
Rw1_kv:
v_smfmac_f32_16x16x64_bf16 v[42:45], v[58:61], a[232:239], v6
ds_read_b128 v[58:61], v0 offset:6144
v_bfe_u32 v72, v0, 4, 4
s_waitcnt lgkmcnt(2)
v_smfmac_f32_16x16x64_bf16 v[30:33], v[62:65], a[24:31], v6
v_lshlrev_b32 v72, 7, v72
v_smfmac_f32_16x16x64_bf16 v[34:37], v[62:65], a[96:103], v6
v_bfe_u32 v73, v0, 8, 1
v_smfmac_f32_16x16x64_bf16 v[38:41], v[62:65], a[168:175], v6
v_lshl_add_u32 v72, v73, 24, v72
v_smfmac_f32_16x16x64_bf16 v[42:45], v[62:65], a[240:247], v6
ds_read_b128 v[62:65], v0 offset:7168
s_add_u32 s16, s16, 262144
s_waitcnt lgkmcnt(2)
v_smfmac_f32_16x16x64_bf16 v[30:33], v[54:57], a[32:39], v6
s_mov_b32 exec_hi, 0
buffer_load_dword v79, v72, s[8:11], s16 offen
s_mov_b32 exec_hi, -1
v_smfmac_f32_16x16x64_bf16 v[34:37], v[54:57], a[104:111], v6
v_bfe_u32 v73, v0, 4, 5
v_smfmac_f32_16x16x64_bf16 v[38:41], v[54:57], a[176:183], v6
v_mul_u32_u24 v73, 10624, v73
v_smfmac_f32_16x16x64_bf16 v[42:45], v[54:57], a[248:255], v6
ds_read_b128 v[54:57], v0 offset:8192
v_add_u32 v73, s45, v73
s_waitcnt lgkmcnt(2)
v_smfmac_f32_16x16x64_bf16 v[30:33], v[58:61], a[48:55], v6
s_add_u32 s25, s20, 339968
v_smfmac_f32_16x16x64_bf16 v[34:37], v[58:61], a[120:127], v6
s_mov_b32 exec_hi, 0
buffer_load_dword v79, v73, s[8:11], s25 offen
s_mov_b32 exec_hi, -1
s_add_u32 s25, s21, s46
v_smfmac_f32_16x16x64_bf16 v[38:41], v[58:61], a[192:199], v6
v_lshlrev_b32 v72, 9, v0
v_smfmac_f32_16x16x64_bf16 v[42:45], v[58:61], v[88:95], v6
s_mov_b64 exec, 3
buffer_load_dword v79, v72, s[8:11], s25 offen
s_mov_b64 exec, -1
s_waitcnt lgkmcnt(1)
v_smfmac_f32_16x16x64_bf16 v[30:33], v[62:65], a[56:63], v6
s_add_u32 s25, s14, 2
s_min_u32 s25, s25, 63
s_lshr_b32 s25, s25, 2
s_lshl_b32 s25, s25, 7
v_smfmac_f32_16x16x64_bf16 v[34:37], v[62:65], a[128:135], v6
s_add_u32 s25, s25, 70273024
s_add_u32 s27, s14, 2
s_and_b32 s27, s27, 3
s_cmp_eq_u32 s27, 0
s_cselect_b32 s25, s25, 0x80000000
v_mov_b32 v72, s25
s_mov_b64 exec, 1
buffer_load_dword v79, v72, s[8:11], 0 offen sc1
s_mov_b64 exec, -1
v_smfmac_f32_16x16x64_bf16 v[38:41], v[62:65], a[200:207], v6
v_mov_b32 v70, s14
v_smfmac_f32_16x16x64_bf16 v[42:45], v[62:65], v[96:103], v6
s_cmp_eq_u32 s14, s30
s_cselect_b32 s25, 0x80000000, s32
v_mov_b32 v71, s25
s_waitcnt lgkmcnt(0)
v_smfmac_f32_16x16x64_bf16 v[30:33], v[54:57], a[64:71], v6
s_mov_b64 exec, 1
buffer_store_dword v70, v71, s[8:11], 0 offen sc1
s_mov_b64 exec, -1
v_smfmac_f32_16x16x64_bf16 v[34:37], v[54:57], a[136:143], v6
v_add_u32 v78, s36, v2
v_cndmask_b32 v78, -16, v78, s[38:39]
v_smfmac_f32_16x16x64_bf16 v[38:41], v[54:57], a[208:215], v6
v_smfmac_f32_16x16x64_bf16 v[42:45], v[54:57], v[104:111], v6
ds_read_b128 v[54:57], v0 offset:6144
ds_read_b128 v[58:61], v0 offset:7168
ds_read_b128 v[62:65], v0 offset:8192
s_branch R_qkd
R_av2:
buffer_load_dwordx4 v[58:61], v0, s[8:11], s22 offen sc1
buffer_load_dwordx4 v[62:65], v0, s[8:11], s26 offen sc1
s_add_u32 s29, s29, 1
s_cmp_gt_u32 s29, 1048576
s_cbranch_scc1 R_bail
s_waitcnt vmcnt(0)
v_max3_u32 v78, v58, v60, v62
v_max_u32 v78, v78, v64
v_cmp_eq_u32 vcc, -1, v78
s_cbranch_vccnz R_av2
ds_write_b128 v1, v[58:61] offset:0
ds_write_b128 v1, v[62:65] offset:4096
R_qv2:
v_smfmac_f32_16x16x64_bf16 v[30:33], v[58:61], a[16:23], v6
s_add_u32 s26, s16, 16777216
v_smfmac_f32_16x16x64_bf16 v[34:37], v[58:61], a[88:95], v6
buffer_load_dwordx4 v[14:17], v0, s[8:11], s16 offen sc1
v_smfmac_f32_16x16x64_bf16 v[38:41], v[58:61], a[160:167], v6
v_smfmac_f32_16x16x64_bf16 v[42:45], v[58:61], a[232:239], v6
s_waitcnt lgkmcnt(0)
s_barrier
ds_read_b128 v[54:57], v0 offset:0
ds_read_b128 v[58:61], v0 offset:1024
v_smfmac_f32_16x16x64_bf16 v[30:33], v[62:65], a[48:55], v6
buffer_load_dwordx4 v[18:21], v0, s[8:11], s16 offen offset:1024 sc1
v_smfmac_f32_16x16x64_bf16 v[34:37], v[62:65], a[120:127], v6
v_smfmac_f32_16x16x64_bf16 v[38:41], v[62:65], a[192:199], v6
v_smfmac_f32_16x16x64_bf16 v[42:45], v[62:65], v[88:95], v6
ds_read_b128 v[62:65], v0 offset:3072
s_waitcnt lgkmcnt(2)
v_smfmac_f32_16x16x64_bf16 v[30:33], v[54:57], a[0:7], v6
buffer_load_dwordx4 v[22:25], v0, s[8:11], s26 offen sc1
v_smfmac_f32_16x16x64_bf16 v[34:37], v[54:57], a[72:79], v6
v_smfmac_f32_16x16x64_bf16 v[38:41], v[54:57], a[144:151], v6
v_smfmac_f32_16x16x64_bf16 v[42:45], v[54:57], a[216:223], v6
ds_read_b128 v[54:57], v0 offset:4096
buffer_load_dwordx4 v[26:29], v0, s[8:11], s26 offen offset:1024 sc1
s_waitcnt lgkmcnt(2)
v_smfmac_f32_16x16x64_bf16 v[30:33], v[58:61], a[8:15], v6
v_smfmac_f32_16x16x64_bf16 v[34:37], v[58:61], a[80:87], v6
v_readfirstlane_b32 s25, v79
v_smfmac_f32_16x16x64_bf16 v[38:41], v[58:61], a[152:159], v6
s_add_u32 s27, s14, 1
s_and_b32 s27, s27, 3
s_cmp_lg_u32 s27, 0
s_cbranch_scc1 Rw2_kv
s_cmp_ge_u32 s25, 128
s_cbranch_scc1 Rw2_kv
s_add_u32 s25, s14, 1
s_min_u32 s25, s25, 63
s_lshr_b32 s25, s25, 2
s_lshl_b32 s25, s25, 7
s_add_u32 s25, s25, 70273024
v_mov_b32 v72, s25
Rw2_kvp:
buffer_load_dword v73, v72, s[8:11], 0 offen sc1
s_waitcnt vmcnt(0)
v_readfirstlane_b32 s25, v73
s_add_u32 s29, s29, 1
s_cmp_gt_u32 s29, 1048576
s_cbranch_scc1 R_bail
s_cmp_ge_u32 s25, 128
s_cbranch_scc0 Rw2_kvp
Rw2_kv:
v_smfmac_f32_16x16x64_bf16 v[42:45], v[58:61], a[224:231], v6
ds_read_b128 v[58:61], v0 offset:5120
v_bfe_u32 v72, v0, 4, 4
s_waitcnt lgkmcnt(2)
v_smfmac_f32_16x16x64_bf16 v[30:33], v[62:65], a[24:31], v6
v_lshlrev_b32 v72, 7, v72
v_smfmac_f32_16x16x64_bf16 v[34:37], v[62:65], a[96:103], v6
v_bfe_u32 v73, v0, 8, 1
v_smfmac_f32_16x16x64_bf16 v[38:41], v[62:65], a[168:175], v6
v_lshl_add_u32 v72, v73, 24, v72
v_smfmac_f32_16x16x64_bf16 v[42:45], v[62:65], a[240:247], v6
ds_read_b128 v[62:65], v0 offset:7168
s_add_u32 s16, s16, 262144
s_waitcnt lgkmcnt(2)
v_smfmac_f32_16x16x64_bf16 v[30:33], v[54:57], a[32:39], v6
s_mov_b32 exec_hi, 0
buffer_load_dword v79, v72, s[8:11], s16 offen
s_mov_b32 exec_hi, -1
v_smfmac_f32_16x16x64_bf16 v[34:37], v[54:57], a[104:111], v6
v_bfe_u32 v73, v0, 4, 5
v_smfmac_f32_16x16x64_bf16 v[38:41], v[54:57], a[176:183], v6
v_mul_u32_u24 v73, 10624, v73
v_smfmac_f32_16x16x64_bf16 v[42:45], v[54:57], a[248:255], v6
ds_read_b128 v[54:57], v0 offset:8192
v_add_u32 v73, s45, v73
s_waitcnt lgkmcnt(2)
v_smfmac_f32_16x16x64_bf16 v[30:33], v[58:61], a[40:47], v6
s_add_u32 s25, s20, 339968
v_smfmac_f32_16x16x64_bf16 v[34:37], v[58:61], a[112:119], v6
s_mov_b32 exec_hi, 0
buffer_load_dword v79, v73, s[8:11], s25 offen
s_mov_b32 exec_hi, -1
s_add_u32 s25, s21, s46
v_smfmac_f32_16x16x64_bf16 v[38:41], v[58:61], a[184:191], v6
v_lshlrev_b32 v72, 9, v0
v_smfmac_f32_16x16x64_bf16 v[42:45], v[58:61], v[80:87], v6
s_mov_b64 exec, 3
buffer_load_dword v79, v72, s[8:11], s25 offen
s_mov_b64 exec, -1
s_waitcnt lgkmcnt(1)
v_smfmac_f32_16x16x64_bf16 v[30:33], v[62:65], a[56:63], v6
s_add_u32 s25, s14, 2
s_min_u32 s25, s25, 63
s_lshr_b32 s25, s25, 2
s_lshl_b32 s25, s25, 7
v_smfmac_f32_16x16x64_bf16 v[34:37], v[62:65], a[128:135], v6
s_add_u32 s25, s25, 70273024
s_add_u32 s27, s14, 2
s_and_b32 s27, s27, 3
s_cmp_eq_u32 s27, 0
s_cselect_b32 s25, s25, 0x80000000
v_mov_b32 v72, s25
s_mov_b64 exec, 1
buffer_load_dword v79, v72, s[8:11], 0 offen sc1
s_mov_b64 exec, -1
v_smfmac_f32_16x16x64_bf16 v[38:41], v[62:65], a[200:207], v6
v_mov_b32 v70, s14
v_smfmac_f32_16x16x64_bf16 v[42:45], v[62:65], v[96:103], v6
s_cmp_eq_u32 s14, s30
s_cselect_b32 s25, 0x80000000, s32
v_mov_b32 v71, s25
s_waitcnt lgkmcnt(0)
v_smfmac_f32_16x16x64_bf16 v[30:33], v[54:57], a[64:71], v6
s_mov_b64 exec, 1
buffer_store_dword v70, v71, s[8:11], 0 offen sc1
s_mov_b64 exec, -1
v_smfmac_f32_16x16x64_bf16 v[34:37], v[54:57], a[136:143], v6
v_add_u32 v78, s36, v2
v_cndmask_b32 v78, -16, v78, s[38:39]
v_smfmac_f32_16x16x64_bf16 v[38:41], v[54:57], a[208:215], v6
v_smfmac_f32_16x16x64_bf16 v[42:45], v[54:57], v[104:111], v6
ds_read_b128 v[54:57], v0 offset:6144
ds_read_b128 v[58:61], v0 offset:7168
ds_read_b128 v[62:65], v0 offset:8192
s_branch R_qkd
R_av3:
buffer_load_dwordx4 v[58:61], v0, s[8:11], s22 offen sc1
buffer_load_dwordx4 v[62:65], v0, s[8:11], s26 offen sc1
s_add_u32 s29, s29, 1
s_cmp_gt_u32 s29, 1048576
s_cbranch_scc1 R_bail
s_waitcnt vmcnt(0)
v_max3_u32 v78, v58, v60, v62
v_max_u32 v78, v78, v64
v_cmp_eq_u32 vcc, -1, v78
s_cbranch_vccnz R_av3
ds_write_b128 v1, v[58:61] offset:0
ds_write_b128 v1, v[62:65] offset:4096
R_qv3:
v_smfmac_f32_16x16x64_bf16 v[30:33], v[58:61], a[24:31], v6
s_add_u32 s26, s16, 16777216
v_smfmac_f32_16x16x64_bf16 v[34:37], v[58:61], a[96:103], v6
buffer_load_dwordx4 v[14:17], v0, s[8:11], s16 offen sc1
v_smfmac_f32_16x16x64_bf16 v[38:41], v[58:61], a[168:175], v6
v_smfmac_f32_16x16x64_bf16 v[42:45], v[58:61], a[240:247], v6
s_waitcnt lgkmcnt(0)
s_barrier
ds_read_b128 v[54:57], v0 offset:0
ds_read_b128 v[58:61], v0 offset:1024
v_smfmac_f32_16x16x64_bf16 v[30:33], v[62:65], a[56:63], v6
buffer_load_dwordx4 v[18:21], v0, s[8:11], s16 offen offset:1024 sc1
v_smfmac_f32_16x16x64_bf16 v[34:37], v[62:65], a[128:135], v6
v_smfmac_f32_16x16x64_bf16 v[38:41], v[62:65], a[200:207], v6
v_smfmac_f32_16x16x64_bf16 v[42:45], v[62:65], v[96:103], v6
ds_read_b128 v[62:65], v0 offset:2048
s_waitcnt lgkmcnt(2)
v_smfmac_f32_16x16x64_bf16 v[30:33], v[54:57], a[0:7], v6
buffer_load_dwordx4 v[22:25], v0, s[8:11], s26 offen sc1
v_smfmac_f32_16x16x64_bf16 v[34:37], v[54:57], a[72:79], v6
v_smfmac_f32_16x16x64_bf16 v[38:41], v[54:57], a[144:151], v6
v_smfmac_f32_16x16x64_bf16 v[42:45], v[54:57], a[216:223], v6
ds_read_b128 v[54:57], v0 offset:4096
buffer_load_dwordx4 v[26:29], v0, s[8:11], s26 offen offset:1024 sc1
s_waitcnt lgkmcnt(2)
v_smfmac_f32_16x16x64_bf16 v[30:33], v[58:61], a[8:15], v6
v_smfmac_f32_16x16x64_bf16 v[34:37], v[58:61], a[80:87], v6
v_readfirstlane_b32 s25, v79
v_smfmac_f32_16x16x64_bf16 v[38:41], v[58:61], a[152:159], v6
s_add_u32 s27, s14, 1
s_and_b32 s27, s27, 3
s_cmp_lg_u32 s27, 0
s_cbranch_scc1 Rw3_kv
s_cmp_ge_u32 s25, 128
s_cbranch_scc1 Rw3_kv
s_add_u32 s25, s14, 1
s_min_u32 s25, s25, 63
s_lshr_b32 s25, s25, 2
s_lshl_b32 s25, s25, 7
s_add_u32 s25, s25, 70273024
v_mov_b32 v72, s25
Rw3_kvp:
buffer_load_dword v73, v72, s[8:11], 0 offen sc1
s_waitcnt vmcnt(0)
v_readfirstlane_b32 s25, v73
s_add_u32 s29, s29, 1
s_cmp_gt_u32 s29, 1048576
s_cbranch_scc1 R_bail
s_cmp_ge_u32 s25, 128
s_cbranch_scc0 Rw3_kvp
Rw3_kv:
v_smfmac_f32_16x16x64_bf16 v[42:45], v[58:61], a[224:231], v6
ds_read_b128 v[58:61], v0 offset:5120
v_bfe_u32 v72, v0, 4, 4
s_waitcnt lgkmcnt(2)
v_smfmac_f32_16x16x64_bf16 v[30:33], v[62:65], a[16:23], v6
v_lshlrev_b32 v72, 7, v72
v_smfmac_f32_16x16x64_bf16 v[34:37], v[62:65], a[88:95], v6
v_bfe_u32 v73, v0, 8, 1
v_smfmac_f32_16x16x64_bf16 v[38:41], v[62:65], a[160:167], v6
v_lshl_add_u32 v72, v73, 24, v72
v_smfmac_f32_16x16x64_bf16 v[42:45], v[62:65], a[232:239], v6
ds_read_b128 v[62:65], v0 offset:6144
s_add_u32 s16, s16, 262144
s_waitcnt lgkmcnt(2)
v_smfmac_f32_16x16x64_bf16 v[30:33], v[54:57], a[32:39], v6
s_mov_b32 exec_hi, 0
buffer_load_dword v79, v72, s[8:11], s16 offen
s_mov_b32 exec_hi, -1
v_smfmac_f32_16x16x64_bf16 v[34:37], v[54:57], a[104:111], v6
v_bfe_u32 v73, v0, 4, 5
v_smfmac_f32_16x16x64_bf16 v[38:41], v[54:57], a[176:183], v6
v_mul_u32_u24 v73, 10624, v73
v_smfmac_f32_16x16x64_bf16 v[42:45], v[54:57], a[248:255], v6
ds_read_b128 v[54:57], v0 offset:8192
v_add_u32 v73, s45, v73
s_waitcnt lgkmcnt(2)
v_smfmac_f32_16x16x64_bf16 v[30:33], v[58:61], a[40:47], v6
s_add_u32 s25, s20, 339968
v_smfmac_f32_16x16x64_bf16 v[34:37], v[58:61], a[112:119], v6
s_mov_b32 exec_hi, 0
buffer_load_dword v79, v73, s[8:11], s25 offen
s_mov_b32 exec_hi, -1
s_add_u32 s25, s21, s46
v_smfmac_f32_16x16x64_bf16 v[38:41], v[58:61], a[184:191], v6
v_lshlrev_b32 v72, 9, v0
v_smfmac_f32_16x16x64_bf16 v[42:45], v[58:61], v[80:87], v6
s_mov_b64 exec, 3
buffer_load_dword v79, v72, s[8:11], s25 offen
s_mov_b64 exec, -1
s_waitcnt lgkmcnt(1)
v_smfmac_f32_16x16x64_bf16 v[30:33], v[62:65], a[48:55], v6
s_add_u32 s25, s14, 2
s_min_u32 s25, s25, 63
s_lshr_b32 s25, s25, 2
s_lshl_b32 s25, s25, 7
v_smfmac_f32_16x16x64_bf16 v[34:37], v[62:65], a[120:127], v6
s_add_u32 s25, s25, 70273024
s_add_u32 s27, s14, 2
s_and_b32 s27, s27, 3
s_cmp_eq_u32 s27, 0
s_cselect_b32 s25, s25, 0x80000000
v_mov_b32 v72, s25
s_mov_b64 exec, 1
buffer_load_dword v79, v72, s[8:11], 0 offen sc1
s_mov_b64 exec, -1
v_smfmac_f32_16x16x64_bf16 v[38:41], v[62:65], a[192:199], v6
v_mov_b32 v70, s14
v_smfmac_f32_16x16x64_bf16 v[42:45], v[62:65], v[88:95], v6
s_cmp_eq_u32 s14, s30
s_cselect_b32 s25, 0x80000000, s32
v_mov_b32 v71, s25
s_waitcnt lgkmcnt(0)
v_smfmac_f32_16x16x64_bf16 v[30:33], v[54:57], a[64:71], v6
s_mov_b64 exec, 1
buffer_store_dword v70, v71, s[8:11], 0 offen sc1
s_mov_b64 exec, -1
v_smfmac_f32_16x16x64_bf16 v[34:37], v[54:57], a[136:143], v6
v_add_u32 v78, s36, v2
v_cndmask_b32 v78, -16, v78, s[38:39]
v_smfmac_f32_16x16x64_bf16 v[38:41], v[54:57], a[208:215], v6
v_smfmac_f32_16x16x64_bf16 v[42:45], v[54:57], v[104:111], v6
ds_read_b128 v[54:57], v0 offset:6144
ds_read_b128 v[58:61], v0 offset:7168
ds_read_b128 v[62:65], v0 offset:8192
R_qkd:
v_cvt_pk_bf16_f32 v66, v30, v31
v_cvt_pk_bf16_f32 v67, v32, v33
v_cvt_pk_bf16_f32 v68, v34, v35
v_cvt_pk_bf16_f32 v69, v36, v37
s_nop 1
v_cvt_pk_bf16_f32 v70, v38, v39
v_mfma_f32_16x16x16_bf16 v[30:33], v[66:67], v[8:9], 0
v_cvt_pk_bf16_f32 v71, v40, v41
v_cvt_pk_bf16_f32 v72, v42, v43
v_mfma_f32_16x16x16_bf16 v[34:37], v[68:69], v[8:9], 0
v_cvt_pk_bf16_f32 v73, v44, v45
s_nop 0
v_mfma_f32_16x16x16_bf16 v[38:41], v[70:71], v[8:9], 0
v_mfma_f32_16x16x16_bf16 v[42:45], v[72:73], v[8:9], 0
s_waitcnt lgkmcnt(2)
v_smfmac_f32_16x16x64_bf16 v[46:49], v[54:57], v[160:167], v6
v_cvt_pk_bf16_f32 v66, v30, v31
v_cvt_pk_bf16_f32 v67, v32, v33
v_cvt_pk_bf16_f32 v68, v34, v35
v_cvt_pk_bf16_f32 v69, v36, v37
v_smfmac_f32_16x16x64_bf16 v[50:53], v[54:57], v[232:239], v6
ds_read_b128 v[54:57], v0 offset:0
v_mov_b32_dpp v74, v66 row_ror:8 row_mask:0xf bank_mask:0xf
v_mov_b32_dpp v75, v67 row_ror:8 row_mask:0xf bank_mask:0xf
v_mov_b32_dpp v76, v68 row_ror:8 row_mask:0xf bank_mask:0xf
v_mov_b32_dpp v77, v69 row_ror:8 row_mask:0xf bank_mask:0xf
s_waitcnt vmcnt(5)
v_mfma_f32_16x16x32_bf16 v[30:33], v[14:17], v[66:69], 0
v_cvt_pk_bf16_f32 v70, v38, v39
v_cvt_pk_bf16_f32 v71, v40, v41
v_mfma_f32_16x16x32_bf16 v[30:33], v[18:21], v[74:77], v[30:33]
v_cvt_pk_bf16_f32 v72, v42, v43
v_cvt_pk_bf16_f32 v73, v44, v45
s_nop 1
v_mfma_f32_16x16x32_bf16 v[34:37], v[70:73], v[66:69], 0
s_waitcnt lgkmcnt(2)
v_smfmac_f32_16x16x64_bf16 v[46:49], v[58:61], v[168:175], v6
v_smfmac_f32_16x16x64_bf16 v[50:53], v[58:61], v[240:247], v6
ds_read_b128 v[58:61], v0 offset:1024
ds_write_b128 v1, v[30:33] offset:9216
ds_write_b128 v78, v[34:37]
buffer_store_dwordx4 v[70:73], v7, s[8:11], s17 offen sc1
s_waitcnt lgkmcnt(4)
v_smfmac_f32_16x16x64_bf16 v[46:49], v[62:65], v[176:183], v6
v_smfmac_f32_16x16x64_bf16 v[50:53], v[62:65], v[248:255], v6
ds_read_b128 v[62:65], v0 offset:2048
s_waitcnt lgkmcnt(4)
v_smfmac_f32_16x16x64_bf16 v[46:49], v[54:57], v[112:119], v6
v_smfmac_f32_16x16x64_bf16 v[50:53], v[54:57], v[184:191], v6
ds_read_b128 v[54:57], v0 offset:3072
s_waitcnt lgkmcnt(2)
s_barrier
ds_read_b128 v[30:33], v0 offset:9216
ds_read_b128 v[14:17], v0 offset:10240
ds_read_b128 v[18:21], v0 offset:11264
ds_read_b128 v[74:77], v0 offset:12288
ds_read_b128 v[34:37], v2 offset:13312
ds_read_b128 v[66:69], v2 offset:13568
ds_read_b128 v[42:45], v2 offset:13824
ds_read_b128 v[38:41], v2 offset:14080
v_smfmac_f32_16x16x64_bf16 v[46:49], v[58:61], v[120:127], v6
v_smfmac_f32_16x16x64_bf16 v[50:53], v[58:61], v[192:199], v6
ds_read_b128 v[58:61], v0 offset:4096
s_waitcnt lgkmcnt(10)
v_smfmac_f32_16x16x64_bf16 v[46:49], v[62:65], v[128:135], v6
v_smfmac_f32_16x16x64_bf16 v[50:53], v[62:65], v[200:207], v6
ds_read_b128 v[62:65], v0 offset:5120
s_waitcnt lgkmcnt(10)
v_smfmac_f32_16x16x64_bf16 v[46:49], v[54:57], v[136:143], v6
v_smfmac_f32_16x16x64_bf16 v[50:53], v[54:57], v[208:215], v6
s_waitcnt lgkmcnt(6)
v_pk_add_f32 v[30:31], v[30:31], v[14:15]
v_pk_add_f32 v[32:33], v[32:33], v[16:17]
v_pk_add_f32 v[30:31], v[30:31], v[18:19]
v_pk_add_f32 v[32:33], v[32:33], v[20:21]
v_pk_add_f32 v[30:31], v[30:31], v[74:75]
v_pk_add_f32 v[32:33], v[32:33], v[76:77]
s_waitcnt lgkmcnt(2)
v_pk_add_f32 v[34:35], v[34:35], v[66:67]
v_pk_add_f32 v[36:37], v[36:37], v[68:69]
v_pk_add_f32 v[34:35], v[34:35], v[42:43]
v_pk_add_f32 v[36:37], v[36:37], v[44:45]
v_pk_add_f32 v[34:35], v[34:35], v[38:39]
v_pk_add_f32 v[36:37], v[36:37], v[40:41]
v_max3_f32 v78, v30, v31, v32
v_max3_f32 v42, v33, v34, v35
v_max3_f32 v78, v78, v36, v37
v_max_f32 v78, v78, v42
s_waitcnt lgkmcnt(1)
v_smfmac_f32_16x16x64_bf16 v[46:49], v[58:61], v[144:151], v6
ds_read_b128 v[14:17], v1 offset:16384
v_max_f32_dpp v78, v78, v78 row_ror:8 row_mask:0xf bank_mask:0xf
v_smfmac_f32_16x16x64_bf16 v[50:53], v[58:61], v[216:223], v6
v_mov_b32 v42, v78
ds_read_b128 v[18:21], v1 offset:20480
s_waitcnt lgkmcnt(2)
v_smfmac_f32_16x16x64_bf16 v[46:49], v[62:65], v[152:159], v6
v_permlane16_swap_b32 v78, v42
v_max_f32 v78, v78, v42
v_mov_b32 v42, v78
v_smfmac_f32_16x16x64_bf16 v[50:53], v[62:65], v[224:231], v6
s_nop 0
v_permlane32_swap_b32 v78, v42
v_max_f32 v78, v78, v42
v_mul_f32 v78, s15, v78
v_fma_f32 v30, v30, s15, -v78
v_fma_f32 v31, v31, s15, -v78
v_fma_f32 v32, v32, s15, -v78
v_fma_f32 v33, v33, s15, -v78
v_fma_f32 v34, v34, s15, -v78
v_fma_f32 v35, v35, s15, -v78
v_fma_f32 v36, v36, s15, -v78
v_fma_f32 v37, v37, s15, -v78
v_exp_f32 v30, v30
v_exp_f32 v31, v31
v_exp_f32 v32, v32
v_exp_f32 v33, v33
v_exp_f32 v34, v34
v_exp_f32 v35, v35
v_exp_f32 v36, v36
v_exp_f32 v37, v37
v_cvt_pk_bf16_f32 v74, v30, v31
v_cvt_pk_bf16_f32 v75, v32, v33
v_cvt_pk_bf16_f32 v70, v34, v35
v_cvt_pk_bf16_f32 v71, v36, v37
v_pk_add_f32 v[72:73], v[30:31], v[32:33]
v_pk_add_f32 v[34:35], v[34:35], v[36:37]
v_mov_b32_dpp v76, v74 row_ror:8 row_mask:0xf bank_mask:0xf
v_mov_b32_dpp v77, v75 row_ror:8 row_mask:0xf bank_mask:0xf
v_add_f32 v72, v72, v73
v_add_f32 v73, v34, v35
v_mfma_f32_16x16x32_bf16 v[38:41], v[22:25], v[74:77], 0
v_fmamk_f32 v72, v73, 0x3e800000, v72
v_cvt_pk_bf16_f32 v66, v46, v47
v_mfma_f32_16x16x32_bf16 v[42:45], v[26:29], v[74:77], 0
v_cvt_pk_bf16_f32 v67, v48, v49
v_add_f32_dpp v72, v72, v72 row_ror:8 row_mask:0xf bank_mask:0xf
v_mov_b32 v73, v72
v_cvt_pk_bf16_f32 v68, v50, v51
v_mfma_f32_16x16x16_bf16 v[38:41], v[66:67], v[70:71], v[38:41]
v_cvt_pk_bf16_f32 v69, v52, v53
v_permlane16_swap_b32 v72, v73
v_add_f32 v72, v72, v73
v_mov_b32 v73, v72
v_mfma_f32_16x16x16_bf16 v[42:45], v[68:69], v[70:71], v[42:45]
s_add_u32 s47, s17, 8388608
s_cmp_eq_u32 s14, 63
s_cbranch_scc1 R_done
v_permlane32_swap_b32 v72, v73
v_add_f32 v72, v72, v73
v_rcp_f32 v78, v72
ds_read_b128 v[22:25], v1 offset:24576
ds_read_b128 v[26:29], v1 offset:28672
v_pk_mul_f32 v[38:39], v[38:39], v[78:79] op_sel_hi:[1,0]
v_pk_mul_f32 v[40:41], v[40:41], v[78:79] op_sel_hi:[1,0]
v_pk_mul_f32 v[42:43], v[42:43], v[78:79] op_sel_hi:[1,0]
v_pk_mul_f32 v[44:45], v[44:45], v[78:79] op_sel_hi:[1,0]
v_cvt_pk_bf16_f32 v70, v38, v39
v_cvt_pk_bf16_f32 v71, v40, v41
ds_write_b64 v3, v[70:71]
v_cvt_pk_bf16_f32 v72, v42, v43
v_cvt_pk_bf16_f32 v73, v44, v45
ds_write_b64 v3, v[72:73] offset:512
v_add_u32 v78, 0x10000, v1
buffer_store_dwordx4 v[66:69], v0, s[8:11], s47 offen sc1
ds_read_b128 v[38:41], v1 offset:32768
ds_read_b128 v[42:45], v1 offset:36864
s_waitcnt lgkmcnt(2)
s_barrier
ds_read_b128 v[46:49], v0 offset:14336
ds_read_b128 v[50:53], v0 offset:14464
ds_read_b128 v[54:57], v0 offset:15360
ds_read_b128 v[58:61], v0 offset:15488
ds_read_b128 v[66:69], v1 offset:40960
ds_read_b128 v[70:73], v1 offset:45056
s_waitcnt lgkmcnt(5)
v_mfma_f32_16x16x32_bf16 v[30:33], v[14:17], v[46:49], 0
ds_read_b128 v[14:17], v1 offset:49152
s_waitcnt lgkmcnt(5)
v_mfma_f32_16x16x32_bf16 v[30:33], v[18:21], v[50:53], v[30:33]
ds_read_b128 v[18:21], v1 offset:53248
s_waitcnt lgkmcnt(5)
v_mfma_f32_16x16x32_bf16 v[30:33], v[22:25], v[54:57], v[30:33]
ds_read_b128 v[22:25], v1 offset:57344
s_waitcnt lgkmcnt(5)
v_mfma_f32_16x16x32_bf16 v[30:33], v[26:29], v[58:61], v[30:33]
ds_read_b128 v[26:29], v1 offset:61440
s_waitcnt lgkmcnt(4)
v_mfma_f32_16x16x32_bf16 v[34:37], v[38:41], v[46:49], 0
ds_read_b128 v[38:41], v78 offset:0
v_mfma_f32_16x16x32_bf16 v[34:37], v[42:45], v[50:53], v[34:37]
ds_read_b128 v[42:45], v78 offset:4096
v_mfma_f32_16x16x32_bf16 v[34:37], v[66:69], v[54:57], v[34:37]
ds_read_b128 v[66:69], v78 offset:8192
v_cvt_pk_bf16_f32 v62, v30, v31
v_cvt_pk_bf16_f32 v63, v32, v33
v_mfma_f32_16x16x32_bf16 v[34:37], v[70:73], v[58:61], v[34:37]
ds_read_b128 v[70:73], v78 offset:12288
s_waitcnt lgkmcnt(4)
v_mfma_f32_16x16x32_bf16 v[30:33], v[14:17], v[46:49], 0
ds_read_b128 v[14:17], v78 offset:16384
v_mfma_f32_16x16x32_bf16 v[30:33], v[18:21], v[50:53], v[30:33]
ds_read_b128 v[18:21], v78 offset:20480
v_mfma_f32_16x16x32_bf16 v[30:33], v[22:25], v[54:57], v[30:33]
ds_read_b128 v[22:25], v78 offset:24576
v_cvt_pk_bf16_f32 v64, v34, v35
v_cvt_pk_bf16_f32 v65, v36, v37
v_mfma_f32_16x16x32_bf16 v[30:33], v[26:29], v[58:61], v[30:33]
ds_read_b128 v[26:29], v78 offset:28672
s_waitcnt lgkmcnt(4)
v_mfma_f32_16x16x32_bf16 v[34:37], v[38:41], v[46:49], 0
ds_read_b128 v[38:41], v78 offset:32768
v_mfma_f32_16x16x32_bf16 v[34:37], v[42:45], v[50:53], v[34:37]
ds_read_b128 v[42:45], v78 offset:36864
v_mfma_f32_16x16x32_bf16 v[34:37], v[66:69], v[54:57], v[34:37]
ds_read_b128 v[66:69], v78 offset:40960
v_cvt_pk_bf16_f32 v74, v30, v31
v_cvt_pk_bf16_f32 v75, v32, v33
v_mfma_f32_16x16x32_bf16 v[34:37], v[70:73], v[58:61], v[34:37]
ds_read_b128 v[70:73], v78 offset:45056
s_waitcnt lgkmcnt(4)
v_mfma_f32_16x16x32_bf16 v[30:33], v[14:17], v[46:49], 0
ds_read_b128 v[14:17], v78 offset:49152
v_mfma_f32_16x16x32_bf16 v[30:33], v[18:21], v[50:53], v[30:33]
ds_read_b128 v[18:21], v78 offset:53248
v_mfma_f32_16x16x32_bf16 v[30:33], v[22:25], v[54:57], v[30:33]
ds_read_b128 v[22:25], v78 offset:57344
v_cvt_pk_bf16_f32 v76, v34, v35
v_cvt_pk_bf16_f32 v77, v36, v37
v_mfma_f32_16x16x32_bf16 v[30:33], v[26:29], v[58:61], v[30:33]
ds_read_b128 v[26:29], v78 offset:61440
v_mov_b32_dpp v62, v74 row_ror:8 row_mask:0xf bank_mask:0xc
v_mov_b32_dpp v63, v75 row_ror:8 row_mask:0xf bank_mask:0xc
v_mov_b32_dpp v64, v76 row_ror:8 row_mask:0xf bank_mask:0xc
v_mov_b32_dpp v65, v77 row_ror:8 row_mask:0xf bank_mask:0xc
buffer_store_dwordx4 v[62:65], v0, s[8:11], s18 offen offset:0
s_waitcnt lgkmcnt(4)
v_mfma_f32_16x16x32_bf16 v[34:37], v[38:41], v[46:49], 0
v_add_u32 v78, 0x10000, v78
ds_read_b128 v[38:41], v78 offset:0
v_mfma_f32_16x16x32_bf16 v[34:37], v[42:45], v[50:53], v[34:37]
ds_read_b128 v[42:45], v78 offset:4096
v_mfma_f32_16x16x32_bf16 v[34:37], v[66:69], v[54:57], v[34:37]
ds_read_b128 v[66:69], v78 offset:8192
v_cvt_pk_bf16_f32 v62, v30, v31
v_cvt_pk_bf16_f32 v63, v32, v33
v_mfma_f32_16x16x32_bf16 v[34:37], v[70:73], v[58:61], v[34:37]
ds_read_b128 v[70:73], v78 offset:12288
s_waitcnt lgkmcnt(4)
v_mfma_f32_16x16x32_bf16 v[30:33], v[14:17], v[46:49], 0
ds_read_b128 v[14:17], v78 offset:16384
v_mfma_f32_16x16x32_bf16 v[30:33], v[18:21], v[50:53], v[30:33]
ds_read_b128 v[18:21], v78 offset:20480
v_mfma_f32_16x16x32_bf16 v[30:33], v[22:25], v[54:57], v[30:33]
ds_read_b128 v[22:25], v78 offset:24576
v_cvt_pk_bf16_f32 v64, v34, v35
v_cvt_pk_bf16_f32 v65, v36, v37
v_mfma_f32_16x16x32_bf16 v[30:33], v[26:29], v[58:61], v[30:33]
ds_read_b128 v[26:29], v78 offset:28672
s_waitcnt lgkmcnt(4)
v_mfma_f32_16x16x32_bf16 v[34:37], v[38:41], v[46:49], 0
v_mfma_f32_16x16x32_bf16 v[34:37], v[42:45], v[50:53], v[34:37]
v_mfma_f32_16x16x32_bf16 v[34:37], v[66:69], v[54:57], v[34:37]
v_cvt_pk_bf16_f32 v74, v30, v31
v_cvt_pk_bf16_f32 v75, v32, v33
v_mfma_f32_16x16x32_bf16 v[34:37], v[70:73], v[58:61], v[34:37]
s_waitcnt lgkmcnt(0)
v_mfma_f32_16x16x32_bf16 v[30:33], v[14:17], v[46:49], 0
v_mfma_f32_16x16x32_bf16 v[30:33], v[18:21], v[50:53], v[30:33]
v_mfma_f32_16x16x32_bf16 v[30:33], v[22:25], v[54:57], v[30:33]
v_cvt_pk_bf16_f32 v76, v34, v35
v_cvt_pk_bf16_f32 v77, v36, v37
v_mfma_f32_16x16x32_bf16 v[30:33], v[26:29], v[58:61], v[30:33]
v_mov_b32_dpp v62, v74 row_ror:8 row_mask:0xf bank_mask:0xc
v_mov_b32_dpp v63, v75 row_ror:8 row_mask:0xf bank_mask:0xc
v_mov_b32_dpp v64, v76 row_ror:8 row_mask:0xf bank_mask:0xc
v_mov_b32_dpp v65, v77 row_ror:8 row_mask:0xf bank_mask:0xc
buffer_store_dwordx4 v[62:65], v0, s[8:11], s18 offen offset:1024
v_mov_b32 v38, 0
v_mov_b32 v39, 0
v_mov_b32 v40, 0
v_mov_b32 v41, 0
v_mov_b32 v42, 0
v_mov_b32 v43, 0
v_mov_b32 v44, 0
v_mov_b32 v45, 0
v_cvt_pk_bf16_f32 v62, v30, v31
v_cvt_pk_bf16_f32 v63, v32, v33
buffer_store_dwordx2 v[62:63], v7, s[8:11], s19 offen
v_mov_b32 v30, 0
v_mov_b32 v31, 0
v_mov_b32 v32, 0
v_mov_b32 v33, 0
v_mov_b32 v34, 0
v_mov_b32 v35, 0
v_mov_b32 v36, 0
v_mov_b32 v37, 0
v_mov_b32 v46, 0
v_mov_b32 v47, 0
v_mov_b32 v48, 0
v_mov_b32 v49, 0
v_mov_b32 v50, 0
v_mov_b32 v51, 0
v_mov_b32 v52, 0
v_mov_b32 v53, 0
s_nop 15
s_nop 15
s_cmp_eq_u32 s23, 0
s_cbranch_scc1 R_nred
s_add_u32 s26, s20, 84992
s_add_u32 s27, s20, 169984
s_add_u32 s28, s20, 254976
buffer_load_dwordx4 v[54:57], v4, s[8:11], s20 offen sc1
buffer_load_dwordx4 v[58:61], v4, s[8:11], s26 offen sc1
buffer_load_dwordx4 v[62:65], v4, s[8:11], s27 offen sc1
buffer_load_dwordx4 v[74:77], v4, s[8:11], s28 offen sc1
s_nop 15
buffer_load_dwordx4 v[14:17], v4, s[8:11], s20 offen sc1
buffer_load_dwordx4 v[18:21], v4, s[8:11], s26 offen sc1
buffer_load_dwordx4 v[22:25], v4, s[8:11], s27 offen sc1
buffer_load_dwordx4 v[26:29], v4, s[8:11], s28 offen sc1
R_ra:
s_waitcnt vmcnt(7)
v_mfma_f32_16x16x32_bf16 v[70:73], v[10:13], v[54:57], 0
s_waitcnt vmcnt(6)
v_mfma_f32_16x16x32_bf16 v[70:73], v[10:13], v[58:61], v[70:73]
s_waitcnt vmcnt(5)
v_mfma_f32_16x16x32_bf16 v[70:73], v[10:13], v[62:65], v[70:73]
s_waitcnt vmcnt(4)
v_mfma_f32_16x16x32_bf16 v[70:73], v[10:13], v[74:77], v[70:73]
s_nop 7
v_cmp_u_f32 vcc, v70, v70
v_add_f32_dpp v70, v70, v70 row_ror:8 row_mask:0xf bank_mask:0xf
v_add_f32_dpp v71, v71, v71 row_ror:8 row_mask:0xf bank_mask:0xf
v_add_f32_dpp v72, v72, v72 row_ror:8 row_mask:0xf bank_mask:0xf
v_add_f32_dpp v73, v73, v73 row_ror:8 row_mask:0xf bank_mask:0xf
v_cvt_pk_bf16_f32 v66, v70, v71
v_cvt_pk_bf16_f32 v67, v72, v73
s_cbranch_vccz R_rok
buffer_load_dwordx4 v[54:57], v4, s[8:11], s20 offen sc1
buffer_load_dwordx4 v[58:61], v4, s[8:11], s26 offen sc1
buffer_load_dwordx4 v[62:65], v4, s[8:11], s27 offen sc1
buffer_load_dwordx4 v[74:77], v4, s[8:11], s28 offen sc1
s_add_u32 s29, s29, 1
s_cmp_gt_u32 s29, 1048576
s_cbranch_scc1 R_bail
s_waitcnt vmcnt(7)
v_mfma_f32_16x16x32_bf16 v[70:73], v[10:13], v[14:17], 0
s_waitcnt vmcnt(6)
v_mfma_f32_16x16x32_bf16 v[70:73], v[10:13], v[18:21], v[70:73]
s_waitcnt vmcnt(5)
v_mfma_f32_16x16x32_bf16 v[70:73], v[10:13], v[22:25], v[70:73]
s_waitcnt vmcnt(4)
v_mfma_f32_16x16x32_bf16 v[70:73], v[10:13], v[26:29], v[70:73]
s_nop 7
v_cmp_u_f32 vcc, v70, v70
v_add_f32_dpp v70, v70, v70 row_ror:8 row_mask:0xf bank_mask:0xf
v_add_f32_dpp v71, v71, v71 row_ror:8 row_mask:0xf bank_mask:0xf
v_add_f32_dpp v72, v72, v72 row_ror:8 row_mask:0xf bank_mask:0xf
v_add_f32_dpp v73, v73, v73 row_ror:8 row_mask:0xf bank_mask:0xf
v_cvt_pk_bf16_f32 v66, v70, v71
v_cvt_pk_bf16_f32 v67, v72, v73
s_cbranch_vccz R_rok
buffer_load_dwordx4 v[14:17], v4, s[8:11], s20 offen sc1
buffer_load_dwordx4 v[18:21], v4, s[8:11], s26 offen sc1
buffer_load_dwordx4 v[22:25], v4, s[8:11], s27 offen sc1
buffer_load_dwordx4 v[26:29], v4, s[8:11], s28 offen sc1
s_add_u32 s29, s29, 1
s_cmp_gt_u32 s29, 1048576
s_cbranch_scc1 R_bail
s_branch R_ra
R_rok:
buffer_store_dwordx2 v[66:67], v5, s[8:11], s21 offen
R_nred:
R_cons:
s_barrier
s_add_u32 s22, s21, s37
s_add_u32 s26, s22, 4096
s_add_u32 s27, s21, 8192
s_add_u32 s14, s14, 1
s_add_u32 s20, s20, 339968
s_add_u32 s17, s17, 131072
s_add_u32 s18, s20, s42
s_add_u32 s19, s20, s43
s_add_u32 s21, s21, 9216
s_nop 7
R_adisp:
s_cmp_eq_u32 s13, 0
s_cbranch_scc1 R_av0
s_cmp_eq_u32 s13, 1
s_cbranch_scc1 R_av1
s_cmp_eq_u32 s13, 2
s_cbranch_scc1 R_av2
s_branch R_av3
R_bail:
s_endpgm
R_done:
buffer_store_dwordx4 v[66:69], v0, s[8:11], s47 offen sc1
s_waitcnt vmcnt(0) lgkmcnt(0)
s_barrier
s_cmp_lg_u32 s13, 0
s_cbranch_scc1 R_fin
v_mov_b32 v78, 64
v_mov_b32 v77, s32
s_mov_b64 exec, 1
buffer_store_dword v78, v77, s[8:11], 0 offen sc1
s_mov_b64 exec, -1
s_waitcnt vmcnt(0)
R_fin:
s_cmp_eq_u32 s13, 0
s_cbranch_scc0 K_end
s_cmp_eq_u32 s12, 0
s_cbranch_scc0 K_end
buffer_wbl2 sc1
s_waitcnt vmcnt(0)
s_branch K_end
RS_entry:
RS_loop:
s_cmp_eq_u32 s30, 0
s_cbranch_scc1 RS_l0
s_sub_u32 s25, s21, 9216
s_add_u32 s22, s25, s37
s_add_u32 s26, s22, 4096
s_add_u32 s27, s25, 8192
s_branch RS_adisp
RS_l0:
s_cmp_eq_u32 s13, 0
s_cbranch_scc1 RS_qv0
s_cmp_eq_u32 s13, 1
s_cbranch_scc1 RS_qv1
s_cmp_eq_u32 s13, 2
s_cbranch_scc1 RS_qv2
s_branch RS_qv3
RS_av0:
buffer_load_dwordx4 v[58:61], v0, s[8:11], s22 offen sc1
buffer_load_dwordx4 v[62:65], v0, s[8:11], s26 offen sc1
buffer_load_dwordx4 v[66:69], v0, s[8:11], s27 offen sc1
s_add_u32 s29, s29, 1
s_cmp_gt_u32 s29, 1048576
s_cbranch_scc1 RS_bail
s_waitcnt vmcnt(0)
v_max3_u32 v78, v58, v60, v62
v_max3_u32 v78, v78, v64, v66
v_max_u32 v78, v78, v68
v_cmp_eq_u32 vcc, -1, v78
s_cbranch_vccnz RS_av0
ds_write_b128 v1, v[58:61] offset:0
ds_write_b128 v1, v[62:65] offset:4096
ds_write_b128 v0, v[66:69] offset:8192
RS_qv0:
v_smfmac_f32_16x16x64_bf16 v[30:33], v[58:61], a[0:7], v6
s_add_u32 s26, s16, 16777216
v_smfmac_f32_16x16x64_bf16 v[34:37], v[58:61], a[72:79], v6
buffer_load_dwordx4 v[14:17], v0, s[8:11], s16 offen sc1
v_smfmac_f32_16x16x64_bf16 v[38:41], v[58:61], a[144:151], v6
v_smfmac_f32_16x16x64_bf16 v[42:45], v[58:61], a[216:223], v6
s_waitcnt lgkmcnt(0)
s_barrier
ds_read_b128 v[54:57], v0 offset:1024
ds_read_b128 v[58:61], v0 offset:2048
v_smfmac_f32_16x16x64_bf16 v[30:33], v[62:65], a[32:39], v6
buffer_load_dwordx4 v[18:21], v0, s[8:11], s16 offen offset:1024 sc1
v_smfmac_f32_16x16x64_bf16 v[34:37], v[62:65], a[104:111], v6
v_smfmac_f32_16x16x64_bf16 v[38:41], v[62:65], a[176:183], v6
v_smfmac_f32_16x16x64_bf16 v[42:45], v[62:65], a[248:255], v6
ds_read_b128 v[62:65], v0 offset:3072
v_smfmac_f32_16x16x64_bf16 v[30:33], v[66:69], a[64:71], v6
buffer_load_dwordx4 v[22:25], v0, s[8:11], s26 offen sc1
v_smfmac_f32_16x16x64_bf16 v[34:37], v[66:69], a[136:143], v6
v_smfmac_f32_16x16x64_bf16 v[38:41], v[66:69], a[208:215], v6
v_smfmac_f32_16x16x64_bf16 v[42:45], v[66:69], v[104:111], v6
s_waitcnt lgkmcnt(2)
v_smfmac_f32_16x16x64_bf16 v[30:33], v[54:57], a[8:15], v6
buffer_load_dwordx4 v[26:29], v0, s[8:11], s26 offen offset:1024 sc1
v_smfmac_f32_16x16x64_bf16 v[34:37], v[54:57], a[80:87], v6
v_smfmac_f32_16x16x64_bf16 v[38:41], v[54:57], a[152:159], v6
v_readfirstlane_b32 s25, v79
v_smfmac_f32_16x16x64_bf16 v[42:45], v[54:57], a[224:231], v6
ds_read_b128 v[54:57], v0 offset:5120
s_add_u32 s27, s14, 1
s_and_b32 s27, s27, 3
s_cmp_lg_u32 s27, 0
s_cbranch_scc1 RSw0_kv
s_cmp_ge_u32 s25, 128
s_cbranch_scc1 RSw0_kv
s_add_u32 s25, s14, 1
s_min_u32 s25, s25, 63
s_lshr_b32 s25, s25, 2
s_lshl_b32 s25, s25, 7
s_add_u32 s25, s25, 70273024
v_mov_b32 v72, s25
RSw0_kvp:
buffer_load_dword v73, v72, s[8:11], 0 offen sc1
s_waitcnt vmcnt(0)
v_readfirstlane_b32 s25, v73
s_add_u32 s29, s29, 1
s_cmp_gt_u32 s29, 1048576
s_cbranch_scc1 RS_bail
s_cmp_ge_u32 s25, 128
s_cbranch_scc0 RSw0_kvp
RSw0_kv:
s_waitcnt lgkmcnt(2)
v_smfmac_f32_16x16x64_bf16 v[30:33], v[58:61], a[16:23], v6
v_bfe_u32 v72, v0, 4, 4
v_smfmac_f32_16x16x64_bf16 v[34:37], v[58:61], a[88:95], v6
v_lshlrev_b32 v72, 7, v72
v_smfmac_f32_16x16x64_bf16 v[38:41], v[58:61], a[160:167], v6
v_bfe_u32 v73, v0, 8, 1
v_smfmac_f32_16x16x64_bf16 v[42:45], v[58:61], a[232:239], v6
ds_read_b128 v[58:61], v0 offset:6144
v_lshl_add_u32 v72, v73, 24, v72
s_waitcnt lgkmcnt(2)
v_smfmac_f32_16x16x64_bf16 v[30:33], v[62:65], a[24:31], v6
s_add_u32 s16, s16, 262144
v_smfmac_f32_16x16x64_bf16 v[34:37], v[62:65], a[96:103], v6
s_mov_b32 exec_hi, 0
buffer_load_dword v79, v72, s[8:11], s16 offen sc1
s_mov_b32 exec_hi, -1
v_smfmac_f32_16x16x64_bf16 v[38:41], v[62:65], a[168:175], v6
v_bfe_u32 v73, v0, 4, 5
v_smfmac_f32_16x16x64_bf16 v[42:45], v[62:65], a[240:247], v6
ds_read_b128 v[62:65], v0 offset:7168
v_mul_u32_u24 v73, 10624, v73
s_waitcnt lgkmcnt(2)
v_smfmac_f32_16x16x64_bf16 v[30:33], v[54:57], a[40:47], v6
v_add_u32 v73, s45, v73
v_smfmac_f32_16x16x64_bf16 v[34:37], v[54:57], a[112:119], v6
s_add_u32 s25, s20, 339968
s_mov_b32 exec_hi, 0
buffer_load_dword v79, v73, s[8:11], s25 offen sc1
s_mov_b32 exec_hi, -1
v_smfmac_f32_16x16x64_bf16 v[38:41], v[54:57], a[184:191], v6
s_add_u32 s25, s21, s46
v_smfmac_f32_16x16x64_bf16 v[42:45], v[54:57], v[80:87], v6
v_lshlrev_b32 v72, 9, v0
s_waitcnt lgkmcnt(1)
v_smfmac_f32_16x16x64_bf16 v[30:33], v[58:61], a[48:55], v6
s_mov_b64 exec, 3
buffer_load_dword v79, v72, s[8:11], s25 offen sc1
s_mov_b64 exec, -1
v_smfmac_f32_16x16x64_bf16 v[34:37], v[58:61], a[120:127], v6
s_add_u32 s25, s14, 2
s_min_u32 s25, s25, 63
s_lshr_b32 s25, s25, 2
s_lshl_b32 s25, s25, 7
s_add_u32 s25, s25, 70273024
s_add_u32 s27, s14, 2
s_and_b32 s27, s27, 3
s_cmp_eq_u32 s27, 0
s_cselect_b32 s25, s25, 0x80000000
v_mov_b32 v72, s25
v_smfmac_f32_16x16x64_bf16 v[38:41], v[58:61], a[192:199], v6
s_mov_b64 exec, 1
buffer_load_dword v79, v72, s[8:11], 0 offen sc1
s_mov_b64 exec, -1
v_smfmac_f32_16x16x64_bf16 v[42:45], v[58:61], v[88:95], v6
v_mov_b32 v70, s14
s_waitcnt lgkmcnt(0)
v_smfmac_f32_16x16x64_bf16 v[30:33], v[62:65], a[56:63], v6
s_cmp_eq_u32 s14, s30
s_cselect_b32 s25, 0x80000000, s32
v_mov_b32 v71, s25
v_smfmac_f32_16x16x64_bf16 v[34:37], v[62:65], a[128:135], v6
s_mov_b64 exec, 1
buffer_store_dword v70, v71, s[8:11], 0 offen sc1
s_mov_b64 exec, -1
v_add_u32 v78, s36, v2
v_smfmac_f32_16x16x64_bf16 v[38:41], v[62:65], a[200:207], v6
v_smfmac_f32_16x16x64_bf16 v[42:45], v[62:65], v[96:103], v6
v_cndmask_b32 v78, -16, v78, s[38:39]
ds_read_b128 v[54:57], v0 offset:6144
ds_read_b128 v[58:61], v0 offset:7168
ds_read_b128 v[62:65], v0 offset:8192
s_branch RS_qkd
RS_av1:
buffer_load_dwordx4 v[58:61], v0, s[8:11], s22 offen sc1
buffer_load_dwordx4 v[62:65], v0, s[8:11], s26 offen sc1
s_add_u32 s29, s29, 1
s_cmp_gt_u32 s29, 1048576
s_cbranch_scc1 RS_bail
s_waitcnt vmcnt(0)
v_max3_u32 v78, v58, v60, v62
v_max_u32 v78, v78, v64
v_cmp_eq_u32 vcc, -1, v78
s_cbranch_vccnz RS_av1
ds_write_b128 v1, v[58:61] offset:0
ds_write_b128 v1, v[62:65] offset:4096
RS_qv1:
v_smfmac_f32_16x16x64_bf16 v[30:33], v[58:61], a[8:15], v6
s_add_u32 s26, s16, 16777216
v_smfmac_f32_16x16x64_bf16 v[34:37], v[58:61], a[80:87], v6
buffer_load_dwordx4 v[14:17], v0, s[8:11], s16 offen sc1
v_smfmac_f32_16x16x64_bf16 v[38:41], v[58:61], a[152:159], v6
v_smfmac_f32_16x16x64_bf16 v[42:45], v[58:61], a[224:231], v6
s_waitcnt lgkmcnt(0)
s_barrier
ds_read_b128 v[54:57], v0 offset:0
ds_read_b128 v[58:61], v0 offset:2048
v_smfmac_f32_16x16x64_bf16 v[30:33], v[62:65], a[40:47], v6
buffer_load_dwordx4 v[18:21], v0, s[8:11], s16 offen offset:1024 sc1
v_smfmac_f32_16x16x64_bf16 v[34:37], v[62:65], a[112:119], v6
v_smfmac_f32_16x16x64_bf16 v[38:41], v[62:65], a[184:191], v6
v_smfmac_f32_16x16x64_bf16 v[42:45], v[62:65], v[80:87], v6
ds_read_b128 v[62:65], v0 offset:3072
s_waitcnt lgkmcnt(2)
v_smfmac_f32_16x16x64_bf16 v[30:33], v[54:57], a[0:7], v6
buffer_load_dwordx4 v[22:25], v0, s[8:11], s26 offen sc1
v_smfmac_f32_16x16x64_bf16 v[34:37], v[54:57], a[72:79], v6
v_smfmac_f32_16x16x64_bf16 v[38:41], v[54:57], a[144:151], v6
v_smfmac_f32_16x16x64_bf16 v[42:45], v[54:57], a[216:223], v6
ds_read_b128 v[54:57], v0 offset:4096
buffer_load_dwordx4 v[26:29], v0, s[8:11], s26 offen offset:1024 sc1
s_waitcnt lgkmcnt(2)
v_smfmac_f32_16x16x64_bf16 v[30:33], v[58:61], a[16:23], v6
v_smfmac_f32_16x16x64_bf16 v[34:37], v[58:61], a[88:95], v6
v_readfirstlane_b32 s25, v79
v_smfmac_f32_16x16x64_bf16 v[38:41], v[58:61], a[160:167], v6
s_add_u32 s27, s14, 1
s_and_b32 s27, s27, 3
s_cmp_lg_u32 s27, 0
s_cbranch_scc1 RSw1_kv
s_cmp_ge_u32 s25, 128
s_cbranch_scc1 RSw1_kv
s_add_u32 s25, s14, 1
s_min_u32 s25, s25, 63
s_lshr_b32 s25, s25, 2
s_lshl_b32 s25, s25, 7
s_add_u32 s25, s25, 70273024
v_mov_b32 v72, s25
RSw1_kvp:
buffer_load_dword v73, v72, s[8:11], 0 offen sc1
s_waitcnt vmcnt(0)
v_readfirstlane_b32 s25, v73
s_add_u32 s29, s29, 1
s_cmp_gt_u32 s29, 1048576
s_cbranch_scc1 RS_bail
s_cmp_ge_u32 s25, 128
s_cbranch_scc0 RSw1_kvp
RSw1_kv:
v_smfmac_f32_16x16x64_bf16 v[42:45], v[58:61], a[232:239], v6
ds_read_b128 v[58:61], v0 offset:6144
v_bfe_u32 v72, v0, 4, 4
s_waitcnt lgkmcnt(2)
v_smfmac_f32_16x16x64_bf16 v[30:33], v[62:65], a[24:31], v6
v_lshlrev_b32 v72, 7, v72
v_smfmac_f32_16x16x64_bf16 v[34:37], v[62:65], a[96:103], v6
v_bfe_u32 v73, v0, 8, 1
v_smfmac_f32_16x16x64_bf16 v[38:41], v[62:65], a[168:175], v6
v_lshl_add_u32 v72, v73, 24, v72
v_smfmac_f32_16x16x64_bf16 v[42:45], v[62:65], a[240:247], v6
ds_read_b128 v[62:65], v0 offset:7168
s_add_u32 s16, s16, 262144
s_waitcnt lgkmcnt(2)
v_smfmac_f32_16x16x64_bf16 v[30:33], v[54:57], a[32:39], v6
s_mov_b32 exec_hi, 0
buffer_load_dword v79, v72, s[8:11], s16 offen sc1
s_mov_b32 exec_hi, -1
v_smfmac_f32_16x16x64_bf16 v[34:37], v[54:57], a[104:111], v6
v_bfe_u32 v73, v0, 4, 5
v_smfmac_f32_16x16x64_bf16 v[38:41], v[54:57], a[176:183], v6
v_mul_u32_u24 v73, 10624, v73
v_smfmac_f32_16x16x64_bf16 v[42:45], v[54:57], a[248:255], v6
ds_read_b128 v[54:57], v0 offset:8192
v_add_u32 v73, s45, v73
s_waitcnt lgkmcnt(2)
v_smfmac_f32_16x16x64_bf16 v[30:33], v[58:61], a[48:55], v6
s_add_u32 s25, s20, 339968
v_smfmac_f32_16x16x64_bf16 v[34:37], v[58:61], a[120:127], v6
s_mov_b32 exec_hi, 0
buffer_load_dword v79, v73, s[8:11], s25 offen sc1
s_mov_b32 exec_hi, -1
s_add_u32 s25, s21, s46
v_smfmac_f32_16x16x64_bf16 v[38:41], v[58:61], a[192:199], v6
v_lshlrev_b32 v72, 9, v0
v_smfmac_f32_16x16x64_bf16 v[42:45], v[58:61], v[88:95], v6
s_mov_b64 exec, 3
buffer_load_dword v79, v72, s[8:11], s25 offen sc1
s_mov_b64 exec, -1
s_waitcnt lgkmcnt(1)
v_smfmac_f32_16x16x64_bf16 v[30:33], v[62:65], a[56:63], v6
s_add_u32 s25, s14, 2
s_min_u32 s25, s25, 63
s_lshr_b32 s25, s25, 2
s_lshl_b32 s25, s25, 7
v_smfmac_f32_16x16x64_bf16 v[34:37], v[62:65], a[128:135], v6
s_add_u32 s25, s25, 70273024
s_add_u32 s27, s14, 2
s_and_b32 s27, s27, 3
s_cmp_eq_u32 s27, 0
s_cselect_b32 s25, s25, 0x80000000
v_mov_b32 v72, s25
s_mov_b64 exec, 1
buffer_load_dword v79, v72, s[8:11], 0 offen sc1
s_mov_b64 exec, -1
v_smfmac_f32_16x16x64_bf16 v[38:41], v[62:65], a[200:207], v6
v_mov_b32 v70, s14
v_smfmac_f32_16x16x64_bf16 v[42:45], v[62:65], v[96:103], v6
s_cmp_eq_u32 s14, s30
s_cselect_b32 s25, 0x80000000, s32
v_mov_b32 v71, s25
s_waitcnt lgkmcnt(0)
v_smfmac_f32_16x16x64_bf16 v[30:33], v[54:57], a[64:71], v6
s_mov_b64 exec, 1
buffer_store_dword v70, v71, s[8:11], 0 offen sc1
s_mov_b64 exec, -1
v_smfmac_f32_16x16x64_bf16 v[34:37], v[54:57], a[136:143], v6
v_add_u32 v78, s36, v2
v_cndmask_b32 v78, -16, v78, s[38:39]
v_smfmac_f32_16x16x64_bf16 v[38:41], v[54:57], a[208:215], v6
v_smfmac_f32_16x16x64_bf16 v[42:45], v[54:57], v[104:111], v6
ds_read_b128 v[54:57], v0 offset:6144
ds_read_b128 v[58:61], v0 offset:7168
ds_read_b128 v[62:65], v0 offset:8192
s_branch RS_qkd
RS_av2:
buffer_load_dwordx4 v[58:61], v0, s[8:11], s22 offen sc1
buffer_load_dwordx4 v[62:65], v0, s[8:11], s26 offen sc1
s_add_u32 s29, s29, 1
s_cmp_gt_u32 s29, 1048576
s_cbranch_scc1 RS_bail
s_waitcnt vmcnt(0)
v_max3_u32 v78, v58, v60, v62
v_max_u32 v78, v78, v64
v_cmp_eq_u32 vcc, -1, v78
s_cbranch_vccnz RS_av2
ds_write_b128 v1, v[58:61] offset:0
ds_write_b128 v1, v[62:65] offset:4096
RS_qv2:
v_smfmac_f32_16x16x64_bf16 v[30:33], v[58:61], a[16:23], v6
s_add_u32 s26, s16, 16777216
v_smfmac_f32_16x16x64_bf16 v[34:37], v[58:61], a[88:95], v6
buffer_load_dwordx4 v[14:17], v0, s[8:11], s16 offen sc1
v_smfmac_f32_16x16x64_bf16 v[38:41], v[58:61], a[160:167], v6
v_smfmac_f32_16x16x64_bf16 v[42:45], v[58:61], a[232:239], v6
s_waitcnt lgkmcnt(0)
s_barrier
ds_read_b128 v[54:57], v0 offset:0
ds_read_b128 v[58:61], v0 offset:1024
v_smfmac_f32_16x16x64_bf16 v[30:33], v[62:65], a[48:55], v6
buffer_load_dwordx4 v[18:21], v0, s[8:11], s16 offen offset:1024 sc1
v_smfmac_f32_16x16x64_bf16 v[34:37], v[62:65], a[120:127], v6
v_smfmac_f32_16x16x64_bf16 v[38:41], v[62:65], a[192:199], v6
v_smfmac_f32_16x16x64_bf16 v[42:45], v[62:65], v[88:95], v6
ds_read_b128 v[62:65], v0 offset:3072
s_waitcnt lgkmcnt(2)
v_smfmac_f32_16x16x64_bf16 v[30:33], v[54:57], a[0:7], v6
buffer_load_dwordx4 v[22:25], v0, s[8:11], s26 offen sc1
v_smfmac_f32_16x16x64_bf16 v[34:37], v[54:57], a[72:79], v6
v_smfmac_f32_16x16x64_bf16 v[38:41], v[54:57], a[144:151], v6
v_smfmac_f32_16x16x64_bf16 v[42:45], v[54:57], a[216:223], v6
ds_read_b128 v[54:57], v0 offset:4096
buffer_load_dwordx4 v[26:29], v0, s[8:11], s26 offen offset:1024 sc1
s_waitcnt lgkmcnt(2)
v_smfmac_f32_16x16x64_bf16 v[30:33], v[58:61], a[8:15], v6
v_smfmac_f32_16x16x64_bf16 v[34:37], v[58:61], a[80:87], v6
v_readfirstlane_b32 s25, v79
v_smfmac_f32_16x16x64_bf16 v[38:41], v[58:61], a[152:159], v6
s_add_u32 s27, s14, 1
s_and_b32 s27, s27, 3
s_cmp_lg_u32 s27, 0
s_cbranch_scc1 RSw2_kv
s_cmp_ge_u32 s25, 128
s_cbranch_scc1 RSw2_kv
s_add_u32 s25, s14, 1
s_min_u32 s25, s25, 63
s_lshr_b32 s25, s25, 2
s_lshl_b32 s25, s25, 7
s_add_u32 s25, s25, 70273024
v_mov_b32 v72, s25
RSw2_kvp:
buffer_load_dword v73, v72, s[8:11], 0 offen sc1
s_waitcnt vmcnt(0)
v_readfirstlane_b32 s25, v73
s_add_u32 s29, s29, 1
s_cmp_gt_u32 s29, 1048576
s_cbranch_scc1 RS_bail
s_cmp_ge_u32 s25, 128
s_cbranch_scc0 RSw2_kvp
RSw2_kv:
v_smfmac_f32_16x16x64_bf16 v[42:45], v[58:61], a[224:231], v6
ds_read_b128 v[58:61], v0 offset:5120
v_bfe_u32 v72, v0, 4, 4
s_waitcnt lgkmcnt(2)
v_smfmac_f32_16x16x64_bf16 v[30:33], v[62:65], a[24:31], v6
v_lshlrev_b32 v72, 7, v72
v_smfmac_f32_16x16x64_bf16 v[34:37], v[62:65], a[96:103], v6
v_bfe_u32 v73, v0, 8, 1
v_smfmac_f32_16x16x64_bf16 v[38:41], v[62:65], a[168:175], v6
v_lshl_add_u32 v72, v73, 24, v72
v_smfmac_f32_16x16x64_bf16 v[42:45], v[62:65], a[240:247], v6
ds_read_b128 v[62:65], v0 offset:7168
s_add_u32 s16, s16, 262144
s_waitcnt lgkmcnt(2)
v_smfmac_f32_16x16x64_bf16 v[30:33], v[54:57], a[32:39], v6
s_mov_b32 exec_hi, 0
buffer_load_dword v79, v72, s[8:11], s16 offen sc1
s_mov_b32 exec_hi, -1
v_smfmac_f32_16x16x64_bf16 v[34:37], v[54:57], a[104:111], v6
v_bfe_u32 v73, v0, 4, 5
v_smfmac_f32_16x16x64_bf16 v[38:41], v[54:57], a[176:183], v6
v_mul_u32_u24 v73, 10624, v73
v_smfmac_f32_16x16x64_bf16 v[42:45], v[54:57], a[248:255], v6
ds_read_b128 v[54:57], v0 offset:8192
v_add_u32 v73, s45, v73
s_waitcnt lgkmcnt(2)
v_smfmac_f32_16x16x64_bf16 v[30:33], v[58:61], a[40:47], v6
s_add_u32 s25, s20, 339968
v_smfmac_f32_16x16x64_bf16 v[34:37], v[58:61], a[112:119], v6
s_mov_b32 exec_hi, 0
buffer_load_dword v79, v73, s[8:11], s25 offen sc1
s_mov_b32 exec_hi, -1
s_add_u32 s25, s21, s46
v_smfmac_f32_16x16x64_bf16 v[38:41], v[58:61], a[184:191], v6
v_lshlrev_b32 v72, 9, v0
v_smfmac_f32_16x16x64_bf16 v[42:45], v[58:61], v[80:87], v6
s_mov_b64 exec, 3
buffer_load_dword v79, v72, s[8:11], s25 offen sc1
s_mov_b64 exec, -1
s_waitcnt lgkmcnt(1)
v_smfmac_f32_16x16x64_bf16 v[30:33], v[62:65], a[56:63], v6
s_add_u32 s25, s14, 2
s_min_u32 s25, s25, 63
s_lshr_b32 s25, s25, 2
s_lshl_b32 s25, s25, 7
v_smfmac_f32_16x16x64_bf16 v[34:37], v[62:65], a[128:135], v6
s_add_u32 s25, s25, 70273024
s_add_u32 s27, s14, 2
s_and_b32 s27, s27, 3
s_cmp_eq_u32 s27, 0
s_cselect_b32 s25, s25, 0x80000000
v_mov_b32 v72, s25
s_mov_b64 exec, 1
buffer_load_dword v79, v72, s[8:11], 0 offen sc1
s_mov_b64 exec, -1
v_smfmac_f32_16x16x64_bf16 v[38:41], v[62:65], a[200:207], v6
v_mov_b32 v70, s14
v_smfmac_f32_16x16x64_bf16 v[42:45], v[62:65], v[96:103], v6
s_cmp_eq_u32 s14, s30
s_cselect_b32 s25, 0x80000000, s32
v_mov_b32 v71, s25
s_waitcnt lgkmcnt(0)
v_smfmac_f32_16x16x64_bf16 v[30:33], v[54:57], a[64:71], v6
s_mov_b64 exec, 1
buffer_store_dword v70, v71, s[8:11], 0 offen sc1
s_mov_b64 exec, -1
v_smfmac_f32_16x16x64_bf16 v[34:37], v[54:57], a[136:143], v6
v_add_u32 v78, s36, v2
v_cndmask_b32 v78, -16, v78, s[38:39]
v_smfmac_f32_16x16x64_bf16 v[38:41], v[54:57], a[208:215], v6
v_smfmac_f32_16x16x64_bf16 v[42:45], v[54:57], v[104:111], v6
ds_read_b128 v[54:57], v0 offset:6144
ds_read_b128 v[58:61], v0 offset:7168
ds_read_b128 v[62:65], v0 offset:8192
s_branch RS_qkd
RS_av3:
buffer_load_dwordx4 v[58:61], v0, s[8:11], s22 offen sc1
buffer_load_dwordx4 v[62:65], v0, s[8:11], s26 offen sc1
s_add_u32 s29, s29, 1
s_cmp_gt_u32 s29, 1048576
s_cbranch_scc1 RS_bail
s_waitcnt vmcnt(0)
v_max3_u32 v78, v58, v60, v62
v_max_u32 v78, v78, v64
v_cmp_eq_u32 vcc, -1, v78
s_cbranch_vccnz RS_av3
ds_write_b128 v1, v[58:61] offset:0
ds_write_b128 v1, v[62:65] offset:4096
RS_qv3:
v_smfmac_f32_16x16x64_bf16 v[30:33], v[58:61], a[24:31], v6
s_add_u32 s26, s16, 16777216
v_smfmac_f32_16x16x64_bf16 v[34:37], v[58:61], a[96:103], v6
buffer_load_dwordx4 v[14:17], v0, s[8:11], s16 offen sc1
v_smfmac_f32_16x16x64_bf16 v[38:41], v[58:61], a[168:175], v6
v_smfmac_f32_16x16x64_bf16 v[42:45], v[58:61], a[240:247], v6
s_waitcnt lgkmcnt(0)
s_barrier
ds_read_b128 v[54:57], v0 offset:0
ds_read_b128 v[58:61], v0 offset:1024
v_smfmac_f32_16x16x64_bf16 v[30:33], v[62:65], a[56:63], v6
buffer_load_dwordx4 v[18:21], v0, s[8:11], s16 offen offset:1024 sc1
v_smfmac_f32_16x16x64_bf16 v[34:37], v[62:65], a[128:135], v6
v_smfmac_f32_16x16x64_bf16 v[38:41], v[62:65], a[200:207], v6
v_smfmac_f32_16x16x64_bf16 v[42:45], v[62:65], v[96:103], v6
ds_read_b128 v[62:65], v0 offset:2048
s_waitcnt lgkmcnt(2)
v_smfmac_f32_16x16x64_bf16 v[30:33], v[54:57], a[0:7], v6
buffer_load_dwordx4 v[22:25], v0, s[8:11], s26 offen sc1
v_smfmac_f32_16x16x64_bf16 v[34:37], v[54:57], a[72:79], v6
v_smfmac_f32_16x16x64_bf16 v[38:41], v[54:57], a[144:151], v6
v_smfmac_f32_16x16x64_bf16 v[42:45], v[54:57], a[216:223], v6
ds_read_b128 v[54:57], v0 offset:4096
buffer_load_dwordx4 v[26:29], v0, s[8:11], s26 offen offset:1024 sc1
s_waitcnt lgkmcnt(2)
v_smfmac_f32_16x16x64_bf16 v[30:33], v[58:61], a[8:15], v6
v_smfmac_f32_16x16x64_bf16 v[34:37], v[58:61], a[80:87], v6
v_readfirstlane_b32 s25, v79
v_smfmac_f32_16x16x64_bf16 v[38:41], v[58:61], a[152:159], v6
s_add_u32 s27, s14, 1
s_and_b32 s27, s27, 3
s_cmp_lg_u32 s27, 0
s_cbranch_scc1 RSw3_kv
s_cmp_ge_u32 s25, 128
s_cbranch_scc1 RSw3_kv
s_add_u32 s25, s14, 1
s_min_u32 s25, s25, 63
s_lshr_b32 s25, s25, 2
s_lshl_b32 s25, s25, 7
s_add_u32 s25, s25, 70273024
v_mov_b32 v72, s25
RSw3_kvp:
buffer_load_dword v73, v72, s[8:11], 0 offen sc1
s_waitcnt vmcnt(0)
v_readfirstlane_b32 s25, v73
s_add_u32 s29, s29, 1
s_cmp_gt_u32 s29, 1048576
s_cbranch_scc1 RS_bail
s_cmp_ge_u32 s25, 128
s_cbranch_scc0 RSw3_kvp
RSw3_kv:
v_smfmac_f32_16x16x64_bf16 v[42:45], v[58:61], a[224:231], v6
ds_read_b128 v[58:61], v0 offset:5120
v_bfe_u32 v72, v0, 4, 4
s_waitcnt lgkmcnt(2)
v_smfmac_f32_16x16x64_bf16 v[30:33], v[62:65], a[16:23], v6
v_lshlrev_b32 v72, 7, v72
v_smfmac_f32_16x16x64_bf16 v[34:37], v[62:65], a[88:95], v6
v_bfe_u32 v73, v0, 8, 1
v_smfmac_f32_16x16x64_bf16 v[38:41], v[62:65], a[160:167], v6
v_lshl_add_u32 v72, v73, 24, v72
v_smfmac_f32_16x16x64_bf16 v[42:45], v[62:65], a[232:239], v6
ds_read_b128 v[62:65], v0 offset:6144
s_add_u32 s16, s16, 262144
s_waitcnt lgkmcnt(2)
v_smfmac_f32_16x16x64_bf16 v[30:33], v[54:57], a[32:39], v6
s_mov_b32 exec_hi, 0
buffer_load_dword v79, v72, s[8:11], s16 offen sc1
s_mov_b32 exec_hi, -1
v_smfmac_f32_16x16x64_bf16 v[34:37], v[54:57], a[104:111], v6
v_bfe_u32 v73, v0, 4, 5
v_smfmac_f32_16x16x64_bf16 v[38:41], v[54:57], a[176:183], v6
v_mul_u32_u24 v73, 10624, v73
v_smfmac_f32_16x16x64_bf16 v[42:45], v[54:57], a[248:255], v6
ds_read_b128 v[54:57], v0 offset:8192
v_add_u32 v73, s45, v73
s_waitcnt lgkmcnt(2)
v_smfmac_f32_16x16x64_bf16 v[30:33], v[58:61], a[40:47], v6
s_add_u32 s25, s20, 339968
v_smfmac_f32_16x16x64_bf16 v[34:37], v[58:61], a[112:119], v6
s_mov_b32 exec_hi, 0
buffer_load_dword v79, v73, s[8:11], s25 offen sc1
s_mov_b32 exec_hi, -1
s_add_u32 s25, s21, s46
v_smfmac_f32_16x16x64_bf16 v[38:41], v[58:61], a[184:191], v6
v_lshlrev_b32 v72, 9, v0
v_smfmac_f32_16x16x64_bf16 v[42:45], v[58:61], v[80:87], v6
s_mov_b64 exec, 3
buffer_load_dword v79, v72, s[8:11], s25 offen sc1
s_mov_b64 exec, -1
s_waitcnt lgkmcnt(1)
v_smfmac_f32_16x16x64_bf16 v[30:33], v[62:65], a[48:55], v6
s_add_u32 s25, s14, 2
s_min_u32 s25, s25, 63
s_lshr_b32 s25, s25, 2
s_lshl_b32 s25, s25, 7
v_smfmac_f32_16x16x64_bf16 v[34:37], v[62:65], a[120:127], v6
s_add_u32 s25, s25, 70273024
s_add_u32 s27, s14, 2
s_and_b32 s27, s27, 3
s_cmp_eq_u32 s27, 0
s_cselect_b32 s25, s25, 0x80000000
v_mov_b32 v72, s25
s_mov_b64 exec, 1
buffer_load_dword v79, v72, s[8:11], 0 offen sc1
s_mov_b64 exec, -1
v_smfmac_f32_16x16x64_bf16 v[38:41], v[62:65], a[192:199], v6
v_mov_b32 v70, s14
v_smfmac_f32_16x16x64_bf16 v[42:45], v[62:65], v[88:95], v6
s_cmp_eq_u32 s14, s30
s_cselect_b32 s25, 0x80000000, s32
v_mov_b32 v71, s25
s_waitcnt lgkmcnt(0)
v_smfmac_f32_16x16x64_bf16 v[30:33], v[54:57], a[64:71], v6
s_mov_b64 exec, 1
buffer_store_dword v70, v71, s[8:11], 0 offen sc1
s_mov_b64 exec, -1
v_smfmac_f32_16x16x64_bf16 v[34:37], v[54:57], a[136:143], v6
v_add_u32 v78, s36, v2
v_cndmask_b32 v78, -16, v78, s[38:39]
v_smfmac_f32_16x16x64_bf16 v[38:41], v[54:57], a[208:215], v6
v_smfmac_f32_16x16x64_bf16 v[42:45], v[54:57], v[104:111], v6
ds_read_b128 v[54:57], v0 offset:6144
ds_read_b128 v[58:61], v0 offset:7168
ds_read_b128 v[62:65], v0 offset:8192
RS_qkd:
v_cvt_pk_bf16_f32 v66, v30, v31
v_cvt_pk_bf16_f32 v67, v32, v33
v_cvt_pk_bf16_f32 v68, v34, v35
v_cvt_pk_bf16_f32 v69, v36, v37
s_nop 1
v_cvt_pk_bf16_f32 v70, v38, v39
v_mfma_f32_16x16x16_bf16 v[30:33], v[66:67], v[8:9], 0
v_cvt_pk_bf16_f32 v71, v40, v41
v_cvt_pk_bf16_f32 v72, v42, v43
v_mfma_f32_16x16x16_bf16 v[34:37], v[68:69], v[8:9], 0
v_cvt_pk_bf16_f32 v73, v44, v45
s_nop 0
v_mfma_f32_16x16x16_bf16 v[38:41], v[70:71], v[8:9], 0
v_mfma_f32_16x16x16_bf16 v[42:45], v[72:73], v[8:9], 0
s_waitcnt lgkmcnt(2)
v_smfmac_f32_16x16x64_bf16 v[46:49], v[54:57], v[160:167], v6
v_cvt_pk_bf16_f32 v66, v30, v31
v_cvt_pk_bf16_f32 v67, v32, v33
v_cvt_pk_bf16_f32 v68, v34, v35
v_cvt_pk_bf16_f32 v69, v36, v37
v_smfmac_f32_16x16x64_bf16 v[50:53], v[54:57], v[232:239], v6
ds_read_b128 v[54:57], v0 offset:0
v_mov_b32_dpp v74, v66 row_ror:8 row_mask:0xf bank_mask:0xf
v_mov_b32_dpp v75, v67 row_ror:8 row_mask:0xf bank_mask:0xf
v_mov_b32_dpp v76, v68 row_ror:8 row_mask:0xf bank_mask:0xf
v_mov_b32_dpp v77, v69 row_ror:8 row_mask:0xf bank_mask:0xf
s_waitcnt vmcnt(5)
v_mfma_f32_16x16x32_bf16 v[30:33], v[14:17], v[66:69], 0
v_cvt_pk_bf16_f32 v70, v38, v39
v_cvt_pk_bf16_f32 v71, v40, v41
v_mfma_f32_16x16x32_bf16 v[30:33], v[18:21], v[74:77], v[30:33]
v_cvt_pk_bf16_f32 v72, v42, v43
v_cvt_pk_bf16_f32 v73, v44, v45
s_nop 1
v_mfma_f32_16x16x32_bf16 v[34:37], v[70:73], v[66:69], 0
s_waitcnt lgkmcnt(2)
v_smfmac_f32_16x16x64_bf16 v[46:49], v[58:61], v[168:175], v6
v_smfmac_f32_16x16x64_bf16 v[50:53], v[58:61], v[240:247], v6
ds_read_b128 v[58:61], v0 offset:1024
ds_write_b128 v1, v[30:33] offset:9216
ds_write_b128 v78, v[34:37]
buffer_store_dwordx4 v[70:73], v7, s[8:11], s17 offen sc1
s_waitcnt lgkmcnt(4)
v_smfmac_f32_16x16x64_bf16 v[46:49], v[62:65], v[176:183], v6
v_smfmac_f32_16x16x64_bf16 v[50:53], v[62:65], v[248:255], v6
ds_read_b128 v[62:65], v0 offset:2048
s_waitcnt lgkmcnt(4)
v_smfmac_f32_16x16x64_bf16 v[46:49], v[54:57], v[112:119], v6
v_smfmac_f32_16x16x64_bf16 v[50:53], v[54:57], v[184:191], v6
ds_read_b128 v[54:57], v0 offset:3072
s_waitcnt lgkmcnt(2)
s_barrier
ds_read_b128 v[30:33], v0 offset:9216
ds_read_b128 v[14:17], v0 offset:10240
ds_read_b128 v[18:21], v0 offset:11264
ds_read_b128 v[74:77], v0 offset:12288
ds_read_b128 v[34:37], v2 offset:13312
ds_read_b128 v[66:69], v2 offset:13568
ds_read_b128 v[42:45], v2 offset:13824
ds_read_b128 v[38:41], v2 offset:14080
v_smfmac_f32_16x16x64_bf16 v[46:49], v[58:61], v[120:127], v6
v_smfmac_f32_16x16x64_bf16 v[50:53], v[58:61], v[192:199], v6
ds_read_b128 v[58:61], v0 offset:4096
s_waitcnt lgkmcnt(10)
v_smfmac_f32_16x16x64_bf16 v[46:49], v[62:65], v[128:135], v6
v_smfmac_f32_16x16x64_bf16 v[50:53], v[62:65], v[200:207], v6
ds_read_b128 v[62:65], v0 offset:5120
s_waitcnt lgkmcnt(10)
v_smfmac_f32_16x16x64_bf16 v[46:49], v[54:57], v[136:143], v6
v_smfmac_f32_16x16x64_bf16 v[50:53], v[54:57], v[208:215], v6
s_waitcnt lgkmcnt(6)
v_pk_add_f32 v[30:31], v[30:31], v[14:15]
v_pk_add_f32 v[32:33], v[32:33], v[16:17]
v_pk_add_f32 v[30:31], v[30:31], v[18:19]
v_pk_add_f32 v[32:33], v[32:33], v[20:21]
v_pk_add_f32 v[30:31], v[30:31], v[74:75]
v_pk_add_f32 v[32:33], v[32:33], v[76:77]
s_waitcnt lgkmcnt(2)
v_pk_add_f32 v[34:35], v[34:35], v[66:67]
v_pk_add_f32 v[36:37], v[36:37], v[68:69]
v_pk_add_f32 v[34:35], v[34:35], v[42:43]
v_pk_add_f32 v[36:37], v[36:37], v[44:45]
v_pk_add_f32 v[34:35], v[34:35], v[38:39]
v_pk_add_f32 v[36:37], v[36:37], v[40:41]
v_max3_f32 v78, v30, v31, v32
v_max3_f32 v42, v33, v34, v35
v_max3_f32 v78, v78, v36, v37
v_max_f32 v78, v78, v42
s_waitcnt lgkmcnt(1)
v_smfmac_f32_16x16x64_bf16 v[46:49], v[58:61], v[144:151], v6
ds_read_b128 v[14:17], v1 offset:16384
v_max_f32_dpp v78, v78, v78 row_ror:8 row_mask:0xf bank_mask:0xf
v_smfmac_f32_16x16x64_bf16 v[50:53], v[58:61], v[216:223], v6
v_mov_b32 v42, v78
ds_read_b128 v[18:21], v1 offset:20480
s_waitcnt lgkmcnt(2)
v_smfmac_f32_16x16x64_bf16 v[46:49], v[62:65], v[152:159], v6
v_permlane16_swap_b32 v78, v42
v_max_f32 v78, v78, v42
v_mov_b32 v42, v78
v_smfmac_f32_16x16x64_bf16 v[50:53], v[62:65], v[224:231], v6
s_nop 0
v_permlane32_swap_b32 v78, v42
v_max_f32 v78, v78, v42
v_mul_f32 v78, s15, v78
v_fma_f32 v30, v30, s15, -v78
v_fma_f32 v31, v31, s15, -v78
v_fma_f32 v32, v32, s15, -v78
v_fma_f32 v33, v33, s15, -v78
v_fma_f32 v34, v34, s15, -v78
v_fma_f32 v35, v35, s15, -v78
v_fma_f32 v36, v36, s15, -v78
v_fma_f32 v37, v37, s15, -v78
v_exp_f32 v30, v30
v_exp_f32 v31, v31
v_exp_f32 v32, v32
v_exp_f32 v33, v33
v_exp_f32 v34, v34
v_exp_f32 v35, v35
v_exp_f32 v36, v36
v_exp_f32 v37, v37
v_cvt_pk_bf16_f32 v74, v30, v31
v_cvt_pk_bf16_f32 v75, v32, v33
v_cvt_pk_bf16_f32 v70, v34, v35
v_cvt_pk_bf16_f32 v71, v36, v37
v_pk_add_f32 v[72:73], v[30:31], v[32:33]
v_pk_add_f32 v[34:35], v[34:35], v[36:37]
v_mov_b32_dpp v76, v74 row_ror:8 row_mask:0xf bank_mask:0xf
v_mov_b32_dpp v77, v75 row_ror:8 row_mask:0xf bank_mask:0xf
v_add_f32 v72, v72, v73
v_add_f32 v73, v34, v35
v_mfma_f32_16x16x32_bf16 v[38:41], v[22:25], v[74:77], 0
v_fmamk_f32 v72, v73, 0x3e800000, v72
v_cvt_pk_bf16_f32 v66, v46, v47
v_mfma_f32_16x16x32_bf16 v[42:45], v[26:29], v[74:77], 0
v_cvt_pk_bf16_f32 v67, v48, v49
v_add_f32_dpp v72, v72, v72 row_ror:8 row_mask:0xf bank_mask:0xf
v_mov_b32 v73, v72
v_cvt_pk_bf16_f32 v68, v50, v51
v_mfma_f32_16x16x16_bf16 v[38:41], v[66:67], v[70:71], v[38:41]
v_cvt_pk_bf16_f32 v69, v52, v53
v_permlane16_swap_b32 v72, v73
v_add_f32 v72, v72, v73
v_mov_b32 v73, v72
v_mfma_f32_16x16x16_bf16 v[42:45], v[68:69], v[70:71], v[42:45]
s_add_u32 s47, s17, 8388608
s_cmp_eq_u32 s14, 63
s_cbranch_scc1 RS_done
v_permlane32_swap_b32 v72, v73
v_add_f32 v72, v72, v73
v_rcp_f32 v78, v72
ds_read_b128 v[22:25], v1 offset:24576
ds_read_b128 v[26:29], v1 offset:28672
v_pk_mul_f32 v[38:39], v[38:39], v[78:79] op_sel_hi:[1,0]
v_pk_mul_f32 v[40:41], v[40:41], v[78:79] op_sel_hi:[1,0]
v_pk_mul_f32 v[42:43], v[42:43], v[78:79] op_sel_hi:[1,0]
v_pk_mul_f32 v[44:45], v[44:45], v[78:79] op_sel_hi:[1,0]
v_cvt_pk_bf16_f32 v70, v38, v39
v_cvt_pk_bf16_f32 v71, v40, v41
ds_write_b64 v3, v[70:71]
v_cvt_pk_bf16_f32 v72, v42, v43
v_cvt_pk_bf16_f32 v73, v44, v45
ds_write_b64 v3, v[72:73] offset:512
v_add_u32 v78, 0x10000, v1
buffer_store_dwordx4 v[66:69], v0, s[8:11], s47 offen sc1
ds_read_b128 v[38:41], v1 offset:32768
ds_read_b128 v[42:45], v1 offset:36864
s_waitcnt lgkmcnt(2)
s_barrier
ds_read_b128 v[46:49], v0 offset:14336
ds_read_b128 v[50:53], v0 offset:14464
ds_read_b128 v[54:57], v0 offset:15360
ds_read_b128 v[58:61], v0 offset:15488
ds_read_b128 v[66:69], v1 offset:40960
ds_read_b128 v[70:73], v1 offset:45056
s_waitcnt lgkmcnt(5)
v_mfma_f32_16x16x32_bf16 v[30:33], v[14:17], v[46:49], 0
ds_read_b128 v[14:17], v1 offset:49152
s_waitcnt lgkmcnt(5)
v_mfma_f32_16x16x32_bf16 v[30:33], v[18:21], v[50:53], v[30:33]
ds_read_b128 v[18:21], v1 offset:53248
s_waitcnt lgkmcnt(5)
v_mfma_f32_16x16x32_bf16 v[30:33], v[22:25], v[54:57], v[30:33]
ds_read_b128 v[22:25], v1 offset:57344
s_waitcnt lgkmcnt(5)
v_mfma_f32_16x16x32_bf16 v[30:33], v[26:29], v[58:61], v[30:33]
ds_read_b128 v[26:29], v1 offset:61440
s_waitcnt lgkmcnt(4)
v_mfma_f32_16x16x32_bf16 v[34:37], v[38:41], v[46:49], 0
ds_read_b128 v[38:41], v78 offset:0
v_mfma_f32_16x16x32_bf16 v[34:37], v[42:45], v[50:53], v[34:37]
ds_read_b128 v[42:45], v78 offset:4096
v_mfma_f32_16x16x32_bf16 v[34:37], v[66:69], v[54:57], v[34:37]
ds_read_b128 v[66:69], v78 offset:8192
v_cvt_pk_bf16_f32 v62, v30, v31
v_cvt_pk_bf16_f32 v63, v32, v33
v_mfma_f32_16x16x32_bf16 v[34:37], v[70:73], v[58:61], v[34:37]
ds_read_b128 v[70:73], v78 offset:12288
s_waitcnt lgkmcnt(4)
v_mfma_f32_16x16x32_bf16 v[30:33], v[14:17], v[46:49], 0
ds_read_b128 v[14:17], v78 offset:16384
v_mfma_f32_16x16x32_bf16 v[30:33], v[18:21], v[50:53], v[30:33]
ds_read_b128 v[18:21], v78 offset:20480
v_mfma_f32_16x16x32_bf16 v[30:33], v[22:25], v[54:57], v[30:33]
ds_read_b128 v[22:25], v78 offset:24576
v_cvt_pk_bf16_f32 v64, v34, v35
v_cvt_pk_bf16_f32 v65, v36, v37
v_mfma_f32_16x16x32_bf16 v[30:33], v[26:29], v[58:61], v[30:33]
ds_read_b128 v[26:29], v78 offset:28672
s_waitcnt lgkmcnt(4)
v_mfma_f32_16x16x32_bf16 v[34:37], v[38:41], v[46:49], 0
ds_read_b128 v[38:41], v78 offset:32768
v_mfma_f32_16x16x32_bf16 v[34:37], v[42:45], v[50:53], v[34:37]
ds_read_b128 v[42:45], v78 offset:36864
v_mfma_f32_16x16x32_bf16 v[34:37], v[66:69], v[54:57], v[34:37]
ds_read_b128 v[66:69], v78 offset:40960
v_cvt_pk_bf16_f32 v74, v30, v31
v_cvt_pk_bf16_f32 v75, v32, v33
v_mfma_f32_16x16x32_bf16 v[34:37], v[70:73], v[58:61], v[34:37]
ds_read_b128 v[70:73], v78 offset:45056
s_waitcnt lgkmcnt(4)
v_mfma_f32_16x16x32_bf16 v[30:33], v[14:17], v[46:49], 0
ds_read_b128 v[14:17], v78 offset:49152
v_mfma_f32_16x16x32_bf16 v[30:33], v[18:21], v[50:53], v[30:33]
ds_read_b128 v[18:21], v78 offset:53248
v_mfma_f32_16x16x32_bf16 v[30:33], v[22:25], v[54:57], v[30:33]
ds_read_b128 v[22:25], v78 offset:57344
v_cvt_pk_bf16_f32 v76, v34, v35
v_cvt_pk_bf16_f32 v77, v36, v37
v_mfma_f32_16x16x32_bf16 v[30:33], v[26:29], v[58:61], v[30:33]
ds_read_b128 v[26:29], v78 offset:61440
v_mov_b32_dpp v62, v74 row_ror:8 row_mask:0xf bank_mask:0xc
v_mov_b32_dpp v63, v75 row_ror:8 row_mask:0xf bank_mask:0xc
v_mov_b32_dpp v64, v76 row_ror:8 row_mask:0xf bank_mask:0xc
v_mov_b32_dpp v65, v77 row_ror:8 row_mask:0xf bank_mask:0xc
buffer_store_dwordx4 v[62:65], v0, s[8:11], s18 offen offset:0 sc1
s_waitcnt lgkmcnt(4)
v_mfma_f32_16x16x32_bf16 v[34:37], v[38:41], v[46:49], 0
v_add_u32 v78, 0x10000, v78
ds_read_b128 v[38:41], v78 offset:0
v_mfma_f32_16x16x32_bf16 v[34:37], v[42:45], v[50:53], v[34:37]
ds_read_b128 v[42:45], v78 offset:4096
v_mfma_f32_16x16x32_bf16 v[34:37], v[66:69], v[54:57], v[34:37]
ds_read_b128 v[66:69], v78 offset:8192
v_cvt_pk_bf16_f32 v62, v30, v31
v_cvt_pk_bf16_f32 v63, v32, v33
v_mfma_f32_16x16x32_bf16 v[34:37], v[70:73], v[58:61], v[34:37]
ds_read_b128 v[70:73], v78 offset:12288
s_waitcnt lgkmcnt(4)
v_mfma_f32_16x16x32_bf16 v[30:33], v[14:17], v[46:49], 0
ds_read_b128 v[14:17], v78 offset:16384
v_mfma_f32_16x16x32_bf16 v[30:33], v[18:21], v[50:53], v[30:33]
ds_read_b128 v[18:21], v78 offset:20480
v_mfma_f32_16x16x32_bf16 v[30:33], v[22:25], v[54:57], v[30:33]
ds_read_b128 v[22:25], v78 offset:24576
v_cvt_pk_bf16_f32 v64, v34, v35
v_cvt_pk_bf16_f32 v65, v36, v37
v_mfma_f32_16x16x32_bf16 v[30:33], v[26:29], v[58:61], v[30:33]
ds_read_b128 v[26:29], v78 offset:28672
s_waitcnt lgkmcnt(4)
v_mfma_f32_16x16x32_bf16 v[34:37], v[38:41], v[46:49], 0
v_mfma_f32_16x16x32_bf16 v[34:37], v[42:45], v[50:53], v[34:37]
v_mfma_f32_16x16x32_bf16 v[34:37], v[66:69], v[54:57], v[34:37]
v_cvt_pk_bf16_f32 v74, v30, v31
v_cvt_pk_bf16_f32 v75, v32, v33
v_mfma_f32_16x16x32_bf16 v[34:37], v[70:73], v[58:61], v[34:37]
s_waitcnt lgkmcnt(0)
v_mfma_f32_16x16x32_bf16 v[30:33], v[14:17], v[46:49], 0
v_mfma_f32_16x16x32_bf16 v[30:33], v[18:21], v[50:53], v[30:33]
v_mfma_f32_16x16x32_bf16 v[30:33], v[22:25], v[54:57], v[30:33]
v_cvt_pk_bf16_f32 v76, v34, v35
v_cvt_pk_bf16_f32 v77, v36, v37
v_mfma_f32_16x16x32_bf16 v[30:33], v[26:29], v[58:61], v[30:33]
v_mov_b32_dpp v62, v74 row_ror:8 row_mask:0xf bank_mask:0xc
v_mov_b32_dpp v63, v75 row_ror:8 row_mask:0xf bank_mask:0xc
v_mov_b32_dpp v64, v76 row_ror:8 row_mask:0xf bank_mask:0xc
v_mov_b32_dpp v65, v77 row_ror:8 row_mask:0xf bank_mask:0xc
buffer_store_dwordx4 v[62:65], v0, s[8:11], s18 offen offset:1024 sc1
v_mov_b32 v38, 0
v_mov_b32 v39, 0
v_mov_b32 v40, 0
v_mov_b32 v41, 0
v_mov_b32 v42, 0
v_mov_b32 v43, 0
v_mov_b32 v44, 0
v_mov_b32 v45, 0
v_cvt_pk_bf16_f32 v62, v30, v31
v_cvt_pk_bf16_f32 v63, v32, v33
buffer_store_dwordx2 v[62:63], v7, s[8:11], s19 offen sc1
v_mov_b32 v30, 0
v_mov_b32 v31, 0
v_mov_b32 v32, 0
v_mov_b32 v33, 0
v_mov_b32 v34, 0
v_mov_b32 v35, 0
v_mov_b32 v36, 0
v_mov_b32 v37, 0
v_mov_b32 v46, 0
v_mov_b32 v47, 0
v_mov_b32 v48, 0
v_mov_b32 v49, 0
v_mov_b32 v50, 0
v_mov_b32 v51, 0
v_mov_b32 v52, 0
v_mov_b32 v53, 0
s_nop 15
s_nop 15
s_cmp_eq_u32 s23, 0
s_cbranch_scc1 RS_nred
s_add_u32 s26, s20, 84992
s_add_u32 s27, s20, 169984
s_add_u32 s28, s20, 254976
buffer_load_dwordx4 v[54:57], v4, s[8:11], s20 offen sc1
buffer_load_dwordx4 v[58:61], v4, s[8:11], s26 offen sc1
buffer_load_dwordx4 v[62:65], v4, s[8:11], s27 offen sc1
buffer_load_dwordx4 v[74:77], v4, s[8:11], s28 offen sc1
s_nop 15
buffer_load_dwordx4 v[14:17], v4, s[8:11], s20 offen sc1
buffer_load_dwordx4 v[18:21], v4, s[8:11], s26 offen sc1
buffer_load_dwordx4 v[22:25], v4, s[8:11], s27 offen sc1
buffer_load_dwordx4 v[26:29], v4, s[8:11], s28 offen sc1
RS_ra:
s_waitcnt vmcnt(7)
v_mfma_f32_16x16x32_bf16 v[70:73], v[10:13], v[54:57], 0
s_waitcnt vmcnt(6)
v_mfma_f32_16x16x32_bf16 v[70:73], v[10:13], v[58:61], v[70:73]
s_waitcnt vmcnt(5)
v_mfma_f32_16x16x32_bf16 v[70:73], v[10:13], v[62:65], v[70:73]
s_waitcnt vmcnt(4)
v_mfma_f32_16x16x32_bf16 v[70:73], v[10:13], v[74:77], v[70:73]
s_nop 7
v_cmp_u_f32 vcc, v70, v70
v_add_f32_dpp v70, v70, v70 row_ror:8 row_mask:0xf bank_mask:0xf
v_add_f32_dpp v71, v71, v71 row_ror:8 row_mask:0xf bank_mask:0xf
v_add_f32_dpp v72, v72, v72 row_ror:8 row_mask:0xf bank_mask:0xf
v_add_f32_dpp v73, v73, v73 row_ror:8 row_mask:0xf bank_mask:0xf
v_cvt_pk_bf16_f32 v66, v70, v71
v_cvt_pk_bf16_f32 v67, v72, v73
s_cbranch_vccz RS_rok
buffer_load_dwordx4 v[54:57], v4, s[8:11], s20 offen sc1
buffer_load_dwordx4 v[58:61], v4, s[8:11], s26 offen sc1
buffer_load_dwordx4 v[62:65], v4, s[8:11], s27 offen sc1
buffer_load_dwordx4 v[74:77], v4, s[8:11], s28 offen sc1
s_add_u32 s29, s29, 1
s_cmp_gt_u32 s29, 1048576
s_cbranch_scc1 RS_bail
s_waitcnt vmcnt(7)
v_mfma_f32_16x16x32_bf16 v[70:73], v[10:13], v[14:17], 0
s_waitcnt vmcnt(6)
v_mfma_f32_16x16x32_bf16 v[70:73], v[10:13], v[18:21], v[70:73]
s_waitcnt vmcnt(5)
v_mfma_f32_16x16x32_bf16 v[70:73], v[10:13], v[22:25], v[70:73]
s_waitcnt vmcnt(4)
v_mfma_f32_16x16x32_bf16 v[70:73], v[10:13], v[26:29], v[70:73]
s_nop 7
v_cmp_u_f32 vcc, v70, v70
v_add_f32_dpp v70, v70, v70 row_ror:8 row_mask:0xf bank_mask:0xf
v_add_f32_dpp v71, v71, v71 row_ror:8 row_mask:0xf bank_mask:0xf
v_add_f32_dpp v72, v72, v72 row_ror:8 row_mask:0xf bank_mask:0xf
v_add_f32_dpp v73, v73, v73 row_ror:8 row_mask:0xf bank_mask:0xf
v_cvt_pk_bf16_f32 v66, v70, v71
v_cvt_pk_bf16_f32 v67, v72, v73
s_cbranch_vccz RS_rok
buffer_load_dwordx4 v[14:17], v4, s[8:11], s20 offen sc1
buffer_load_dwordx4 v[18:21], v4, s[8:11], s26 offen sc1
buffer_load_dwordx4 v[22:25], v4, s[8:11], s27 offen sc1
buffer_load_dwordx4 v[26:29], v4, s[8:11], s28 offen sc1
s_add_u32 s29, s29, 1
s_cmp_gt_u32 s29, 1048576
s_cbranch_scc1 RS_bail
s_branch RS_ra
RS_rok:
buffer_store_dwordx2 v[66:67], v5, s[8:11], s21 offen sc1
RS_nred:
RS_cons:
s_barrier
s_add_u32 s25, s14, 1
s_cmp_eq_u32 s25, s31
s_cbranch_scc1 RS_done2
s_add_u32 s22, s21, s37
s_add_u32 s26, s22, 4096
s_add_u32 s27, s21, 8192
s_add_u32 s14, s14, 1
s_add_u32 s20, s20, 339968
s_add_u32 s17, s17, 131072
s_add_u32 s18, s20, s42
s_add_u32 s19, s20, s43
s_add_u32 s21, s21, 9216
s_nop 7
RS_adisp:
s_cmp_eq_u32 s13, 0
s_cbranch_scc1 RS_av0
s_cmp_eq_u32 s13, 1
s_cbranch_scc1 RS_av1
s_cmp_eq_u32 s13, 2
s_cbranch_scc1 RS_av2
s_branch RS_av3
RS_bail:
s_endpgm
RS_done:
buffer_store_dwordx4 v[66:69], v0, s[8:11], s47 offen sc1
s_waitcnt vmcnt(0) lgkmcnt(0)
s_barrier
s_cmp_lg_u32 s13, 0
s_cbranch_scc1 RS_fin
v_mov_b32 v78, 64
v_mov_b32 v77, s32
s_mov_b64 exec, 1
buffer_store_dword v78, v77, s[8:11], 0 offen sc1
s_mov_b64 exec, -1
s_waitcnt vmcnt(0)
s_branch RS_fin
RS_done2:
s_waitcnt vmcnt(0) lgkmcnt(0)
s_barrier
s_cmp_lg_u32 s13, 0
s_cbranch_scc1 RS_fin
v_mov_b32 v78, s31
v_mov_b32 v77, s32
s_mov_b64 exec, 1
buffer_atomic_umax v78, v77, s[8:11], 0 offen
s_mov_b64 exec, -1
s_waitcnt vmcnt(0)
RS_fin:
s_cmp_eq_u32 s31, 64
s_cbranch_scc1 K_end
s_mov_b32 s51, 1
s_branch K_worker2
K_worker:
s_mov_b32 s51, 0
K_worker2:
s_load_dwordx2 s[84:85], s[0:1], 0
s_load_dwordx2 s[86:87], s[0:1], 16
s_load_dwordx2 s[88:89], s[0:1], 24
s_load_dwordx2 s[90:91], s[0:1], 32
s_load_dwordx2 s[92:93], s[0:1], 40
s_load_dwordx2 s[94:95], s[0:1], 64
s_load_dwordx2 s[96:97], s[0:1], 72
s_load_dwordx2 s[98:99], s[0:1], 80
s_load_dwordx2 s[100:101], s[0:1], 88
s_load_dwordx2 s[56:57], s[0:1], 104
s_getpc_b64 s[40:41]
K_pc:
s_add_u32 s40, s40, K_items-K_pc
s_addc_u32 s41, s41, 0
s_mov_b32 s42, 0
s_mov_b32 s50, 65535
s_cmp_eq_u32 s51, 1
s_cbranch_scc1 K_wr2
s_cmp_eq_u32 s13, 0
s_cbranch_scc0 K_wr1
s_mov_b32 s33, 1
s_atomic_add s33, s[60:61], 128 glc
s_waitcnt lgkmcnt(0)
v_mov_b32 v4, 163824
v_mov_b32 v2, s33
s_mov_b64 exec, 1
ds_write_b32 v4, v2
s_waitcnt lgkmcnt(0)
s_mov_b64 exec, -1
K_wr1:
s_barrier
v_mov_b32 v4, 163824
ds_read_b32 v2, v4
s_waitcnt lgkmcnt(0)
v_readfirstlane_b32 s33, v2
s_barrier
K_wr2:
s_waitcnt lgkmcnt(0)
s_add_u32 s56, s56, 70270976
s_addc_u32 s57, s57, 0
s_cmp_lt_u32 s33, 224
s_cbranch_scc1 K_w0
s_mov_b32 s24, 0
K_an:
s_load_dword s25, s[60:61], 0 glc
s_load_dword s26, s[60:61], 128 glc
s_waitcnt lgkmcnt(0)
s_add_u32 s27, s25, s26
s_cmp_ge_u32 s27, 256
s_cbranch_scc1 K_an1
s_sleep 4
s_add_u32 s24, s24, 1
s_cmp_lt_u32 s24, 300000
s_cbranch_scc1 K_an
s_endpgm
K_an1:
s_sub_u32 s12, s33, 224
s_add_u32 s12, s12, s25
s_mov_b32 s30, 0
s_mov_b32 s31, 64
K_toR:
v_mbcnt_lo_u32_b32 v0, -1, 0
v_mbcnt_hi_u32_b32 v0, -1, v0
s_load_dwordx2 s[48:49], s[0:1], 8
s_load_dwordx2 s[50:51], s[0:1], 16
s_load_dwordx2 s[52:53], s[0:1], 24
s_load_dwordx2 s[54:55], s[0:1], 32
s_load_dwordx2 s[56:57], s[0:1], 40
s_waitcnt lgkmcnt(0)
s_branch K_R
K_w0:
s_mul_hi_u32 s25, s33, 613566757
s_mul_i32 s25, s25, 7
s_sub_u32 s25, s33, s25
s_sub_u32 s26, s3, 1
s_cmp_lt_u32 s26, 7
s_cselect_b32 s30, s26, s25
s_mov_b32 s31, 0
v_mbcnt_lo_u32_b32 v0, -1, 0
v_mbcnt_hi_u32_b32 v0, -1, v0
s_add_u32 s43, s33, 636
s_cmp_eq_u32 s51, 1
s_cbranch_scc1 K_pop
s_cmp_lt_u32 s33, 68
s_cbranch_scc0 K_warm
s_cmp_lt_u32 s33, 64
s_cbranch_scc0 K_wS
s_mov_b32 s20, s33
s_lshr_b32 s47, s33, 2
s_add_u32 s47, s47, 0
s_branch K_st0
K_wS:
s_sub_u32 s20, s33, 64
s_mov_b32 s47, 1048592
s_branch K_st1
K_pop:
s_lshl_b32 s25, s30, 3
s_load_dwordx2 s[34:35], s[40:41], s25
s_cmp_eq_u32 s13, 0
s_cbranch_scc0 K_n1
s_lshl_b32 s25, s30, 2
s_add_u32 s52, s60, s25
s_addc_u32 s53, s61, 0
s_mov_b32 s43, 1
s_atomic_add s43, s[52:53], 192 glc
s_waitcnt lgkmcnt(0)
v_mov_b32 v4, 163824
v_mov_b32 v2, s43
s_mov_b64 exec, 1
ds_write_b32 v4, v2
s_waitcnt lgkmcnt(0)
s_mov_b64 exec, -1
K_n1:
s_waitcnt vmcnt(0) lgkmcnt(0)
s_barrier
v_mov_b32 v4, 163824
ds_read_b32 v2, v4
s_waitcnt lgkmcnt(0)
v_readfirstlane_b32 s43, v2
s_barrier
s_cmp_eq_u32 s42, 1
s_cbranch_scc1 K_i1
s_mov_b32 s24, 0
v_mov_b32 v76, 16
L_pg_3:
global_load_dword v77, v76, s[60:61] sc1
s_waitcnt vmcnt(0)
v_readfirstlane_b32 s25, v77
s_cmp_ge_u32 s25, 1
s_cbranch_scc1 L_pg_3_ok
s_sleep 4
s_add_u32 s24, s24, 1
s_cmp_lt_u32 s24, 300000
s_cbranch_scc1 L_pg_3
s_endpgm
L_pg_3_ok:
s_mov_b32 s42, 1
K_i1:
s_and_b32 s52, s50, 0xffff
s_cmp_eq_u32 s52, 65535
s_cbranch_scc1 L_sg_4
s_cmp_eq_u32 s13, 0
s_cbranch_scc0 L_sg_4
s_lshl_b32 s52, s52, 7
s_add_u32 s52, s56, s52
s_addc_u32 s53, s57, 0
s_lshr_b32 s54, s50, 16
s_max_u32 s54, s54, 1
s_atomic_add s54, s[52:53], 0
L_sg_4:
s_mov_b32 s50, 65535
s_cmp_lt_u32 s43, s35
s_cbranch_scc1 K_have
s_add_u32 s31, s31, 1
s_cmp_ge_u32 s31, 7
s_cbranch_scc1 K_roles
s_add_u32 s30, s30, 1
s_cmp_eq_u32 s30, 7
s_cselect_b32 s30, 0, s30
s_branch K_pop
K_have:
s_add_u32 s43, s43, s34
s_lshl_b32 s25, s43, 4
s_add_u32 s25, s25, 64
s_load_dwordx4 s[44:47], s[40:41], s25
s_waitcnt lgkmcnt(0)
s_cmp_eq_u32 s13, 0
s_cbranch_scc0 K_d2
s_lshr_b32 s26, s45, 16
s_cmp_eq_u32 s26, 65535
s_cbranch_scc1 L_dep_5_ok
s_lshl_b32 s26, s26, 7
s_add_u32 s26, s26, 70270976
s_and_b32 s27, s45, 0xffff
v_mov_b32 v76, s26
s_mov_b32 s24, 0
L_dep_5:
buffer_load_dword v77, v76, s[8:11], 0 offen sc1
s_waitcnt vmcnt(0)
v_readfirstlane_b32 s25, v77
s_cmp_ge_u32 s25, s27
s_cbranch_scc1 L_dep_5_ok
s_sleep 4
s_add_u32 s24, s24, 1
s_cmp_lt_u32 s24, 300000
s_cbranch_scc1 L_dep_5
s_endpgm
L_dep_5_ok:
s_lshr_b32 s26, s46, 16
s_cmp_eq_u32 s26, 65535
s_cbranch_scc1 L_dep_6_ok
s_lshl_b32 s26, s26, 7
s_add_u32 s26, s26, 70270976
s_and_b32 s27, s46, 0xffff
v_mov_b32 v76, s26
s_mov_b32 s24, 0
L_dep_6:
buffer_load_dword v77, v76, s[8:11], 0 offen sc1
s_waitcnt vmcnt(0)
v_readfirstlane_b32 s25, v77
s_cmp_ge_u32 s25, s27
s_cbranch_scc1 L_dep_6_ok
s_sleep 4
s_add_u32 s24, s24, 1
s_cmp_lt_u32 s24, 300000
s_cbranch_scc1 L_dep_6
s_endpgm
L_dep_6_ok:
K_d2:
s_barrier
v_mbcnt_lo_u32_b32 v0, -1, 0
v_mbcnt_hi_u32_b32 v0, -1, v0
s_bfe_u32 s20, s44, 0x80008
s_bfe_u32 s21, s44, 0x80010
s_lshr_b32 s22, s44, 24
s_and_b32 s25, s44, 0xff
s_cmp_eq_u32 s25, 2
s_cbranch_scc1 K_st2
s_cmp_eq_u32 s25, 1
s_cbranch_scc1 K_st1
s_branch K_st12
K_st0:
s_mov_b32 s64, s84
s_and_b32 s65, s85, 0xffff
s_mov_b32 s66, 2359296
s_mov_b32 s67, 0x20000
v_and_b32 v1, 31, v0
v_lshrrev_b32 v2, 5, v0
v_mul_u32_u24 v3, 1152, v1
v_lshl_add_u32 v3, v2, 4, v3
s_mul_i32 s76, s20, 36864
s_lshl_b32 s77, s13, 6
s_add_u32 s76, s76, s77
v_lshlrev_b32 v0, 4, v0
v_mov_b32 v4, 0x80000000
s_cmp_lt_u32 s13, 2
s_cselect_b32 s78, 0, 0x80000000
v_or_b32 v5, s78, v3
buffer_load_dwordx4 v[16:19], v3, s[64:67], s76 offen offset:0
buffer_load_dwordx4 v[20:23], v3, s[64:67], s76 offen offset:32
buffer_load_dwordx4 v[24:27], v3, s[64:67], s76 offen offset:256
buffer_load_dwordx4 v[28:31], v3, s[64:67], s76 offen offset:288
buffer_load_dwordx4 v[32:35], v3, s[64:67], s76 offen offset:512
buffer_load_dwordx4 v[36:39], v3, s[64:67], s76 offen offset:544
buffer_load_dwordx4 v[40:43], v3, s[64:67], s76 offen offset:768
buffer_load_dwordx4 v[44:47], v3, s[64:67], s76 offen offset:800
buffer_load_dwordx4 v[48:51], v5, s[64:67], s76 offen offset:1024
buffer_load_dwordx4 v[52:55], v5, s[64:67], s76 offen offset:1056
s_waitcnt vmcnt(0)
v_permlane32_swap_b32 v16, v18
v_permlane32_swap_b32 v17, v19
v_permlane32_swap_b32 v20, v22
v_permlane32_swap_b32 v21, v23
v_permlane32_swap_b32 v24, v26
v_permlane32_swap_b32 v25, v27
v_permlane32_swap_b32 v28, v30
v_permlane32_swap_b32 v29, v31
v_permlane32_swap_b32 v32, v34
v_permlane32_swap_b32 v33, v35
v_permlane32_swap_b32 v36, v38
v_permlane32_swap_b32 v37, v39
v_permlane32_swap_b32 v40, v42
v_permlane32_swap_b32 v41, v43
v_permlane32_swap_b32 v44, v46
v_permlane32_swap_b32 v45, v47
v_permlane32_swap_b32 v48, v50
v_permlane32_swap_b32 v49, v51
v_permlane32_swap_b32 v52, v54
v_permlane32_swap_b32 v53, v55
v_swap_b32 v18, v20
v_swap_b32 v19, v21
v_swap_b32 v26, v28
v_swap_b32 v27, v29
v_swap_b32 v34, v36
v_swap_b32 v35, v37
v_swap_b32 v42, v44
v_swap_b32 v43, v45
v_swap_b32 v50, v52
v_swap_b32 v51, v53
s_mul_i32 s79, s20, 36864
s_lshl_b32 s80, s13, 11
s_add_u32 s79, s79, s80
v_or_b32 v6, s78, v0
s_add_u32 s80, s79, 73924608
buffer_store_dwordx4 v[16:19], v0, s[8:11], s80 offen sc1
buffer_store_dwordx4 v[20:23], v0, s[8:11], s80 offen offset:1024 sc1
s_add_u32 s80, s79, 73932800
buffer_store_dwordx4 v[24:27], v0, s[8:11], s80 offen sc1
buffer_store_dwordx4 v[28:31], v0, s[8:11], s80 offen offset:1024 sc1
s_add_u32 s80, s79, 73940992
buffer_store_dwordx4 v[32:35], v0, s[8:11], s80 offen sc1
buffer_store_dwordx4 v[36:39], v0, s[8:11], s80 offen offset:1024 sc1
s_add_u32 s80, s79, 73949184
buffer_store_dwordx4 v[40:43], v0, s[8:11], s80 offen sc1
buffer_store_dwordx4 v[44:47], v0, s[8:11], s80 offen offset:1024 sc1
s_add_u32 s80, s79, 73957376
buffer_store_dwordx4 v[48:51], v6, s[8:11], s80 offen sc1
buffer_store_dwordx4 v[52:55], v6, s[8:11], s80 offen offset:1024 sc1
v_lshlrev_b32 v64, 16, v16
v_and_b32 v65, 0xffff0000, v16
v_lshlrev_b32 v66, 16, v17
v_and_b32 v67, 0xffff0000, v17
v_lshlrev_b32 v68, 16, v18
v_and_b32 v69, 0xffff0000, v18
v_lshlrev_b32 v70, 16, v19
v_and_b32 v71, 0xffff0000, v19
v_lshlrev_b32 v72, 16, v20
v_and_b32 v73, 0xffff0000, v20
v_lshlrev_b32 v74, 16, v21
v_and_b32 v75, 0xffff0000, v21
v_lshlrev_b32 v76, 16, v22
v_and_b32 v77, 0xffff0000, v22
v_lshlrev_b32 v78, 16, v23
v_and_b32 v79, 0xffff0000, v23
v_lshlrev_b32 v80, 16, v24
v_and_b32 v81, 0xffff0000, v24
v_lshlrev_b32 v82, 16, v25
v_and_b32 v83, 0xffff0000, v25
v_lshlrev_b32 v84, 16, v26
v_and_b32 v85, 0xffff0000, v26
v_lshlrev_b32 v86, 16, v27
v_and_b32 v87, 0xffff0000, v27
v_lshlrev_b32 v88, 16, v28
v_and_b32 v89, 0xffff0000, v28
v_lshlrev_b32 v90, 16, v29
v_and_b32 v91, 0xffff0000, v29
v_lshlrev_b32 v92, 16, v30
v_and_b32 v93, 0xffff0000, v30
v_lshlrev_b32 v94, 16, v31
v_and_b32 v95, 0xffff0000, v31
v_lshlrev_b32 v96, 16, v32
v_and_b32 v97, 0xffff0000, v32
v_lshlrev_b32 v98, 16, v33
v_and_b32 v99, 0xffff0000, v33
v_lshlrev_b32 v100, 16, v34
v_and_b32 v101, 0xffff0000, v34
v_lshlrev_b32 v102, 16, v35
v_and_b32 v103, 0xffff0000, v35
v_lshlrev_b32 v104, 16, v36
v_and_b32 v105, 0xffff0000, v36
v_lshlrev_b32 v106, 16, v37
v_and_b32 v107, 0xffff0000, v37
v_lshlrev_b32 v108, 16, v38
v_and_b32 v109, 0xffff0000, v38
v_lshlrev_b32 v110, 16, v39
v_and_b32 v111, 0xffff0000, v39
v_lshlrev_b32 v112, 16, v40
v_and_b32 v113, 0xffff0000, v40
v_lshlrev_b32 v114, 16, v41
v_and_b32 v115, 0xffff0000, v41
v_lshlrev_b32 v116, 16, v42
v_and_b32 v117, 0xffff0000, v42
v_lshlrev_b32 v118, 16, v43
v_and_b32 v119, 0xffff0000, v43
v_lshlrev_b32 v120, 16, v44
v_and_b32 v121, 0xffff0000, v44
v_lshlrev_b32 v122, 16, v45
v_and_b32 v123, 0xffff0000, v45
v_lshlrev_b32 v124, 16, v46
v_and_b32 v125, 0xffff0000, v46
v_lshlrev_b32 v126, 16, v47
v_and_b32 v127, 0xffff0000, v47
v_lshlrev_b32 v128, 16, v48
v_and_b32 v129, 0xffff0000, v48
v_lshlrev_b32 v130, 16, v49
v_and_b32 v131, 0xffff0000, v49
v_lshlrev_b32 v132, 16, v50
v_and_b32 v133, 0xffff0000, v50
v_lshlrev_b32 v134, 16, v51
v_and_b32 v135, 0xffff0000, v51
v_lshlrev_b32 v136, 16, v52
v_and_b32 v137, 0xffff0000, v52
v_lshlrev_b32 v138, 16, v53
v_and_b32 v139, 0xffff0000, v53
v_lshlrev_b32 v140, 16, v54
v_and_b32 v141, 0xffff0000, v54
v_lshlrev_b32 v142, 16, v55
v_and_b32 v143, 0xffff0000, v55
v_mov_b32 v8, 0
v_mov_b32 v9, 0
v_add_f32 v8, v8, v64
v_add_f32 v8, v8, v65
v_add_f32 v8, v8, v66
v_add_f32 v8, v8, v67
v_add_f32 v8, v8, v68
v_add_f32 v8, v8, v69
v_add_f32 v8, v8, v70
v_add_f32 v8, v8, v71
v_add_f32 v8, v8, v72
v_add_f32 v8, v8, v73
v_add_f32 v8, v8, v74
v_add_f32 v8, v8, v75
v_add_f32 v8, v8, v76
v_add_f32 v8, v8, v77
v_add_f32 v8, v8, v78
v_add_f32 v8, v8, v79
v_add_f32 v8, v8, v80
v_add_f32 v8, v8, v81
v_add_f32 v8, v8, v82
v_add_f32 v8, v8, v83
v_add_f32 v8, v8, v84
v_add_f32 v8, v8, v85
v_add_f32 v8, v8, v86
v_add_f32 v8, v8, v87
v_add_f32 v8, v8, v88
v_add_f32 v8, v8, v89
v_add_f32 v8, v8, v90
v_add_f32 v8, v8, v91
v_add_f32 v8, v8, v92
v_add_f32 v8, v8, v93
v_add_f32 v8, v8, v94
v_add_f32 v8, v8, v95
v_add_f32 v8, v8, v96
v_add_f32 v8, v8, v97
v_add_f32 v8, v8, v98
v_add_f32 v8, v8, v99
v_add_f32 v8, v8, v100
v_add_f32 v8, v8, v101
v_add_f32 v8, v8, v102
v_add_f32 v8, v8, v103
v_add_f32 v8, v8, v104
v_add_f32 v8, v8, v105
v_add_f32 v8, v8, v106
v_add_f32 v8, v8, v107
v_add_f32 v8, v8, v108
v_add_f32 v8, v8, v109
v_add_f32 v8, v8, v110
v_add_f32 v8, v8, v111
v_add_f32 v8, v8, v112
v_add_f32 v8, v8, v113
v_add_f32 v8, v8, v114
v_add_f32 v8, v8, v115
v_add_f32 v8, v8, v116
v_add_f32 v8, v8, v117
v_add_f32 v8, v8, v118
v_add_f32 v8, v8, v119
v_add_f32 v8, v8, v120
v_add_f32 v8, v8, v121
v_add_f32 v8, v8, v122
v_add_f32 v8, v8, v123
v_add_f32 v8, v8, v124
v_add_f32 v8, v8, v125
v_add_f32 v8, v8, v126
v_add_f32 v8, v8, v127
v_add_f32 v8, v8, v128
v_add_f32 v8, v8, v129
v_add_f32 v8, v8, v130
v_add_f32 v8, v8, v131
v_add_f32 v8, v8, v132
v_add_f32 v8, v8, v133
v_add_f32 v8, v8, v134
v_add_f32 v8, v8, v135
v_add_f32 v8, v8, v136
v_add_f32 v8, v8, v137
v_add_f32 v8, v8, v138
v_add_f32 v8, v8, v139
v_add_f32 v8, v8, v140
v_add_f32 v8, v8, v141
v_add_f32 v8, v8, v142
v_add_f32 v8, v8, v143
v_mov_b32 v10, v8
s_nop 1
v_permlane32_swap_b32 v8, v10
v_add_f32 v8, v8, v10
v_and_b32 v11, 0x1f0, v0
v_lshrrev_b32 v11, 2, v11
s_lshl_b32 s81, s13, 7
v_add_u32 v12, s81, v11
ds_write_b32 v12, v8 offset:0
s_waitcnt lgkmcnt(0)
s_barrier
ds_read_b32 v12, v11 offset:0
ds_read_b32 v13, v11 offset:128
ds_read_b32 v14, v11 offset:256
ds_read_b32 v15, v11 offset:384
s_waitcnt lgkmcnt(0)
v_add_f32 v12, v12, v13
v_add_f32 v14, v14, v15
v_add_f32 v8, v12, v14
v_mul_f32 v8, 0x3ae38e39, v8
v_sub_f32 v64, v64, v8
v_sub_f32 v65, v65, v8
v_sub_f32 v66, v66, v8
v_sub_f32 v67, v67, v8
v_sub_f32 v68, v68, v8
v_sub_f32 v69, v69, v8
v_sub_f32 v70, v70, v8
v_sub_f32 v71, v71, v8
v_sub_f32 v72, v72, v8
v_sub_f32 v73, v73, v8
v_sub_f32 v74, v74, v8
v_sub_f32 v75, v75, v8
v_sub_f32 v76, v76, v8
v_sub_f32 v77, v77, v8
v_sub_f32 v78, v78, v8
v_sub_f32 v79, v79, v8
v_sub_f32 v80, v80, v8
v_sub_f32 v81, v81, v8
v_sub_f32 v82, v82, v8
v_sub_f32 v83, v83, v8
v_sub_f32 v84, v84, v8
v_sub_f32 v85, v85, v8
v_sub_f32 v86, v86, v8
v_sub_f32 v87, v87, v8
v_sub_f32 v88, v88, v8
v_sub_f32 v89, v89, v8
v_sub_f32 v90, v90, v8
v_sub_f32 v91, v91, v8
v_sub_f32 v92, v92, v8
v_sub_f32 v93, v93, v8
v_sub_f32 v94, v94, v8
v_sub_f32 v95, v95, v8
v_sub_f32 v96, v96, v8
v_sub_f32 v97, v97, v8
v_sub_f32 v98, v98, v8
v_sub_f32 v99, v99, v8
v_sub_f32 v100, v100, v8
v_sub_f32 v101, v101, v8
v_sub_f32 v102, v102, v8
v_sub_f32 v103, v103, v8
v_sub_f32 v104, v104, v8
v_sub_f32 v105, v105, v8
v_sub_f32 v106, v106, v8
v_sub_f32 v107, v107, v8
v_sub_f32 v108, v108, v8
v_sub_f32 v109, v109, v8
v_sub_f32 v110, v110, v8
v_sub_f32 v111, v111, v8
v_sub_f32 v112, v112, v8
v_sub_f32 v113, v113, v8
v_sub_f32 v114, v114, v8
v_sub_f32 v115, v115, v8
v_sub_f32 v116, v116, v8
v_sub_f32 v117, v117, v8
v_sub_f32 v118, v118, v8
v_sub_f32 v119, v119, v8
v_sub_f32 v120, v120, v8
v_sub_f32 v121, v121, v8
v_sub_f32 v122, v122, v8
v_sub_f32 v123, v123, v8
v_sub_f32 v124, v124, v8
v_sub_f32 v125, v125, v8
v_sub_f32 v126, v126, v8
v_sub_f32 v127, v127, v8
v_sub_f32 v128, v128, v8
v_sub_f32 v129, v129, v8
v_sub_f32 v130, v130, v8
v_sub_f32 v131, v131, v8
v_sub_f32 v132, v132, v8
v_sub_f32 v133, v133, v8
v_sub_f32 v134, v134, v8
v_sub_f32 v135, v135, v8
v_sub_f32 v136, v136, v8
v_sub_f32 v137, v137, v8
v_sub_f32 v138, v138, v8
v_sub_f32 v139, v139, v8
v_sub_f32 v140, v140, v8
v_sub_f32 v141, v141, v8
v_sub_f32 v142, v142, v8
v_sub_f32 v143, v143, v8
s_cmp_lt_u32 s13, 2
s_cselect_b32 s82, 1.0, 0
v_mul_f32 v128, s82, v128
v_mul_f32 v129, s82, v129
v_mul_f32 v130, s82, v130
v_mul_f32 v131, s82, v131
v_mul_f32 v132, s82, v132
v_mul_f32 v133, s82, v133
v_mul_f32 v134, s82, v134
v_mul_f32 v135, s82, v135
v_mul_f32 v136, s82, v136
v_mul_f32 v137, s82, v137
v_mul_f32 v138, s82, v138
v_mul_f32 v139, s82, v139
v_mul_f32 v140, s82, v140
v_mul_f32 v141, s82, v141
v_mul_f32 v142, s82, v142
v_mul_f32 v143, s82, v143
v_fmac_f32 v9, v64, v64
v_fmac_f32 v9, v65, v65
v_fmac_f32 v9, v66, v66
v_fmac_f32 v9, v67, v67
v_fmac_f32 v9, v68, v68
v_fmac_f32 v9, v69, v69
v_fmac_f32 v9, v70, v70
v_fmac_f32 v9, v71, v71
v_fmac_f32 v9, v72, v72
v_fmac_f32 v9, v73, v73
v_fmac_f32 v9, v74, v74
v_fmac_f32 v9, v75, v75
v_fmac_f32 v9, v76, v76
v_fmac_f32 v9, v77, v77
v_fmac_f32 v9, v78, v78
v_fmac_f32 v9, v79, v79
v_fmac_f32 v9, v80, v80
v_fmac_f32 v9, v81, v81
v_fmac_f32 v9, v82, v82
v_fmac_f32 v9, v83, v83
v_fmac_f32 v9, v84, v84
v_fmac_f32 v9, v85, v85
v_fmac_f32 v9, v86, v86
v_fmac_f32 v9, v87, v87
v_fmac_f32 v9, v88, v88
v_fmac_f32 v9, v89, v89
v_fmac_f32 v9, v90, v90
v_fmac_f32 v9, v91, v91
v_fmac_f32 v9, v92, v92
v_fmac_f32 v9, v93, v93
v_fmac_f32 v9, v94, v94
v_fmac_f32 v9, v95, v95
v_fmac_f32 v9, v96, v96
v_fmac_f32 v9, v97, v97
v_fmac_f32 v9, v98, v98
v_fmac_f32 v9, v99, v99
v_fmac_f32 v9, v100, v100
v_fmac_f32 v9, v101, v101
v_fmac_f32 v9, v102, v102
v_fmac_f32 v9, v103, v103
v_fmac_f32 v9, v104, v104
v_fmac_f32 v9, v105, v105
v_fmac_f32 v9, v106, v106
v_fmac_f32 v9, v107, v107
v_fmac_f32 v9, v108, v108
v_fmac_f32 v9, v109, v109
v_fmac_f32 v9, v110, v110
v_fmac_f32 v9, v111, v111
v_fmac_f32 v9, v112, v112
v_fmac_f32 v9, v113, v113
v_fmac_f32 v9, v114, v114
v_fmac_f32 v9, v115, v115
v_fmac_f32 v9, v116, v116
v_fmac_f32 v9, v117, v117
v_fmac_f32 v9, v118, v118
v_fmac_f32 v9, v119, v119
v_fmac_f32 v9, v120, v120
v_fmac_f32 v9, v121, v121
v_fmac_f32 v9, v122, v122
v_fmac_f32 v9, v123, v123
v_fmac_f32 v9, v124, v124
v_fmac_f32 v9, v125, v125
v_fmac_f32 v9, v126, v126
v_fmac_f32 v9, v127, v127
v_fmac_f32 v9, v128, v128
v_fmac_f32 v9, v129, v129
v_fmac_f32 v9, v130, v130
v_fmac_f32 v9, v131, v131
v_fmac_f32 v9, v132, v132
v_fmac_f32 v9, v133, v133
v_fmac_f32 v9, v134, v134
v_fmac_f32 v9, v135, v135
v_fmac_f32 v9, v136, v136
v_fmac_f32 v9, v137, v137
v_fmac_f32 v9, v138, v138
v_fmac_f32 v9, v139, v139
v_fmac_f32 v9, v140, v140
v_fmac_f32 v9, v141, v141
v_fmac_f32 v9, v142, v142
v_fmac_f32 v9, v143, v143
v_mov_b32 v10, v9
s_nop 1
v_permlane32_swap_b32 v9, v10
v_add_f32 v9, v9, v10
v_and_b32 v11, 0x1f0, v0
v_lshrrev_b32 v11, 2, v11
s_lshl_b32 s81, s13, 7
v_add_u32 v12, s81, v11
ds_write_b32 v12, v9 offset:512
s_waitcnt lgkmcnt(0)
s_barrier
ds_read_b32 v12, v11 offset:512
ds_read_b32 v13, v11 offset:640
ds_read_b32 v14, v11 offset:768
ds_read_b32 v15, v11 offset:896
s_waitcnt lgkmcnt(0)
v_add_f32 v12, v12, v13
v_add_f32 v14, v14, v15
v_add_f32 v9, v12, v14
v_mov_b32 v10, 0x3727c5ac
v_fmac_f32 v10, 0x3ae38e39, v9
v_rsq_f32 v9, v10
s_nop 0
v_mul_f32 v64, v9, v64
v_mul_f32 v65, v9, v65
v_cvt_pk_bf16_f32 v16, v64, v65
v_mul_f32 v66, v9, v66
v_mul_f32 v67, v9, v67
v_cvt_pk_bf16_f32 v17, v66, v67
v_mul_f32 v68, v9, v68
v_mul_f32 v69, v9, v69
v_cvt_pk_bf16_f32 v18, v68, v69
v_mul_f32 v70, v9, v70
v_mul_f32 v71, v9, v71
v_cvt_pk_bf16_f32 v19, v70, v71
v_mul_f32 v72, v9, v72
v_mul_f32 v73, v9, v73
v_cvt_pk_bf16_f32 v20, v72, v73
v_mul_f32 v74, v9, v74
v_mul_f32 v75, v9, v75
v_cvt_pk_bf16_f32 v21, v74, v75
v_mul_f32 v76, v9, v76
v_mul_f32 v77, v9, v77
v_cvt_pk_bf16_f32 v22, v76, v77
v_mul_f32 v78, v9, v78
v_mul_f32 v79, v9, v79
v_cvt_pk_bf16_f32 v23, v78, v79
v_mul_f32 v80, v9, v80
v_mul_f32 v81, v9, v81
v_cvt_pk_bf16_f32 v24, v80, v81
v_mul_f32 v82, v9, v82
v_mul_f32 v83, v9, v83
v_cvt_pk_bf16_f32 v25, v82, v83
v_mul_f32 v84, v9, v84
v_mul_f32 v85, v9, v85
v_cvt_pk_bf16_f32 v26, v84, v85
v_mul_f32 v86, v9, v86
v_mul_f32 v87, v9, v87
v_cvt_pk_bf16_f32 v27, v86, v87
v_mul_f32 v88, v9, v88
v_mul_f32 v89, v9, v89
v_cvt_pk_bf16_f32 v28, v88, v89
v_mul_f32 v90, v9, v90
v_mul_f32 v91, v9, v91
v_cvt_pk_bf16_f32 v29, v90, v91
v_mul_f32 v92, v9, v92
v_mul_f32 v93, v9, v93
v_cvt_pk_bf16_f32 v30, v92, v93
v_mul_f32 v94, v9, v94
v_mul_f32 v95, v9, v95
v_cvt_pk_bf16_f32 v31, v94, v95
v_mul_f32 v96, v9, v96
v_mul_f32 v97, v9, v97
v_cvt_pk_bf16_f32 v32, v96, v97
v_mul_f32 v98, v9, v98
v_mul_f32 v99, v9, v99
v_cvt_pk_bf16_f32 v33, v98, v99
v_mul_f32 v100, v9, v100
v_mul_f32 v101, v9, v101
v_cvt_pk_bf16_f32 v34, v100, v101
v_mul_f32 v102, v9, v102
v_mul_f32 v103, v9, v103
v_cvt_pk_bf16_f32 v35, v102, v103
v_mul_f32 v104, v9, v104
v_mul_f32 v105, v9, v105
v_cvt_pk_bf16_f32 v36, v104, v105
v_mul_f32 v106, v9, v106
v_mul_f32 v107, v9, v107
v_cvt_pk_bf16_f32 v37, v106, v107
v_mul_f32 v108, v9, v108
v_mul_f32 v109, v9, v109
v_cvt_pk_bf16_f32 v38, v108, v109
v_mul_f32 v110, v9, v110
v_mul_f32 v111, v9, v111
v_cvt_pk_bf16_f32 v39, v110, v111
v_mul_f32 v112, v9, v112
v_mul_f32 v113, v9, v113
v_cvt_pk_bf16_f32 v40, v112, v113
v_mul_f32 v114, v9, v114
v_mul_f32 v115, v9, v115
v_cvt_pk_bf16_f32 v41, v114, v115
v_mul_f32 v116, v9, v116
v_mul_f32 v117, v9, v117
v_cvt_pk_bf16_f32 v42, v116, v117
v_mul_f32 v118, v9, v118
v_mul_f32 v119, v9, v119
v_cvt_pk_bf16_f32 v43, v118, v119
v_mul_f32 v120, v9, v120
v_mul_f32 v121, v9, v121
v_cvt_pk_bf16_f32 v44, v120, v121
v_mul_f32 v122, v9, v122
v_mul_f32 v123, v9, v123
v_cvt_pk_bf16_f32 v45, v122, v123
v_mul_f32 v124, v9, v124
v_mul_f32 v125, v9, v125
v_cvt_pk_bf16_f32 v46, v124, v125
v_mul_f32 v126, v9, v126
v_mul_f32 v127, v9, v127
v_cvt_pk_bf16_f32 v47, v126, v127
v_mul_f32 v128, v9, v128
v_mul_f32 v129, v9, v129
v_cvt_pk_bf16_f32 v48, v128, v129
v_mul_f32 v130, v9, v130
v_mul_f32 v131, v9, v131
v_cvt_pk_bf16_f32 v49, v130, v131
v_mul_f32 v132, v9, v132
v_mul_f32 v133, v9, v133
v_cvt_pk_bf16_f32 v50, v132, v133
v_mul_f32 v134, v9, v134
v_mul_f32 v135, v9, v135
v_cvt_pk_bf16_f32 v51, v134, v135
v_mul_f32 v136, v9, v136
v_mul_f32 v137, v9, v137
v_cvt_pk_bf16_f32 v52, v136, v137
v_mul_f32 v138, v9, v138
v_mul_f32 v139, v9, v139
v_cvt_pk_bf16_f32 v53, v138, v139
v_mul_f32 v140, v9, v140
v_mul_f32 v141, v9, v141
v_cvt_pk_bf16_f32 v54, v140, v141
v_mul_f32 v142, v9, v142
v_mul_f32 v143, v9, v143
v_cvt_pk_bf16_f32 v55, v142, v143
s_add_u32 s80, s79, 71303168
buffer_store_dwordx4 v[16:19], v0, s[8:11], s80 offen sc1
buffer_store_dwordx4 v[20:23], v0, s[8:11], s80 offen offset:1024 sc1
s_add_u32 s80, s79, 71311360
buffer_store_dwordx4 v[24:27], v0, s[8:11], s80 offen sc1
buffer_store_dwordx4 v[28:31], v0, s[8:11], s80 offen offset:1024 sc1
s_add_u32 s80, s79, 71319552
buffer_store_dwordx4 v[32:35], v0, s[8:11], s80 offen sc1
buffer_store_dwordx4 v[36:39], v0, s[8:11], s80 offen offset:1024 sc1
s_add_u32 s80, s79, 71327744
buffer_store_dwordx4 v[40:43], v0, s[8:11], s80 offen sc1
buffer_store_dwordx4 v[44:47], v0, s[8:11], s80 offen offset:1024 sc1
s_add_u32 s80, s79, 71335936
buffer_store_dwordx4 v[48:51], v6, s[8:11], s80 offen sc1
buffer_store_dwordx4 v[52:55], v6, s[8:11], s80 offen offset:1024 sc1
s_branch K_sig
K_st1:
v_lshlrev_b32 v0, 4, v0
v_mov_b32 v4, -1
v_mov_b32 v5, -1
v_mov_b32 v6, -1
v_mov_b32 v7, -1
s_mul_i32 s76, s20, 339968
s_lshl_b32 s77, s13, 10
s_add_u32 s76, s76, s77
s_add_u32 s76, s76, 205520896
s_mov_b32 s78, 0
L_sf_7:
buffer_store_dwordx4 v[4:7], v0, s[8:11], s76 offen sc1
s_add_u32 s76, s76, 4096
s_add_u32 s78, s78, 1
s_cmp_lt_u32 s78, 83
s_cbranch_scc1 L_sf_7
s_add_u32 s76, s20, 1
s_mul_i32 s76, s76, 9216
s_lshl_b32 s77, s13, 10
s_add_u32 s76, s76, s77
s_add_u32 s76, s76, 67108864
buffer_store_dwordx4 v[4:7], v0, s[8:11], s76 offen sc1
s_add_u32 s76, s76, 4096
buffer_store_dwordx4 v[4:7], v0, s[8:11], s76 offen sc1
s_mul_i32 s76, s20, 9216
s_add_u32 s76, s76, 67126272
buffer_store_dwordx4 v[4:7], v0, s[8:11], s76 offen sc1
s_branch K_sig
K_st2:
v_lshrrev_b32 v10, 3, v0
v_and_b32 v11, 7, v0
v_bfe_u32 v12, v0, 4, 1
v_lshlrev_b32 v12, 2, v12
v_xor_b32 v11, v11, v12
s_mov_b32 s76, 8192
v_mul_lo_u32 v1, v10, s76
v_lshl_add_u32 v1, v11, 4, v1
v_lshrrev_b32 v10, 5, v0
v_bfe_u32 v11, v0, 2, 2
v_lshl_add_u32 v10, v10, 2, v11
v_lshlrev_b32 v10, 7, v10
v_bfe_u32 v12, v0, 4, 1
v_lshl_add_u32 v10, v12, 5, v10
v_and_b32 v12, 3, v0
v_lshl_add_u32 v10, v12, 3, v10
v_lshrrev_b32 v11, 1, v11
v_lshlrev_b32 v11, 6, v11
v_add_u32 v2, v10, v11
v_xor_b32 v11, 64, v11
v_add_u32 v3, v10, v11
v_add_u32 v4, 0x10000, v2
v_add_u32 v5, 0x10000, v3
v_add_u32 v6, 0x20000, v2
v_add_u32 v7, 0x20000, v3
v_lshlrev_b32 v0, 4, v0
s_cmp_eq_u32 s21, 0
s_cselect_b32 s76, s88, s86
s_cselect_b32 s77, s89, s87
s_cmp_eq_u32 s21, 1
s_cselect_b32 s76, s90, s76
s_cselect_b32 s77, s91, s77
s_mov_b32 s64, s76
s_and_b32 s65, s77, 0xffff
s_mov_b32 s66, 4718592
s_mov_b32 s67, 0x20000
s_mul_i32 s23, s22, 4
s_lshl_b32 s73, s23, 8
s_mul_i32 s76, s13, 131072
s_add_u32 s73, s73, s76
s_lshl_b32 s83, s13, 11
s_lshl_b32 s24, s20, 2
s_add_u32 s24, s24, s13
s_mul_i32 s72, s24, 36864
s_add_u32 s72, s72, 71303168
s_cmp_eq_u32 s21, 0
s_cselect_b32 s82, 0, 33554432
s_cmp_eq_u32 s21, 1
s_cselect_b32 s82, 16777216, s82
s_lshl_b32 s81, s24, 5
s_add_u32 s81, s81, s23
s_lshl_b32 s81, s81, 13
s_add_u32 s82, s82, s81
v_bfe_u32 v104, v0, 8, 1
v_lshlrev_b32 v104, 10, v104
v_lshrrev_b32 v105, 9, v0
v_lshl_add_u32 v104, v105, 8, v104
v_and_b32 v105, 0xf0, v0
v_add_u32 v104, v104, v105
s_cmp_eq_u32 s21, 1
s_cbranch_scc1 L_a2v_8
s_add_u32 m0, s83, 0
s_add_u32 s76, s73, 0
buffer_load_dwordx4 v1, s[64:67], s76 offen lds
s_add_u32 m0, s83, 1024
s_add_u32 s76, s73, 65536
buffer_load_dwordx4 v1, s[64:67], s76 offen lds
s_add_u32 m0, s83, 8192
s_add_u32 s76, s73, 128
buffer_load_dwordx4 v1, s[64:67], s76 offen lds
s_add_u32 m0, s83, 9216
s_add_u32 s76, s73, 65664
buffer_load_dwordx4 v1, s[64:67], s76 offen lds
s_add_u32 s76, s72, 0
buffer_load_dwordx4 a[0:3], v0, s[8:11], s76 offen offset:0 sc1
s_add_u32 s76, s72, 0
buffer_load_dwordx4 a[4:7], v0, s[8:11], s76 offen offset:1024 sc1
s_add_u32 s76, s72, 0
buffer_load_dwordx4 a[8:11], v0, s[8:11], s76 offen offset:2048 sc1
s_add_u32 s76, s72, 0
buffer_load_dwordx4 a[12:15], v0, s[8:11], s76 offen offset:3072 sc1
s_add_u32 m0, s83, 16384
s_add_u32 s76, s73, 524288
buffer_load_dwordx4 v1, s[64:67], s76 offen lds
s_add_u32 m0, s83, 17408
s_add_u32 s76, s73, 589824
buffer_load_dwordx4 v1, s[64:67], s76 offen lds
s_add_u32 m0, s83, 24576
s_add_u32 s76, s73, 524416
buffer_load_dwordx4 v1, s[64:67], s76 offen lds
s_add_u32 m0, s83, 25600
s_add_u32 s76, s73, 589952
buffer_load_dwordx4 v1, s[64:67], s76 offen lds
s_add_u32 s76, s72, 4096
buffer_load_dwordx4 a[16:19], v0, s[8:11], s76 offen offset:0 sc1
s_add_u32 s76, s72, 4096
buffer_load_dwordx4 a[20:23], v0, s[8:11], s76 offen offset:1024 sc1
s_add_u32 s76, s72, 4096
buffer_load_dwordx4 a[24:27], v0, s[8:11], s76 offen offset:2048 sc1
s_add_u32 s76, s72, 4096
buffer_load_dwordx4 a[28:31], v0, s[8:11], s76 offen offset:3072 sc1
s_add_u32 m0, s83, 32768
s_add_u32 s76, s73, 1048576
buffer_load_dwordx4 v1, s[64:67], s76 offen lds
s_add_u32 m0, s83, 33792
s_add_u32 s76, s73, 1114112
buffer_load_dwordx4 v1, s[64:67], s76 offen lds
s_add_u32 m0, s83, 40960
s_add_u32 s76, s73, 1048704
buffer_load_dwordx4 v1, s[64:67], s76 offen lds
s_add_u32 m0, s83, 41984
s_add_u32 s76, s73, 1114240
buffer_load_dwordx4 v1, s[64:67], s76 offen lds
s_add_u32 s76, s72, 8192
buffer_load_dwordx4 a[32:35], v0, s[8:11], s76 offen offset:0 sc1
s_add_u32 s76, s72, 8192
buffer_load_dwordx4 a[36:39], v0, s[8:11], s76 offen offset:1024 sc1
s_add_u32 s76, s72, 8192
buffer_load_dwordx4 a[40:43], v0, s[8:11], s76 offen offset:2048 sc1
s_add_u32 s76, s72, 8192
buffer_load_dwordx4 a[44:47], v0, s[8:11], s76 offen offset:3072 sc1
s_add_u32 m0, s83, 49152
s_add_u32 s76, s73, 1572864
buffer_load_dwordx4 v1, s[64:67], s76 offen lds
s_add_u32 m0, s83, 50176
s_add_u32 s76, s73, 1638400
buffer_load_dwordx4 v1, s[64:67], s76 offen lds
s_add_u32 m0, s83, 57344
s_add_u32 s76, s73, 1572992
buffer_load_dwordx4 v1, s[64:67], s76 offen lds
s_add_u32 m0, s83, 58368
s_add_u32 s76, s73, 1638528
buffer_load_dwordx4 v1, s[64:67], s76 offen lds
s_add_u32 s76, s72, 12288
buffer_load_dwordx4 a[48:51], v0, s[8:11], s76 offen offset:0 sc1
s_add_u32 s76, s72, 12288
buffer_load_dwordx4 a[52:55], v0, s[8:11], s76 offen offset:1024 sc1
s_add_u32 s76, s72, 12288
buffer_load_dwordx4 a[56:59], v0, s[8:11], s76 offen offset:2048 sc1
s_add_u32 s76, s72, 12288
buffer_load_dwordx4 a[60:63], v0, s[8:11], s76 offen offset:3072 sc1
s_waitcnt vmcnt(24)
s_barrier
ds_read_b64_tr_b16 v[8:9], v2 offset:0
ds_read_b64_tr_b16 v[10:11], v2 offset:2048
ds_read_b64_tr_b16 v[12:13], v3 offset:0
ds_read_b64_tr_b16 v[14:15], v3 offset:2048
ds_read_b64_tr_b16 v[16:17], v2 offset:8192
ds_read_b64_tr_b16 v[18:19], v2 offset:10240
ds_read_b64_tr_b16 v[20:21], v3 offset:8192
ds_read_b64_tr_b16 v[22:23], v3 offset:10240
s_waitcnt lgkmcnt(6)
v_mfma_f32_32x32x16_bf16 v[40:55], v[8:11], a[0:3], 0
ds_read_b64_tr_b16 v[24:25], v2 offset:1024
ds_read_b64_tr_b16 v[26:27], v2 offset:3072
s_waitcnt lgkmcnt(6)
v_mfma_f32_32x32x16_bf16 v[56:71], v[12:15], a[0:3], 0
ds_read_b64_tr_b16 v[28:29], v3 offset:1024
ds_read_b64_tr_b16 v[30:31], v3 offset:3072
s_waitcnt lgkmcnt(6)
v_mfma_f32_32x32x16_bf16 v[72:87], v[16:19], a[0:3], 0
ds_read_b64_tr_b16 v[32:33], v2 offset:9216
ds_read_b64_tr_b16 v[34:35], v2 offset:11264
s_waitcnt lgkmcnt(6)
v_mfma_f32_32x32x16_bf16 v[88:103], v[20:23], a[0:3], 0
ds_read_b64_tr_b16 v[36:37], v3 offset:9216
ds_read_b64_tr_b16 v[38:39], v3 offset:11264
s_waitcnt lgkmcnt(6)
v_mfma_f32_32x32x16_bf16 v[40:55], v[24:27], a[4:7], v[40:55]
ds_read_b64_tr_b16 v[8:9], v2 offset:4096
ds_read_b64_tr_b16 v[10:11], v2 offset:6144
s_waitcnt lgkmcnt(6)
v_mfma_f32_32x32x16_bf16 v[56:71], v[28:31], a[4:7], v[56:71]
ds_read_b64_tr_b16 v[12:13], v3 offset:4096
ds_read_b64_tr_b16 v[14:15], v3 offset:6144
s_waitcnt lgkmcnt(6)
v_mfma_f32_32x32x16_bf16 v[72:87], v[32:35], a[4:7], v[72:87]
ds_read_b64_tr_b16 v[16:17], v2 offset:12288
ds_read_b64_tr_b16 v[18:19], v2 offset:14336
s_waitcnt lgkmcnt(6)
v_mfma_f32_32x32x16_bf16 v[88:103], v[36:39], a[4:7], v[88:103]
ds_read_b64_tr_b16 v[20:21], v3 offset:12288
ds_read_b64_tr_b16 v[22:23], v3 offset:14336
s_waitcnt lgkmcnt(6)
v_mfma_f32_32x32x16_bf16 v[40:55], v[8:11], a[8:11], v[40:55]
ds_read_b64_tr_b16 v[24:25], v2 offset:5120
ds_read_b64_tr_b16 v[26:27], v2 offset:7168
s_waitcnt lgkmcnt(6)
v_mfma_f32_32x32x16_bf16 v[56:71], v[12:15], a[8:11], v[56:71]
ds_read_b64_tr_b16 v[28:29], v3 offset:5120
ds_read_b64_tr_b16 v[30:31], v3 offset:7168
s_waitcnt lgkmcnt(6)
v_mfma_f32_32x32x16_bf16 v[72:87], v[16:19], a[8:11], v[72:87]
ds_read_b64_tr_b16 v[32:33], v2 offset:13312
ds_read_b64_tr_b16 v[34:35], v2 offset:15360
s_waitcnt lgkmcnt(6)
v_mfma_f32_32x32x16_bf16 v[88:103], v[20:23], a[8:11], v[88:103]
ds_read_b64_tr_b16 v[36:37], v3 offset:13312
ds_read_b64_tr_b16 v[38:39], v3 offset:15360
s_waitcnt vmcnt(20)
s_waitcnt vmcnt(16)
s_barrier
s_waitcnt lgkmcnt(6)
v_mfma_f32_32x32x16_bf16 v[40:55], v[24:27], a[12:15], v[40:55]
ds_read_b64_tr_b16 v[8:9], v2 offset:16384
ds_read_b64_tr_b16 v[10:11], v2 offset:18432
s_waitcnt lgkmcnt(6)
v_mfma_f32_32x32x16_bf16 v[56:71], v[28:31], a[12:15], v[56:71]
ds_read_b64_tr_b16 v[12:13], v3 offset:16384
ds_read_b64_tr_b16 v[14:15], v3 offset:18432
s_waitcnt lgkmcnt(6)
v_mfma_f32_32x32x16_bf16 v[72:87], v[32:35], a[12:15], v[72:87]
ds_read_b64_tr_b16 v[16:17], v2 offset:24576
ds_read_b64_tr_b16 v[18:19], v2 offset:26624
s_waitcnt lgkmcnt(6)
v_mfma_f32_32x32x16_bf16 v[88:103], v[36:39], a[12:15], v[88:103]
ds_read_b64_tr_b16 v[20:21], v3 offset:24576
ds_read_b64_tr_b16 v[22:23], v3 offset:26624
s_waitcnt lgkmcnt(6)
v_mfma_f32_32x32x16_bf16 v[40:55], v[8:11], a[16:19], v[40:55]
ds_read_b64_tr_b16 v[24:25], v2 offset:17408
ds_read_b64_tr_b16 v[26:27], v2 offset:19456
s_waitcnt lgkmcnt(6)
v_mfma_f32_32x32x16_bf16 v[56:71], v[12:15], a[16:19], v[56:71]
ds_read_b64_tr_b16 v[28:29], v3 offset:17408
ds_read_b64_tr_b16 v[30:31], v3 offset:19456
s_add_u32 s76, s72, 16384
buffer_load_dwordx4 a[64:67], v0, s[8:11], s76 offen offset:0 sc1
s_waitcnt lgkmcnt(6)
v_mfma_f32_32x32x16_bf16 v[72:87], v[16:19], a[16:19], v[72:87]
ds_read_b64_tr_b16 v[32:33], v2 offset:25600
ds_read_b64_tr_b16 v[34:35], v2 offset:27648
s_waitcnt lgkmcnt(6)
v_mfma_f32_32x32x16_bf16 v[88:103], v[20:23], a[16:19], v[88:103]
ds_read_b64_tr_b16 v[36:37], v3 offset:25600
ds_read_b64_tr_b16 v[38:39], v3 offset:27648
s_add_u32 s76, s72, 16384
buffer_load_dwordx4 a[68:71], v0, s[8:11], s76 offen offset:1024 sc1
s_waitcnt lgkmcnt(6)
v_mfma_f32_32x32x16_bf16 v[40:55], v[24:27], a[20:23], v[40:55]
ds_read_b64_tr_b16 v[8:9], v2 offset:20480
ds_read_b64_tr_b16 v[10:11], v2 offset:22528
s_waitcnt lgkmcnt(6)
v_mfma_f32_32x32x16_bf16 v[56:71], v[28:31], a[20:23], v[56:71]
ds_read_b64_tr_b16 v[12:13], v3 offset:20480
ds_read_b64_tr_b16 v[14:15], v3 offset:22528
s_add_u32 s76, s72, 16384
buffer_load_dwordx4 a[72:75], v0, s[8:11], s76 offen offset:2048 sc1
s_waitcnt lgkmcnt(6)
v_mfma_f32_32x32x16_bf16 v[72:87], v[32:35], a[20:23], v[72:87]
ds_read_b64_tr_b16 v[16:17], v2 offset:28672
ds_read_b64_tr_b16 v[18:19], v2 offset:30720
s_waitcnt lgkmcnt(6)
v_mfma_f32_32x32x16_bf16 v[88:103], v[36:39], a[20:23], v[88:103]
ds_read_b64_tr_b16 v[20:21], v3 offset:28672
ds_read_b64_tr_b16 v[22:23], v3 offset:30720
s_add_u32 s76, s72, 16384
buffer_load_dwordx4 a[76:79], v0, s[8:11], s76 offen offset:3072 sc1
s_waitcnt lgkmcnt(6)
v_mfma_f32_32x32x16_bf16 v[40:55], v[8:11], a[24:27], v[40:55]
ds_read_b64_tr_b16 v[24:25], v2 offset:21504
ds_read_b64_tr_b16 v[26:27], v2 offset:23552
s_waitcnt lgkmcnt(6)
v_mfma_f32_32x32x16_bf16 v[56:71], v[12:15], a[24:27], v[56:71]
ds_read_b64_tr_b16 v[28:29], v3 offset:21504
ds_read_b64_tr_b16 v[30:31], v3 offset:23552
s_add_u32 s76, s72, 20480
buffer_load_dwordx4 a[80:83], v0, s[8:11], s76 offen offset:0 sc1
s_waitcnt lgkmcnt(6)
v_mfma_f32_32x32x16_bf16 v[72:87], v[16:19], a[24:27], v[72:87]
ds_read_b64_tr_b16 v[32:33], v2 offset:29696
ds_read_b64_tr_b16 v[34:35], v2 offset:31744
s_waitcnt lgkmcnt(6)
v_mfma_f32_32x32x16_bf16 v[88:103], v[20:23], a[24:27], v[88:103]
ds_read_b64_tr_b16 v[36:37], v3 offset:29696
ds_read_b64_tr_b16 v[38:39], v3 offset:31744
s_add_u32 s76, s72, 20480
buffer_load_dwordx4 a[84:87], v0, s[8:11], s76 offen offset:1024 sc1
s_waitcnt vmcnt(18)
s_waitcnt vmcnt(14)
s_barrier
s_waitcnt lgkmcnt(6)
v_mfma_f32_32x32x16_bf16 v[40:55], v[24:27], a[28:31], v[40:55]
ds_read_b64_tr_b16 v[8:9], v2 offset:32768
ds_read_b64_tr_b16 v[10:11], v2 offset:34816
s_waitcnt lgkmcnt(6)
v_mfma_f32_32x32x16_bf16 v[56:71], v[28:31], a[28:31], v[56:71]
ds_read_b64_tr_b16 v[12:13], v3 offset:32768
ds_read_b64_tr_b16 v[14:15], v3 offset:34816
s_add_u32 s76, s72, 20480
buffer_load_dwordx4 a[88:91], v0, s[8:11], s76 offen offset:2048 sc1
s_waitcnt lgkmcnt(6)
v_mfma_f32_32x32x16_bf16 v[72:87], v[32:35], a[28:31], v[72:87]
ds_read_b64_tr_b16 v[16:17], v2 offset:40960
ds_read_b64_tr_b16 v[18:19], v2 offset:43008
s_waitcnt lgkmcnt(6)
v_mfma_f32_32x32x16_bf16 v[88:103], v[36:39], a[28:31], v[88:103]
ds_read_b64_tr_b16 v[20:21], v3 offset:40960
ds_read_b64_tr_b16 v[22:23], v3 offset:43008
s_add_u32 s76, s72, 20480
buffer_load_dwordx4 a[92:95], v0, s[8:11], s76 offen offset:3072 sc1
s_waitcnt lgkmcnt(6)
v_mfma_f32_32x32x16_bf16 v[40:55], v[8:11], a[32:35], v[40:55]
ds_read_b64_tr_b16 v[24:25], v2 offset:33792
ds_read_b64_tr_b16 v[26:27], v2 offset:35840
s_waitcnt lgkmcnt(6)
v_mfma_f32_32x32x16_bf16 v[56:71], v[12:15], a[32:35], v[56:71]
ds_read_b64_tr_b16 v[28:29], v3 offset:33792
ds_read_b64_tr_b16 v[30:31], v3 offset:35840
s_add_u32 m0, s83, 65536
s_add_u32 s76, s73, 2097152
buffer_load_dwordx4 v1, s[64:67], s76 offen lds
s_waitcnt lgkmcnt(6)
v_mfma_f32_32x32x16_bf16 v[72:87], v[16:19], a[32:35], v[72:87]
ds_read_b64_tr_b16 v[32:33], v2 offset:41984
ds_read_b64_tr_b16 v[34:35], v2 offset:44032
s_waitcnt lgkmcnt(6)
v_mfma_f32_32x32x16_bf16 v[88:103], v[20:23], a[32:35], v[88:103]
ds_read_b64_tr_b16 v[36:37], v3 offset:41984
ds_read_b64_tr_b16 v[38:39], v3 offset:44032
s_add_u32 m0, s83, 66560
s_add_u32 s76, s73, 2162688
buffer_load_dwordx4 v1, s[64:67], s76 offen lds
s_waitcnt lgkmcnt(6)
v_mfma_f32_32x32x16_bf16 v[40:55], v[24:27], a[36:39], v[40:55]
ds_read_b64_tr_b16 v[8:9], v2 offset:36864
ds_read_b64_tr_b16 v[10:11], v2 offset:38912
s_waitcnt lgkmcnt(6)
v_mfma_f32_32x32x16_bf16 v[56:71], v[28:31], a[36:39], v[56:71]
ds_read_b64_tr_b16 v[12:13], v3 offset:36864
ds_read_b64_tr_b16 v[14:15], v3 offset:38912
s_add_u32 m0, s83, 73728
s_add_u32 s76, s73, 2097280
buffer_load_dwordx4 v1, s[64:67], s76 offen lds
s_waitcnt lgkmcnt(6)
v_mfma_f32_32x32x16_bf16 v[72:87], v[32:35], a[36:39], v[72:87]
ds_read_b64_tr_b16 v[16:17], v2 offset:45056
ds_read_b64_tr_b16 v[18:19], v2 offset:47104
s_waitcnt lgkmcnt(6)
v_mfma_f32_32x32x16_bf16 v[88:103], v[36:39], a[36:39], v[88:103]
ds_read_b64_tr_b16 v[20:21], v3 offset:45056
ds_read_b64_tr_b16 v[22:23], v3 offset:47104
s_add_u32 m0, s83, 74752
s_add_u32 s76, s73, 2162816
buffer_load_dwordx4 v1, s[64:67], s76 offen lds
s_waitcnt lgkmcnt(6)
v_mfma_f32_32x32x16_bf16 v[40:55], v[8:11], a[40:43], v[40:55]
ds_read_b64_tr_b16 v[24:25], v2 offset:37888
ds_read_b64_tr_b16 v[26:27], v2 offset:39936
s_waitcnt lgkmcnt(6)
v_mfma_f32_32x32x16_bf16 v[56:71], v[12:15], a[40:43], v[56:71]
ds_read_b64_tr_b16 v[28:29], v3 offset:37888
ds_read_b64_tr_b16 v[30:31], v3 offset:39936
s_add_u32 m0, s83, 81920
s_add_u32 s76, s73, 2621440
buffer_load_dwordx4 v1, s[64:67], s76 offen lds
s_waitcnt lgkmcnt(6)
v_mfma_f32_32x32x16_bf16 v[72:87], v[16:19], a[40:43], v[72:87]
ds_read_b64_tr_b16 v[32:33], v2 offset:46080
ds_read_b64_tr_b16 v[34:35], v2 offset:48128
s_waitcnt lgkmcnt(6)
v_mfma_f32_32x32x16_bf16 v[88:103], v[20:23], a[40:43], v[88:103]
ds_read_b64_tr_b16 v[36:37], v3 offset:46080
ds_read_b64_tr_b16 v[38:39], v3 offset:48128
s_add_u32 m0, s83, 82944
s_add_u32 s76, s73, 2686976
buffer_load_dwordx4 v1, s[64:67], s76 offen lds
s_waitcnt vmcnt(18)
s_waitcnt vmcnt(14)
s_barrier
s_waitcnt lgkmcnt(6)
v_mfma_f32_32x32x16_bf16 v[40:55], v[24:27], a[44:47], v[40:55]
ds_read_b64_tr_b16 v[8:9], v2 offset:49152
ds_read_b64_tr_b16 v[10:11], v2 offset:51200
s_waitcnt lgkmcnt(6)
v_mfma_f32_32x32x16_bf16 v[56:71], v[28:31], a[44:47], v[56:71]
ds_read_b64_tr_b16 v[12:13], v3 offset:49152
ds_read_b64_tr_b16 v[14:15], v3 offset:51200
s_add_u32 m0, s83, 90112
s_add_u32 s76, s73, 2621568
buffer_load_dwordx4 v1, s[64:67], s76 offen lds
s_waitcnt lgkmcnt(6)
v_mfma_f32_32x32x16_bf16 v[72:87], v[32:35], a[44:47], v[72:87]
ds_read_b64_tr_b16 v[16:17], v2 offset:57344
ds_read_b64_tr_b16 v[18:19], v2 offset:59392
s_waitcnt lgkmcnt(6)
v_mfma_f32_32x32x16_bf16 v[88:103], v[36:39], a[44:47], v[88:103]
ds_read_b64_tr_b16 v[20:21], v3 offset:57344
ds_read_b64_tr_b16 v[22:23], v3 offset:59392
s_add_u32 m0, s83, 91136
s_add_u32 s76, s73, 2687104
buffer_load_dwordx4 v1, s[64:67], s76 offen lds
s_waitcnt lgkmcnt(6)
v_mfma_f32_32x32x16_bf16 v[40:55], v[8:11], a[48:51], v[40:55]
ds_read_b64_tr_b16 v[24:25], v2 offset:50176
ds_read_b64_tr_b16 v[26:27], v2 offset:52224
s_waitcnt lgkmcnt(6)
v_mfma_f32_32x32x16_bf16 v[56:71], v[12:15], a[48:51], v[56:71]
ds_read_b64_tr_b16 v[28:29], v3 offset:50176
ds_read_b64_tr_b16 v[30:31], v3 offset:52224
s_add_u32 s76, s72, 24576
buffer_load_dwordx4 a[96:99], v0, s[8:11], s76 offen offset:0 sc1
s_waitcnt lgkmcnt(6)
v_mfma_f32_32x32x16_bf16 v[72:87], v[16:19], a[48:51], v[72:87]
ds_read_b64_tr_b16 v[32:33], v2 offset:58368
ds_read_b64_tr_b16 v[34:35], v2 offset:60416
s_waitcnt lgkmcnt(6)
v_mfma_f32_32x32x16_bf16 v[88:103], v[20:23], a[48:51], v[88:103]
ds_read_b64_tr_b16 v[36:37], v3 offset:58368
ds_read_b64_tr_b16 v[38:39], v3 offset:60416
s_add_u32 s76, s72, 24576
buffer_load_dwordx4 a[100:103], v0, s[8:11], s76 offen offset:1024 sc1
s_waitcnt lgkmcnt(6)
v_mfma_f32_32x32x16_bf16 v[40:55], v[24:27], a[52:55], v[40:55]
ds_read_b64_tr_b16 v[8:9], v2 offset:53248
ds_read_b64_tr_b16 v[10:11], v2 offset:55296
s_waitcnt lgkmcnt(6)
v_mfma_f32_32x32x16_bf16 v[56:71], v[28:31], a[52:55], v[56:71]
ds_read_b64_tr_b16 v[12:13], v3 offset:53248
ds_read_b64_tr_b16 v[14:15], v3 offset:55296
s_add_u32 s76, s72, 24576
buffer_load_dwordx4 a[104:107], v0, s[8:11], s76 offen offset:2048 sc1
s_waitcnt lgkmcnt(6)
v_mfma_f32_32x32x16_bf16 v[72:87], v[32:35], a[52:55], v[72:87]
ds_read_b64_tr_b16 v[16:17], v2 offset:61440
ds_read_b64_tr_b16 v[18:19], v2 offset:63488
s_waitcnt lgkmcnt(6)
v_mfma_f32_32x32x16_bf16 v[88:103], v[36:39], a[52:55], v[88:103]
ds_read_b64_tr_b16 v[20:21], v3 offset:61440
ds_read_b64_tr_b16 v[22:23], v3 offset:63488
s_add_u32 s76, s72, 24576
buffer_load_dwordx4 a[108:111], v0, s[8:11], s76 offen offset:3072 sc1
s_waitcnt lgkmcnt(6)
v_mfma_f32_32x32x16_bf16 v[40:55], v[8:11], a[56:59], v[40:55]
ds_read_b64_tr_b16 v[24:25], v2 offset:54272
ds_read_b64_tr_b16 v[26:27], v2 offset:56320
s_waitcnt lgkmcnt(6)
v_mfma_f32_32x32x16_bf16 v[56:71], v[12:15], a[56:59], v[56:71]
ds_read_b64_tr_b16 v[28:29], v3 offset:54272
ds_read_b64_tr_b16 v[30:31], v3 offset:56320
s_add_u32 s76, s72, 28672
buffer_load_dwordx4 a[112:115], v0, s[8:11], s76 offen offset:0 sc1
s_waitcnt lgkmcnt(6)
v_mfma_f32_32x32x16_bf16 v[72:87], v[16:19], a[56:59], v[72:87]
ds_read_b64_tr_b16 v[32:33], v2 offset:62464
ds_read_b64_tr_b16 v[34:35], v2 offset:64512
s_waitcnt lgkmcnt(6)
v_mfma_f32_32x32x16_bf16 v[88:103], v[20:23], a[56:59], v[88:103]
ds_read_b64_tr_b16 v[36:37], v3 offset:62464
ds_read_b64_tr_b16 v[38:39], v3 offset:64512
s_add_u32 s76, s72, 28672
buffer_load_dwordx4 a[116:119], v0, s[8:11], s76 offen offset:1024 sc1
s_waitcnt vmcnt(10)
s_barrier
s_waitcnt lgkmcnt(6)
v_mfma_f32_32x32x16_bf16 v[40:55], v[24:27], a[60:63], v[40:55]
ds_read_b64_tr_b16 v[8:9], v4 offset:0
ds_read_b64_tr_b16 v[10:11], v4 offset:2048
s_waitcnt lgkmcnt(6)
v_mfma_f32_32x32x16_bf16 v[56:71], v[28:31], a[60:63], v[56:71]
ds_read_b64_tr_b16 v[12:13], v5 offset:0
ds_read_b64_tr_b16 v[14:15], v5 offset:2048
s_add_u32 s76, s72, 28672
buffer_load_dwordx4 a[120:123], v0, s[8:11], s76 offen offset:2048 sc1
s_waitcnt lgkmcnt(6)
v_mfma_f32_32x32x16_bf16 v[72:87], v[32:35], a[60:63], v[72:87]
ds_read_b64_tr_b16 v[16:17], v4 offset:8192
ds_read_b64_tr_b16 v[18:19], v4 offset:10240
s_waitcnt lgkmcnt(6)
v_mfma_f32_32x32x16_bf16 v[88:103], v[36:39], a[60:63], v[88:103]
ds_read_b64_tr_b16 v[20:21], v5 offset:8192
ds_read_b64_tr_b16 v[22:23], v5 offset:10240
s_add_u32 s76, s72, 28672
buffer_load_dwordx4 a[124:127], v0, s[8:11], s76 offen offset:3072 sc1
s_waitcnt lgkmcnt(6)
v_mfma_f32_32x32x16_bf16 v[40:55], v[8:11], a[64:67], v[40:55]
ds_read_b64_tr_b16 v[24:25], v4 offset:1024
ds_read_b64_tr_b16 v[26:27], v4 offset:3072
s_waitcnt lgkmcnt(6)
v_mfma_f32_32x32x16_bf16 v[56:71], v[12:15], a[64:67], v[56:71]
ds_read_b64_tr_b16 v[28:29], v5 offset:1024
ds_read_b64_tr_b16 v[30:31], v5 offset:3072
s_add_u32 m0, s83, 98304
s_add_u32 s76, s73, 3145728
buffer_load_dwordx4 v1, s[64:67], s76 offen lds
s_waitcnt lgkmcnt(6)
v_mfma_f32_32x32x16_bf16 v[72:87], v[16:19], a[64:67], v[72:87]
ds_read_b64_tr_b16 v[32:33], v4 offset:9216
ds_read_b64_tr_b16 v[34:35], v4 offset:11264
s_waitcnt lgkmcnt(6)
v_mfma_f32_32x32x16_bf16 v[88:103], v[20:23], a[64:67], v[88:103]
ds_read_b64_tr_b16 v[36:37], v5 offset:9216
ds_read_b64_tr_b16 v[38:39], v5 offset:11264
s_add_u32 m0, s83, 99328
s_add_u32 s76, s73, 3211264
buffer_load_dwordx4 v1, s[64:67], s76 offen lds
s_waitcnt lgkmcnt(6)
v_mfma_f32_32x32x16_bf16 v[40:55], v[24:27], a[68:71], v[40:55]
ds_read_b64_tr_b16 v[8:9], v4 offset:4096
ds_read_b64_tr_b16 v[10:11], v4 offset:6144
s_waitcnt lgkmcnt(6)
v_mfma_f32_32x32x16_bf16 v[56:71], v[28:31], a[68:71], v[56:71]
ds_read_b64_tr_b16 v[12:13], v5 offset:4096
ds_read_b64_tr_b16 v[14:15], v5 offset:6144
s_add_u32 m0, s83, 106496
s_add_u32 s76, s73, 3145856
buffer_load_dwordx4 v1, s[64:67], s76 offen lds
s_waitcnt lgkmcnt(6)
v_mfma_f32_32x32x16_bf16 v[72:87], v[32:35], a[68:71], v[72:87]
ds_read_b64_tr_b16 v[16:17], v4 offset:12288
ds_read_b64_tr_b16 v[18:19], v4 offset:14336
s_waitcnt lgkmcnt(6)
v_mfma_f32_32x32x16_bf16 v[88:103], v[36:39], a[68:71], v[88:103]
ds_read_b64_tr_b16 v[20:21], v5 offset:12288
ds_read_b64_tr_b16 v[22:23], v5 offset:14336
s_add_u32 m0, s83, 107520
s_add_u32 s76, s73, 3211392
buffer_load_dwordx4 v1, s[64:67], s76 offen lds
s_waitcnt lgkmcnt(6)
v_mfma_f32_32x32x16_bf16 v[40:55], v[8:11], a[72:75], v[40:55]
ds_read_b64_tr_b16 v[24:25], v4 offset:5120
ds_read_b64_tr_b16 v[26:27], v4 offset:7168
s_waitcnt lgkmcnt(6)
v_mfma_f32_32x32x16_bf16 v[56:71], v[12:15], a[72:75], v[56:71]
ds_read_b64_tr_b16 v[28:29], v5 offset:5120
ds_read_b64_tr_b16 v[30:31], v5 offset:7168
s_add_u32 m0, s83, 114688
s_add_u32 s76, s73, 3670016
buffer_load_dwordx4 v1, s[64:67], s76 offen lds
s_waitcnt lgkmcnt(6)
v_mfma_f32_32x32x16_bf16 v[72:87], v[16:19], a[72:75], v[72:87]
ds_read_b64_tr_b16 v[32:33], v4 offset:13312
ds_read_b64_tr_b16 v[34:35], v4 offset:15360
s_waitcnt lgkmcnt(6)
v_mfma_f32_32x32x16_bf16 v[88:103], v[20:23], a[72:75], v[88:103]
ds_read_b64_tr_b16 v[36:37], v5 offset:13312
ds_read_b64_tr_b16 v[38:39], v5 offset:15360
s_add_u32 m0, s83, 115712
s_add_u32 s76, s73, 3735552
buffer_load_dwordx4 v1, s[64:67], s76 offen lds
s_waitcnt vmcnt(14)
s_barrier
s_waitcnt lgkmcnt(6)
v_mfma_f32_32x32x16_bf16 v[40:55], v[24:27], a[76:79], v[40:55]
ds_read_b64_tr_b16 v[8:9], v4 offset:16384
ds_read_b64_tr_b16 v[10:11], v4 offset:18432
s_waitcnt lgkmcnt(6)
v_mfma_f32_32x32x16_bf16 v[56:71], v[28:31], a[76:79], v[56:71]
ds_read_b64_tr_b16 v[12:13], v5 offset:16384
ds_read_b64_tr_b16 v[14:15], v5 offset:18432
s_add_u32 m0, s83, 122880
s_add_u32 s76, s73, 3670144
buffer_load_dwordx4 v1, s[64:67], s76 offen lds
s_waitcnt lgkmcnt(6)
v_mfma_f32_32x32x16_bf16 v[72:87], v[32:35], a[76:79], v[72:87]
ds_read_b64_tr_b16 v[16:17], v4 offset:24576
ds_read_b64_tr_b16 v[18:19], v4 offset:26624
s_waitcnt lgkmcnt(6)
v_mfma_f32_32x32x16_bf16 v[88:103], v[36:39], a[76:79], v[88:103]
ds_read_b64_tr_b16 v[20:21], v5 offset:24576
ds_read_b64_tr_b16 v[22:23], v5 offset:26624
s_add_u32 m0, s83, 123904
s_add_u32 s76, s73, 3735680
buffer_load_dwordx4 v1, s[64:67], s76 offen lds
s_waitcnt lgkmcnt(6)
v_mfma_f32_32x32x16_bf16 v[40:55], v[8:11], a[80:83], v[40:55]
ds_read_b64_tr_b16 v[24:25], v4 offset:17408
ds_read_b64_tr_b16 v[26:27], v4 offset:19456
s_waitcnt lgkmcnt(6)
v_mfma_f32_32x32x16_bf16 v[56:71], v[12:15], a[80:83], v[56:71]
ds_read_b64_tr_b16 v[28:29], v5 offset:17408
ds_read_b64_tr_b16 v[30:31], v5 offset:19456
s_add_u32 s76, s72, 32768
buffer_load_dwordx4 a[128:131], v0, s[8:11], s76 offen offset:0 sc1
s_waitcnt lgkmcnt(6)
v_mfma_f32_32x32x16_bf16 v[72:87], v[16:19], a[80:83], v[72:87]
ds_read_b64_tr_b16 v[32:33], v4 offset:25600
ds_read_b64_tr_b16 v[34:35], v4 offset:27648
s_waitcnt lgkmcnt(6)
v_mfma_f32_32x32x16_bf16 v[88:103], v[20:23], a[80:83], v[88:103]
ds_read_b64_tr_b16 v[36:37], v5 offset:25600
ds_read_b64_tr_b16 v[38:39], v5 offset:27648
s_add_u32 s76, s72, 32768
buffer_load_dwordx4 a[132:135], v0, s[8:11], s76 offen offset:1024 sc1
s_waitcnt lgkmcnt(6)
v_mfma_f32_32x32x16_bf16 v[40:55], v[24:27], a[84:87], v[40:55]
ds_read_b64_tr_b16 v[8:9], v4 offset:20480
ds_read_b64_tr_b16 v[10:11], v4 offset:22528
s_waitcnt lgkmcnt(6)
v_mfma_f32_32x32x16_bf16 v[56:71], v[28:31], a[84:87], v[56:71]
ds_read_b64_tr_b16 v[12:13], v5 offset:20480
ds_read_b64_tr_b16 v[14:15], v5 offset:22528
s_add_u32 s76, s72, 32768
buffer_load_dwordx4 a[136:139], v0, s[8:11], s76 offen offset:2048 sc1
s_waitcnt lgkmcnt(6)
v_mfma_f32_32x32x16_bf16 v[72:87], v[32:35], a[84:87], v[72:87]
ds_read_b64_tr_b16 v[16:17], v4 offset:28672
ds_read_b64_tr_b16 v[18:19], v4 offset:30720
s_waitcnt lgkmcnt(6)
v_mfma_f32_32x32x16_bf16 v[88:103], v[36:39], a[84:87], v[88:103]
ds_read_b64_tr_b16 v[20:21], v5 offset:28672
ds_read_b64_tr_b16 v[22:23], v5 offset:30720
s_add_u32 s76, s72, 32768
buffer_load_dwordx4 a[140:143], v0, s[8:11], s76 offen offset:3072 sc1
s_waitcnt lgkmcnt(6)
v_mfma_f32_32x32x16_bf16 v[40:55], v[8:11], a[88:91], v[40:55]
ds_read_b64_tr_b16 v[24:25], v4 offset:21504
ds_read_b64_tr_b16 v[26:27], v4 offset:23552
s_waitcnt lgkmcnt(6)
v_mfma_f32_32x32x16_bf16 v[56:71], v[12:15], a[88:91], v[56:71]
ds_read_b64_tr_b16 v[28:29], v5 offset:21504
ds_read_b64_tr_b16 v[30:31], v5 offset:23552
s_add_u32 m0, s83, 131072
s_add_u32 s76, s73, 4194304
buffer_load_dwordx4 v1, s[64:67], s76 offen lds
s_waitcnt lgkmcnt(6)
v_mfma_f32_32x32x16_bf16 v[72:87], v[16:19], a[88:91], v[72:87]
ds_read_b64_tr_b16 v[32:33], v4 offset:29696
ds_read_b64_tr_b16 v[34:35], v4 offset:31744
s_waitcnt lgkmcnt(6)
v_mfma_f32_32x32x16_bf16 v[88:103], v[20:23], a[88:91], v[88:103]
ds_read_b64_tr_b16 v[36:37], v5 offset:29696
ds_read_b64_tr_b16 v[38:39], v5 offset:31744
s_add_u32 m0, s83, 132096
s_add_u32 s76, s73, 4259840
buffer_load_dwordx4 v1, s[64:67], s76 offen lds
s_waitcnt vmcnt(10)
s_barrier
s_waitcnt lgkmcnt(6)
v_mfma_f32_32x32x16_bf16 v[40:55], v[24:27], a[92:95], v[40:55]
ds_read_b64_tr_b16 v[8:9], v4 offset:32768
ds_read_b64_tr_b16 v[10:11], v4 offset:34816
s_waitcnt lgkmcnt(6)
v_mfma_f32_32x32x16_bf16 v[56:71], v[28:31], a[92:95], v[56:71]
ds_read_b64_tr_b16 v[12:13], v5 offset:32768
ds_read_b64_tr_b16 v[14:15], v5 offset:34816
s_add_u32 m0, s83, 139264
s_add_u32 s76, s73, 4194432
buffer_load_dwordx4 v1, s[64:67], s76 offen lds
s_waitcnt lgkmcnt(6)
v_mfma_f32_32x32x16_bf16 v[72:87], v[32:35], a[92:95], v[72:87]
ds_read_b64_tr_b16 v[16:17], v4 offset:40960
ds_read_b64_tr_b16 v[18:19], v4 offset:43008
s_waitcnt lgkmcnt(6)
v_mfma_f32_32x32x16_bf16 v[88:103], v[36:39], a[92:95], v[88:103]
ds_read_b64_tr_b16 v[20:21], v5 offset:40960
ds_read_b64_tr_b16 v[22:23], v5 offset:43008
s_add_u32 m0, s83, 140288
s_add_u32 s76, s73, 4259968
buffer_load_dwordx4 v1, s[64:67], s76 offen lds
s_waitcnt lgkmcnt(6)
v_mfma_f32_32x32x16_bf16 v[40:55], v[8:11], a[96:99], v[40:55]
ds_read_b64_tr_b16 v[24:25], v4 offset:33792
ds_read_b64_tr_b16 v[26:27], v4 offset:35840
s_waitcnt lgkmcnt(6)
v_mfma_f32_32x32x16_bf16 v[56:71], v[12:15], a[96:99], v[56:71]
ds_read_b64_tr_b16 v[28:29], v5 offset:33792
ds_read_b64_tr_b16 v[30:31], v5 offset:35840
s_add_u32 m0, s83, 0
s_add_u32 s76, s73, 256
buffer_load_dwordx4 v1, s[64:67], s76 offen lds
s_waitcnt lgkmcnt(6)
v_mfma_f32_32x32x16_bf16 v[72:87], v[16:19], a[96:99], v[72:87]
ds_read_b64_tr_b16 v[32:33], v4 offset:41984
ds_read_b64_tr_b16 v[34:35], v4 offset:44032
s_waitcnt lgkmcnt(6)
v_mfma_f32_32x32x16_bf16 v[88:103], v[20:23], a[96:99], v[88:103]
ds_read_b64_tr_b16 v[36:37], v5 offset:41984
ds_read_b64_tr_b16 v[38:39], v5 offset:44032
s_add_u32 m0, s83, 1024
s_add_u32 s76, s73, 65792
buffer_load_dwordx4 v1, s[64:67], s76 offen lds
s_waitcnt lgkmcnt(6)
v_mfma_f32_32x32x16_bf16 v[40:55], v[24:27], a[100:103], v[40:55]
ds_read_b64_tr_b16 v[8:9], v4 offset:36864
ds_read_b64_tr_b16 v[10:11], v4 offset:38912
s_waitcnt lgkmcnt(6)
v_mfma_f32_32x32x16_bf16 v[56:71], v[28:31], a[100:103], v[56:71]
ds_read_b64_tr_b16 v[12:13], v5 offset:36864
ds_read_b64_tr_b16 v[14:15], v5 offset:38912
s_add_u32 m0, s83, 8192
s_add_u32 s76, s73, 384
buffer_load_dwordx4 v1, s[64:67], s76 offen lds
s_waitcnt lgkmcnt(6)
v_mfma_f32_32x32x16_bf16 v[72:87], v[32:35], a[100:103], v[72:87]
ds_read_b64_tr_b16 v[16:17], v4 offset:45056
ds_read_b64_tr_b16 v[18:19], v4 offset:47104
s_waitcnt lgkmcnt(6)
v_mfma_f32_32x32x16_bf16 v[88:103], v[36:39], a[100:103], v[88:103]
ds_read_b64_tr_b16 v[20:21], v5 offset:45056
ds_read_b64_tr_b16 v[22:23], v5 offset:47104
s_add_u32 m0, s83, 9216
s_add_u32 s76, s73, 65920
buffer_load_dwordx4 v1, s[64:67], s76 offen lds
s_waitcnt lgkmcnt(6)
v_mfma_f32_32x32x16_bf16 v[40:55], v[8:11], a[104:107], v[40:55]
ds_read_b64_tr_b16 v[24:25], v4 offset:37888
ds_read_b64_tr_b16 v[26:27], v4 offset:39936
s_waitcnt lgkmcnt(6)
v_mfma_f32_32x32x16_bf16 v[56:71], v[12:15], a[104:107], v[56:71]
ds_read_b64_tr_b16 v[28:29], v5 offset:37888
ds_read_b64_tr_b16 v[30:31], v5 offset:39936
s_add_u32 m0, s83, 16384
s_add_u32 s76, s73, 524544
buffer_load_dwordx4 v1, s[64:67], s76 offen lds
s_waitcnt lgkmcnt(6)
v_mfma_f32_32x32x16_bf16 v[72:87], v[16:19], a[104:107], v[72:87]
ds_read_b64_tr_b16 v[32:33], v4 offset:46080
ds_read_b64_tr_b16 v[34:35], v4 offset:48128
s_waitcnt lgkmcnt(6)
v_mfma_f32_32x32x16_bf16 v[88:103], v[20:23], a[104:107], v[88:103]
ds_read_b64_tr_b16 v[36:37], v5 offset:46080
ds_read_b64_tr_b16 v[38:39], v5 offset:48128
s_add_u32 m0, s83, 17408
s_add_u32 s76, s73, 590080
buffer_load_dwordx4 v1, s[64:67], s76 offen lds
s_waitcnt vmcnt(14)
s_barrier
s_waitcnt lgkmcnt(6)
v_mfma_f32_32x32x16_bf16 v[40:55], v[24:27], a[108:111], v[40:55]
ds_read_b64_tr_b16 v[8:9], v4 offset:49152
ds_read_b64_tr_b16 v[10:11], v4 offset:51200
s_waitcnt lgkmcnt(6)
v_mfma_f32_32x32x16_bf16 v[56:71], v[28:31], a[108:111], v[56:71]
ds_read_b64_tr_b16 v[12:13], v5 offset:49152
ds_read_b64_tr_b16 v[14:15], v5 offset:51200
s_add_u32 m0, s83, 24576
s_add_u32 s76, s73, 524672
buffer_load_dwordx4 v1, s[64:67], s76 offen lds
s_waitcnt lgkmcnt(6)
v_mfma_f32_32x32x16_bf16 v[72:87], v[32:35], a[108:111], v[72:87]
ds_read_b64_tr_b16 v[16:17], v4 offset:57344
ds_read_b64_tr_b16 v[18:19], v4 offset:59392
s_waitcnt lgkmcnt(6)
v_mfma_f32_32x32x16_bf16 v[88:103], v[36:39], a[108:111], v[88:103]
ds_read_b64_tr_b16 v[20:21], v5 offset:57344
ds_read_b64_tr_b16 v[22:23], v5 offset:59392
s_add_u32 m0, s83, 25600
s_add_u32 s76, s73, 590208
buffer_load_dwordx4 v1, s[64:67], s76 offen lds
s_waitcnt lgkmcnt(6)
v_mfma_f32_32x32x16_bf16 v[40:55], v[8:11], a[112:115], v[40:55]
ds_read_b64_tr_b16 v[24:25], v4 offset:50176
ds_read_b64_tr_b16 v[26:27], v4 offset:52224
s_waitcnt lgkmcnt(6)
v_mfma_f32_32x32x16_bf16 v[56:71], v[12:15], a[112:115], v[56:71]
ds_read_b64_tr_b16 v[28:29], v5 offset:50176
ds_read_b64_tr_b16 v[30:31], v5 offset:52224
s_add_u32 m0, s83, 32768
s_add_u32 s76, s73, 1048832
buffer_load_dwordx4 v1, s[64:67], s76 offen lds
s_waitcnt lgkmcnt(6)
v_mfma_f32_32x32x16_bf16 v[72:87], v[16:19], a[112:115], v[72:87]
ds_read_b64_tr_b16 v[32:33], v4 offset:58368
ds_read_b64_tr_b16 v[34:35], v4 offset:60416
s_waitcnt lgkmcnt(6)
v_mfma_f32_32x32x16_bf16 v[88:103], v[20:23], a[112:115], v[88:103]
ds_read_b64_tr_b16 v[36:37], v5 offset:58368
ds_read_b64_tr_b16 v[38:39], v5 offset:60416
s_add_u32 m0, s83, 33792
s_add_u32 s76, s73, 1114368
buffer_load_dwordx4 v1, s[64:67], s76 offen lds
s_waitcnt lgkmcnt(6)
v_mfma_f32_32x32x16_bf16 v[40:55], v[24:27], a[116:119], v[40:55]
ds_read_b64_tr_b16 v[8:9], v4 offset:53248
ds_read_b64_tr_b16 v[10:11], v4 offset:55296
s_waitcnt lgkmcnt(6)
v_mfma_f32_32x32x16_bf16 v[56:71], v[28:31], a[116:119], v[56:71]
ds_read_b64_tr_b16 v[12:13], v5 offset:53248
ds_read_b64_tr_b16 v[14:15], v5 offset:55296
s_add_u32 m0, s83, 40960
s_add_u32 s76, s73, 1048960
buffer_load_dwordx4 v1, s[64:67], s76 offen lds
s_waitcnt lgkmcnt(6)
v_mfma_f32_32x32x16_bf16 v[72:87], v[32:35], a[116:119], v[72:87]
ds_read_b64_tr_b16 v[16:17], v4 offset:61440
ds_read_b64_tr_b16 v[18:19], v4 offset:63488
s_waitcnt lgkmcnt(6)
v_mfma_f32_32x32x16_bf16 v[88:103], v[36:39], a[116:119], v[88:103]
ds_read_b64_tr_b16 v[20:21], v5 offset:61440
ds_read_b64_tr_b16 v[22:23], v5 offset:63488
s_add_u32 m0, s83, 41984
s_add_u32 s76, s73, 1114496
buffer_load_dwordx4 v1, s[64:67], s76 offen lds
s_waitcnt lgkmcnt(6)
v_mfma_f32_32x32x16_bf16 v[40:55], v[8:11], a[120:123], v[40:55]
ds_read_b64_tr_b16 v[24:25], v4 offset:54272
ds_read_b64_tr_b16 v[26:27], v4 offset:56320
s_waitcnt lgkmcnt(6)
v_mfma_f32_32x32x16_bf16 v[56:71], v[12:15], a[120:123], v[56:71]
ds_read_b64_tr_b16 v[28:29], v5 offset:54272
ds_read_b64_tr_b16 v[30:31], v5 offset:56320
s_add_u32 m0, s83, 49152
s_add_u32 s76, s73, 1573120
buffer_load_dwordx4 v1, s[64:67], s76 offen lds
s_waitcnt lgkmcnt(6)
v_mfma_f32_32x32x16_bf16 v[72:87], v[16:19], a[120:123], v[72:87]
ds_read_b64_tr_b16 v[32:33], v4 offset:62464
ds_read_b64_tr_b16 v[34:35], v4 offset:64512
s_waitcnt lgkmcnt(6)
v_mfma_f32_32x32x16_bf16 v[88:103], v[20:23], a[120:123], v[88:103]
ds_read_b64_tr_b16 v[36:37], v5 offset:62464
ds_read_b64_tr_b16 v[38:39], v5 offset:64512
s_add_u32 m0, s83, 50176
s_add_u32 s76, s73, 1638656
buffer_load_dwordx4 v1, s[64:67], s76 offen lds
s_waitcnt vmcnt(14)
s_barrier
s_waitcnt lgkmcnt(6)
v_mfma_f32_32x32x16_bf16 v[40:55], v[24:27], a[124:127], v[40:55]
ds_read_b64_tr_b16 v[8:9], v6 offset:0
ds_read_b64_tr_b16 v[10:11], v6 offset:2048
s_waitcnt lgkmcnt(6)
v_mfma_f32_32x32x16_bf16 v[56:71], v[28:31], a[124:127], v[56:71]
ds_read_b64_tr_b16 v[12:13], v7 offset:0
ds_read_b64_tr_b16 v[14:15], v7 offset:2048
s_add_u32 m0, s83, 57344
s_add_u32 s76, s73, 1573248
buffer_load_dwordx4 v1, s[64:67], s76 offen lds
s_waitcnt lgkmcnt(6)
v_mfma_f32_32x32x16_bf16 v[72:87], v[32:35], a[124:127], v[72:87]
ds_read_b64_tr_b16 v[16:17], v6 offset:8192
ds_read_b64_tr_b16 v[18:19], v6 offset:10240
s_waitcnt lgkmcnt(6)
v_mfma_f32_32x32x16_bf16 v[88:103], v[36:39], a[124:127], v[88:103]
ds_read_b64_tr_b16 v[20:21], v7 offset:8192
ds_read_b64_tr_b16 v[22:23], v7 offset:10240
s_add_u32 m0, s83, 58368
s_add_u32 s76, s73, 1638784
buffer_load_dwordx4 v1, s[64:67], s76 offen lds
s_waitcnt lgkmcnt(6)
v_mfma_f32_32x32x16_bf16 v[40:55], v[8:11], a[128:131], v[40:55]
ds_read_b64_tr_b16 v[24:25], v6 offset:1024
ds_read_b64_tr_b16 v[26:27], v6 offset:3072
s_waitcnt lgkmcnt(6)
v_mfma_f32_32x32x16_bf16 v[56:71], v[12:15], a[128:131], v[56:71]
ds_read_b64_tr_b16 v[28:29], v7 offset:1024
ds_read_b64_tr_b16 v[30:31], v7 offset:3072
s_add_u32 m0, s83, 65536
s_add_u32 s76, s73, 2097408
buffer_load_dwordx4 v1, s[64:67], s76 offen lds
s_waitcnt lgkmcnt(6)
v_mfma_f32_32x32x16_bf16 v[72:87], v[16:19], a[128:131], v[72:87]
ds_read_b64_tr_b16 v[32:33], v6 offset:9216
ds_read_b64_tr_b16 v[34:35], v6 offset:11264
s_waitcnt lgkmcnt(6)
v_mfma_f32_32x32x16_bf16 v[88:103], v[20:23], a[128:131], v[88:103]
ds_read_b64_tr_b16 v[36:37], v7 offset:9216
ds_read_b64_tr_b16 v[38:39], v7 offset:11264
s_add_u32 m0, s83, 66560
s_add_u32 s76, s73, 2162944
buffer_load_dwordx4 v1, s[64:67], s76 offen lds
s_waitcnt lgkmcnt(6)
v_mfma_f32_32x32x16_bf16 v[40:55], v[24:27], a[132:135], v[40:55]
ds_read_b64_tr_b16 v[8:9], v6 offset:4096
ds_read_b64_tr_b16 v[10:11], v6 offset:6144
s_waitcnt lgkmcnt(6)
v_mfma_f32_32x32x16_bf16 v[56:71], v[28:31], a[132:135], v[56:71]
ds_read_b64_tr_b16 v[12:13], v7 offset:4096
ds_read_b64_tr_b16 v[14:15], v7 offset:6144
s_add_u32 m0, s83, 73728
s_add_u32 s76, s73, 2097536
buffer_load_dwordx4 v1, s[64:67], s76 offen lds
s_waitcnt lgkmcnt(6)
v_mfma_f32_32x32x16_bf16 v[72:87], v[32:35], a[132:135], v[72:87]
ds_read_b64_tr_b16 v[16:17], v6 offset:12288
ds_read_b64_tr_b16 v[18:19], v6 offset:14336
s_waitcnt lgkmcnt(6)
v_mfma_f32_32x32x16_bf16 v[88:103], v[36:39], a[132:135], v[88:103]
ds_read_b64_tr_b16 v[20:21], v7 offset:12288
ds_read_b64_tr_b16 v[22:23], v7 offset:14336
s_add_u32 m0, s83, 74752
s_add_u32 s76, s73, 2163072
buffer_load_dwordx4 v1, s[64:67], s76 offen lds
s_waitcnt lgkmcnt(6)
v_mfma_f32_32x32x16_bf16 v[40:55], v[8:11], a[136:139], v[40:55]
ds_read_b64_tr_b16 v[24:25], v6 offset:5120
ds_read_b64_tr_b16 v[26:27], v6 offset:7168
s_waitcnt lgkmcnt(6)
v_mfma_f32_32x32x16_bf16 v[56:71], v[12:15], a[136:139], v[56:71]
ds_read_b64_tr_b16 v[28:29], v7 offset:5120
ds_read_b64_tr_b16 v[30:31], v7 offset:7168
s_add_u32 m0, s83, 81920
s_add_u32 s76, s73, 2621696
buffer_load_dwordx4 v1, s[64:67], s76 offen lds
s_waitcnt lgkmcnt(6)
v_mfma_f32_32x32x16_bf16 v[72:87], v[16:19], a[136:139], v[72:87]
ds_read_b64_tr_b16 v[32:33], v6 offset:13312
ds_read_b64_tr_b16 v[34:35], v6 offset:15360
s_waitcnt lgkmcnt(6)
v_mfma_f32_32x32x16_bf16 v[88:103], v[20:23], a[136:139], v[88:103]
ds_read_b64_tr_b16 v[36:37], v7 offset:13312
ds_read_b64_tr_b16 v[38:39], v7 offset:15360
s_add_u32 m0, s83, 82944
s_add_u32 s76, s73, 2687232
buffer_load_dwordx4 v1, s[64:67], s76 offen lds
s_waitcnt vmcnt(18)
s_barrier
s_waitcnt lgkmcnt(6)
v_mfma_f32_32x32x16_bf16 v[40:55], v[24:27], a[140:143], v[40:55]
ds_read_b64_tr_b16 v[8:9], v2 offset:0
ds_read_b64_tr_b16 v[10:11], v2 offset:2048
s_waitcnt lgkmcnt(6)
v_mfma_f32_32x32x16_bf16 v[56:71], v[28:31], a[140:143], v[56:71]
ds_read_b64_tr_b16 v[12:13], v3 offset:0
ds_read_b64_tr_b16 v[14:15], v3 offset:2048
s_add_u32 m0, s83, 90112
s_add_u32 s76, s73, 2621824
buffer_load_dwordx4 v1, s[64:67], s76 offen lds
s_waitcnt lgkmcnt(6)
v_mfma_f32_32x32x16_bf16 v[72:87], v[32:35], a[140:143], v[72:87]
ds_read_b64_tr_b16 v[16:17], v2 offset:8192
ds_read_b64_tr_b16 v[18:19], v2 offset:10240
s_waitcnt lgkmcnt(6)
v_mfma_f32_32x32x16_bf16 v[88:103], v[36:39], a[140:143], v[88:103]
ds_read_b64_tr_b16 v[20:21], v3 offset:8192
ds_read_b64_tr_b16 v[22:23], v3 offset:10240
s_add_u32 m0, s83, 91136
s_add_u32 s76, s73, 2687360
buffer_load_dwordx4 v1, s[64:67], s76 offen lds
s_nop 11
s_add_u32 s77, s82, 0
v_cvt_pk_bf16_f32 v106, v40, v41
v_cvt_pk_bf16_f32 v107, v42, v43
v_cvt_pk_bf16_f32 v108, v48, v49
v_cvt_pk_bf16_f32 v109, v50, v51
buffer_store_dwordx4 v[106:109], v104, s[8:11], s77 offen offset:0 sc1
v_cvt_pk_bf16_f32 v110, v44, v45
v_cvt_pk_bf16_f32 v111, v46, v47
v_cvt_pk_bf16_f32 v112, v52, v53
v_cvt_pk_bf16_f32 v113, v54, v55
buffer_store_dwordx4 v[110:113], v104, s[8:11], s77 offen offset:512 sc1
s_add_u32 s77, s82, 2048
v_cvt_pk_bf16_f32 v114, v56, v57
v_cvt_pk_bf16_f32 v115, v58, v59
v_cvt_pk_bf16_f32 v116, v64, v65
v_cvt_pk_bf16_f32 v117, v66, v67
buffer_store_dwordx4 v[114:117], v104, s[8:11], s77 offen offset:0 sc1
v_cvt_pk_bf16_f32 v118, v60, v61
v_cvt_pk_bf16_f32 v119, v62, v63
v_cvt_pk_bf16_f32 v120, v68, v69
v_cvt_pk_bf16_f32 v121, v70, v71
buffer_store_dwordx4 v[118:121], v104, s[8:11], s77 offen offset:512 sc1
s_add_u32 s77, s82, 4096
v_cvt_pk_bf16_f32 v106, v72, v73
v_cvt_pk_bf16_f32 v107, v74, v75
v_cvt_pk_bf16_f32 v108, v80, v81
v_cvt_pk_bf16_f32 v109, v82, v83
buffer_store_dwordx4 v[106:109], v104, s[8:11], s77 offen offset:0 sc1
v_cvt_pk_bf16_f32 v110, v76, v77
v_cvt_pk_bf16_f32 v111, v78, v79
v_cvt_pk_bf16_f32 v112, v84, v85
v_cvt_pk_bf16_f32 v113, v86, v87
buffer_store_dwordx4 v[110:113], v104, s[8:11], s77 offen offset:512 sc1
s_add_u32 s77, s82, 6144
v_cvt_pk_bf16_f32 v114, v88, v89
v_cvt_pk_bf16_f32 v115, v90, v91
v_cvt_pk_bf16_f32 v116, v96, v97
v_cvt_pk_bf16_f32 v117, v98, v99
buffer_store_dwordx4 v[114:117], v104, s[8:11], s77 offen offset:0 sc1
v_cvt_pk_bf16_f32 v118, v92, v93
v_cvt_pk_bf16_f32 v119, v94, v95
v_cvt_pk_bf16_f32 v120, v100, v101
v_cvt_pk_bf16_f32 v121, v102, v103
buffer_store_dwordx4 v[118:121], v104, s[8:11], s77 offen offset:512 sc1
s_waitcnt lgkmcnt(6)
v_mfma_f32_32x32x16_bf16 v[40:55], v[8:11], a[0:3], 0
ds_read_b64_tr_b16 v[24:25], v2 offset:1024
ds_read_b64_tr_b16 v[26:27], v2 offset:3072
s_waitcnt lgkmcnt(6)
v_mfma_f32_32x32x16_bf16 v[56:71], v[12:15], a[0:3], 0
ds_read_b64_tr_b16 v[28:29], v3 offset:1024
ds_read_b64_tr_b16 v[30:31], v3 offset:3072
s_add_u32 m0, s83, 98304
s_add_u32 s76, s73, 3145984
buffer_load_dwordx4 v1, s[64:67], s76 offen lds
s_waitcnt lgkmcnt(6)
v_mfma_f32_32x32x16_bf16 v[72:87], v[16:19], a[0:3], 0
ds_read_b64_tr_b16 v[32:33], v2 offset:9216
ds_read_b64_tr_b16 v[34:35], v2 offset:11264
s_waitcnt lgkmcnt(6)
v_mfma_f32_32x32x16_bf16 v[88:103], v[20:23], a[0:3], 0
ds_read_b64_tr_b16 v[36:37], v3 offset:9216
ds_read_b64_tr_b16 v[38:39], v3 offset:11264
s_add_u32 m0, s83, 99328
s_add_u32 s76, s73, 3211520
buffer_load_dwordx4 v1, s[64:67], s76 offen lds
s_waitcnt lgkmcnt(6)
v_mfma_f32_32x32x16_bf16 v[40:55], v[24:27], a[4:7], v[40:55]
ds_read_b64_tr_b16 v[8:9], v2 offset:4096
ds_read_b64_tr_b16 v[10:11], v2 offset:6144
s_waitcnt lgkmcnt(6)
v_mfma_f32_32x32x16_bf16 v[56:71], v[28:31], a[4:7], v[56:71]
ds_read_b64_tr_b16 v[12:13], v3 offset:4096
ds_read_b64_tr_b16 v[14:15], v3 offset:6144
s_add_u32 m0, s83, 106496
s_add_u32 s76, s73, 3146112
buffer_load_dwordx4 v1, s[64:67], s76 offen lds
s_waitcnt lgkmcnt(6)
v_mfma_f32_32x32x16_bf16 v[72:87], v[32:35], a[4:7], v[72:87]
ds_read_b64_tr_b16 v[16:17], v2 offset:12288
ds_read_b64_tr_b16 v[18:19], v2 offset:14336
s_waitcnt lgkmcnt(6)
v_mfma_f32_32x32x16_bf16 v[88:103], v[36:39], a[4:7], v[88:103]
ds_read_b64_tr_b16 v[20:21], v3 offset:12288
ds_read_b64_tr_b16 v[22:23], v3 offset:14336
s_add_u32 m0, s83, 107520
s_add_u32 s76, s73, 3211648
buffer_load_dwordx4 v1, s[64:67], s76 offen lds
s_waitcnt lgkmcnt(6)
v_mfma_f32_32x32x16_bf16 v[40:55], v[8:11], a[8:11], v[40:55]
ds_read_b64_tr_b16 v[24:25], v2 offset:5120
ds_read_b64_tr_b16 v[26:27], v2 offset:7168
s_waitcnt lgkmcnt(6)
v_mfma_f32_32x32x16_bf16 v[56:71], v[12:15], a[8:11], v[56:71]
ds_read_b64_tr_b16 v[28:29], v3 offset:5120
ds_read_b64_tr_b16 v[30:31], v3 offset:7168
s_add_u32 m0, s83, 114688
s_add_u32 s76, s73, 3670272
buffer_load_dwordx4 v1, s[64:67], s76 offen lds
s_waitcnt lgkmcnt(6)
v_mfma_f32_32x32x16_bf16 v[72:87], v[16:19], a[8:11], v[72:87]
ds_read_b64_tr_b16 v[32:33], v2 offset:13312
ds_read_b64_tr_b16 v[34:35], v2 offset:15360
s_waitcnt lgkmcnt(6)
v_mfma_f32_32x32x16_bf16 v[88:103], v[20:23], a[8:11], v[88:103]
ds_read_b64_tr_b16 v[36:37], v3 offset:13312
ds_read_b64_tr_b16 v[38:39], v3 offset:15360
s_add_u32 m0, s83, 115712
s_add_u32 s76, s73, 3735808
buffer_load_dwordx4 v1, s[64:67], s76 offen lds
s_waitcnt vmcnt(30)
s_barrier
s_waitcnt lgkmcnt(6)
v_mfma_f32_32x32x16_bf16 v[40:55], v[24:27], a[12:15], v[40:55]
ds_read_b64_tr_b16 v[8:9], v2 offset:16384
ds_read_b64_tr_b16 v[10:11], v2 offset:18432
s_waitcnt lgkmcnt(6)
v_mfma_f32_32x32x16_bf16 v[56:71], v[28:31], a[12:15], v[56:71]
ds_read_b64_tr_b16 v[12:13], v3 offset:16384
ds_read_b64_tr_b16 v[14:15], v3 offset:18432
s_add_u32 m0, s83, 122880
s_add_u32 s76, s73, 3670400
buffer_load_dwordx4 v1, s[64:67], s76 offen lds
s_waitcnt lgkmcnt(6)
v_mfma_f32_32x32x16_bf16 v[72:87], v[32:35], a[12:15], v[72:87]
ds_read_b64_tr_b16 v[16:17], v2 offset:24576
ds_read_b64_tr_b16 v[18:19], v2 offset:26624
s_waitcnt lgkmcnt(6)
v_mfma_f32_32x32x16_bf16 v[88:103], v[36:39], a[12:15], v[88:103]
ds_read_b64_tr_b16 v[20:21], v3 offset:24576
ds_read_b64_tr_b16 v[22:23], v3 offset:26624
s_add_u32 m0, s83, 123904
s_add_u32 s76, s73, 3735936
buffer_load_dwordx4 v1, s[64:67], s76 offen lds
s_waitcnt lgkmcnt(6)
v_mfma_f32_32x32x16_bf16 v[40:55], v[8:11], a[16:19], v[40:55]
ds_read_b64_tr_b16 v[24:25], v2 offset:17408
ds_read_b64_tr_b16 v[26:27], v2 offset:19456
s_waitcnt lgkmcnt(6)
v_mfma_f32_32x32x16_bf16 v[56:71], v[12:15], a[16:19], v[56:71]
ds_read_b64_tr_b16 v[28:29], v3 offset:17408
ds_read_b64_tr_b16 v[30:31], v3 offset:19456
s_add_u32 m0, s83, 131072
s_add_u32 s76, s73, 4194560
buffer_load_dwordx4 v1, s[64:67], s76 offen lds
s_waitcnt lgkmcnt(6)
v_mfma_f32_32x32x16_bf16 v[72:87], v[16:19], a[16:19], v[72:87]
ds_read_b64_tr_b16 v[32:33], v2 offset:25600
ds_read_b64_tr_b16 v[34:35], v2 offset:27648
s_waitcnt lgkmcnt(6)
v_mfma_f32_32x32x16_bf16 v[88:103], v[20:23], a[16:19], v[88:103]
ds_read_b64_tr_b16 v[36:37], v3 offset:25600
ds_read_b64_tr_b16 v[38:39], v3 offset:27648
s_add_u32 m0, s83, 132096
s_add_u32 s76, s73, 4260096
buffer_load_dwordx4 v1, s[64:67], s76 offen lds
s_waitcnt lgkmcnt(6)
v_mfma_f32_32x32x16_bf16 v[40:55], v[24:27], a[20:23], v[40:55]
ds_read_b64_tr_b16 v[8:9], v2 offset:20480
ds_read_b64_tr_b16 v[10:11], v2 offset:22528
s_waitcnt lgkmcnt(6)
v_mfma_f32_32x32x16_bf16 v[56:71], v[28:31], a[20:23], v[56:71]
ds_read_b64_tr_b16 v[12:13], v3 offset:20480
ds_read_b64_tr_b16 v[14:15], v3 offset:22528
s_add_u32 m0, s83, 139264
s_add_u32 s76, s73, 4194688
buffer_load_dwordx4 v1, s[64:67], s76 offen lds
s_waitcnt lgkmcnt(6)
v_mfma_f32_32x32x16_bf16 v[72:87], v[32:35], a[20:23], v[72:87]
ds_read_b64_tr_b16 v[16:17], v2 offset:28672
ds_read_b64_tr_b16 v[18:19], v2 offset:30720
s_waitcnt lgkmcnt(6)
v_mfma_f32_32x32x16_bf16 v[88:103], v[36:39], a[20:23], v[88:103]
ds_read_b64_tr_b16 v[20:21], v3 offset:28672
ds_read_b64_tr_b16 v[22:23], v3 offset:30720
s_add_u32 m0, s83, 140288
s_add_u32 s76, s73, 4260224
buffer_load_dwordx4 v1, s[64:67], s76 offen lds
s_waitcnt lgkmcnt(6)
v_mfma_f32_32x32x16_bf16 v[40:55], v[8:11], a[24:27], v[40:55]
ds_read_b64_tr_b16 v[24:25], v2 offset:21504
ds_read_b64_tr_b16 v[26:27], v2 offset:23552
s_waitcnt lgkmcnt(6)
v_mfma_f32_32x32x16_bf16 v[56:71], v[12:15], a[24:27], v[56:71]
ds_read_b64_tr_b16 v[28:29], v3 offset:21504
ds_read_b64_tr_b16 v[30:31], v3 offset:23552
s_waitcnt lgkmcnt(6)
v_mfma_f32_32x32x16_bf16 v[72:87], v[16:19], a[24:27], v[72:87]
ds_read_b64_tr_b16 v[32:33], v2 offset:29696
ds_read_b64_tr_b16 v[34:35], v2 offset:31744
s_waitcnt lgkmcnt(6)
v_mfma_f32_32x32x16_bf16 v[88:103], v[20:23], a[24:27], v[88:103]
ds_read_b64_tr_b16 v[36:37], v3 offset:29696
ds_read_b64_tr_b16 v[38:39], v3 offset:31744
s_waitcnt vmcnt(32)
s_barrier
s_waitcnt lgkmcnt(6)
v_mfma_f32_32x32x16_bf16 v[40:55], v[24:27], a[28:31], v[40:55]
ds_read_b64_tr_b16 v[8:9], v2 offset:32768
ds_read_b64_tr_b16 v[10:11], v2 offset:34816
s_waitcnt lgkmcnt(6)
v_mfma_f32_32x32x16_bf16 v[56:71], v[28:31], a[28:31], v[56:71]
ds_read_b64_tr_b16 v[12:13], v3 offset:32768
ds_read_b64_tr_b16 v[14:15], v3 offset:34816
s_waitcnt lgkmcnt(6)
v_mfma_f32_32x32x16_bf16 v[72:87], v[32:35], a[28:31], v[72:87]
ds_read_b64_tr_b16 v[16:17], v2 offset:40960
ds_read_b64_tr_b16 v[18:19], v2 offset:43008
s_waitcnt lgkmcnt(6)
v_mfma_f32_32x32x16_bf16 v[88:103], v[36:39], a[28:31], v[88:103]
ds_read_b64_tr_b16 v[20:21], v3 offset:40960
ds_read_b64_tr_b16 v[22:23], v3 offset:43008
s_waitcnt lgkmcnt(6)
v_mfma_f32_32x32x16_bf16 v[40:55], v[8:11], a[32:35], v[40:55]
ds_read_b64_tr_b16 v[24:25], v2 offset:33792
ds_read_b64_tr_b16 v[26:27], v2 offset:35840
s_waitcnt lgkmcnt(6)
v_mfma_f32_32x32x16_bf16 v[56:71], v[12:15], a[32:35], v[56:71]
ds_read_b64_tr_b16 v[28:29], v3 offset:33792
ds_read_b64_tr_b16 v[30:31], v3 offset:35840
s_add_u32 m0, s83, 0
s_add_u32 s76, s73, 512
buffer_load_dwordx4 v1, s[64:67], s76 offen lds
s_waitcnt lgkmcnt(6)
v_mfma_f32_32x32x16_bf16 v[72:87], v[16:19], a[32:35], v[72:87]
ds_read_b64_tr_b16 v[32:33], v2 offset:41984
ds_read_b64_tr_b16 v[34:35], v2 offset:44032
s_waitcnt lgkmcnt(6)
v_mfma_f32_32x32x16_bf16 v[88:103], v[20:23], a[32:35], v[88:103]
ds_read_b64_tr_b16 v[36:37], v3 offset:41984
ds_read_b64_tr_b16 v[38:39], v3 offset:44032
s_add_u32 m0, s83, 1024
s_add_u32 s76, s73, 66048
buffer_load_dwordx4 v1, s[64:67], s76 offen lds
s_waitcnt lgkmcnt(6)
v_mfma_f32_32x32x16_bf16 v[40:55], v[24:27], a[36:39], v[40:55]
ds_read_b64_tr_b16 v[8:9], v2 offset:36864
ds_read_b64_tr_b16 v[10:11], v2 offset:38912
s_waitcnt lgkmcnt(6)
v_mfma_f32_32x32x16_bf16 v[56:71], v[28:31], a[36:39], v[56:71]
ds_read_b64_tr_b16 v[12:13], v3 offset:36864
ds_read_b64_tr_b16 v[14:15], v3 offset:38912
s_add_u32 m0, s83, 8192
s_add_u32 s76, s73, 640
buffer_load_dwordx4 v1, s[64:67], s76 offen lds
s_waitcnt lgkmcnt(6)
v_mfma_f32_32x32x16_bf16 v[72:87], v[32:35], a[36:39], v[72:87]
ds_read_b64_tr_b16 v[16:17], v2 offset:45056
ds_read_b64_tr_b16 v[18:19], v2 offset:47104
s_waitcnt lgkmcnt(6)
v_mfma_f32_32x32x16_bf16 v[88:103], v[36:39], a[36:39], v[88:103]
ds_read_b64_tr_b16 v[20:21], v3 offset:45056
ds_read_b64_tr_b16 v[22:23], v3 offset:47104
s_add_u32 m0, s83, 9216
s_add_u32 s76, s73, 66176
buffer_load_dwordx4 v1, s[64:67], s76 offen lds
s_waitcnt lgkmcnt(6)
v_mfma_f32_32x32x16_bf16 v[40:55], v[8:11], a[40:43], v[40:55]
ds_read_b64_tr_b16 v[24:25], v2 offset:37888
ds_read_b64_tr_b16 v[26:27], v2 offset:39936
s_waitcnt lgkmcnt(6)
v_mfma_f32_32x32x16_bf16 v[56:71], v[12:15], a[40:43], v[56:71]
ds_read_b64_tr_b16 v[28:29], v3 offset:37888
ds_read_b64_tr_b16 v[30:31], v3 offset:39936
s_waitcnt lgkmcnt(6)
v_mfma_f32_32x32x16_bf16 v[72:87], v[16:19], a[40:43], v[72:87]
ds_read_b64_tr_b16 v[32:33], v2 offset:46080
ds_read_b64_tr_b16 v[34:35], v2 offset:48128
s_waitcnt lgkmcnt(6)
v_mfma_f32_32x32x16_bf16 v[88:103], v[20:23], a[40:43], v[88:103]
ds_read_b64_tr_b16 v[36:37], v3 offset:46080
ds_read_b64_tr_b16 v[38:39], v3 offset:48128
s_waitcnt vmcnt(32)
s_barrier
s_waitcnt lgkmcnt(6)
v_mfma_f32_32x32x16_bf16 v[40:55], v[24:27], a[44:47], v[40:55]
ds_read_b64_tr_b16 v[8:9], v2 offset:49152
ds_read_b64_tr_b16 v[10:11], v2 offset:51200
s_waitcnt lgkmcnt(6)
v_mfma_f32_32x32x16_bf16 v[56:71], v[28:31], a[44:47], v[56:71]
ds_read_b64_tr_b16 v[12:13], v3 offset:49152
ds_read_b64_tr_b16 v[14:15], v3 offset:51200
s_waitcnt lgkmcnt(6)
v_mfma_f32_32x32x16_bf16 v[72:87], v[32:35], a[44:47], v[72:87]
ds_read_b64_tr_b16 v[16:17], v2 offset:57344
ds_read_b64_tr_b16 v[18:19], v2 offset:59392
s_waitcnt lgkmcnt(6)
v_mfma_f32_32x32x16_bf16 v[88:103], v[36:39], a[44:47], v[88:103]
ds_read_b64_tr_b16 v[20:21], v3 offset:57344
ds_read_b64_tr_b16 v[22:23], v3 offset:59392
s_waitcnt lgkmcnt(6)
v_mfma_f32_32x32x16_bf16 v[40:55], v[8:11], a[48:51], v[40:55]
ds_read_b64_tr_b16 v[24:25], v2 offset:50176
ds_read_b64_tr_b16 v[26:27], v2 offset:52224
s_waitcnt lgkmcnt(6)
v_mfma_f32_32x32x16_bf16 v[56:71], v[12:15], a[48:51], v[56:71]
ds_read_b64_tr_b16 v[28:29], v3 offset:50176
ds_read_b64_tr_b16 v[30:31], v3 offset:52224
s_add_u32 m0, s83, 16384
s_add_u32 s76, s73, 524800
buffer_load_dwordx4 v1, s[64:67], s76 offen lds
s_waitcnt lgkmcnt(6)
v_mfma_f32_32x32x16_bf16 v[72:87], v[16:19], a[48:51], v[72:87]
ds_read_b64_tr_b16 v[32:33], v2 offset:58368
ds_read_b64_tr_b16 v[34:35], v2 offset:60416
s_waitcnt lgkmcnt(6)
v_mfma_f32_32x32x16_bf16 v[88:103], v[20:23], a[48:51], v[88:103]
ds_read_b64_tr_b16 v[36:37], v3 offset:58368
ds_read_b64_tr_b16 v[38:39], v3 offset:60416
s_add_u32 m0, s83, 17408
s_add_u32 s76, s73, 590336
buffer_load_dwordx4 v1, s[64:67], s76 offen lds
s_waitcnt lgkmcnt(6)
v_mfma_f32_32x32x16_bf16 v[40:55], v[24:27], a[52:55], v[40:55]
ds_read_b64_tr_b16 v[8:9], v2 offset:53248
ds_read_b64_tr_b16 v[10:11], v2 offset:55296
s_waitcnt lgkmcnt(6)
v_mfma_f32_32x32x16_bf16 v[56:71], v[28:31], a[52:55], v[56:71]
ds_read_b64_tr_b16 v[12:13], v3 offset:53248
ds_read_b64_tr_b16 v[14:15], v3 offset:55296
s_add_u32 m0, s83, 24576
s_add_u32 s76, s73, 524928
buffer_load_dwordx4 v1, s[64:67], s76 offen lds
s_waitcnt lgkmcnt(6)
v_mfma_f32_32x32x16_bf16 v[72:87], v[32:35], a[52:55], v[72:87]
ds_read_b64_tr_b16 v[16:17], v2 offset:61440
ds_read_b64_tr_b16 v[18:19], v2 offset:63488
s_waitcnt lgkmcnt(6)
v_mfma_f32_32x32x16_bf16 v[88:103], v[36:39], a[52:55], v[88:103]
ds_read_b64_tr_b16 v[20:21], v3 offset:61440
ds_read_b64_tr_b16 v[22:23], v3 offset:63488
s_add_u32 m0, s83, 25600
s_add_u32 s76, s73, 590464
buffer_load_dwordx4 v1, s[64:67], s76 offen lds
s_waitcnt lgkmcnt(6)
v_mfma_f32_32x32x16_bf16 v[40:55], v[8:11], a[56:59], v[40:55]
ds_read_b64_tr_b16 v[24:25], v2 offset:54272
ds_read_b64_tr_b16 v[26:27], v2 offset:56320
s_waitcnt lgkmcnt(6)
v_mfma_f32_32x32x16_bf16 v[56:71], v[12:15], a[56:59], v[56:71]
ds_read_b64_tr_b16 v[28:29], v3 offset:54272
ds_read_b64_tr_b16 v[30:31], v3 offset:56320
s_waitcnt lgkmcnt(6)
v_mfma_f32_32x32x16_bf16 v[72:87], v[16:19], a[56:59], v[72:87]
ds_read_b64_tr_b16 v[32:33], v2 offset:62464
ds_read_b64_tr_b16 v[34:35], v2 offset:64512
s_waitcnt lgkmcnt(6)
v_mfma_f32_32x32x16_bf16 v[88:103], v[20:23], a[56:59], v[88:103]
ds_read_b64_tr_b16 v[36:37], v3 offset:62464
ds_read_b64_tr_b16 v[38:39], v3 offset:64512
s_waitcnt vmcnt(32)
s_barrier
s_waitcnt lgkmcnt(6)
v_mfma_f32_32x32x16_bf16 v[40:55], v[24:27], a[60:63], v[40:55]
ds_read_b64_tr_b16 v[8:9], v4 offset:0
ds_read_b64_tr_b16 v[10:11], v4 offset:2048
s_waitcnt lgkmcnt(6)
v_mfma_f32_32x32x16_bf16 v[56:71], v[28:31], a[60:63], v[56:71]
ds_read_b64_tr_b16 v[12:13], v5 offset:0
ds_read_b64_tr_b16 v[14:15], v5 offset:2048
s_waitcnt lgkmcnt(6)
v_mfma_f32_32x32x16_bf16 v[72:87], v[32:35], a[60:63], v[72:87]
ds_read_b64_tr_b16 v[16:17], v4 offset:8192
ds_read_b64_tr_b16 v[18:19], v4 offset:10240
s_waitcnt lgkmcnt(6)
v_mfma_f32_32x32x16_bf16 v[88:103], v[36:39], a[60:63], v[88:103]
ds_read_b64_tr_b16 v[20:21], v5 offset:8192
ds_read_b64_tr_b16 v[22:23], v5 offset:10240
s_waitcnt lgkmcnt(6)
v_mfma_f32_32x32x16_bf16 v[40:55], v[8:11], a[64:67], v[40:55]
ds_read_b64_tr_b16 v[24:25], v4 offset:1024
ds_read_b64_tr_b16 v[26:27], v4 offset:3072
s_waitcnt lgkmcnt(6)
v_mfma_f32_32x32x16_bf16 v[56:71], v[12:15], a[64:67], v[56:71]
ds_read_b64_tr_b16 v[28:29], v5 offset:1024
ds_read_b64_tr_b16 v[30:31], v5 offset:3072
s_add_u32 m0, s83, 32768
s_add_u32 s76, s73, 1049088
buffer_load_dwordx4 v1, s[64:67], s76 offen lds
s_waitcnt lgkmcnt(6)
v_mfma_f32_32x32x16_bf16 v[72:87], v[16:19], a[64:67], v[72:87]
ds_read_b64_tr_b16 v[32:33], v4 offset:9216
ds_read_b64_tr_b16 v[34:35], v4 offset:11264
s_waitcnt lgkmcnt(6)
v_mfma_f32_32x32x16_bf16 v[88:103], v[20:23], a[64:67], v[88:103]
ds_read_b64_tr_b16 v[36:37], v5 offset:9216
ds_read_b64_tr_b16 v[38:39], v5 offset:11264
s_add_u32 m0, s83, 33792
s_add_u32 s76, s73, 1114624
buffer_load_dwordx4 v1, s[64:67], s76 offen lds
s_waitcnt lgkmcnt(6)
v_mfma_f32_32x32x16_bf16 v[40:55], v[24:27], a[68:71], v[40:55]
ds_read_b64_tr_b16 v[8:9], v4 offset:4096
ds_read_b64_tr_b16 v[10:11], v4 offset:6144
s_waitcnt lgkmcnt(6)
v_mfma_f32_32x32x16_bf16 v[56:71], v[28:31], a[68:71], v[56:71]
ds_read_b64_tr_b16 v[12:13], v5 offset:4096
ds_read_b64_tr_b16 v[14:15], v5 offset:6144
s_add_u32 m0, s83, 40960
s_add_u32 s76, s73, 1049216
buffer_load_dwordx4 v1, s[64:67], s76 offen lds
s_waitcnt lgkmcnt(6)
v_mfma_f32_32x32x16_bf16 v[72:87], v[32:35], a[68:71], v[72:87]
ds_read_b64_tr_b16 v[16:17], v4 offset:12288
ds_read_b64_tr_b16 v[18:19], v4 offset:14336
s_waitcnt lgkmcnt(6)
v_mfma_f32_32x32x16_bf16 v[88:103], v[36:39], a[68:71], v[88:103]
ds_read_b64_tr_b16 v[20:21], v5 offset:12288
ds_read_b64_tr_b16 v[22:23], v5 offset:14336
s_add_u32 m0, s83, 41984
s_add_u32 s76, s73, 1114752
buffer_load_dwordx4 v1, s[64:67], s76 offen lds
s_waitcnt lgkmcnt(6)
v_mfma_f32_32x32x16_bf16 v[40:55], v[8:11], a[72:75], v[40:55]
ds_read_b64_tr_b16 v[24:25], v4 offset:5120
ds_read_b64_tr_b16 v[26:27], v4 offset:7168
s_waitcnt lgkmcnt(6)
v_mfma_f32_32x32x16_bf16 v[56:71], v[12:15], a[72:75], v[56:71]
ds_read_b64_tr_b16 v[28:29], v5 offset:5120
ds_read_b64_tr_b16 v[30:31], v5 offset:7168
s_waitcnt lgkmcnt(6)
v_mfma_f32_32x32x16_bf16 v[72:87], v[16:19], a[72:75], v[72:87]
ds_read_b64_tr_b16 v[32:33], v4 offset:13312
ds_read_b64_tr_b16 v[34:35], v4 offset:15360
s_waitcnt lgkmcnt(6)
v_mfma_f32_32x32x16_bf16 v[88:103], v[20:23], a[72:75], v[88:103]
ds_read_b64_tr_b16 v[36:37], v5 offset:13312
ds_read_b64_tr_b16 v[38:39], v5 offset:15360
s_waitcnt vmcnt(32)
s_barrier
s_waitcnt lgkmcnt(6)
v_mfma_f32_32x32x16_bf16 v[40:55], v[24:27], a[76:79], v[40:55]
ds_read_b64_tr_b16 v[8:9], v4 offset:16384
ds_read_b64_tr_b16 v[10:11], v4 offset:18432
s_waitcnt lgkmcnt(6)
v_mfma_f32_32x32x16_bf16 v[56:71], v[28:31], a[76:79], v[56:71]
ds_read_b64_tr_b16 v[12:13], v5 offset:16384
ds_read_b64_tr_b16 v[14:15], v5 offset:18432
s_waitcnt lgkmcnt(6)
v_mfma_f32_32x32x16_bf16 v[72:87], v[32:35], a[76:79], v[72:87]
ds_read_b64_tr_b16 v[16:17], v4 offset:24576
ds_read_b64_tr_b16 v[18:19], v4 offset:26624
s_waitcnt lgkmcnt(6)
v_mfma_f32_32x32x16_bf16 v[88:103], v[36:39], a[76:79], v[88:103]
ds_read_b64_tr_b16 v[20:21], v5 offset:24576
ds_read_b64_tr_b16 v[22:23], v5 offset:26624
s_waitcnt lgkmcnt(6)
v_mfma_f32_32x32x16_bf16 v[40:55], v[8:11], a[80:83], v[40:55]
ds_read_b64_tr_b16 v[24:25], v4 offset:17408
ds_read_b64_tr_b16 v[26:27], v4 offset:19456
s_waitcnt lgkmcnt(6)
v_mfma_f32_32x32x16_bf16 v[56:71], v[12:15], a[80:83], v[56:71]
ds_read_b64_tr_b16 v[28:29], v5 offset:17408
ds_read_b64_tr_b16 v[30:31], v5 offset:19456
s_add_u32 m0, s83, 49152
s_add_u32 s76, s73, 1573376
buffer_load_dwordx4 v1, s[64:67], s76 offen lds
s_waitcnt lgkmcnt(6)
v_mfma_f32_32x32x16_bf16 v[72:87], v[16:19], a[80:83], v[72:87]
ds_read_b64_tr_b16 v[32:33], v4 offset:25600
ds_read_b64_tr_b16 v[34:35], v4 offset:27648
s_waitcnt lgkmcnt(6)
v_mfma_f32_32x32x16_bf16 v[88:103], v[20:23], a[80:83], v[88:103]
ds_read_b64_tr_b16 v[36:37], v5 offset:25600
ds_read_b64_tr_b16 v[38:39], v5 offset:27648
s_add_u32 m0, s83, 50176
s_add_u32 s76, s73, 1638912
buffer_load_dwordx4 v1, s[64:67], s76 offen lds
s_waitcnt lgkmcnt(6)
v_mfma_f32_32x32x16_bf16 v[40:55], v[24:27], a[84:87], v[40:55]
ds_read_b64_tr_b16 v[8:9], v4 offset:20480
ds_read_b64_tr_b16 v[10:11], v4 offset:22528
s_waitcnt lgkmcnt(6)
v_mfma_f32_32x32x16_bf16 v[56:71], v[28:31], a[84:87], v[56:71]
ds_read_b64_tr_b16 v[12:13], v5 offset:20480
ds_read_b64_tr_b16 v[14:15], v5 offset:22528
s_add_u32 m0, s83, 57344
s_add_u32 s76, s73, 1573504
buffer_load_dwordx4 v1, s[64:67], s76 offen lds
s_waitcnt lgkmcnt(6)
v_mfma_f32_32x32x16_bf16 v[72:87], v[32:35], a[84:87], v[72:87]
ds_read_b64_tr_b16 v[16:17], v4 offset:28672
ds_read_b64_tr_b16 v[18:19], v4 offset:30720
s_waitcnt lgkmcnt(6)
v_mfma_f32_32x32x16_bf16 v[88:103], v[36:39], a[84:87], v[88:103]
ds_read_b64_tr_b16 v[20:21], v5 offset:28672
ds_read_b64_tr_b16 v[22:23], v5 offset:30720
s_add_u32 m0, s83, 58368
s_add_u32 s76, s73, 1639040
buffer_load_dwordx4 v1, s[64:67], s76 offen lds
s_waitcnt lgkmcnt(6)
v_mfma_f32_32x32x16_bf16 v[40:55], v[8:11], a[88:91], v[40:55]
ds_read_b64_tr_b16 v[24:25], v4 offset:21504
ds_read_b64_tr_b16 v[26:27], v4 offset:23552
s_waitcnt lgkmcnt(6)
v_mfma_f32_32x32x16_bf16 v[56:71], v[12:15], a[88:91], v[56:71]
ds_read_b64_tr_b16 v[28:29], v5 offset:21504
ds_read_b64_tr_b16 v[30:31], v5 offset:23552
s_waitcnt lgkmcnt(6)
v_mfma_f32_32x32x16_bf16 v[72:87], v[16:19], a[88:91], v[72:87]
ds_read_b64_tr_b16 v[32:33], v4 offset:29696
ds_read_b64_tr_b16 v[34:35], v4 offset:31744
s_waitcnt lgkmcnt(6)
v_mfma_f32_32x32x16_bf16 v[88:103], v[20:23], a[88:91], v[88:103]
ds_read_b64_tr_b16 v[36:37], v5 offset:29696
ds_read_b64_tr_b16 v[38:39], v5 offset:31744
s_waitcnt vmcnt(24)
s_barrier
s_waitcnt lgkmcnt(6)
v_mfma_f32_32x32x16_bf16 v[40:55], v[24:27], a[92:95], v[40:55]
ds_read_b64_tr_b16 v[8:9], v4 offset:32768
ds_read_b64_tr_b16 v[10:11], v4 offset:34816
s_waitcnt lgkmcnt(6)
v_mfma_f32_32x32x16_bf16 v[56:71], v[28:31], a[92:95], v[56:71]
ds_read_b64_tr_b16 v[12:13], v5 offset:32768
ds_read_b64_tr_b16 v[14:15], v5 offset:34816
s_waitcnt lgkmcnt(6)
v_mfma_f32_32x32x16_bf16 v[72:87], v[32:35], a[92:95], v[72:87]
ds_read_b64_tr_b16 v[16:17], v4 offset:40960
ds_read_b64_tr_b16 v[18:19], v4 offset:43008
s_waitcnt lgkmcnt(6)
v_mfma_f32_32x32x16_bf16 v[88:103], v[36:39], a[92:95], v[88:103]
ds_read_b64_tr_b16 v[20:21], v5 offset:40960
ds_read_b64_tr_b16 v[22:23], v5 offset:43008
s_waitcnt lgkmcnt(6)
v_mfma_f32_32x32x16_bf16 v[40:55], v[8:11], a[96:99], v[40:55]
ds_read_b64_tr_b16 v[24:25], v4 offset:33792
ds_read_b64_tr_b16 v[26:27], v4 offset:35840
s_waitcnt lgkmcnt(6)
v_mfma_f32_32x32x16_bf16 v[56:71], v[12:15], a[96:99], v[56:71]
ds_read_b64_tr_b16 v[28:29], v5 offset:33792
ds_read_b64_tr_b16 v[30:31], v5 offset:35840
s_add_u32 m0, s83, 65536
s_add_u32 s76, s73, 2097664
buffer_load_dwordx4 v1, s[64:67], s76 offen lds
s_waitcnt lgkmcnt(6)
v_mfma_f32_32x32x16_bf16 v[72:87], v[16:19], a[96:99], v[72:87]
ds_read_b64_tr_b16 v[32:33], v4 offset:41984
ds_read_b64_tr_b16 v[34:35], v4 offset:44032
s_waitcnt lgkmcnt(6)
v_mfma_f32_32x32x16_bf16 v[88:103], v[20:23], a[96:99], v[88:103]
ds_read_b64_tr_b16 v[36:37], v5 offset:41984
ds_read_b64_tr_b16 v[38:39], v5 offset:44032
s_add_u32 m0, s83, 66560
s_add_u32 s76, s73, 2163200
buffer_load_dwordx4 v1, s[64:67], s76 offen lds
s_waitcnt lgkmcnt(6)
v_mfma_f32_32x32x16_bf16 v[40:55], v[24:27], a[100:103], v[40:55]
ds_read_b64_tr_b16 v[8:9], v4 offset:36864
ds_read_b64_tr_b16 v[10:11], v4 offset:38912
s_waitcnt lgkmcnt(6)
v_mfma_f32_32x32x16_bf16 v[56:71], v[28:31], a[100:103], v[56:71]
ds_read_b64_tr_b16 v[12:13], v5 offset:36864
ds_read_b64_tr_b16 v[14:15], v5 offset:38912
s_add_u32 m0, s83, 73728
s_add_u32 s76, s73, 2097792
buffer_load_dwordx4 v1, s[64:67], s76 offen lds
s_waitcnt lgkmcnt(6)
v_mfma_f32_32x32x16_bf16 v[72:87], v[32:35], a[100:103], v[72:87]
ds_read_b64_tr_b16 v[16:17], v4 offset:45056
ds_read_b64_tr_b16 v[18:19], v4 offset:47104
s_waitcnt lgkmcnt(6)
v_mfma_f32_32x32x16_bf16 v[88:103], v[36:39], a[100:103], v[88:103]
ds_read_b64_tr_b16 v[20:21], v5 offset:45056
ds_read_b64_tr_b16 v[22:23], v5 offset:47104
s_add_u32 m0, s83, 74752
s_add_u32 s76, s73, 2163328
buffer_load_dwordx4 v1, s[64:67], s76 offen lds
s_waitcnt lgkmcnt(6)
v_mfma_f32_32x32x16_bf16 v[40:55], v[8:11], a[104:107], v[40:55]
ds_read_b64_tr_b16 v[24:25], v4 offset:37888
ds_read_b64_tr_b16 v[26:27], v4 offset:39936
s_waitcnt lgkmcnt(6)
v_mfma_f32_32x32x16_bf16 v[56:71], v[12:15], a[104:107], v[56:71]
ds_read_b64_tr_b16 v[28:29], v5 offset:37888
ds_read_b64_tr_b16 v[30:31], v5 offset:39936
s_waitcnt lgkmcnt(6)
v_mfma_f32_32x32x16_bf16 v[72:87], v[16:19], a[104:107], v[72:87]
ds_read_b64_tr_b16 v[32:33], v4 offset:46080
ds_read_b64_tr_b16 v[34:35], v4 offset:48128
s_waitcnt lgkmcnt(6)
v_mfma_f32_32x32x16_bf16 v[88:103], v[20:23], a[104:107], v[88:103]
ds_read_b64_tr_b16 v[36:37], v5 offset:46080
ds_read_b64_tr_b16 v[38:39], v5 offset:48128
s_waitcnt vmcnt(24)
s_barrier
s_waitcnt lgkmcnt(6)
v_mfma_f32_32x32x16_bf16 v[40:55], v[24:27], a[108:111], v[40:55]
ds_read_b64_tr_b16 v[8:9], v4 offset:49152
ds_read_b64_tr_b16 v[10:11], v4 offset:51200
s_waitcnt lgkmcnt(6)
v_mfma_f32_32x32x16_bf16 v[56:71], v[28:31], a[108:111], v[56:71]
ds_read_b64_tr_b16 v[12:13], v5 offset:49152
ds_read_b64_tr_b16 v[14:15], v5 offset:51200
s_waitcnt lgkmcnt(6)
v_mfma_f32_32x32x16_bf16 v[72:87], v[32:35], a[108:111], v[72:87]
ds_read_b64_tr_b16 v[16:17], v4 offset:57344
ds_read_b64_tr_b16 v[18:19], v4 offset:59392
s_waitcnt lgkmcnt(6)
v_mfma_f32_32x32x16_bf16 v[88:103], v[36:39], a[108:111], v[88:103]
ds_read_b64_tr_b16 v[20:21], v5 offset:57344
ds_read_b64_tr_b16 v[22:23], v5 offset:59392
s_waitcnt lgkmcnt(6)
v_mfma_f32_32x32x16_bf16 v[40:55], v[8:11], a[112:115], v[40:55]
ds_read_b64_tr_b16 v[24:25], v4 offset:50176
ds_read_b64_tr_b16 v[26:27], v4 offset:52224
s_waitcnt lgkmcnt(6)
v_mfma_f32_32x32x16_bf16 v[56:71], v[12:15], a[112:115], v[56:71]
ds_read_b64_tr_b16 v[28:29], v5 offset:50176
ds_read_b64_tr_b16 v[30:31], v5 offset:52224
s_add_u32 m0, s83, 81920
s_add_u32 s76, s73, 2621952
buffer_load_dwordx4 v1, s[64:67], s76 offen lds
s_waitcnt lgkmcnt(6)
v_mfma_f32_32x32x16_bf16 v[72:87], v[16:19], a[112:115], v[72:87]
ds_read_b64_tr_b16 v[32:33], v4 offset:58368
ds_read_b64_tr_b16 v[34:35], v4 offset:60416
s_waitcnt lgkmcnt(6)
v_mfma_f32_32x32x16_bf16 v[88:103], v[20:23], a[112:115], v[88:103]
ds_read_b64_tr_b16 v[36:37], v5 offset:58368
ds_read_b64_tr_b16 v[38:39], v5 offset:60416
s_add_u32 m0, s83, 82944
s_add_u32 s76, s73, 2687488
buffer_load_dwordx4 v1, s[64:67], s76 offen lds
s_waitcnt lgkmcnt(6)
v_mfma_f32_32x32x16_bf16 v[40:55], v[24:27], a[116:119], v[40:55]
ds_read_b64_tr_b16 v[8:9], v4 offset:53248
ds_read_b64_tr_b16 v[10:11], v4 offset:55296
s_waitcnt lgkmcnt(6)
v_mfma_f32_32x32x16_bf16 v[56:71], v[28:31], a[116:119], v[56:71]
ds_read_b64_tr_b16 v[12:13], v5 offset:53248
ds_read_b64_tr_b16 v[14:15], v5 offset:55296
s_add_u32 m0, s83, 90112
s_add_u32 s76, s73, 2622080
buffer_load_dwordx4 v1, s[64:67], s76 offen lds
s_waitcnt lgkmcnt(6)
v_mfma_f32_32x32x16_bf16 v[72:87], v[32:35], a[116:119], v[72:87]
ds_read_b64_tr_b16 v[16:17], v4 offset:61440
ds_read_b64_tr_b16 v[18:19], v4 offset:63488
s_waitcnt lgkmcnt(6)
v_mfma_f32_32x32x16_bf16 v[88:103], v[36:39], a[116:119], v[88:103]
ds_read_b64_tr_b16 v[20:21], v5 offset:61440
ds_read_b64_tr_b16 v[22:23], v5 offset:63488
s_add_u32 m0, s83, 91136
s_add_u32 s76, s73, 2687616
buffer_load_dwordx4 v1, s[64:67], s76 offen lds
s_waitcnt lgkmcnt(6)
v_mfma_f32_32x32x16_bf16 v[40:55], v[8:11], a[120:123], v[40:55]
ds_read_b64_tr_b16 v[24:25], v4 offset:54272
ds_read_b64_tr_b16 v[26:27], v4 offset:56320
s_waitcnt lgkmcnt(6)
v_mfma_f32_32x32x16_bf16 v[56:71], v[12:15], a[120:123], v[56:71]
ds_read_b64_tr_b16 v[28:29], v5 offset:54272
ds_read_b64_tr_b16 v[30:31], v5 offset:56320
s_waitcnt lgkmcnt(6)
v_mfma_f32_32x32x16_bf16 v[72:87], v[16:19], a[120:123], v[72:87]
ds_read_b64_tr_b16 v[32:33], v4 offset:62464
ds_read_b64_tr_b16 v[34:35], v4 offset:64512
s_waitcnt lgkmcnt(6)
v_mfma_f32_32x32x16_bf16 v[88:103], v[20:23], a[120:123], v[88:103]
ds_read_b64_tr_b16 v[36:37], v5 offset:62464
ds_read_b64_tr_b16 v[38:39], v5 offset:64512
s_waitcnt vmcnt(24)
s_barrier
s_waitcnt lgkmcnt(6)
v_mfma_f32_32x32x16_bf16 v[40:55], v[24:27], a[124:127], v[40:55]
ds_read_b64_tr_b16 v[8:9], v6 offset:0
ds_read_b64_tr_b16 v[10:11], v6 offset:2048
s_waitcnt lgkmcnt(6)
v_mfma_f32_32x32x16_bf16 v[56:71], v[28:31], a[124:127], v[56:71]
ds_read_b64_tr_b16 v[12:13], v7 offset:0
ds_read_b64_tr_b16 v[14:15], v7 offset:2048
s_waitcnt lgkmcnt(6)
v_mfma_f32_32x32x16_bf16 v[72:87], v[32:35], a[124:127], v[72:87]
ds_read_b64_tr_b16 v[16:17], v6 offset:8192
ds_read_b64_tr_b16 v[18:19], v6 offset:10240
s_waitcnt lgkmcnt(6)
v_mfma_f32_32x32x16_bf16 v[88:103], v[36:39], a[124:127], v[88:103]
ds_read_b64_tr_b16 v[20:21], v7 offset:8192
ds_read_b64_tr_b16 v[22:23], v7 offset:10240
s_waitcnt lgkmcnt(6)
v_mfma_f32_32x32x16_bf16 v[40:55], v[8:11], a[128:131], v[40:55]
ds_read_b64_tr_b16 v[24:25], v6 offset:1024
ds_read_b64_tr_b16 v[26:27], v6 offset:3072
s_waitcnt lgkmcnt(6)
v_mfma_f32_32x32x16_bf16 v[56:71], v[12:15], a[128:131], v[56:71]
ds_read_b64_tr_b16 v[28:29], v7 offset:1024
ds_read_b64_tr_b16 v[30:31], v7 offset:3072
s_add_u32 m0, s83, 98304
s_add_u32 s76, s73, 3146240
buffer_load_dwordx4 v1, s[64:67], s76 offen lds
s_waitcnt lgkmcnt(6)
v_mfma_f32_32x32x16_bf16 v[72:87], v[16:19], a[128:131], v[72:87]
ds_read_b64_tr_b16 v[32:33], v6 offset:9216
ds_read_b64_tr_b16 v[34:35], v6 offset:11264
s_waitcnt lgkmcnt(6)
v_mfma_f32_32x32x16_bf16 v[88:103], v[20:23], a[128:131], v[88:103]
ds_read_b64_tr_b16 v[36:37], v7 offset:9216
ds_read_b64_tr_b16 v[38:39], v7 offset:11264
s_add_u32 m0, s83, 99328
s_add_u32 s76, s73, 3211776
buffer_load_dwordx4 v1, s[64:67], s76 offen lds
s_waitcnt lgkmcnt(6)
v_mfma_f32_32x32x16_bf16 v[40:55], v[24:27], a[132:135], v[40:55]
ds_read_b64_tr_b16 v[8:9], v6 offset:4096
ds_read_b64_tr_b16 v[10:11], v6 offset:6144
s_waitcnt lgkmcnt(6)
v_mfma_f32_32x32x16_bf16 v[56:71], v[28:31], a[132:135], v[56:71]
ds_read_b64_tr_b16 v[12:13], v7 offset:4096
ds_read_b64_tr_b16 v[14:15], v7 offset:6144
s_add_u32 m0, s83, 106496
s_add_u32 s76, s73, 3146368
buffer_load_dwordx4 v1, s[64:67], s76 offen lds
s_waitcnt lgkmcnt(6)
v_mfma_f32_32x32x16_bf16 v[72:87], v[32:35], a[132:135], v[72:87]
ds_read_b64_tr_b16 v[16:17], v6 offset:12288
ds_read_b64_tr_b16 v[18:19], v6 offset:14336
s_waitcnt lgkmcnt(6)
v_mfma_f32_32x32x16_bf16 v[88:103], v[36:39], a[132:135], v[88:103]
ds_read_b64_tr_b16 v[20:21], v7 offset:12288
ds_read_b64_tr_b16 v[22:23], v7 offset:14336
s_add_u32 m0, s83, 107520
s_add_u32 s76, s73, 3211904
buffer_load_dwordx4 v1, s[64:67], s76 offen lds
s_waitcnt lgkmcnt(6)
v_mfma_f32_32x32x16_bf16 v[40:55], v[8:11], a[136:139], v[40:55]
ds_read_b64_tr_b16 v[24:25], v6 offset:5120
ds_read_b64_tr_b16 v[26:27], v6 offset:7168
s_waitcnt lgkmcnt(6)
v_mfma_f32_32x32x16_bf16 v[56:71], v[12:15], a[136:139], v[56:71]
ds_read_b64_tr_b16 v[28:29], v7 offset:5120
ds_read_b64_tr_b16 v[30:31], v7 offset:7168
s_waitcnt lgkmcnt(6)
v_mfma_f32_32x32x16_bf16 v[72:87], v[16:19], a[136:139], v[72:87]
ds_read_b64_tr_b16 v[32:33], v6 offset:13312
ds_read_b64_tr_b16 v[34:35], v6 offset:15360
s_waitcnt lgkmcnt(6)
v_mfma_f32_32x32x16_bf16 v[88:103], v[20:23], a[136:139], v[88:103]
ds_read_b64_tr_b16 v[36:37], v7 offset:13312
ds_read_b64_tr_b16 v[38:39], v7 offset:15360
s_waitcnt vmcnt(24)
s_barrier
s_waitcnt lgkmcnt(6)
v_mfma_f32_32x32x16_bf16 v[40:55], v[24:27], a[140:143], v[40:55]
ds_read_b64_tr_b16 v[8:9], v2 offset:0
ds_read_b64_tr_b16 v[10:11], v2 offset:2048
s_waitcnt lgkmcnt(6)
v_mfma_f32_32x32x16_bf16 v[56:71], v[28:31], a[140:143], v[56:71]
ds_read_b64_tr_b16 v[12:13], v3 offset:0
ds_read_b64_tr_b16 v[14:15], v3 offset:2048
s_waitcnt lgkmcnt(6)
v_mfma_f32_32x32x16_bf16 v[72:87], v[32:35], a[140:143], v[72:87]
ds_read_b64_tr_b16 v[16:17], v2 offset:8192
ds_read_b64_tr_b16 v[18:19], v2 offset:10240
s_waitcnt lgkmcnt(6)
v_mfma_f32_32x32x16_bf16 v[88:103], v[36:39], a[140:143], v[88:103]
ds_read_b64_tr_b16 v[20:21], v3 offset:8192
ds_read_b64_tr_b16 v[22:23], v3 offset:10240
s_nop 11
s_add_u32 s77, s82, 8192
v_cvt_pk_bf16_f32 v106, v40, v41
v_cvt_pk_bf16_f32 v107, v42, v43
v_cvt_pk_bf16_f32 v108, v48, v49
v_cvt_pk_bf16_f32 v109, v50, v51
buffer_store_dwordx4 v[106:109], v104, s[8:11], s77 offen offset:0 sc1
v_cvt_pk_bf16_f32 v110, v44, v45
v_cvt_pk_bf16_f32 v111, v46, v47
v_cvt_pk_bf16_f32 v112, v52, v53
v_cvt_pk_bf16_f32 v113, v54, v55
buffer_store_dwordx4 v[110:113], v104, s[8:11], s77 offen offset:512 sc1
s_add_u32 s77, s82, 10240
v_cvt_pk_bf16_f32 v114, v56, v57
v_cvt_pk_bf16_f32 v115, v58, v59
v_cvt_pk_bf16_f32 v116, v64, v65
v_cvt_pk_bf16_f32 v117, v66, v67
buffer_store_dwordx4 v[114:117], v104, s[8:11], s77 offen offset:0 sc1
v_cvt_pk_bf16_f32 v118, v60, v61
v_cvt_pk_bf16_f32 v119, v62, v63
v_cvt_pk_bf16_f32 v120, v68, v69
v_cvt_pk_bf16_f32 v121, v70, v71
buffer_store_dwordx4 v[118:121], v104, s[8:11], s77 offen offset:512 sc1
s_add_u32 s77, s82, 12288
v_cvt_pk_bf16_f32 v106, v72, v73
v_cvt_pk_bf16_f32 v107, v74, v75
v_cvt_pk_bf16_f32 v108, v80, v81
v_cvt_pk_bf16_f32 v109, v82, v83
buffer_store_dwordx4 v[106:109], v104, s[8:11], s77 offen offset:0 sc1
v_cvt_pk_bf16_f32 v110, v76, v77
v_cvt_pk_bf16_f32 v111, v78, v79
v_cvt_pk_bf16_f32 v112, v84, v85
v_cvt_pk_bf16_f32 v113, v86, v87
buffer_store_dwordx4 v[110:113], v104, s[8:11], s77 offen offset:512 sc1
s_add_u32 s77, s82, 14336
v_cvt_pk_bf16_f32 v114, v88, v89
v_cvt_pk_bf16_f32 v115, v90, v91
v_cvt_pk_bf16_f32 v116, v96, v97
v_cvt_pk_bf16_f32 v117, v98, v99
buffer_store_dwordx4 v[114:117], v104, s[8:11], s77 offen offset:0 sc1
v_cvt_pk_bf16_f32 v118, v92, v93
v_cvt_pk_bf16_f32 v119, v94, v95
v_cvt_pk_bf16_f32 v120, v100, v101
v_cvt_pk_bf16_f32 v121, v102, v103
buffer_store_dwordx4 v[118:121], v104, s[8:11], s77 offen offset:512 sc1
s_waitcnt lgkmcnt(6)
v_mfma_f32_32x32x16_bf16 v[40:55], v[8:11], a[0:3], 0
ds_read_b64_tr_b16 v[24:25], v2 offset:1024
ds_read_b64_tr_b16 v[26:27], v2 offset:3072
s_waitcnt lgkmcnt(6)
v_mfma_f32_32x32x16_bf16 v[56:71], v[12:15], a[0:3], 0
ds_read_b64_tr_b16 v[28:29], v3 offset:1024
ds_read_b64_tr_b16 v[30:31], v3 offset:3072
s_add_u32 m0, s83, 114688
s_add_u32 s76, s73, 3670528
buffer_load_dwordx4 v1, s[64:67], s76 offen lds
s_waitcnt lgkmcnt(6)
v_mfma_f32_32x32x16_bf16 v[72:87], v[16:19], a[0:3], 0
ds_read_b64_tr_b16 v[32:33], v2 offset:9216
ds_read_b64_tr_b16 v[34:35], v2 offset:11264
s_waitcnt lgkmcnt(6)
v_mfma_f32_32x32x16_bf16 v[88:103], v[20:23], a[0:3], 0
ds_read_b64_tr_b16 v[36:37], v3 offset:9216
ds_read_b64_tr_b16 v[38:39], v3 offset:11264
s_add_u32 m0, s83, 115712
s_add_u32 s76, s73, 3736064
buffer_load_dwordx4 v1, s[64:67], s76 offen lds
s_waitcnt lgkmcnt(6)
v_mfma_f32_32x32x16_bf16 v[40:55], v[24:27], a[4:7], v[40:55]
ds_read_b64_tr_b16 v[8:9], v2 offset:4096
ds_read_b64_tr_b16 v[10:11], v2 offset:6144
s_waitcnt lgkmcnt(6)
v_mfma_f32_32x32x16_bf16 v[56:71], v[28:31], a[4:7], v[56:71]
ds_read_b64_tr_b16 v[12:13], v3 offset:4096
ds_read_b64_tr_b16 v[14:15], v3 offset:6144
s_add_u32 m0, s83, 122880
s_add_u32 s76, s73, 3670656
buffer_load_dwordx4 v1, s[64:67], s76 offen lds
s_waitcnt lgkmcnt(6)
v_mfma_f32_32x32x16_bf16 v[72:87], v[32:35], a[4:7], v[72:87]
ds_read_b64_tr_b16 v[16:17], v2 offset:12288
ds_read_b64_tr_b16 v[18:19], v2 offset:14336
s_waitcnt lgkmcnt(6)
v_mfma_f32_32x32x16_bf16 v[88:103], v[36:39], a[4:7], v[88:103]
ds_read_b64_tr_b16 v[20:21], v3 offset:12288
ds_read_b64_tr_b16 v[22:23], v3 offset:14336
s_add_u32 m0, s83, 123904
s_add_u32 s76, s73, 3736192
buffer_load_dwordx4 v1, s[64:67], s76 offen lds
s_waitcnt lgkmcnt(6)
v_mfma_f32_32x32x16_bf16 v[40:55], v[8:11], a[8:11], v[40:55]
ds_read_b64_tr_b16 v[24:25], v2 offset:5120
ds_read_b64_tr_b16 v[26:27], v2 offset:7168
s_waitcnt lgkmcnt(6)
v_mfma_f32_32x32x16_bf16 v[56:71], v[12:15], a[8:11], v[56:71]
ds_read_b64_tr_b16 v[28:29], v3 offset:5120
ds_read_b64_tr_b16 v[30:31], v3 offset:7168
s_waitcnt lgkmcnt(6)
v_mfma_f32_32x32x16_bf16 v[72:87], v[16:19], a[8:11], v[72:87]
ds_read_b64_tr_b16 v[32:33], v2 offset:13312
ds_read_b64_tr_b16 v[34:35], v2 offset:15360
s_waitcnt lgkmcnt(6)
v_mfma_f32_32x32x16_bf16 v[88:103], v[20:23], a[8:11], v[88:103]
ds_read_b64_tr_b16 v[36:37], v3 offset:13312
ds_read_b64_tr_b16 v[38:39], v3 offset:15360
s_waitcnt vmcnt(32)
s_barrier
s_waitcnt lgkmcnt(6)
v_mfma_f32_32x32x16_bf16 v[40:55], v[24:27], a[12:15], v[40:55]
ds_read_b64_tr_b16 v[8:9], v2 offset:16384
ds_read_b64_tr_b16 v[10:11], v2 offset:18432
s_waitcnt lgkmcnt(6)
v_mfma_f32_32x32x16_bf16 v[56:71], v[28:31], a[12:15], v[56:71]
ds_read_b64_tr_b16 v[12:13], v3 offset:16384
ds_read_b64_tr_b16 v[14:15], v3 offset:18432
s_waitcnt lgkmcnt(6)
v_mfma_f32_32x32x16_bf16 v[72:87], v[32:35], a[12:15], v[72:87]
ds_read_b64_tr_b16 v[16:17], v2 offset:24576
ds_read_b64_tr_b16 v[18:19], v2 offset:26624
s_waitcnt lgkmcnt(6)
v_mfma_f32_32x32x16_bf16 v[88:103], v[36:39], a[12:15], v[88:103]
ds_read_b64_tr_b16 v[20:21], v3 offset:24576
ds_read_b64_tr_b16 v[22:23], v3 offset:26624
s_waitcnt lgkmcnt(6)
v_mfma_f32_32x32x16_bf16 v[40:55], v[8:11], a[16:19], v[40:55]
ds_read_b64_tr_b16 v[24:25], v2 offset:17408
ds_read_b64_tr_b16 v[26:27], v2 offset:19456
s_waitcnt lgkmcnt(6)
v_mfma_f32_32x32x16_bf16 v[56:71], v[12:15], a[16:19], v[56:71]
ds_read_b64_tr_b16 v[28:29], v3 offset:17408
ds_read_b64_tr_b16 v[30:31], v3 offset:19456
s_add_u32 m0, s83, 131072
s_add_u32 s76, s73, 4194816
buffer_load_dwordx4 v1, s[64:67], s76 offen lds
s_waitcnt lgkmcnt(6)
v_mfma_f32_32x32x16_bf16 v[72:87], v[16:19], a[16:19], v[72:87]
ds_read_b64_tr_b16 v[32:33], v2 offset:25600
ds_read_b64_tr_b16 v[34:35], v2 offset:27648
s_waitcnt lgkmcnt(6)
v_mfma_f32_32x32x16_bf16 v[88:103], v[20:23], a[16:19], v[88:103]
ds_read_b64_tr_b16 v[36:37], v3 offset:25600
ds_read_b64_tr_b16 v[38:39], v3 offset:27648
s_add_u32 m0, s83, 132096
s_add_u32 s76, s73, 4260352
buffer_load_dwordx4 v1, s[64:67], s76 offen lds
s_waitcnt lgkmcnt(6)
v_mfma_f32_32x32x16_bf16 v[40:55], v[24:27], a[20:23], v[40:55]
ds_read_b64_tr_b16 v[8:9], v2 offset:20480
ds_read_b64_tr_b16 v[10:11], v2 offset:22528
s_waitcnt lgkmcnt(6)
v_mfma_f32_32x32x16_bf16 v[56:71], v[28:31], a[20:23], v[56:71]
ds_read_b64_tr_b16 v[12:13], v3 offset:20480
ds_read_b64_tr_b16 v[14:15], v3 offset:22528
s_add_u32 m0, s83, 139264
s_add_u32 s76, s73, 4194944
buffer_load_dwordx4 v1, s[64:67], s76 offen lds
s_waitcnt lgkmcnt(6)
v_mfma_f32_32x32x16_bf16 v[72:87], v[32:35], a[20:23], v[72:87]
ds_read_b64_tr_b16 v[16:17], v2 offset:28672
ds_read_b64_tr_b16 v[18:19], v2 offset:30720
s_waitcnt lgkmcnt(6)
v_mfma_f32_32x32x16_bf16 v[88:103], v[36:39], a[20:23], v[88:103]
ds_read_b64_tr_b16 v[20:21], v3 offset:28672
ds_read_b64_tr_b16 v[22:23], v3 offset:30720
s_add_u32 m0, s83, 140288
s_add_u32 s76, s73, 4260480
buffer_load_dwordx4 v1, s[64:67], s76 offen lds
s_waitcnt lgkmcnt(6)
v_mfma_f32_32x32x16_bf16 v[40:55], v[8:11], a[24:27], v[40:55]
ds_read_b64_tr_b16 v[24:25], v2 offset:21504
ds_read_b64_tr_b16 v[26:27], v2 offset:23552
s_waitcnt lgkmcnt(6)
v_mfma_f32_32x32x16_bf16 v[56:71], v[12:15], a[24:27], v[56:71]
ds_read_b64_tr_b16 v[28:29], v3 offset:21504
ds_read_b64_tr_b16 v[30:31], v3 offset:23552
s_waitcnt lgkmcnt(6)
v_mfma_f32_32x32x16_bf16 v[72:87], v[16:19], a[24:27], v[72:87]
ds_read_b64_tr_b16 v[32:33], v2 offset:29696
ds_read_b64_tr_b16 v[34:35], v2 offset:31744
s_waitcnt lgkmcnt(6)
v_mfma_f32_32x32x16_bf16 v[88:103], v[20:23], a[24:27], v[88:103]
ds_read_b64_tr_b16 v[36:37], v3 offset:29696
ds_read_b64_tr_b16 v[38:39], v3 offset:31744
s_waitcnt vmcnt(32)
s_barrier
s_waitcnt lgkmcnt(6)
v_mfma_f32_32x32x16_bf16 v[40:55], v[24:27], a[28:31], v[40:55]
ds_read_b64_tr_b16 v[8:9], v2 offset:32768
ds_read_b64_tr_b16 v[10:11], v2 offset:34816
s_waitcnt lgkmcnt(6)
v_mfma_f32_32x32x16_bf16 v[56:71], v[28:31], a[28:31], v[56:71]
ds_read_b64_tr_b16 v[12:13], v3 offset:32768
ds_read_b64_tr_b16 v[14:15], v3 offset:34816
s_waitcnt lgkmcnt(6)
v_mfma_f32_32x32x16_bf16 v[72:87], v[32:35], a[28:31], v[72:87]
ds_read_b64_tr_b16 v[16:17], v2 offset:40960
ds_read_b64_tr_b16 v[18:19], v2 offset:43008
s_waitcnt lgkmcnt(6)
v_mfma_f32_32x32x16_bf16 v[88:103], v[36:39], a[28:31], v[88:103]
ds_read_b64_tr_b16 v[20:21], v3 offset:40960
ds_read_b64_tr_b16 v[22:23], v3 offset:43008
s_waitcnt lgkmcnt(6)
v_mfma_f32_32x32x16_bf16 v[40:55], v[8:11], a[32:35], v[40:55]
ds_read_b64_tr_b16 v[24:25], v2 offset:33792
ds_read_b64_tr_b16 v[26:27], v2 offset:35840
s_waitcnt lgkmcnt(6)
v_mfma_f32_32x32x16_bf16 v[56:71], v[12:15], a[32:35], v[56:71]
ds_read_b64_tr_b16 v[28:29], v3 offset:33792
ds_read_b64_tr_b16 v[30:31], v3 offset:35840
s_add_u32 m0, s83, 0
s_add_u32 s76, s73, 768
buffer_load_dwordx4 v1, s[64:67], s76 offen lds
s_waitcnt lgkmcnt(6)
v_mfma_f32_32x32x16_bf16 v[72:87], v[16:19], a[32:35], v[72:87]
ds_read_b64_tr_b16 v[32:33], v2 offset:41984
ds_read_b64_tr_b16 v[34:35], v2 offset:44032
s_waitcnt lgkmcnt(6)
v_mfma_f32_32x32x16_bf16 v[88:103], v[20:23], a[32:35], v[88:103]
ds_read_b64_tr_b16 v[36:37], v3 offset:41984
ds_read_b64_tr_b16 v[38:39], v3 offset:44032
s_add_u32 m0, s83, 1024
s_add_u32 s76, s73, 66304
buffer_load_dwordx4 v1, s[64:67], s76 offen lds
s_waitcnt lgkmcnt(6)
v_mfma_f32_32x32x16_bf16 v[40:55], v[24:27], a[36:39], v[40:55]
ds_read_b64_tr_b16 v[8:9], v2 offset:36864
ds_read_b64_tr_b16 v[10:11], v2 offset:38912
s_waitcnt lgkmcnt(6)
v_mfma_f32_32x32x16_bf16 v[56:71], v[28:31], a[36:39], v[56:71]
ds_read_b64_tr_b16 v[12:13], v3 offset:36864
ds_read_b64_tr_b16 v[14:15], v3 offset:38912
s_add_u32 m0, s83, 8192
s_add_u32 s76, s73, 896
buffer_load_dwordx4 v1, s[64:67], s76 offen lds
s_waitcnt lgkmcnt(6)
v_mfma_f32_32x32x16_bf16 v[72:87], v[32:35], a[36:39], v[72:87]
ds_read_b64_tr_b16 v[16:17], v2 offset:45056
ds_read_b64_tr_b16 v[18:19], v2 offset:47104
s_waitcnt lgkmcnt(6)
v_mfma_f32_32x32x16_bf16 v[88:103], v[36:39], a[36:39], v[88:103]
ds_read_b64_tr_b16 v[20:21], v3 offset:45056
ds_read_b64_tr_b16 v[22:23], v3 offset:47104
s_add_u32 m0, s83, 9216
s_add_u32 s76, s73, 66432
buffer_load_dwordx4 v1, s[64:67], s76 offen lds
s_waitcnt lgkmcnt(6)
v_mfma_f32_32x32x16_bf16 v[40:55], v[8:11], a[40:43], v[40:55]
ds_read_b64_tr_b16 v[24:25], v2 offset:37888
ds_read_b64_tr_b16 v[26:27], v2 offset:39936
s_waitcnt lgkmcnt(6)
v_mfma_f32_32x32x16_bf16 v[56:71], v[12:15], a[40:43], v[56:71]
ds_read_b64_tr_b16 v[28:29], v3 offset:37888
ds_read_b64_tr_b16 v[30:31], v3 offset:39936
s_waitcnt lgkmcnt(6)
v_mfma_f32_32x32x16_bf16 v[72:87], v[16:19], a[40:43], v[72:87]
ds_read_b64_tr_b16 v[32:33], v2 offset:46080
ds_read_b64_tr_b16 v[34:35], v2 offset:48128
s_waitcnt lgkmcnt(6)
v_mfma_f32_32x32x16_bf16 v[88:103], v[20:23], a[40:43], v[88:103]
ds_read_b64_tr_b16 v[36:37], v3 offset:46080
ds_read_b64_tr_b16 v[38:39], v3 offset:48128
s_waitcnt vmcnt(32)
s_barrier
s_waitcnt lgkmcnt(6)
v_mfma_f32_32x32x16_bf16 v[40:55], v[24:27], a[44:47], v[40:55]
ds_read_b64_tr_b16 v[8:9], v2 offset:49152
ds_read_b64_tr_b16 v[10:11], v2 offset:51200
s_waitcnt lgkmcnt(6)
v_mfma_f32_32x32x16_bf16 v[56:71], v[28:31], a[44:47], v[56:71]
ds_read_b64_tr_b16 v[12:13], v3 offset:49152
ds_read_b64_tr_b16 v[14:15], v3 offset:51200
s_waitcnt lgkmcnt(6)
v_mfma_f32_32x32x16_bf16 v[72:87], v[32:35], a[44:47], v[72:87]
ds_read_b64_tr_b16 v[16:17], v2 offset:57344
ds_read_b64_tr_b16 v[18:19], v2 offset:59392
s_waitcnt lgkmcnt(6)
v_mfma_f32_32x32x16_bf16 v[88:103], v[36:39], a[44:47], v[88:103]
ds_read_b64_tr_b16 v[20:21], v3 offset:57344
ds_read_b64_tr_b16 v[22:23], v3 offset:59392
s_waitcnt lgkmcnt(6)
v_mfma_f32_32x32x16_bf16 v[40:55], v[8:11], a[48:51], v[40:55]
ds_read_b64_tr_b16 v[24:25], v2 offset:50176
ds_read_b64_tr_b16 v[26:27], v2 offset:52224
s_waitcnt lgkmcnt(6)
v_mfma_f32_32x32x16_bf16 v[56:71], v[12:15], a[48:51], v[56:71]
ds_read_b64_tr_b16 v[28:29], v3 offset:50176
ds_read_b64_tr_b16 v[30:31], v3 offset:52224
s_add_u32 m0, s83, 16384
s_add_u32 s76, s73, 525056
buffer_load_dwordx4 v1, s[64:67], s76 offen lds
s_waitcnt lgkmcnt(6)
v_mfma_f32_32x32x16_bf16 v[72:87], v[16:19], a[48:51], v[72:87]
ds_read_b64_tr_b16 v[32:33], v2 offset:58368
ds_read_b64_tr_b16 v[34:35], v2 offset:60416
s_waitcnt lgkmcnt(6)
v_mfma_f32_32x32x16_bf16 v[88:103], v[20:23], a[48:51], v[88:103]
ds_read_b64_tr_b16 v[36:37], v3 offset:58368
ds_read_b64_tr_b16 v[38:39], v3 offset:60416
s_add_u32 m0, s83, 17408
s_add_u32 s76, s73, 590592
buffer_load_dwordx4 v1, s[64:67], s76 offen lds
s_waitcnt lgkmcnt(6)
v_mfma_f32_32x32x16_bf16 v[40:55], v[24:27], a[52:55], v[40:55]
ds_read_b64_tr_b16 v[8:9], v2 offset:53248
ds_read_b64_tr_b16 v[10:11], v2 offset:55296
s_waitcnt lgkmcnt(6)
v_mfma_f32_32x32x16_bf16 v[56:71], v[28:31], a[52:55], v[56:71]
ds_read_b64_tr_b16 v[12:13], v3 offset:53248
ds_read_b64_tr_b16 v[14:15], v3 offset:55296
s_add_u32 m0, s83, 24576
s_add_u32 s76, s73, 525184
buffer_load_dwordx4 v1, s[64:67], s76 offen lds
s_waitcnt lgkmcnt(6)
v_mfma_f32_32x32x16_bf16 v[72:87], v[32:35], a[52:55], v[72:87]
ds_read_b64_tr_b16 v[16:17], v2 offset:61440
ds_read_b64_tr_b16 v[18:19], v2 offset:63488
s_waitcnt lgkmcnt(6)
v_mfma_f32_32x32x16_bf16 v[88:103], v[36:39], a[52:55], v[88:103]
ds_read_b64_tr_b16 v[20:21], v3 offset:61440
ds_read_b64_tr_b16 v[22:23], v3 offset:63488
s_add_u32 m0, s83, 25600
s_add_u32 s76, s73, 590720
buffer_load_dwordx4 v1, s[64:67], s76 offen lds
s_waitcnt lgkmcnt(6)
v_mfma_f32_32x32x16_bf16 v[40:55], v[8:11], a[56:59], v[40:55]
ds_read_b64_tr_b16 v[24:25], v2 offset:54272
ds_read_b64_tr_b16 v[26:27], v2 offset:56320
s_waitcnt lgkmcnt(6)
v_mfma_f32_32x32x16_bf16 v[56:71], v[12:15], a[56:59], v[56:71]
ds_read_b64_tr_b16 v[28:29], v3 offset:54272
ds_read_b64_tr_b16 v[30:31], v3 offset:56320
s_waitcnt lgkmcnt(6)
v_mfma_f32_32x32x16_bf16 v[72:87], v[16:19], a[56:59], v[72:87]
ds_read_b64_tr_b16 v[32:33], v2 offset:62464
ds_read_b64_tr_b16 v[34:35], v2 offset:64512
s_waitcnt lgkmcnt(6)
v_mfma_f32_32x32x16_bf16 v[88:103], v[20:23], a[56:59], v[88:103]
ds_read_b64_tr_b16 v[36:37], v3 offset:62464
ds_read_b64_tr_b16 v[38:39], v3 offset:64512
s_waitcnt vmcnt(32)
s_barrier
s_waitcnt lgkmcnt(6)
v_mfma_f32_32x32x16_bf16 v[40:55], v[24:27], a[60:63], v[40:55]
ds_read_b64_tr_b16 v[8:9], v4 offset:0
ds_read_b64_tr_b16 v[10:11], v4 offset:2048
s_waitcnt lgkmcnt(6)
v_mfma_f32_32x32x16_bf16 v[56:71], v[28:31], a[60:63], v[56:71]
ds_read_b64_tr_b16 v[12:13], v5 offset:0
ds_read_b64_tr_b16 v[14:15], v5 offset:2048
s_waitcnt lgkmcnt(6)
v_mfma_f32_32x32x16_bf16 v[72:87], v[32:35], a[60:63], v[72:87]
ds_read_b64_tr_b16 v[16:17], v4 offset:8192
ds_read_b64_tr_b16 v[18:19], v4 offset:10240
s_waitcnt lgkmcnt(6)
v_mfma_f32_32x32x16_bf16 v[88:103], v[36:39], a[60:63], v[88:103]
ds_read_b64_tr_b16 v[20:21], v5 offset:8192
ds_read_b64_tr_b16 v[22:23], v5 offset:10240
s_waitcnt lgkmcnt(6)
v_mfma_f32_32x32x16_bf16 v[40:55], v[8:11], a[64:67], v[40:55]
ds_read_b64_tr_b16 v[24:25], v4 offset:1024
ds_read_b64_tr_b16 v[26:27], v4 offset:3072
s_waitcnt lgkmcnt(6)
v_mfma_f32_32x32x16_bf16 v[56:71], v[12:15], a[64:67], v[56:71]
ds_read_b64_tr_b16 v[28:29], v5 offset:1024
ds_read_b64_tr_b16 v[30:31], v5 offset:3072
s_add_u32 m0, s83, 32768
s_add_u32 s76, s73, 1049344
buffer_load_dwordx4 v1, s[64:67], s76 offen lds
s_waitcnt lgkmcnt(6)
v_mfma_f32_32x32x16_bf16 v[72:87], v[16:19], a[64:67], v[72:87]
ds_read_b64_tr_b16 v[32:33], v4 offset:9216
ds_read_b64_tr_b16 v[34:35], v4 offset:11264
s_waitcnt lgkmcnt(6)
v_mfma_f32_32x32x16_bf16 v[88:103], v[20:23], a[64:67], v[88:103]
ds_read_b64_tr_b16 v[36:37], v5 offset:9216
ds_read_b64_tr_b16 v[38:39], v5 offset:11264
s_add_u32 m0, s83, 33792
s_add_u32 s76, s73, 1114880
buffer_load_dwordx4 v1, s[64:67], s76 offen lds
s_waitcnt lgkmcnt(6)
v_mfma_f32_32x32x16_bf16 v[40:55], v[24:27], a[68:71], v[40:55]
ds_read_b64_tr_b16 v[8:9], v4 offset:4096
ds_read_b64_tr_b16 v[10:11], v4 offset:6144
s_waitcnt lgkmcnt(6)
v_mfma_f32_32x32x16_bf16 v[56:71], v[28:31], a[68:71], v[56:71]
ds_read_b64_tr_b16 v[12:13], v5 offset:4096
ds_read_b64_tr_b16 v[14:15], v5 offset:6144
s_add_u32 m0, s83, 40960
s_add_u32 s76, s73, 1049472
buffer_load_dwordx4 v1, s[64:67], s76 offen lds
s_waitcnt lgkmcnt(6)
v_mfma_f32_32x32x16_bf16 v[72:87], v[32:35], a[68:71], v[72:87]
ds_read_b64_tr_b16 v[16:17], v4 offset:12288
ds_read_b64_tr_b16 v[18:19], v4 offset:14336
s_waitcnt lgkmcnt(6)
v_mfma_f32_32x32x16_bf16 v[88:103], v[36:39], a[68:71], v[88:103]
ds_read_b64_tr_b16 v[20:21], v5 offset:12288
ds_read_b64_tr_b16 v[22:23], v5 offset:14336
s_add_u32 m0, s83, 41984
s_add_u32 s76, s73, 1115008
buffer_load_dwordx4 v1, s[64:67], s76 offen lds
s_waitcnt lgkmcnt(6)
v_mfma_f32_32x32x16_bf16 v[40:55], v[8:11], a[72:75], v[40:55]
ds_read_b64_tr_b16 v[24:25], v4 offset:5120
ds_read_b64_tr_b16 v[26:27], v4 offset:7168
s_waitcnt lgkmcnt(6)
v_mfma_f32_32x32x16_bf16 v[56:71], v[12:15], a[72:75], v[56:71]
ds_read_b64_tr_b16 v[28:29], v5 offset:5120
ds_read_b64_tr_b16 v[30:31], v5 offset:7168
s_waitcnt lgkmcnt(6)
v_mfma_f32_32x32x16_bf16 v[72:87], v[16:19], a[72:75], v[72:87]
ds_read_b64_tr_b16 v[32:33], v4 offset:13312
ds_read_b64_tr_b16 v[34:35], v4 offset:15360
s_waitcnt lgkmcnt(6)
v_mfma_f32_32x32x16_bf16 v[88:103], v[20:23], a[72:75], v[88:103]
ds_read_b64_tr_b16 v[36:37], v5 offset:13312
ds_read_b64_tr_b16 v[38:39], v5 offset:15360
s_waitcnt vmcnt(32)
s_barrier
s_waitcnt lgkmcnt(6)
v_mfma_f32_32x32x16_bf16 v[40:55], v[24:27], a[76:79], v[40:55]
ds_read_b64_tr_b16 v[8:9], v4 offset:16384
ds_read_b64_tr_b16 v[10:11], v4 offset:18432
s_waitcnt lgkmcnt(6)
v_mfma_f32_32x32x16_bf16 v[56:71], v[28:31], a[76:79], v[56:71]
ds_read_b64_tr_b16 v[12:13], v5 offset:16384
ds_read_b64_tr_b16 v[14:15], v5 offset:18432
s_waitcnt lgkmcnt(6)
v_mfma_f32_32x32x16_bf16 v[72:87], v[32:35], a[76:79], v[72:87]
ds_read_b64_tr_b16 v[16:17], v4 offset:24576
ds_read_b64_tr_b16 v[18:19], v4 offset:26624
s_waitcnt lgkmcnt(6)
v_mfma_f32_32x32x16_bf16 v[88:103], v[36:39], a[76:79], v[88:103]
ds_read_b64_tr_b16 v[20:21], v5 offset:24576
ds_read_b64_tr_b16 v[22:23], v5 offset:26624
s_waitcnt lgkmcnt(6)
v_mfma_f32_32x32x16_bf16 v[40:55], v[8:11], a[80:83], v[40:55]
ds_read_b64_tr_b16 v[24:25], v4 offset:17408
ds_read_b64_tr_b16 v[26:27], v4 offset:19456
s_waitcnt lgkmcnt(6)
v_mfma_f32_32x32x16_bf16 v[56:71], v[12:15], a[80:83], v[56:71]
ds_read_b64_tr_b16 v[28:29], v5 offset:17408
ds_read_b64_tr_b16 v[30:31], v5 offset:19456
s_add_u32 m0, s83, 49152
s_add_u32 s76, s73, 1573632
buffer_load_dwordx4 v1, s[64:67], s76 offen lds
s_waitcnt lgkmcnt(6)
v_mfma_f32_32x32x16_bf16 v[72:87], v[16:19], a[80:83], v[72:87]
ds_read_b64_tr_b16 v[32:33], v4 offset:25600
ds_read_b64_tr_b16 v[34:35], v4 offset:27648
s_waitcnt lgkmcnt(6)
v_mfma_f32_32x32x16_bf16 v[88:103], v[20:23], a[80:83], v[88:103]
ds_read_b64_tr_b16 v[36:37], v5 offset:25600
ds_read_b64_tr_b16 v[38:39], v5 offset:27648
s_add_u32 m0, s83, 50176
s_add_u32 s76, s73, 1639168
buffer_load_dwordx4 v1, s[64:67], s76 offen lds
s_waitcnt lgkmcnt(6)
v_mfma_f32_32x32x16_bf16 v[40:55], v[24:27], a[84:87], v[40:55]
ds_read_b64_tr_b16 v[8:9], v4 offset:20480
ds_read_b64_tr_b16 v[10:11], v4 offset:22528
s_waitcnt lgkmcnt(6)
v_mfma_f32_32x32x16_bf16 v[56:71], v[28:31], a[84:87], v[56:71]
ds_read_b64_tr_b16 v[12:13], v5 offset:20480
ds_read_b64_tr_b16 v[14:15], v5 offset:22528
s_add_u32 m0, s83, 57344
s_add_u32 s76, s73, 1573760
buffer_load_dwordx4 v1, s[64:67], s76 offen lds
s_waitcnt lgkmcnt(6)
v_mfma_f32_32x32x16_bf16 v[72:87], v[32:35], a[84:87], v[72:87]
ds_read_b64_tr_b16 v[16:17], v4 offset:28672
ds_read_b64_tr_b16 v[18:19], v4 offset:30720
s_waitcnt lgkmcnt(6)
v_mfma_f32_32x32x16_bf16 v[88:103], v[36:39], a[84:87], v[88:103]
ds_read_b64_tr_b16 v[20:21], v5 offset:28672
ds_read_b64_tr_b16 v[22:23], v5 offset:30720
s_add_u32 m0, s83, 58368
s_add_u32 s76, s73, 1639296
buffer_load_dwordx4 v1, s[64:67], s76 offen lds
s_waitcnt lgkmcnt(6)
v_mfma_f32_32x32x16_bf16 v[40:55], v[8:11], a[88:91], v[40:55]
ds_read_b64_tr_b16 v[24:25], v4 offset:21504
ds_read_b64_tr_b16 v[26:27], v4 offset:23552
s_waitcnt lgkmcnt(6)
v_mfma_f32_32x32x16_bf16 v[56:71], v[12:15], a[88:91], v[56:71]
ds_read_b64_tr_b16 v[28:29], v5 offset:21504
ds_read_b64_tr_b16 v[30:31], v5 offset:23552
s_waitcnt lgkmcnt(6)
v_mfma_f32_32x32x16_bf16 v[72:87], v[16:19], a[88:91], v[72:87]
ds_read_b64_tr_b16 v[32:33], v4 offset:29696
ds_read_b64_tr_b16 v[34:35], v4 offset:31744
s_waitcnt lgkmcnt(6)
v_mfma_f32_32x32x16_bf16 v[88:103], v[20:23], a[88:91], v[88:103]
ds_read_b64_tr_b16 v[36:37], v5 offset:29696
ds_read_b64_tr_b16 v[38:39], v5 offset:31744
s_waitcnt vmcnt(32)
s_barrier
s_waitcnt lgkmcnt(6)
v_mfma_f32_32x32x16_bf16 v[40:55], v[24:27], a[92:95], v[40:55]
ds_read_b64_tr_b16 v[8:9], v4 offset:32768
ds_read_b64_tr_b16 v[10:11], v4 offset:34816
s_waitcnt lgkmcnt(6)
v_mfma_f32_32x32x16_bf16 v[56:71], v[28:31], a[92:95], v[56:71]
ds_read_b64_tr_b16 v[12:13], v5 offset:32768
ds_read_b64_tr_b16 v[14:15], v5 offset:34816
s_waitcnt lgkmcnt(6)
v_mfma_f32_32x32x16_bf16 v[72:87], v[32:35], a[92:95], v[72:87]
ds_read_b64_tr_b16 v[16:17], v4 offset:40960
ds_read_b64_tr_b16 v[18:19], v4 offset:43008
s_waitcnt lgkmcnt(6)
v_mfma_f32_32x32x16_bf16 v[88:103], v[36:39], a[92:95], v[88:103]
ds_read_b64_tr_b16 v[20:21], v5 offset:40960
ds_read_b64_tr_b16 v[22:23], v5 offset:43008
s_waitcnt lgkmcnt(6)
v_mfma_f32_32x32x16_bf16 v[40:55], v[8:11], a[96:99], v[40:55]
ds_read_b64_tr_b16 v[24:25], v4 offset:33792
ds_read_b64_tr_b16 v[26:27], v4 offset:35840
s_waitcnt lgkmcnt(6)
v_mfma_f32_32x32x16_bf16 v[56:71], v[12:15], a[96:99], v[56:71]
ds_read_b64_tr_b16 v[28:29], v5 offset:33792
ds_read_b64_tr_b16 v[30:31], v5 offset:35840
s_add_u32 m0, s83, 65536
s_add_u32 s76, s73, 2097920
buffer_load_dwordx4 v1, s[64:67], s76 offen lds
s_waitcnt lgkmcnt(6)
v_mfma_f32_32x32x16_bf16 v[72:87], v[16:19], a[96:99], v[72:87]
ds_read_b64_tr_b16 v[32:33], v4 offset:41984
ds_read_b64_tr_b16 v[34:35], v4 offset:44032
s_waitcnt lgkmcnt(6)
v_mfma_f32_32x32x16_bf16 v[88:103], v[20:23], a[96:99], v[88:103]
ds_read_b64_tr_b16 v[36:37], v5 offset:41984
ds_read_b64_tr_b16 v[38:39], v5 offset:44032
s_add_u32 m0, s83, 66560
s_add_u32 s76, s73, 2163456
buffer_load_dwordx4 v1, s[64:67], s76 offen lds
s_waitcnt lgkmcnt(6)
v_mfma_f32_32x32x16_bf16 v[40:55], v[24:27], a[100:103], v[40:55]
ds_read_b64_tr_b16 v[8:9], v4 offset:36864
ds_read_b64_tr_b16 v[10:11], v4 offset:38912
s_waitcnt lgkmcnt(6)
v_mfma_f32_32x32x16_bf16 v[56:71], v[28:31], a[100:103], v[56:71]
ds_read_b64_tr_b16 v[12:13], v5 offset:36864
ds_read_b64_tr_b16 v[14:15], v5 offset:38912
s_add_u32 m0, s83, 73728
s_add_u32 s76, s73, 2098048
buffer_load_dwordx4 v1, s[64:67], s76 offen lds
s_waitcnt lgkmcnt(6)
v_mfma_f32_32x32x16_bf16 v[72:87], v[32:35], a[100:103], v[72:87]
ds_read_b64_tr_b16 v[16:17], v4 offset:45056
ds_read_b64_tr_b16 v[18:19], v4 offset:47104
s_waitcnt lgkmcnt(6)
v_mfma_f32_32x32x16_bf16 v[88:103], v[36:39], a[100:103], v[88:103]
ds_read_b64_tr_b16 v[20:21], v5 offset:45056
ds_read_b64_tr_b16 v[22:23], v5 offset:47104
s_add_u32 m0, s83, 74752
s_add_u32 s76, s73, 2163584
buffer_load_dwordx4 v1, s[64:67], s76 offen lds
s_waitcnt lgkmcnt(6)
v_mfma_f32_32x32x16_bf16 v[40:55], v[8:11], a[104:107], v[40:55]
ds_read_b64_tr_b16 v[24:25], v4 offset:37888
ds_read_b64_tr_b16 v[26:27], v4 offset:39936
s_waitcnt lgkmcnt(6)
v_mfma_f32_32x32x16_bf16 v[56:71], v[12:15], a[104:107], v[56:71]
ds_read_b64_tr_b16 v[28:29], v5 offset:37888
ds_read_b64_tr_b16 v[30:31], v5 offset:39936
s_waitcnt lgkmcnt(6)
v_mfma_f32_32x32x16_bf16 v[72:87], v[16:19], a[104:107], v[72:87]
ds_read_b64_tr_b16 v[32:33], v4 offset:46080
ds_read_b64_tr_b16 v[34:35], v4 offset:48128
s_waitcnt lgkmcnt(6)
v_mfma_f32_32x32x16_bf16 v[88:103], v[20:23], a[104:107], v[88:103]
ds_read_b64_tr_b16 v[36:37], v5 offset:46080
ds_read_b64_tr_b16 v[38:39], v5 offset:48128
s_waitcnt vmcnt(24)
s_barrier
s_waitcnt lgkmcnt(6)
v_mfma_f32_32x32x16_bf16 v[40:55], v[24:27], a[108:111], v[40:55]
ds_read_b64_tr_b16 v[8:9], v4 offset:49152
ds_read_b64_tr_b16 v[10:11], v4 offset:51200
s_waitcnt lgkmcnt(6)
v_mfma_f32_32x32x16_bf16 v[56:71], v[28:31], a[108:111], v[56:71]
ds_read_b64_tr_b16 v[12:13], v5 offset:49152
ds_read_b64_tr_b16 v[14:15], v5 offset:51200
s_waitcnt lgkmcnt(6)
v_mfma_f32_32x32x16_bf16 v[72:87], v[32:35], a[108:111], v[72:87]
ds_read_b64_tr_b16 v[16:17], v4 offset:57344
ds_read_b64_tr_b16 v[18:19], v4 offset:59392
s_waitcnt lgkmcnt(6)
v_mfma_f32_32x32x16_bf16 v[88:103], v[36:39], a[108:111], v[88:103]
ds_read_b64_tr_b16 v[20:21], v5 offset:57344
ds_read_b64_tr_b16 v[22:23], v5 offset:59392
s_waitcnt lgkmcnt(6)
v_mfma_f32_32x32x16_bf16 v[40:55], v[8:11], a[112:115], v[40:55]
ds_read_b64_tr_b16 v[24:25], v4 offset:50176
ds_read_b64_tr_b16 v[26:27], v4 offset:52224
s_waitcnt lgkmcnt(6)
v_mfma_f32_32x32x16_bf16 v[56:71], v[12:15], a[112:115], v[56:71]
ds_read_b64_tr_b16 v[28:29], v5 offset:50176
ds_read_b64_tr_b16 v[30:31], v5 offset:52224
s_add_u32 m0, s83, 81920
s_add_u32 s76, s73, 2622208
buffer_load_dwordx4 v1, s[64:67], s76 offen lds
s_waitcnt lgkmcnt(6)
v_mfma_f32_32x32x16_bf16 v[72:87], v[16:19], a[112:115], v[72:87]
ds_read_b64_tr_b16 v[32:33], v4 offset:58368
ds_read_b64_tr_b16 v[34:35], v4 offset:60416
s_waitcnt lgkmcnt(6)
v_mfma_f32_32x32x16_bf16 v[88:103], v[20:23], a[112:115], v[88:103]
ds_read_b64_tr_b16 v[36:37], v5 offset:58368
ds_read_b64_tr_b16 v[38:39], v5 offset:60416
s_add_u32 m0, s83, 82944
s_add_u32 s76, s73, 2687744
buffer_load_dwordx4 v1, s[64:67], s76 offen lds
s_waitcnt lgkmcnt(6)
v_mfma_f32_32x32x16_bf16 v[40:55], v[24:27], a[116:119], v[40:55]
ds_read_b64_tr_b16 v[8:9], v4 offset:53248
ds_read_b64_tr_b16 v[10:11], v4 offset:55296
s_waitcnt lgkmcnt(6)
v_mfma_f32_32x32x16_bf16 v[56:71], v[28:31], a[116:119], v[56:71]
ds_read_b64_tr_b16 v[12:13], v5 offset:53248
ds_read_b64_tr_b16 v[14:15], v5 offset:55296
s_add_u32 m0, s83, 90112
s_add_u32 s76, s73, 2622336
buffer_load_dwordx4 v1, s[64:67], s76 offen lds
s_waitcnt lgkmcnt(6)
v_mfma_f32_32x32x16_bf16 v[72:87], v[32:35], a[116:119], v[72:87]
ds_read_b64_tr_b16 v[16:17], v4 offset:61440
ds_read_b64_tr_b16 v[18:19], v4 offset:63488
s_waitcnt lgkmcnt(6)
v_mfma_f32_32x32x16_bf16 v[88:103], v[36:39], a[116:119], v[88:103]
ds_read_b64_tr_b16 v[20:21], v5 offset:61440
ds_read_b64_tr_b16 v[22:23], v5 offset:63488
s_add_u32 m0, s83, 91136
s_add_u32 s76, s73, 2687872
buffer_load_dwordx4 v1, s[64:67], s76 offen lds
s_waitcnt lgkmcnt(6)
v_mfma_f32_32x32x16_bf16 v[40:55], v[8:11], a[120:123], v[40:55]
ds_read_b64_tr_b16 v[24:25], v4 offset:54272
ds_read_b64_tr_b16 v[26:27], v4 offset:56320
s_waitcnt lgkmcnt(6)
v_mfma_f32_32x32x16_bf16 v[56:71], v[12:15], a[120:123], v[56:71]
ds_read_b64_tr_b16 v[28:29], v5 offset:54272
ds_read_b64_tr_b16 v[30:31], v5 offset:56320
s_waitcnt lgkmcnt(6)
v_mfma_f32_32x32x16_bf16 v[72:87], v[16:19], a[120:123], v[72:87]
ds_read_b64_tr_b16 v[32:33], v4 offset:62464
ds_read_b64_tr_b16 v[34:35], v4 offset:64512
s_waitcnt lgkmcnt(6)
v_mfma_f32_32x32x16_bf16 v[88:103], v[20:23], a[120:123], v[88:103]
ds_read_b64_tr_b16 v[36:37], v5 offset:62464
ds_read_b64_tr_b16 v[38:39], v5 offset:64512
s_waitcnt vmcnt(24)
s_barrier
s_waitcnt lgkmcnt(6)
v_mfma_f32_32x32x16_bf16 v[40:55], v[24:27], a[124:127], v[40:55]
ds_read_b64_tr_b16 v[8:9], v6 offset:0
ds_read_b64_tr_b16 v[10:11], v6 offset:2048
s_waitcnt lgkmcnt(6)
v_mfma_f32_32x32x16_bf16 v[56:71], v[28:31], a[124:127], v[56:71]
ds_read_b64_tr_b16 v[12:13], v7 offset:0
ds_read_b64_tr_b16 v[14:15], v7 offset:2048
s_waitcnt lgkmcnt(6)
v_mfma_f32_32x32x16_bf16 v[72:87], v[32:35], a[124:127], v[72:87]
ds_read_b64_tr_b16 v[16:17], v6 offset:8192
ds_read_b64_tr_b16 v[18:19], v6 offset:10240
s_waitcnt lgkmcnt(6)
v_mfma_f32_32x32x16_bf16 v[88:103], v[36:39], a[124:127], v[88:103]
ds_read_b64_tr_b16 v[20:21], v7 offset:8192
ds_read_b64_tr_b16 v[22:23], v7 offset:10240
s_waitcnt lgkmcnt(6)
v_mfma_f32_32x32x16_bf16 v[40:55], v[8:11], a[128:131], v[40:55]
ds_read_b64_tr_b16 v[24:25], v6 offset:1024
ds_read_b64_tr_b16 v[26:27], v6 offset:3072
s_waitcnt lgkmcnt(6)
v_mfma_f32_32x32x16_bf16 v[56:71], v[12:15], a[128:131], v[56:71]
ds_read_b64_tr_b16 v[28:29], v7 offset:1024
ds_read_b64_tr_b16 v[30:31], v7 offset:3072
s_add_u32 m0, s83, 98304
s_add_u32 s76, s73, 3146496
buffer_load_dwordx4 v1, s[64:67], s76 offen lds
s_waitcnt lgkmcnt(6)
v_mfma_f32_32x32x16_bf16 v[72:87], v[16:19], a[128:131], v[72:87]
ds_read_b64_tr_b16 v[32:33], v6 offset:9216
ds_read_b64_tr_b16 v[34:35], v6 offset:11264
s_waitcnt lgkmcnt(6)
v_mfma_f32_32x32x16_bf16 v[88:103], v[20:23], a[128:131], v[88:103]
ds_read_b64_tr_b16 v[36:37], v7 offset:9216
ds_read_b64_tr_b16 v[38:39], v7 offset:11264
s_add_u32 m0, s83, 99328
s_add_u32 s76, s73, 3212032
buffer_load_dwordx4 v1, s[64:67], s76 offen lds
s_waitcnt lgkmcnt(6)
v_mfma_f32_32x32x16_bf16 v[40:55], v[24:27], a[132:135], v[40:55]
ds_read_b64_tr_b16 v[8:9], v6 offset:4096
ds_read_b64_tr_b16 v[10:11], v6 offset:6144
s_waitcnt lgkmcnt(6)
v_mfma_f32_32x32x16_bf16 v[56:71], v[28:31], a[132:135], v[56:71]
ds_read_b64_tr_b16 v[12:13], v7 offset:4096
ds_read_b64_tr_b16 v[14:15], v7 offset:6144
s_add_u32 m0, s83, 106496
s_add_u32 s76, s73, 3146624
buffer_load_dwordx4 v1, s[64:67], s76 offen lds
s_waitcnt lgkmcnt(6)
v_mfma_f32_32x32x16_bf16 v[72:87], v[32:35], a[132:135], v[72:87]
ds_read_b64_tr_b16 v[16:17], v6 offset:12288
ds_read_b64_tr_b16 v[18:19], v6 offset:14336
s_waitcnt lgkmcnt(6)
v_mfma_f32_32x32x16_bf16 v[88:103], v[36:39], a[132:135], v[88:103]
ds_read_b64_tr_b16 v[20:21], v7 offset:12288
ds_read_b64_tr_b16 v[22:23], v7 offset:14336
s_add_u32 m0, s83, 107520
s_add_u32 s76, s73, 3212160
buffer_load_dwordx4 v1, s[64:67], s76 offen lds
s_waitcnt lgkmcnt(6)
v_mfma_f32_32x32x16_bf16 v[40:55], v[8:11], a[136:139], v[40:55]
ds_read_b64_tr_b16 v[24:25], v6 offset:5120
ds_read_b64_tr_b16 v[26:27], v6 offset:7168
s_waitcnt lgkmcnt(6)
v_mfma_f32_32x32x16_bf16 v[56:71], v[12:15], a[136:139], v[56:71]
ds_read_b64_tr_b16 v[28:29], v7 offset:5120
ds_read_b64_tr_b16 v[30:31], v7 offset:7168
s_waitcnt lgkmcnt(6)
v_mfma_f32_32x32x16_bf16 v[72:87], v[16:19], a[136:139], v[72:87]
ds_read_b64_tr_b16 v[32:33], v6 offset:13312
ds_read_b64_tr_b16 v[34:35], v6 offset:15360
s_waitcnt lgkmcnt(6)
v_mfma_f32_32x32x16_bf16 v[88:103], v[20:23], a[136:139], v[88:103]
ds_read_b64_tr_b16 v[36:37], v7 offset:13312
ds_read_b64_tr_b16 v[38:39], v7 offset:15360
s_waitcnt vmcnt(24)
s_barrier
s_waitcnt lgkmcnt(6)
v_mfma_f32_32x32x16_bf16 v[40:55], v[24:27], a[140:143], v[40:55]
ds_read_b64_tr_b16 v[8:9], v2 offset:0
ds_read_b64_tr_b16 v[10:11], v2 offset:2048
s_waitcnt lgkmcnt(6)
v_mfma_f32_32x32x16_bf16 v[56:71], v[28:31], a[140:143], v[56:71]
ds_read_b64_tr_b16 v[12:13], v3 offset:0
ds_read_b64_tr_b16 v[14:15], v3 offset:2048
s_waitcnt lgkmcnt(6)
v_mfma_f32_32x32x16_bf16 v[72:87], v[32:35], a[140:143], v[72:87]
ds_read_b64_tr_b16 v[16:17], v2 offset:8192
ds_read_b64_tr_b16 v[18:19], v2 offset:10240
s_waitcnt lgkmcnt(6)
v_mfma_f32_32x32x16_bf16 v[88:103], v[36:39], a[140:143], v[88:103]
ds_read_b64_tr_b16 v[20:21], v3 offset:8192
ds_read_b64_tr_b16 v[22:23], v3 offset:10240
s_nop 11
s_add_u32 s77, s82, 16384
v_cvt_pk_bf16_f32 v106, v40, v41
v_cvt_pk_bf16_f32 v107, v42, v43
v_cvt_pk_bf16_f32 v108, v48, v49
v_cvt_pk_bf16_f32 v109, v50, v51
buffer_store_dwordx4 v[106:109], v104, s[8:11], s77 offen offset:0 sc1
v_cvt_pk_bf16_f32 v110, v44, v45
v_cvt_pk_bf16_f32 v111, v46, v47
v_cvt_pk_bf16_f32 v112, v52, v53
v_cvt_pk_bf16_f32 v113, v54, v55
buffer_store_dwordx4 v[110:113], v104, s[8:11], s77 offen offset:512 sc1
s_add_u32 s77, s82, 18432
v_cvt_pk_bf16_f32 v114, v56, v57
v_cvt_pk_bf16_f32 v115, v58, v59
v_cvt_pk_bf16_f32 v116, v64, v65
v_cvt_pk_bf16_f32 v117, v66, v67
buffer_store_dwordx4 v[114:117], v104, s[8:11], s77 offen offset:0 sc1
v_cvt_pk_bf16_f32 v118, v60, v61
v_cvt_pk_bf16_f32 v119, v62, v63
v_cvt_pk_bf16_f32 v120, v68, v69
v_cvt_pk_bf16_f32 v121, v70, v71
buffer_store_dwordx4 v[118:121], v104, s[8:11], s77 offen offset:512 sc1
s_add_u32 s77, s82, 20480
v_cvt_pk_bf16_f32 v106, v72, v73
v_cvt_pk_bf16_f32 v107, v74, v75
v_cvt_pk_bf16_f32 v108, v80, v81
v_cvt_pk_bf16_f32 v109, v82, v83
buffer_store_dwordx4 v[106:109], v104, s[8:11], s77 offen offset:0 sc1
v_cvt_pk_bf16_f32 v110, v76, v77
v_cvt_pk_bf16_f32 v111, v78, v79
v_cvt_pk_bf16_f32 v112, v84, v85
v_cvt_pk_bf16_f32 v113, v86, v87
buffer_store_dwordx4 v[110:113], v104, s[8:11], s77 offen offset:512 sc1
s_add_u32 s77, s82, 22528
v_cvt_pk_bf16_f32 v114, v88, v89
v_cvt_pk_bf16_f32 v115, v90, v91
v_cvt_pk_bf16_f32 v116, v96, v97
v_cvt_pk_bf16_f32 v117, v98, v99
buffer_store_dwordx4 v[114:117], v104, s[8:11], s77 offen offset:0 sc1
v_cvt_pk_bf16_f32 v118, v92, v93
v_cvt_pk_bf16_f32 v119, v94, v95
v_cvt_pk_bf16_f32 v120, v100, v101
v_cvt_pk_bf16_f32 v121, v102, v103
buffer_store_dwordx4 v[118:121], v104, s[8:11], s77 offen offset:512 sc1
s_waitcnt lgkmcnt(6)
v_mfma_f32_32x32x16_bf16 v[40:55], v[8:11], a[0:3], 0
ds_read_b64_tr_b16 v[24:25], v2 offset:1024
ds_read_b64_tr_b16 v[26:27], v2 offset:3072
s_waitcnt lgkmcnt(6)
v_mfma_f32_32x32x16_bf16 v[56:71], v[12:15], a[0:3], 0
ds_read_b64_tr_b16 v[28:29], v3 offset:1024
ds_read_b64_tr_b16 v[30:31], v3 offset:3072
s_add_u32 m0, s83, 114688
s_add_u32 s76, s73, 3670784
buffer_load_dwordx4 v1, s[64:67], s76 offen lds
s_waitcnt lgkmcnt(6)
v_mfma_f32_32x32x16_bf16 v[72:87], v[16:19], a[0:3], 0
ds_read_b64_tr_b16 v[32:33], v2 offset:9216
ds_read_b64_tr_b16 v[34:35], v2 offset:11264
s_waitcnt lgkmcnt(6)
v_mfma_f32_32x32x16_bf16 v[88:103], v[20:23], a[0:3], 0
ds_read_b64_tr_b16 v[36:37], v3 offset:9216
ds_read_b64_tr_b16 v[38:39], v3 offset:11264
s_add_u32 m0, s83, 115712
s_add_u32 s76, s73, 3736320
buffer_load_dwordx4 v1, s[64:67], s76 offen lds
s_waitcnt lgkmcnt(6)
v_mfma_f32_32x32x16_bf16 v[40:55], v[24:27], a[4:7], v[40:55]
ds_read_b64_tr_b16 v[8:9], v2 offset:4096
ds_read_b64_tr_b16 v[10:11], v2 offset:6144
s_waitcnt lgkmcnt(6)
v_mfma_f32_32x32x16_bf16 v[56:71], v[28:31], a[4:7], v[56:71]
ds_read_b64_tr_b16 v[12:13], v3 offset:4096
ds_read_b64_tr_b16 v[14:15], v3 offset:6144
s_add_u32 m0, s83, 122880
s_add_u32 s76, s73, 3670912
buffer_load_dwordx4 v1, s[64:67], s76 offen lds
s_waitcnt lgkmcnt(6)
v_mfma_f32_32x32x16_bf16 v[72:87], v[32:35], a[4:7], v[72:87]
ds_read_b64_tr_b16 v[16:17], v2 offset:12288
ds_read_b64_tr_b16 v[18:19], v2 offset:14336
s_waitcnt lgkmcnt(6)
v_mfma_f32_32x32x16_bf16 v[88:103], v[36:39], a[4:7], v[88:103]
ds_read_b64_tr_b16 v[20:21], v3 offset:12288
ds_read_b64_tr_b16 v[22:23], v3 offset:14336
s_add_u32 m0, s83, 123904
s_add_u32 s76, s73, 3736448
buffer_load_dwordx4 v1, s[64:67], s76 offen lds
s_waitcnt lgkmcnt(6)
v_mfma_f32_32x32x16_bf16 v[40:55], v[8:11], a[8:11], v[40:55]
ds_read_b64_tr_b16 v[24:25], v2 offset:5120
ds_read_b64_tr_b16 v[26:27], v2 offset:7168
s_waitcnt lgkmcnt(6)
v_mfma_f32_32x32x16_bf16 v[56:71], v[12:15], a[8:11], v[56:71]
ds_read_b64_tr_b16 v[28:29], v3 offset:5120
ds_read_b64_tr_b16 v[30:31], v3 offset:7168
s_waitcnt lgkmcnt(6)
v_mfma_f32_32x32x16_bf16 v[72:87], v[16:19], a[8:11], v[72:87]
ds_read_b64_tr_b16 v[32:33], v2 offset:13312
ds_read_b64_tr_b16 v[34:35], v2 offset:15360
s_waitcnt lgkmcnt(6)
v_mfma_f32_32x32x16_bf16 v[88:103], v[20:23], a[8:11], v[88:103]
ds_read_b64_tr_b16 v[36:37], v3 offset:13312
ds_read_b64_tr_b16 v[38:39], v3 offset:15360
s_waitcnt vmcnt(32)
s_barrier
s_waitcnt lgkmcnt(6)
v_mfma_f32_32x32x16_bf16 v[40:55], v[24:27], a[12:15], v[40:55]
ds_read_b64_tr_b16 v[8:9], v2 offset:16384
ds_read_b64_tr_b16 v[10:11], v2 offset:18432
s_waitcnt lgkmcnt(6)
v_mfma_f32_32x32x16_bf16 v[56:71], v[28:31], a[12:15], v[56:71]
ds_read_b64_tr_b16 v[12:13], v3 offset:16384
ds_read_b64_tr_b16 v[14:15], v3 offset:18432
s_waitcnt lgkmcnt(6)
v_mfma_f32_32x32x16_bf16 v[72:87], v[32:35], a[12:15], v[72:87]
ds_read_b64_tr_b16 v[16:17], v2 offset:24576
ds_read_b64_tr_b16 v[18:19], v2 offset:26624
s_waitcnt lgkmcnt(6)
v_mfma_f32_32x32x16_bf16 v[88:103], v[36:39], a[12:15], v[88:103]
ds_read_b64_tr_b16 v[20:21], v3 offset:24576
ds_read_b64_tr_b16 v[22:23], v3 offset:26624
s_waitcnt lgkmcnt(6)
v_mfma_f32_32x32x16_bf16 v[40:55], v[8:11], a[16:19], v[40:55]
ds_read_b64_tr_b16 v[24:25], v2 offset:17408
ds_read_b64_tr_b16 v[26:27], v2 offset:19456
s_waitcnt lgkmcnt(6)
v_mfma_f32_32x32x16_bf16 v[56:71], v[12:15], a[16:19], v[56:71]
ds_read_b64_tr_b16 v[28:29], v3 offset:17408
ds_read_b64_tr_b16 v[30:31], v3 offset:19456
s_add_u32 m0, s83, 131072
s_add_u32 s76, s73, 4195072
buffer_load_dwordx4 v1, s[64:67], s76 offen lds
s_waitcnt lgkmcnt(6)
v_mfma_f32_32x32x16_bf16 v[72:87], v[16:19], a[16:19], v[72:87]
ds_read_b64_tr_b16 v[32:33], v2 offset:25600
ds_read_b64_tr_b16 v[34:35], v2 offset:27648
s_waitcnt lgkmcnt(6)
v_mfma_f32_32x32x16_bf16 v[88:103], v[20:23], a[16:19], v[88:103]
ds_read_b64_tr_b16 v[36:37], v3 offset:25600
ds_read_b64_tr_b16 v[38:39], v3 offset:27648
s_add_u32 m0, s83, 132096
s_add_u32 s76, s73, 4260608
buffer_load_dwordx4 v1, s[64:67], s76 offen lds
s_waitcnt lgkmcnt(6)
v_mfma_f32_32x32x16_bf16 v[40:55], v[24:27], a[20:23], v[40:55]
ds_read_b64_tr_b16 v[8:9], v2 offset:20480
ds_read_b64_tr_b16 v[10:11], v2 offset:22528
s_waitcnt lgkmcnt(6)
v_mfma_f32_32x32x16_bf16 v[56:71], v[28:31], a[20:23], v[56:71]
ds_read_b64_tr_b16 v[12:13], v3 offset:20480
ds_read_b64_tr_b16 v[14:15], v3 offset:22528
s_add_u32 m0, s83, 139264
s_add_u32 s76, s73, 4195200
buffer_load_dwordx4 v1, s[64:67], s76 offen lds
s_waitcnt lgkmcnt(6)
v_mfma_f32_32x32x16_bf16 v[72:87], v[32:35], a[20:23], v[72:87]
ds_read_b64_tr_b16 v[16:17], v2 offset:28672
ds_read_b64_tr_b16 v[18:19], v2 offset:30720
s_waitcnt lgkmcnt(6)
v_mfma_f32_32x32x16_bf16 v[88:103], v[36:39], a[20:23], v[88:103]
ds_read_b64_tr_b16 v[20:21], v3 offset:28672
ds_read_b64_tr_b16 v[22:23], v3 offset:30720
s_add_u32 m0, s83, 140288
s_add_u32 s76, s73, 4260736
buffer_load_dwordx4 v1, s[64:67], s76 offen lds
s_waitcnt lgkmcnt(6)
v_mfma_f32_32x32x16_bf16 v[40:55], v[8:11], a[24:27], v[40:55]
ds_read_b64_tr_b16 v[24:25], v2 offset:21504
ds_read_b64_tr_b16 v[26:27], v2 offset:23552
s_waitcnt lgkmcnt(6)
v_mfma_f32_32x32x16_bf16 v[56:71], v[12:15], a[24:27], v[56:71]
ds_read_b64_tr_b16 v[28:29], v3 offset:21504
ds_read_b64_tr_b16 v[30:31], v3 offset:23552
s_waitcnt lgkmcnt(6)
v_mfma_f32_32x32x16_bf16 v[72:87], v[16:19], a[24:27], v[72:87]
ds_read_b64_tr_b16 v[32:33], v2 offset:29696
ds_read_b64_tr_b16 v[34:35], v2 offset:31744
s_waitcnt lgkmcnt(6)
v_mfma_f32_32x32x16_bf16 v[88:103], v[20:23], a[24:27], v[88:103]
ds_read_b64_tr_b16 v[36:37], v3 offset:29696
ds_read_b64_tr_b16 v[38:39], v3 offset:31744
s_waitcnt vmcnt(32)
s_barrier
s_waitcnt lgkmcnt(6)
v_mfma_f32_32x32x16_bf16 v[40:55], v[24:27], a[28:31], v[40:55]
ds_read_b64_tr_b16 v[8:9], v2 offset:32768
ds_read_b64_tr_b16 v[10:11], v2 offset:34816
s_waitcnt lgkmcnt(6)
v_mfma_f32_32x32x16_bf16 v[56:71], v[28:31], a[28:31], v[56:71]
ds_read_b64_tr_b16 v[12:13], v3 offset:32768
ds_read_b64_tr_b16 v[14:15], v3 offset:34816
s_waitcnt lgkmcnt(6)
v_mfma_f32_32x32x16_bf16 v[72:87], v[32:35], a[28:31], v[72:87]
ds_read_b64_tr_b16 v[16:17], v2 offset:40960
ds_read_b64_tr_b16 v[18:19], v2 offset:43008
s_waitcnt lgkmcnt(6)
v_mfma_f32_32x32x16_bf16 v[88:103], v[36:39], a[28:31], v[88:103]
ds_read_b64_tr_b16 v[20:21], v3 offset:40960
ds_read_b64_tr_b16 v[22:23], v3 offset:43008
s_waitcnt lgkmcnt(6)
v_mfma_f32_32x32x16_bf16 v[40:55], v[8:11], a[32:35], v[40:55]
ds_read_b64_tr_b16 v[24:25], v2 offset:33792
ds_read_b64_tr_b16 v[26:27], v2 offset:35840
s_waitcnt lgkmcnt(6)
v_mfma_f32_32x32x16_bf16 v[56:71], v[12:15], a[32:35], v[56:71]
ds_read_b64_tr_b16 v[28:29], v3 offset:33792
ds_read_b64_tr_b16 v[30:31], v3 offset:35840
s_waitcnt lgkmcnt(6)
v_mfma_f32_32x32x16_bf16 v[72:87], v[16:19], a[32:35], v[72:87]
ds_read_b64_tr_b16 v[32:33], v2 offset:41984
ds_read_b64_tr_b16 v[34:35], v2 offset:44032
s_waitcnt lgkmcnt(6)
v_mfma_f32_32x32x16_bf16 v[88:103], v[20:23], a[32:35], v[88:103]
ds_read_b64_tr_b16 v[36:37], v3 offset:41984
ds_read_b64_tr_b16 v[38:39], v3 offset:44032
s_waitcnt lgkmcnt(6)
v_mfma_f32_32x32x16_bf16 v[40:55], v[24:27], a[36:39], v[40:55]
ds_read_b64_tr_b16 v[8:9], v2 offset:36864
ds_read_b64_tr_b16 v[10:11], v2 offset:38912
s_waitcnt lgkmcnt(6)
v_mfma_f32_32x32x16_bf16 v[56:71], v[28:31], a[36:39], v[56:71]
ds_read_b64_tr_b16 v[12:13], v3 offset:36864
ds_read_b64_tr_b16 v[14:15], v3 offset:38912
s_waitcnt lgkmcnt(6)
v_mfma_f32_32x32x16_bf16 v[72:87], v[32:35], a[36:39], v[72:87]
ds_read_b64_tr_b16 v[16:17], v2 offset:45056
ds_read_b64_tr_b16 v[18:19], v2 offset:47104
s_waitcnt lgkmcnt(6)
v_mfma_f32_32x32x16_bf16 v[88:103], v[36:39], a[36:39], v[88:103]
ds_read_b64_tr_b16 v[20:21], v3 offset:45056
ds_read_b64_tr_b16 v[22:23], v3 offset:47104
s_waitcnt lgkmcnt(6)
v_mfma_f32_32x32x16_bf16 v[40:55], v[8:11], a[40:43], v[40:55]
ds_read_b64_tr_b16 v[24:25], v2 offset:37888
ds_read_b64_tr_b16 v[26:27], v2 offset:39936
s_waitcnt lgkmcnt(6)
v_mfma_f32_32x32x16_bf16 v[56:71], v[12:15], a[40:43], v[56:71]
ds_read_b64_tr_b16 v[28:29], v3 offset:37888
ds_read_b64_tr_b16 v[30:31], v3 offset:39936
s_waitcnt lgkmcnt(6)
v_mfma_f32_32x32x16_bf16 v[72:87], v[16:19], a[40:43], v[72:87]
ds_read_b64_tr_b16 v[32:33], v2 offset:46080
ds_read_b64_tr_b16 v[34:35], v2 offset:48128
s_waitcnt lgkmcnt(6)
v_mfma_f32_32x32x16_bf16 v[88:103], v[20:23], a[40:43], v[88:103]
ds_read_b64_tr_b16 v[36:37], v3 offset:46080
ds_read_b64_tr_b16 v[38:39], v3 offset:48128
s_waitcnt vmcnt(28)
s_barrier
s_waitcnt lgkmcnt(6)
v_mfma_f32_32x32x16_bf16 v[40:55], v[24:27], a[44:47], v[40:55]
ds_read_b64_tr_b16 v[8:9], v2 offset:49152
ds_read_b64_tr_b16 v[10:11], v2 offset:51200
s_waitcnt lgkmcnt(6)
v_mfma_f32_32x32x16_bf16 v[56:71], v[28:31], a[44:47], v[56:71]
ds_read_b64_tr_b16 v[12:13], v3 offset:49152
ds_read_b64_tr_b16 v[14:15], v3 offset:51200
s_waitcnt lgkmcnt(6)
v_mfma_f32_32x32x16_bf16 v[72:87], v[32:35], a[44:47], v[72:87]
ds_read_b64_tr_b16 v[16:17], v2 offset:57344
ds_read_b64_tr_b16 v[18:19], v2 offset:59392
s_waitcnt lgkmcnt(6)
v_mfma_f32_32x32x16_bf16 v[88:103], v[36:39], a[44:47], v[88:103]
ds_read_b64_tr_b16 v[20:21], v3 offset:57344
ds_read_b64_tr_b16 v[22:23], v3 offset:59392
s_waitcnt lgkmcnt(6)
v_mfma_f32_32x32x16_bf16 v[40:55], v[8:11], a[48:51], v[40:55]
ds_read_b64_tr_b16 v[24:25], v2 offset:50176
ds_read_b64_tr_b16 v[26:27], v2 offset:52224
s_waitcnt lgkmcnt(6)
v_mfma_f32_32x32x16_bf16 v[56:71], v[12:15], a[48:51], v[56:71]
ds_read_b64_tr_b16 v[28:29], v3 offset:50176
ds_read_b64_tr_b16 v[30:31], v3 offset:52224
s_waitcnt lgkmcnt(6)
v_mfma_f32_32x32x16_bf16 v[72:87], v[16:19], a[48:51], v[72:87]
ds_read_b64_tr_b16 v[32:33], v2 offset:58368
ds_read_b64_tr_b16 v[34:35], v2 offset:60416
s_waitcnt lgkmcnt(6)
v_mfma_f32_32x32x16_bf16 v[88:103], v[20:23], a[48:51], v[88:103]
ds_read_b64_tr_b16 v[36:37], v3 offset:58368
ds_read_b64_tr_b16 v[38:39], v3 offset:60416
s_waitcnt lgkmcnt(6)
v_mfma_f32_32x32x16_bf16 v[40:55], v[24:27], a[52:55], v[40:55]
ds_read_b64_tr_b16 v[8:9], v2 offset:53248
ds_read_b64_tr_b16 v[10:11], v2 offset:55296
s_waitcnt lgkmcnt(6)
v_mfma_f32_32x32x16_bf16 v[56:71], v[28:31], a[52:55], v[56:71]
ds_read_b64_tr_b16 v[12:13], v3 offset:53248
ds_read_b64_tr_b16 v[14:15], v3 offset:55296
s_waitcnt lgkmcnt(6)
v_mfma_f32_32x32x16_bf16 v[72:87], v[32:35], a[52:55], v[72:87]
ds_read_b64_tr_b16 v[16:17], v2 offset:61440
ds_read_b64_tr_b16 v[18:19], v2 offset:63488
s_waitcnt lgkmcnt(6)
v_mfma_f32_32x32x16_bf16 v[88:103], v[36:39], a[52:55], v[88:103]
ds_read_b64_tr_b16 v[20:21], v3 offset:61440
ds_read_b64_tr_b16 v[22:23], v3 offset:63488
s_waitcnt lgkmcnt(6)
v_mfma_f32_32x32x16_bf16 v[40:55], v[8:11], a[56:59], v[40:55]
ds_read_b64_tr_b16 v[24:25], v2 offset:54272
ds_read_b64_tr_b16 v[26:27], v2 offset:56320
s_waitcnt lgkmcnt(6)
v_mfma_f32_32x32x16_bf16 v[56:71], v[12:15], a[56:59], v[56:71]
ds_read_b64_tr_b16 v[28:29], v3 offset:54272
ds_read_b64_tr_b16 v[30:31], v3 offset:56320
s_waitcnt lgkmcnt(6)
v_mfma_f32_32x32x16_bf16 v[72:87], v[16:19], a[56:59], v[72:87]
ds_read_b64_tr_b16 v[32:33], v2 offset:62464
ds_read_b64_tr_b16 v[34:35], v2 offset:64512
s_waitcnt lgkmcnt(6)
v_mfma_f32_32x32x16_bf16 v[88:103], v[20:23], a[56:59], v[88:103]
ds_read_b64_tr_b16 v[36:37], v3 offset:62464
ds_read_b64_tr_b16 v[38:39], v3 offset:64512
s_waitcnt vmcnt(24)
s_barrier
s_waitcnt lgkmcnt(6)
v_mfma_f32_32x32x16_bf16 v[40:55], v[24:27], a[60:63], v[40:55]
ds_read_b64_tr_b16 v[8:9], v4 offset:0
ds_read_b64_tr_b16 v[10:11], v4 offset:2048
s_waitcnt lgkmcnt(6)
v_mfma_f32_32x32x16_bf16 v[56:71], v[28:31], a[60:63], v[56:71]
ds_read_b64_tr_b16 v[12:13], v5 offset:0
ds_read_b64_tr_b16 v[14:15], v5 offset:2048
s_waitcnt lgkmcnt(6)
v_mfma_f32_32x32x16_bf16 v[72:87], v[32:35], a[60:63], v[72:87]
ds_read_b64_tr_b16 v[16:17], v4 offset:8192
ds_read_b64_tr_b16 v[18:19], v4 offset:10240
s_waitcnt lgkmcnt(6)
v_mfma_f32_32x32x16_bf16 v[88:103], v[36:39], a[60:63], v[88:103]
ds_read_b64_tr_b16 v[20:21], v5 offset:8192
ds_read_b64_tr_b16 v[22:23], v5 offset:10240
s_waitcnt lgkmcnt(6)
v_mfma_f32_32x32x16_bf16 v[40:55], v[8:11], a[64:67], v[40:55]
ds_read_b64_tr_b16 v[24:25], v4 offset:1024
ds_read_b64_tr_b16 v[26:27], v4 offset:3072
s_waitcnt lgkmcnt(6)
v_mfma_f32_32x32x16_bf16 v[56:71], v[12:15], a[64:67], v[56:71]
ds_read_b64_tr_b16 v[28:29], v5 offset:1024
ds_read_b64_tr_b16 v[30:31], v5 offset:3072
s_waitcnt lgkmcnt(6)
v_mfma_f32_32x32x16_bf16 v[72:87], v[16:19], a[64:67], v[72:87]
ds_read_b64_tr_b16 v[32:33], v4 offset:9216
ds_read_b64_tr_b16 v[34:35], v4 offset:11264
s_waitcnt lgkmcnt(6)
v_mfma_f32_32x32x16_bf16 v[88:103], v[20:23], a[64:67], v[88:103]
ds_read_b64_tr_b16 v[36:37], v5 offset:9216
ds_read_b64_tr_b16 v[38:39], v5 offset:11264
s_waitcnt lgkmcnt(6)
v_mfma_f32_32x32x16_bf16 v[40:55], v[24:27], a[68:71], v[40:55]
ds_read_b64_tr_b16 v[8:9], v4 offset:4096
ds_read_b64_tr_b16 v[10:11], v4 offset:6144
s_waitcnt lgkmcnt(6)
v_mfma_f32_32x32x16_bf16 v[56:71], v[28:31], a[68:71], v[56:71]
ds_read_b64_tr_b16 v[12:13], v5 offset:4096
ds_read_b64_tr_b16 v[14:15], v5 offset:6144
s_waitcnt lgkmcnt(6)
v_mfma_f32_32x32x16_bf16 v[72:87], v[32:35], a[68:71], v[72:87]
ds_read_b64_tr_b16 v[16:17], v4 offset:12288
ds_read_b64_tr_b16 v[18:19], v4 offset:14336
s_waitcnt lgkmcnt(6)
v_mfma_f32_32x32x16_bf16 v[88:103], v[36:39], a[68:71], v[88:103]
ds_read_b64_tr_b16 v[20:21], v5 offset:12288
ds_read_b64_tr_b16 v[22:23], v5 offset:14336
s_waitcnt lgkmcnt(6)
v_mfma_f32_32x32x16_bf16 v[40:55], v[8:11], a[72:75], v[40:55]
ds_read_b64_tr_b16 v[24:25], v4 offset:5120
ds_read_b64_tr_b16 v[26:27], v4 offset:7168
s_waitcnt lgkmcnt(6)
v_mfma_f32_32x32x16_bf16 v[56:71], v[12:15], a[72:75], v[56:71]
ds_read_b64_tr_b16 v[28:29], v5 offset:5120
ds_read_b64_tr_b16 v[30:31], v5 offset:7168
s_waitcnt lgkmcnt(6)
v_mfma_f32_32x32x16_bf16 v[72:87], v[16:19], a[72:75], v[72:87]
ds_read_b64_tr_b16 v[32:33], v4 offset:13312
ds_read_b64_tr_b16 v[34:35], v4 offset:15360
s_waitcnt lgkmcnt(6)
v_mfma_f32_32x32x16_bf16 v[88:103], v[20:23], a[72:75], v[88:103]
ds_read_b64_tr_b16 v[36:37], v5 offset:13312
ds_read_b64_tr_b16 v[38:39], v5 offset:15360
s_waitcnt vmcnt(20)
s_barrier
s_waitcnt lgkmcnt(6)
v_mfma_f32_32x32x16_bf16 v[40:55], v[24:27], a[76:79], v[40:55]
ds_read_b64_tr_b16 v[8:9], v4 offset:16384
ds_read_b64_tr_b16 v[10:11], v4 offset:18432
s_waitcnt lgkmcnt(6)
v_mfma_f32_32x32x16_bf16 v[56:71], v[28:31], a[76:79], v[56:71]
ds_read_b64_tr_b16 v[12:13], v5 offset:16384
ds_read_b64_tr_b16 v[14:15], v5 offset:18432
s_waitcnt lgkmcnt(6)
v_mfma_f32_32x32x16_bf16 v[72:87], v[32:35], a[76:79], v[72:87]
ds_read_b64_tr_b16 v[16:17], v4 offset:24576
ds_read_b64_tr_b16 v[18:19], v4 offset:26624
s_waitcnt lgkmcnt(6)
v_mfma_f32_32x32x16_bf16 v[88:103], v[36:39], a[76:79], v[88:103]
ds_read_b64_tr_b16 v[20:21], v5 offset:24576
ds_read_b64_tr_b16 v[22:23], v5 offset:26624
s_waitcnt lgkmcnt(6)
v_mfma_f32_32x32x16_bf16 v[40:55], v[8:11], a[80:83], v[40:55]
ds_read_b64_tr_b16 v[24:25], v4 offset:17408
ds_read_b64_tr_b16 v[26:27], v4 offset:19456
s_waitcnt lgkmcnt(6)
v_mfma_f32_32x32x16_bf16 v[56:71], v[12:15], a[80:83], v[56:71]
ds_read_b64_tr_b16 v[28:29], v5 offset:17408
ds_read_b64_tr_b16 v[30:31], v5 offset:19456
s_waitcnt lgkmcnt(6)
v_mfma_f32_32x32x16_bf16 v[72:87], v[16:19], a[80:83], v[72:87]
ds_read_b64_tr_b16 v[32:33], v4 offset:25600
ds_read_b64_tr_b16 v[34:35], v4 offset:27648
s_waitcnt lgkmcnt(6)
v_mfma_f32_32x32x16_bf16 v[88:103], v[20:23], a[80:83], v[88:103]
ds_read_b64_tr_b16 v[36:37], v5 offset:25600
ds_read_b64_tr_b16 v[38:39], v5 offset:27648
s_waitcnt lgkmcnt(6)
v_mfma_f32_32x32x16_bf16 v[40:55], v[24:27], a[84:87], v[40:55]
ds_read_b64_tr_b16 v[8:9], v4 offset:20480
ds_read_b64_tr_b16 v[10:11], v4 offset:22528
s_waitcnt lgkmcnt(6)
v_mfma_f32_32x32x16_bf16 v[56:71], v[28:31], a[84:87], v[56:71]
ds_read_b64_tr_b16 v[12:13], v5 offset:20480
ds_read_b64_tr_b16 v[14:15], v5 offset:22528
s_waitcnt lgkmcnt(6)
v_mfma_f32_32x32x16_bf16 v[72:87], v[32:35], a[84:87], v[72:87]
ds_read_b64_tr_b16 v[16:17], v4 offset:28672
ds_read_b64_tr_b16 v[18:19], v4 offset:30720
s_waitcnt lgkmcnt(6)
v_mfma_f32_32x32x16_bf16 v[88:103], v[36:39], a[84:87], v[88:103]
ds_read_b64_tr_b16 v[20:21], v5 offset:28672
ds_read_b64_tr_b16 v[22:23], v5 offset:30720
s_waitcnt lgkmcnt(6)
v_mfma_f32_32x32x16_bf16 v[40:55], v[8:11], a[88:91], v[40:55]
ds_read_b64_tr_b16 v[24:25], v4 offset:21504
ds_read_b64_tr_b16 v[26:27], v4 offset:23552
s_waitcnt lgkmcnt(6)
v_mfma_f32_32x32x16_bf16 v[56:71], v[12:15], a[88:91], v[56:71]
ds_read_b64_tr_b16 v[28:29], v5 offset:21504
ds_read_b64_tr_b16 v[30:31], v5 offset:23552
s_waitcnt lgkmcnt(6)
v_mfma_f32_32x32x16_bf16 v[72:87], v[16:19], a[88:91], v[72:87]
ds_read_b64_tr_b16 v[32:33], v4 offset:29696
ds_read_b64_tr_b16 v[34:35], v4 offset:31744
s_waitcnt lgkmcnt(6)
v_mfma_f32_32x32x16_bf16 v[88:103], v[20:23], a[88:91], v[88:103]
ds_read_b64_tr_b16 v[36:37], v5 offset:29696
ds_read_b64_tr_b16 v[38:39], v5 offset:31744
s_waitcnt vmcnt(16)
s_barrier
s_waitcnt lgkmcnt(6)
v_mfma_f32_32x32x16_bf16 v[40:55], v[24:27], a[92:95], v[40:55]
ds_read_b64_tr_b16 v[8:9], v4 offset:32768
ds_read_b64_tr_b16 v[10:11], v4 offset:34816
s_waitcnt lgkmcnt(6)
v_mfma_f32_32x32x16_bf16 v[56:71], v[28:31], a[92:95], v[56:71]
ds_read_b64_tr_b16 v[12:13], v5 offset:32768
ds_read_b64_tr_b16 v[14:15], v5 offset:34816
s_waitcnt lgkmcnt(6)
v_mfma_f32_32x32x16_bf16 v[72:87], v[32:35], a[92:95], v[72:87]
ds_read_b64_tr_b16 v[16:17], v4 offset:40960
ds_read_b64_tr_b16 v[18:19], v4 offset:43008
s_waitcnt lgkmcnt(6)
v_mfma_f32_32x32x16_bf16 v[88:103], v[36:39], a[92:95], v[88:103]
ds_read_b64_tr_b16 v[20:21], v5 offset:40960
ds_read_b64_tr_b16 v[22:23], v5 offset:43008
s_waitcnt lgkmcnt(6)
v_mfma_f32_32x32x16_bf16 v[40:55], v[8:11], a[96:99], v[40:55]
ds_read_b64_tr_b16 v[24:25], v4 offset:33792
ds_read_b64_tr_b16 v[26:27], v4 offset:35840
s_waitcnt lgkmcnt(6)
v_mfma_f32_32x32x16_bf16 v[56:71], v[12:15], a[96:99], v[56:71]
ds_read_b64_tr_b16 v[28:29], v5 offset:33792
ds_read_b64_tr_b16 v[30:31], v5 offset:35840
s_waitcnt lgkmcnt(6)
v_mfma_f32_32x32x16_bf16 v[72:87], v[16:19], a[96:99], v[72:87]
ds_read_b64_tr_b16 v[32:33], v4 offset:41984
ds_read_b64_tr_b16 v[34:35], v4 offset:44032
s_waitcnt lgkmcnt(6)
v_mfma_f32_32x32x16_bf16 v[88:103], v[20:23], a[96:99], v[88:103]
ds_read_b64_tr_b16 v[36:37], v5 offset:41984
ds_read_b64_tr_b16 v[38:39], v5 offset:44032
s_waitcnt lgkmcnt(6)
v_mfma_f32_32x32x16_bf16 v[40:55], v[24:27], a[100:103], v[40:55]
ds_read_b64_tr_b16 v[8:9], v4 offset:36864
ds_read_b64_tr_b16 v[10:11], v4 offset:38912
s_waitcnt lgkmcnt(6)
v_mfma_f32_32x32x16_bf16 v[56:71], v[28:31], a[100:103], v[56:71]
ds_read_b64_tr_b16 v[12:13], v5 offset:36864
ds_read_b64_tr_b16 v[14:15], v5 offset:38912
s_waitcnt lgkmcnt(6)
v_mfma_f32_32x32x16_bf16 v[72:87], v[32:35], a[100:103], v[72:87]
ds_read_b64_tr_b16 v[16:17], v4 offset:45056
ds_read_b64_tr_b16 v[18:19], v4 offset:47104
s_waitcnt lgkmcnt(6)
v_mfma_f32_32x32x16_bf16 v[88:103], v[36:39], a[100:103], v[88:103]
ds_read_b64_tr_b16 v[20:21], v5 offset:45056
ds_read_b64_tr_b16 v[22:23], v5 offset:47104
s_waitcnt lgkmcnt(6)
v_mfma_f32_32x32x16_bf16 v[40:55], v[8:11], a[104:107], v[40:55]
ds_read_b64_tr_b16 v[24:25], v4 offset:37888
ds_read_b64_tr_b16 v[26:27], v4 offset:39936
s_waitcnt lgkmcnt(6)
v_mfma_f32_32x32x16_bf16 v[56:71], v[12:15], a[104:107], v[56:71]
ds_read_b64_tr_b16 v[28:29], v5 offset:37888
ds_read_b64_tr_b16 v[30:31], v5 offset:39936
s_waitcnt lgkmcnt(6)
v_mfma_f32_32x32x16_bf16 v[72:87], v[16:19], a[104:107], v[72:87]
ds_read_b64_tr_b16 v[32:33], v4 offset:46080
ds_read_b64_tr_b16 v[34:35], v4 offset:48128
s_waitcnt lgkmcnt(6)
v_mfma_f32_32x32x16_bf16 v[88:103], v[20:23], a[104:107], v[88:103]
ds_read_b64_tr_b16 v[36:37], v5 offset:46080
ds_read_b64_tr_b16 v[38:39], v5 offset:48128
s_waitcnt vmcnt(4)
s_barrier
s_waitcnt lgkmcnt(6)
v_mfma_f32_32x32x16_bf16 v[40:55], v[24:27], a[108:111], v[40:55]
ds_read_b64_tr_b16 v[8:9], v4 offset:49152
ds_read_b64_tr_b16 v[10:11], v4 offset:51200
s_waitcnt lgkmcnt(6)
v_mfma_f32_32x32x16_bf16 v[56:71], v[28:31], a[108:111], v[56:71]
ds_read_b64_tr_b16 v[12:13], v5 offset:49152
ds_read_b64_tr_b16 v[14:15], v5 offset:51200
s_waitcnt lgkmcnt(6)
v_mfma_f32_32x32x16_bf16 v[72:87], v[32:35], a[108:111], v[72:87]
ds_read_b64_tr_b16 v[16:17], v4 offset:57344
ds_read_b64_tr_b16 v[18:19], v4 offset:59392
s_waitcnt lgkmcnt(6)
v_mfma_f32_32x32x16_bf16 v[88:103], v[36:39], a[108:111], v[88:103]
ds_read_b64_tr_b16 v[20:21], v5 offset:57344
ds_read_b64_tr_b16 v[22:23], v5 offset:59392
s_waitcnt lgkmcnt(6)
v_mfma_f32_32x32x16_bf16 v[40:55], v[8:11], a[112:115], v[40:55]
ds_read_b64_tr_b16 v[24:25], v4 offset:50176
ds_read_b64_tr_b16 v[26:27], v4 offset:52224
s_waitcnt lgkmcnt(6)
v_mfma_f32_32x32x16_bf16 v[56:71], v[12:15], a[112:115], v[56:71]
ds_read_b64_tr_b16 v[28:29], v5 offset:50176
ds_read_b64_tr_b16 v[30:31], v5 offset:52224
s_waitcnt lgkmcnt(6)
v_mfma_f32_32x32x16_bf16 v[72:87], v[16:19], a[112:115], v[72:87]
ds_read_b64_tr_b16 v[32:33], v4 offset:58368
ds_read_b64_tr_b16 v[34:35], v4 offset:60416
s_waitcnt lgkmcnt(6)
v_mfma_f32_32x32x16_bf16 v[88:103], v[20:23], a[112:115], v[88:103]
ds_read_b64_tr_b16 v[36:37], v5 offset:58368
ds_read_b64_tr_b16 v[38:39], v5 offset:60416
s_waitcnt lgkmcnt(6)
v_mfma_f32_32x32x16_bf16 v[40:55], v[24:27], a[116:119], v[40:55]
ds_read_b64_tr_b16 v[8:9], v4 offset:53248
ds_read_b64_tr_b16 v[10:11], v4 offset:55296
s_waitcnt lgkmcnt(6)
v_mfma_f32_32x32x16_bf16 v[56:71], v[28:31], a[116:119], v[56:71]
ds_read_b64_tr_b16 v[12:13], v5 offset:53248
ds_read_b64_tr_b16 v[14:15], v5 offset:55296
s_waitcnt lgkmcnt(6)
v_mfma_f32_32x32x16_bf16 v[72:87], v[32:35], a[116:119], v[72:87]
ds_read_b64_tr_b16 v[16:17], v4 offset:61440
ds_read_b64_tr_b16 v[18:19], v4 offset:63488
s_waitcnt lgkmcnt(6)
v_mfma_f32_32x32x16_bf16 v[88:103], v[36:39], a[116:119], v[88:103]
ds_read_b64_tr_b16 v[20:21], v5 offset:61440
ds_read_b64_tr_b16 v[22:23], v5 offset:63488
s_waitcnt lgkmcnt(6)
v_mfma_f32_32x32x16_bf16 v[40:55], v[8:11], a[120:123], v[40:55]
ds_read_b64_tr_b16 v[24:25], v4 offset:54272
ds_read_b64_tr_b16 v[26:27], v4 offset:56320
s_waitcnt lgkmcnt(6)
v_mfma_f32_32x32x16_bf16 v[56:71], v[12:15], a[120:123], v[56:71]
ds_read_b64_tr_b16 v[28:29], v5 offset:54272
ds_read_b64_tr_b16 v[30:31], v5 offset:56320
s_waitcnt lgkmcnt(6)
v_mfma_f32_32x32x16_bf16 v[72:87], v[16:19], a[120:123], v[72:87]
ds_read_b64_tr_b16 v[32:33], v4 offset:62464
ds_read_b64_tr_b16 v[34:35], v4 offset:64512
s_waitcnt lgkmcnt(6)
v_mfma_f32_32x32x16_bf16 v[88:103], v[20:23], a[120:123], v[88:103]
ds_read_b64_tr_b16 v[36:37], v5 offset:62464
ds_read_b64_tr_b16 v[38:39], v5 offset:64512
s_waitcnt vmcnt(0)
s_barrier
s_waitcnt lgkmcnt(6)
v_mfma_f32_32x32x16_bf16 v[40:55], v[24:27], a[124:127], v[40:55]
ds_read_b64_tr_b16 v[8:9], v6 offset:0
ds_read_b64_tr_b16 v[10:11], v6 offset:2048
s_waitcnt lgkmcnt(6)
v_mfma_f32_32x32x16_bf16 v[56:71], v[28:31], a[124:127], v[56:71]
ds_read_b64_tr_b16 v[12:13], v7 offset:0
ds_read_b64_tr_b16 v[14:15], v7 offset:2048
s_waitcnt lgkmcnt(6)
v_mfma_f32_32x32x16_bf16 v[72:87], v[32:35], a[124:127], v[72:87]
ds_read_b64_tr_b16 v[16:17], v6 offset:8192
ds_read_b64_tr_b16 v[18:19], v6 offset:10240
s_waitcnt lgkmcnt(6)
v_mfma_f32_32x32x16_bf16 v[88:103], v[36:39], a[124:127], v[88:103]
ds_read_b64_tr_b16 v[20:21], v7 offset:8192
ds_read_b64_tr_b16 v[22:23], v7 offset:10240
s_waitcnt lgkmcnt(6)
v_mfma_f32_32x32x16_bf16 v[40:55], v[8:11], a[128:131], v[40:55]
ds_read_b64_tr_b16 v[24:25], v6 offset:1024
ds_read_b64_tr_b16 v[26:27], v6 offset:3072
s_waitcnt lgkmcnt(6)
v_mfma_f32_32x32x16_bf16 v[56:71], v[12:15], a[128:131], v[56:71]
ds_read_b64_tr_b16 v[28:29], v7 offset:1024
ds_read_b64_tr_b16 v[30:31], v7 offset:3072
s_waitcnt lgkmcnt(6)
v_mfma_f32_32x32x16_bf16 v[72:87], v[16:19], a[128:131], v[72:87]
ds_read_b64_tr_b16 v[32:33], v6 offset:9216
ds_read_b64_tr_b16 v[34:35], v6 offset:11264
s_waitcnt lgkmcnt(6)
v_mfma_f32_32x32x16_bf16 v[88:103], v[20:23], a[128:131], v[88:103]
ds_read_b64_tr_b16 v[36:37], v7 offset:9216
ds_read_b64_tr_b16 v[38:39], v7 offset:11264
s_waitcnt lgkmcnt(6)
v_mfma_f32_32x32x16_bf16 v[40:55], v[24:27], a[132:135], v[40:55]
ds_read_b64_tr_b16 v[8:9], v6 offset:4096
ds_read_b64_tr_b16 v[10:11], v6 offset:6144
s_waitcnt lgkmcnt(6)
v_mfma_f32_32x32x16_bf16 v[56:71], v[28:31], a[132:135], v[56:71]
ds_read_b64_tr_b16 v[12:13], v7 offset:4096
ds_read_b64_tr_b16 v[14:15], v7 offset:6144
s_waitcnt lgkmcnt(6)
v_mfma_f32_32x32x16_bf16 v[72:87], v[32:35], a[132:135], v[72:87]
ds_read_b64_tr_b16 v[16:17], v6 offset:12288
ds_read_b64_tr_b16 v[18:19], v6 offset:14336
s_waitcnt lgkmcnt(6)
v_mfma_f32_32x32x16_bf16 v[88:103], v[36:39], a[132:135], v[88:103]
ds_read_b64_tr_b16 v[20:21], v7 offset:12288
ds_read_b64_tr_b16 v[22:23], v7 offset:14336
s_waitcnt lgkmcnt(6)
v_mfma_f32_32x32x16_bf16 v[40:55], v[8:11], a[136:139], v[40:55]
ds_read_b64_tr_b16 v[24:25], v6 offset:5120
ds_read_b64_tr_b16 v[26:27], v6 offset:7168
s_waitcnt lgkmcnt(6)
v_mfma_f32_32x32x16_bf16 v[56:71], v[12:15], a[136:139], v[56:71]
ds_read_b64_tr_b16 v[28:29], v7 offset:5120
ds_read_b64_tr_b16 v[30:31], v7 offset:7168
s_waitcnt lgkmcnt(6)
v_mfma_f32_32x32x16_bf16 v[72:87], v[16:19], a[136:139], v[72:87]
ds_read_b64_tr_b16 v[32:33], v6 offset:13312
ds_read_b64_tr_b16 v[34:35], v6 offset:15360
s_waitcnt lgkmcnt(6)
v_mfma_f32_32x32x16_bf16 v[88:103], v[20:23], a[136:139], v[88:103]
ds_read_b64_tr_b16 v[36:37], v7 offset:13312
ds_read_b64_tr_b16 v[38:39], v7 offset:15360
s_waitcnt lgkmcnt(6)
v_mfma_f32_32x32x16_bf16 v[40:55], v[24:27], a[140:143], v[40:55]
s_waitcnt lgkmcnt(4)
v_mfma_f32_32x32x16_bf16 v[56:71], v[28:31], a[140:143], v[56:71]
s_waitcnt lgkmcnt(2)
v_mfma_f32_32x32x16_bf16 v[72:87], v[32:35], a[140:143], v[72:87]
s_waitcnt lgkmcnt(0)
v_mfma_f32_32x32x16_bf16 v[88:103], v[36:39], a[140:143], v[88:103]
s_nop 11
s_add_u32 s77, s82, 24576
v_cvt_pk_bf16_f32 v106, v40, v41
v_cvt_pk_bf16_f32 v107, v42, v43
v_cvt_pk_bf16_f32 v108, v48, v49
v_cvt_pk_bf16_f32 v109, v50, v51
buffer_store_dwordx4 v[106:109], v104, s[8:11], s77 offen offset:0 sc1
v_cvt_pk_bf16_f32 v110, v44, v45
v_cvt_pk_bf16_f32 v111, v46, v47
v_cvt_pk_bf16_f32 v112, v52, v53
v_cvt_pk_bf16_f32 v113, v54, v55
buffer_store_dwordx4 v[110:113], v104, s[8:11], s77 offen offset:512 sc1
s_add_u32 s77, s82, 26624
v_cvt_pk_bf16_f32 v114, v56, v57
v_cvt_pk_bf16_f32 v115, v58, v59
v_cvt_pk_bf16_f32 v116, v64, v65
v_cvt_pk_bf16_f32 v117, v66, v67
buffer_store_dwordx4 v[114:117], v104, s[8:11], s77 offen offset:0 sc1
v_cvt_pk_bf16_f32 v118, v60, v61
v_cvt_pk_bf16_f32 v119, v62, v63
v_cvt_pk_bf16_f32 v120, v68, v69
v_cvt_pk_bf16_f32 v121, v70, v71
buffer_store_dwordx4 v[118:121], v104, s[8:11], s77 offen offset:512 sc1
s_add_u32 s77, s82, 28672
v_cvt_pk_bf16_f32 v106, v72, v73
v_cvt_pk_bf16_f32 v107, v74, v75
v_cvt_pk_bf16_f32 v108, v80, v81
v_cvt_pk_bf16_f32 v109, v82, v83
buffer_store_dwordx4 v[106:109], v104, s[8:11], s77 offen offset:0 sc1
v_cvt_pk_bf16_f32 v110, v76, v77
v_cvt_pk_bf16_f32 v111, v78, v79
v_cvt_pk_bf16_f32 v112, v84, v85
v_cvt_pk_bf16_f32 v113, v86, v87
buffer_store_dwordx4 v[110:113], v104, s[8:11], s77 offen offset:512 sc1
s_add_u32 s77, s82, 30720
v_cvt_pk_bf16_f32 v114, v88, v89
v_cvt_pk_bf16_f32 v115, v90, v91
v_cvt_pk_bf16_f32 v116, v96, v97
v_cvt_pk_bf16_f32 v117, v98, v99
buffer_store_dwordx4 v[114:117], v104, s[8:11], s77 offen offset:0 sc1
v_cvt_pk_bf16_f32 v118, v92, v93
v_cvt_pk_bf16_f32 v119, v94, v95
v_cvt_pk_bf16_f32 v120, v100, v101
v_cvt_pk_bf16_f32 v121, v102, v103
buffer_store_dwordx4 v[118:121], v104, s[8:11], s77 offen offset:512 sc1
s_branch L_a2e_9
L_a2v_8:
s_add_u32 m0, s83, 0
s_add_u32 s76, s73, 0
buffer_load_dwordx4 v1, s[64:67], s76 offen lds
s_add_u32 m0, s83, 1024
s_add_u32 s76, s73, 65536
buffer_load_dwordx4 v1, s[64:67], s76 offen lds
s_add_u32 m0, s83, 8192
s_add_u32 s76, s73, 128
buffer_load_dwordx4 v1, s[64:67], s76 offen lds
s_add_u32 m0, s83, 9216
s_add_u32 s76, s73, 65664
buffer_load_dwordx4 v1, s[64:67], s76 offen lds
s_add_u32 s76, s72, 0
buffer_load_dwordx4 a[0:3], v0, s[8:11], s76 offen offset:0 sc1
s_add_u32 s76, s72, 0
buffer_load_dwordx4 a[4:7], v0, s[8:11], s76 offen offset:1024 sc1
s_add_u32 s76, s72, 0
buffer_load_dwordx4 a[8:11], v0, s[8:11], s76 offen offset:2048 sc1
s_add_u32 s76, s72, 0
buffer_load_dwordx4 a[12:15], v0, s[8:11], s76 offen offset:3072 sc1
s_add_u32 m0, s83, 16384
s_add_u32 s76, s73, 524288
buffer_load_dwordx4 v1, s[64:67], s76 offen lds
s_add_u32 m0, s83, 17408
s_add_u32 s76, s73, 589824
buffer_load_dwordx4 v1, s[64:67], s76 offen lds
s_add_u32 m0, s83, 24576
s_add_u32 s76, s73, 524416
buffer_load_dwordx4 v1, s[64:67], s76 offen lds
s_add_u32 m0, s83, 25600
s_add_u32 s76, s73, 589952
buffer_load_dwordx4 v1, s[64:67], s76 offen lds
s_add_u32 s76, s72, 4096
buffer_load_dwordx4 a[16:19], v0, s[8:11], s76 offen offset:0 sc1
s_add_u32 s76, s72, 4096
buffer_load_dwordx4 a[20:23], v0, s[8:11], s76 offen offset:1024 sc1
s_add_u32 s76, s72, 4096
buffer_load_dwordx4 a[24:27], v0, s[8:11], s76 offen offset:2048 sc1
s_add_u32 s76, s72, 4096
buffer_load_dwordx4 a[28:31], v0, s[8:11], s76 offen offset:3072 sc1
s_add_u32 m0, s83, 32768
s_add_u32 s76, s73, 1048576
buffer_load_dwordx4 v1, s[64:67], s76 offen lds
s_add_u32 m0, s83, 33792
s_add_u32 s76, s73, 1114112
buffer_load_dwordx4 v1, s[64:67], s76 offen lds
s_add_u32 m0, s83, 40960
s_add_u32 s76, s73, 1048704
buffer_load_dwordx4 v1, s[64:67], s76 offen lds
s_add_u32 m0, s83, 41984
s_add_u32 s76, s73, 1114240
buffer_load_dwordx4 v1, s[64:67], s76 offen lds
s_add_u32 s76, s72, 8192
buffer_load_dwordx4 a[32:35], v0, s[8:11], s76 offen offset:0 sc1
s_add_u32 s76, s72, 8192
buffer_load_dwordx4 a[36:39], v0, s[8:11], s76 offen offset:1024 sc1
s_add_u32 s76, s72, 8192
buffer_load_dwordx4 a[40:43], v0, s[8:11], s76 offen offset:2048 sc1
s_add_u32 s76, s72, 8192
buffer_load_dwordx4 a[44:47], v0, s[8:11], s76 offen offset:3072 sc1
s_add_u32 m0, s83, 49152
s_add_u32 s76, s73, 1572864
buffer_load_dwordx4 v1, s[64:67], s76 offen lds
s_add_u32 m0, s83, 50176
s_add_u32 s76, s73, 1638400
buffer_load_dwordx4 v1, s[64:67], s76 offen lds
s_add_u32 m0, s83, 57344
s_add_u32 s76, s73, 1572992
buffer_load_dwordx4 v1, s[64:67], s76 offen lds
s_add_u32 m0, s83, 58368
s_add_u32 s76, s73, 1638528
buffer_load_dwordx4 v1, s[64:67], s76 offen lds
s_add_u32 s76, s72, 12288
buffer_load_dwordx4 a[48:51], v0, s[8:11], s76 offen offset:0 sc1
s_add_u32 s76, s72, 12288
buffer_load_dwordx4 a[52:55], v0, s[8:11], s76 offen offset:1024 sc1
s_add_u32 s76, s72, 12288
buffer_load_dwordx4 a[56:59], v0, s[8:11], s76 offen offset:2048 sc1
s_add_u32 s76, s72, 12288
buffer_load_dwordx4 a[60:63], v0, s[8:11], s76 offen offset:3072 sc1
s_waitcnt vmcnt(24)
s_barrier
ds_read_b64_tr_b16 v[8:9], v2 offset:0
ds_read_b64_tr_b16 v[10:11], v2 offset:2048
ds_read_b64_tr_b16 v[12:13], v3 offset:0
ds_read_b64_tr_b16 v[14:15], v3 offset:2048
ds_read_b64_tr_b16 v[16:17], v2 offset:8192
ds_read_b64_tr_b16 v[18:19], v2 offset:10240
ds_read_b64_tr_b16 v[20:21], v3 offset:8192
ds_read_b64_tr_b16 v[22:23], v3 offset:10240
s_waitcnt lgkmcnt(6)
v_mfma_f32_32x32x16_bf16 v[40:55], a[0:3], v[8:11], 0
ds_read_b64_tr_b16 v[24:25], v2 offset:1024
ds_read_b64_tr_b16 v[26:27], v2 offset:3072
s_waitcnt lgkmcnt(6)
v_mfma_f32_32x32x16_bf16 v[56:71], a[0:3], v[12:15], 0
ds_read_b64_tr_b16 v[28:29], v3 offset:1024
ds_read_b64_tr_b16 v[30:31], v3 offset:3072
s_waitcnt lgkmcnt(6)
v_mfma_f32_32x32x16_bf16 v[72:87], a[0:3], v[16:19], 0
ds_read_b64_tr_b16 v[32:33], v2 offset:9216
ds_read_b64_tr_b16 v[34:35], v2 offset:11264
s_waitcnt lgkmcnt(6)
v_mfma_f32_32x32x16_bf16 v[88:103], a[0:3], v[20:23], 0
ds_read_b64_tr_b16 v[36:37], v3 offset:9216
ds_read_b64_tr_b16 v[38:39], v3 offset:11264
s_waitcnt lgkmcnt(6)
v_mfma_f32_32x32x16_bf16 v[40:55], a[4:7], v[24:27], v[40:55]
ds_read_b64_tr_b16 v[8:9], v2 offset:4096
ds_read_b64_tr_b16 v[10:11], v2 offset:6144
s_waitcnt lgkmcnt(6)
v_mfma_f32_32x32x16_bf16 v[56:71], a[4:7], v[28:31], v[56:71]
ds_read_b64_tr_b16 v[12:13], v3 offset:4096
ds_read_b64_tr_b16 v[14:15], v3 offset:6144
s_waitcnt lgkmcnt(6)
v_mfma_f32_32x32x16_bf16 v[72:87], a[4:7], v[32:35], v[72:87]
ds_read_b64_tr_b16 v[16:17], v2 offset:12288
ds_read_b64_tr_b16 v[18:19], v2 offset:14336
s_waitcnt lgkmcnt(6)
v_mfma_f32_32x32x16_bf16 v[88:103], a[4:7], v[36:39], v[88:103]
ds_read_b64_tr_b16 v[20:21], v3 offset:12288
ds_read_b64_tr_b16 v[22:23], v3 offset:14336
s_waitcnt lgkmcnt(6)
v_mfma_f32_32x32x16_bf16 v[40:55], a[8:11], v[8:11], v[40:55]
ds_read_b64_tr_b16 v[24:25], v2 offset:5120
ds_read_b64_tr_b16 v[26:27], v2 offset:7168
s_waitcnt lgkmcnt(6)
v_mfma_f32_32x32x16_bf16 v[56:71], a[8:11], v[12:15], v[56:71]
ds_read_b64_tr_b16 v[28:29], v3 offset:5120
ds_read_b64_tr_b16 v[30:31], v3 offset:7168
s_waitcnt lgkmcnt(6)
v_mfma_f32_32x32x16_bf16 v[72:87], a[8:11], v[16:19], v[72:87]
ds_read_b64_tr_b16 v[32:33], v2 offset:13312
ds_read_b64_tr_b16 v[34:35], v2 offset:15360
s_waitcnt lgkmcnt(6)
v_mfma_f32_32x32x16_bf16 v[88:103], a[8:11], v[20:23], v[88:103]
ds_read_b64_tr_b16 v[36:37], v3 offset:13312
ds_read_b64_tr_b16 v[38:39], v3 offset:15360
s_waitcnt vmcnt(20)
s_waitcnt vmcnt(16)
s_barrier
s_waitcnt lgkmcnt(6)
v_mfma_f32_32x32x16_bf16 v[40:55], a[12:15], v[24:27], v[40:55]
ds_read_b64_tr_b16 v[8:9], v2 offset:16384
ds_read_b64_tr_b16 v[10:11], v2 offset:18432
s_waitcnt lgkmcnt(6)
v_mfma_f32_32x32x16_bf16 v[56:71], a[12:15], v[28:31], v[56:71]
ds_read_b64_tr_b16 v[12:13], v3 offset:16384
ds_read_b64_tr_b16 v[14:15], v3 offset:18432
s_waitcnt lgkmcnt(6)
v_mfma_f32_32x32x16_bf16 v[72:87], a[12:15], v[32:35], v[72:87]
ds_read_b64_tr_b16 v[16:17], v2 offset:24576
ds_read_b64_tr_b16 v[18:19], v2 offset:26624
s_waitcnt lgkmcnt(6)
v_mfma_f32_32x32x16_bf16 v[88:103], a[12:15], v[36:39], v[88:103]
ds_read_b64_tr_b16 v[20:21], v3 offset:24576
ds_read_b64_tr_b16 v[22:23], v3 offset:26624
s_waitcnt lgkmcnt(6)
v_mfma_f32_32x32x16_bf16 v[40:55], a[16:19], v[8:11], v[40:55]
ds_read_b64_tr_b16 v[24:25], v2 offset:17408
ds_read_b64_tr_b16 v[26:27], v2 offset:19456
s_waitcnt lgkmcnt(6)
v_mfma_f32_32x32x16_bf16 v[56:71], a[16:19], v[12:15], v[56:71]
ds_read_b64_tr_b16 v[28:29], v3 offset:17408
ds_read_b64_tr_b16 v[30:31], v3 offset:19456
s_add_u32 s76, s72, 16384
buffer_load_dwordx4 a[64:67], v0, s[8:11], s76 offen offset:0 sc1
s_waitcnt lgkmcnt(6)
v_mfma_f32_32x32x16_bf16 v[72:87], a[16:19], v[16:19], v[72:87]
ds_read_b64_tr_b16 v[32:33], v2 offset:25600
ds_read_b64_tr_b16 v[34:35], v2 offset:27648
s_waitcnt lgkmcnt(6)
v_mfma_f32_32x32x16_bf16 v[88:103], a[16:19], v[20:23], v[88:103]
ds_read_b64_tr_b16 v[36:37], v3 offset:25600
ds_read_b64_tr_b16 v[38:39], v3 offset:27648
s_add_u32 s76, s72, 16384
buffer_load_dwordx4 a[68:71], v0, s[8:11], s76 offen offset:1024 sc1
s_waitcnt lgkmcnt(6)
v_mfma_f32_32x32x16_bf16 v[40:55], a[20:23], v[24:27], v[40:55]
ds_read_b64_tr_b16 v[8:9], v2 offset:20480
ds_read_b64_tr_b16 v[10:11], v2 offset:22528
s_waitcnt lgkmcnt(6)
v_mfma_f32_32x32x16_bf16 v[56:71], a[20:23], v[28:31], v[56:71]
ds_read_b64_tr_b16 v[12:13], v3 offset:20480
ds_read_b64_tr_b16 v[14:15], v3 offset:22528
s_add_u32 s76, s72, 16384
buffer_load_dwordx4 a[72:75], v0, s[8:11], s76 offen offset:2048 sc1
s_waitcnt lgkmcnt(6)
v_mfma_f32_32x32x16_bf16 v[72:87], a[20:23], v[32:35], v[72:87]
ds_read_b64_tr_b16 v[16:17], v2 offset:28672
ds_read_b64_tr_b16 v[18:19], v2 offset:30720
s_waitcnt lgkmcnt(6)
v_mfma_f32_32x32x16_bf16 v[88:103], a[20:23], v[36:39], v[88:103]
ds_read_b64_tr_b16 v[20:21], v3 offset:28672
ds_read_b64_tr_b16 v[22:23], v3 offset:30720
s_add_u32 s76, s72, 16384
buffer_load_dwordx4 a[76:79], v0, s[8:11], s76 offen offset:3072 sc1
s_waitcnt lgkmcnt(6)
v_mfma_f32_32x32x16_bf16 v[40:55], a[24:27], v[8:11], v[40:55]
ds_read_b64_tr_b16 v[24:25], v2 offset:21504
ds_read_b64_tr_b16 v[26:27], v2 offset:23552
s_waitcnt lgkmcnt(6)
v_mfma_f32_32x32x16_bf16 v[56:71], a[24:27], v[12:15], v[56:71]
ds_read_b64_tr_b16 v[28:29], v3 offset:21504
ds_read_b64_tr_b16 v[30:31], v3 offset:23552
s_add_u32 s76, s72, 20480
buffer_load_dwordx4 a[80:83], v0, s[8:11], s76 offen offset:0 sc1
s_waitcnt lgkmcnt(6)
v_mfma_f32_32x32x16_bf16 v[72:87], a[24:27], v[16:19], v[72:87]
ds_read_b64_tr_b16 v[32:33], v2 offset:29696
ds_read_b64_tr_b16 v[34:35], v2 offset:31744
s_waitcnt lgkmcnt(6)
v_mfma_f32_32x32x16_bf16 v[88:103], a[24:27], v[20:23], v[88:103]
ds_read_b64_tr_b16 v[36:37], v3 offset:29696
ds_read_b64_tr_b16 v[38:39], v3 offset:31744
s_add_u32 s76, s72, 20480
buffer_load_dwordx4 a[84:87], v0, s[8:11], s76 offen offset:1024 sc1
s_waitcnt vmcnt(18)
s_waitcnt vmcnt(14)
s_barrier
s_waitcnt lgkmcnt(6)
v_mfma_f32_32x32x16_bf16 v[40:55], a[28:31], v[24:27], v[40:55]
ds_read_b64_tr_b16 v[8:9], v2 offset:32768
ds_read_b64_tr_b16 v[10:11], v2 offset:34816
s_waitcnt lgkmcnt(6)
v_mfma_f32_32x32x16_bf16 v[56:71], a[28:31], v[28:31], v[56:71]
ds_read_b64_tr_b16 v[12:13], v3 offset:32768
ds_read_b64_tr_b16 v[14:15], v3 offset:34816
s_add_u32 s76, s72, 20480
buffer_load_dwordx4 a[88:91], v0, s[8:11], s76 offen offset:2048 sc1
s_waitcnt lgkmcnt(6)
v_mfma_f32_32x32x16_bf16 v[72:87], a[28:31], v[32:35], v[72:87]
ds_read_b64_tr_b16 v[16:17], v2 offset:40960
ds_read_b64_tr_b16 v[18:19], v2 offset:43008
s_waitcnt lgkmcnt(6)
v_mfma_f32_32x32x16_bf16 v[88:103], a[28:31], v[36:39], v[88:103]
ds_read_b64_tr_b16 v[20:21], v3 offset:40960
ds_read_b64_tr_b16 v[22:23], v3 offset:43008
s_add_u32 s76, s72, 20480
buffer_load_dwordx4 a[92:95], v0, s[8:11], s76 offen offset:3072 sc1
s_waitcnt lgkmcnt(6)
v_mfma_f32_32x32x16_bf16 v[40:55], a[32:35], v[8:11], v[40:55]
ds_read_b64_tr_b16 v[24:25], v2 offset:33792
ds_read_b64_tr_b16 v[26:27], v2 offset:35840
s_waitcnt lgkmcnt(6)
v_mfma_f32_32x32x16_bf16 v[56:71], a[32:35], v[12:15], v[56:71]
ds_read_b64_tr_b16 v[28:29], v3 offset:33792
ds_read_b64_tr_b16 v[30:31], v3 offset:35840
s_add_u32 m0, s83, 65536
s_add_u32 s76, s73, 2097152
buffer_load_dwordx4 v1, s[64:67], s76 offen lds
s_waitcnt lgkmcnt(6)
v_mfma_f32_32x32x16_bf16 v[72:87], a[32:35], v[16:19], v[72:87]
ds_read_b64_tr_b16 v[32:33], v2 offset:41984
ds_read_b64_tr_b16 v[34:35], v2 offset:44032
s_waitcnt lgkmcnt(6)
v_mfma_f32_32x32x16_bf16 v[88:103], a[32:35], v[20:23], v[88:103]
ds_read_b64_tr_b16 v[36:37], v3 offset:41984
ds_read_b64_tr_b16 v[38:39], v3 offset:44032
s_add_u32 m0, s83, 66560
s_add_u32 s76, s73, 2162688
buffer_load_dwordx4 v1, s[64:67], s76 offen lds
s_waitcnt lgkmcnt(6)
v_mfma_f32_32x32x16_bf16 v[40:55], a[36:39], v[24:27], v[40:55]
ds_read_b64_tr_b16 v[8:9], v2 offset:36864
ds_read_b64_tr_b16 v[10:11], v2 offset:38912
s_waitcnt lgkmcnt(6)
v_mfma_f32_32x32x16_bf16 v[56:71], a[36:39], v[28:31], v[56:71]
ds_read_b64_tr_b16 v[12:13], v3 offset:36864
ds_read_b64_tr_b16 v[14:15], v3 offset:38912
s_add_u32 m0, s83, 73728
s_add_u32 s76, s73, 2097280
buffer_load_dwordx4 v1, s[64:67], s76 offen lds
s_waitcnt lgkmcnt(6)
v_mfma_f32_32x32x16_bf16 v[72:87], a[36:39], v[32:35], v[72:87]
ds_read_b64_tr_b16 v[16:17], v2 offset:45056
ds_read_b64_tr_b16 v[18:19], v2 offset:47104
s_waitcnt lgkmcnt(6)
v_mfma_f32_32x32x16_bf16 v[88:103], a[36:39], v[36:39], v[88:103]
ds_read_b64_tr_b16 v[20:21], v3 offset:45056
ds_read_b64_tr_b16 v[22:23], v3 offset:47104
s_add_u32 m0, s83, 74752
s_add_u32 s76, s73, 2162816
buffer_load_dwordx4 v1, s[64:67], s76 offen lds
s_waitcnt lgkmcnt(6)
v_mfma_f32_32x32x16_bf16 v[40:55], a[40:43], v[8:11], v[40:55]
ds_read_b64_tr_b16 v[24:25], v2 offset:37888
ds_read_b64_tr_b16 v[26:27], v2 offset:39936
s_waitcnt lgkmcnt(6)
v_mfma_f32_32x32x16_bf16 v[56:71], a[40:43], v[12:15], v[56:71]
ds_read_b64_tr_b16 v[28:29], v3 offset:37888
ds_read_b64_tr_b16 v[30:31], v3 offset:39936
s_add_u32 m0, s83, 81920
s_add_u32 s76, s73, 2621440
buffer_load_dwordx4 v1, s[64:67], s76 offen lds
s_waitcnt lgkmcnt(6)
v_mfma_f32_32x32x16_bf16 v[72:87], a[40:43], v[16:19], v[72:87]
ds_read_b64_tr_b16 v[32:33], v2 offset:46080
ds_read_b64_tr_b16 v[34:35], v2 offset:48128
s_waitcnt lgkmcnt(6)
v_mfma_f32_32x32x16_bf16 v[88:103], a[40:43], v[20:23], v[88:103]
ds_read_b64_tr_b16 v[36:37], v3 offset:46080
ds_read_b64_tr_b16 v[38:39], v3 offset:48128
s_add_u32 m0, s83, 82944
s_add_u32 s76, s73, 2686976
buffer_load_dwordx4 v1, s[64:67], s76 offen lds
s_waitcnt vmcnt(18)
s_waitcnt vmcnt(14)
s_barrier
s_waitcnt lgkmcnt(6)
v_mfma_f32_32x32x16_bf16 v[40:55], a[44:47], v[24:27], v[40:55]
ds_read_b64_tr_b16 v[8:9], v2 offset:49152
ds_read_b64_tr_b16 v[10:11], v2 offset:51200
s_waitcnt lgkmcnt(6)
v_mfma_f32_32x32x16_bf16 v[56:71], a[44:47], v[28:31], v[56:71]
ds_read_b64_tr_b16 v[12:13], v3 offset:49152
ds_read_b64_tr_b16 v[14:15], v3 offset:51200
s_add_u32 m0, s83, 90112
s_add_u32 s76, s73, 2621568
buffer_load_dwordx4 v1, s[64:67], s76 offen lds
s_waitcnt lgkmcnt(6)
v_mfma_f32_32x32x16_bf16 v[72:87], a[44:47], v[32:35], v[72:87]
ds_read_b64_tr_b16 v[16:17], v2 offset:57344
ds_read_b64_tr_b16 v[18:19], v2 offset:59392
s_waitcnt lgkmcnt(6)
v_mfma_f32_32x32x16_bf16 v[88:103], a[44:47], v[36:39], v[88:103]
ds_read_b64_tr_b16 v[20:21], v3 offset:57344
ds_read_b64_tr_b16 v[22:23], v3 offset:59392
s_add_u32 m0, s83, 91136
s_add_u32 s76, s73, 2687104
buffer_load_dwordx4 v1, s[64:67], s76 offen lds
s_waitcnt lgkmcnt(6)
v_mfma_f32_32x32x16_bf16 v[40:55], a[48:51], v[8:11], v[40:55]
ds_read_b64_tr_b16 v[24:25], v2 offset:50176
ds_read_b64_tr_b16 v[26:27], v2 offset:52224
s_waitcnt lgkmcnt(6)
v_mfma_f32_32x32x16_bf16 v[56:71], a[48:51], v[12:15], v[56:71]
ds_read_b64_tr_b16 v[28:29], v3 offset:50176
ds_read_b64_tr_b16 v[30:31], v3 offset:52224
s_add_u32 s76, s72, 24576
buffer_load_dwordx4 a[96:99], v0, s[8:11], s76 offen offset:0 sc1
s_waitcnt lgkmcnt(6)
v_mfma_f32_32x32x16_bf16 v[72:87], a[48:51], v[16:19], v[72:87]
ds_read_b64_tr_b16 v[32:33], v2 offset:58368
ds_read_b64_tr_b16 v[34:35], v2 offset:60416
s_waitcnt lgkmcnt(6)
v_mfma_f32_32x32x16_bf16 v[88:103], a[48:51], v[20:23], v[88:103]
ds_read_b64_tr_b16 v[36:37], v3 offset:58368
ds_read_b64_tr_b16 v[38:39], v3 offset:60416
s_add_u32 s76, s72, 24576
buffer_load_dwordx4 a[100:103], v0, s[8:11], s76 offen offset:1024 sc1
s_waitcnt lgkmcnt(6)
v_mfma_f32_32x32x16_bf16 v[40:55], a[52:55], v[24:27], v[40:55]
ds_read_b64_tr_b16 v[8:9], v2 offset:53248
ds_read_b64_tr_b16 v[10:11], v2 offset:55296
s_waitcnt lgkmcnt(6)
v_mfma_f32_32x32x16_bf16 v[56:71], a[52:55], v[28:31], v[56:71]
ds_read_b64_tr_b16 v[12:13], v3 offset:53248
ds_read_b64_tr_b16 v[14:15], v3 offset:55296
s_add_u32 s76, s72, 24576
buffer_load_dwordx4 a[104:107], v0, s[8:11], s76 offen offset:2048 sc1
s_waitcnt lgkmcnt(6)
v_mfma_f32_32x32x16_bf16 v[72:87], a[52:55], v[32:35], v[72:87]
ds_read_b64_tr_b16 v[16:17], v2 offset:61440
ds_read_b64_tr_b16 v[18:19], v2 offset:63488
s_waitcnt lgkmcnt(6)
v_mfma_f32_32x32x16_bf16 v[88:103], a[52:55], v[36:39], v[88:103]
ds_read_b64_tr_b16 v[20:21], v3 offset:61440
ds_read_b64_tr_b16 v[22:23], v3 offset:63488
s_add_u32 s76, s72, 24576
buffer_load_dwordx4 a[108:111], v0, s[8:11], s76 offen offset:3072 sc1
s_waitcnt lgkmcnt(6)
v_mfma_f32_32x32x16_bf16 v[40:55], a[56:59], v[8:11], v[40:55]
ds_read_b64_tr_b16 v[24:25], v2 offset:54272
ds_read_b64_tr_b16 v[26:27], v2 offset:56320
s_waitcnt lgkmcnt(6)
v_mfma_f32_32x32x16_bf16 v[56:71], a[56:59], v[12:15], v[56:71]
ds_read_b64_tr_b16 v[28:29], v3 offset:54272
ds_read_b64_tr_b16 v[30:31], v3 offset:56320
s_add_u32 s76, s72, 28672
buffer_load_dwordx4 a[112:115], v0, s[8:11], s76 offen offset:0 sc1
s_waitcnt lgkmcnt(6)
v_mfma_f32_32x32x16_bf16 v[72:87], a[56:59], v[16:19], v[72:87]
ds_read_b64_tr_b16 v[32:33], v2 offset:62464
ds_read_b64_tr_b16 v[34:35], v2 offset:64512
s_waitcnt lgkmcnt(6)
v_mfma_f32_32x32x16_bf16 v[88:103], a[56:59], v[20:23], v[88:103]
ds_read_b64_tr_b16 v[36:37], v3 offset:62464
ds_read_b64_tr_b16 v[38:39], v3 offset:64512
s_add_u32 s76, s72, 28672
buffer_load_dwordx4 a[116:119], v0, s[8:11], s76 offen offset:1024 sc1
s_waitcnt vmcnt(10)
s_barrier
s_waitcnt lgkmcnt(6)
v_mfma_f32_32x32x16_bf16 v[40:55], a[60:63], v[24:27], v[40:55]
ds_read_b64_tr_b16 v[8:9], v4 offset:0
ds_read_b64_tr_b16 v[10:11], v4 offset:2048
s_waitcnt lgkmcnt(6)
v_mfma_f32_32x32x16_bf16 v[56:71], a[60:63], v[28:31], v[56:71]
ds_read_b64_tr_b16 v[12:13], v5 offset:0
ds_read_b64_tr_b16 v[14:15], v5 offset:2048
s_add_u32 s76, s72, 28672
buffer_load_dwordx4 a[120:123], v0, s[8:11], s76 offen offset:2048 sc1
s_waitcnt lgkmcnt(6)
v_mfma_f32_32x32x16_bf16 v[72:87], a[60:63], v[32:35], v[72:87]
ds_read_b64_tr_b16 v[16:17], v4 offset:8192
ds_read_b64_tr_b16 v[18:19], v4 offset:10240
s_waitcnt lgkmcnt(6)
v_mfma_f32_32x32x16_bf16 v[88:103], a[60:63], v[36:39], v[88:103]
ds_read_b64_tr_b16 v[20:21], v5 offset:8192
ds_read_b64_tr_b16 v[22:23], v5 offset:10240
s_add_u32 s76, s72, 28672
buffer_load_dwordx4 a[124:127], v0, s[8:11], s76 offen offset:3072 sc1
s_waitcnt lgkmcnt(6)
v_mfma_f32_32x32x16_bf16 v[40:55], a[64:67], v[8:11], v[40:55]
ds_read_b64_tr_b16 v[24:25], v4 offset:1024
ds_read_b64_tr_b16 v[26:27], v4 offset:3072
s_waitcnt lgkmcnt(6)
v_mfma_f32_32x32x16_bf16 v[56:71], a[64:67], v[12:15], v[56:71]
ds_read_b64_tr_b16 v[28:29], v5 offset:1024
ds_read_b64_tr_b16 v[30:31], v5 offset:3072
s_add_u32 m0, s83, 98304
s_add_u32 s76, s73, 3145728
buffer_load_dwordx4 v1, s[64:67], s76 offen lds
s_waitcnt lgkmcnt(6)
v_mfma_f32_32x32x16_bf16 v[72:87], a[64:67], v[16:19], v[72:87]
ds_read_b64_tr_b16 v[32:33], v4 offset:9216
ds_read_b64_tr_b16 v[34:35], v4 offset:11264
s_waitcnt lgkmcnt(6)
v_mfma_f32_32x32x16_bf16 v[88:103], a[64:67], v[20:23], v[88:103]
ds_read_b64_tr_b16 v[36:37], v5 offset:9216
ds_read_b64_tr_b16 v[38:39], v5 offset:11264
s_add_u32 m0, s83, 99328
s_add_u32 s76, s73, 3211264
buffer_load_dwordx4 v1, s[64:67], s76 offen lds
s_waitcnt lgkmcnt(6)
v_mfma_f32_32x32x16_bf16 v[40:55], a[68:71], v[24:27], v[40:55]
ds_read_b64_tr_b16 v[8:9], v4 offset:4096
ds_read_b64_tr_b16 v[10:11], v4 offset:6144
s_waitcnt lgkmcnt(6)
v_mfma_f32_32x32x16_bf16 v[56:71], a[68:71], v[28:31], v[56:71]
ds_read_b64_tr_b16 v[12:13], v5 offset:4096
ds_read_b64_tr_b16 v[14:15], v5 offset:6144
s_add_u32 m0, s83, 106496
s_add_u32 s76, s73, 3145856
buffer_load_dwordx4 v1, s[64:67], s76 offen lds
s_waitcnt lgkmcnt(6)
v_mfma_f32_32x32x16_bf16 v[72:87], a[68:71], v[32:35], v[72:87]
ds_read_b64_tr_b16 v[16:17], v4 offset:12288
ds_read_b64_tr_b16 v[18:19], v4 offset:14336
s_waitcnt lgkmcnt(6)
v_mfma_f32_32x32x16_bf16 v[88:103], a[68:71], v[36:39], v[88:103]
ds_read_b64_tr_b16 v[20:21], v5 offset:12288
ds_read_b64_tr_b16 v[22:23], v5 offset:14336
s_add_u32 m0, s83, 107520
s_add_u32 s76, s73, 3211392
buffer_load_dwordx4 v1, s[64:67], s76 offen lds
s_waitcnt lgkmcnt(6)
v_mfma_f32_32x32x16_bf16 v[40:55], a[72:75], v[8:11], v[40:55]
ds_read_b64_tr_b16 v[24:25], v4 offset:5120
ds_read_b64_tr_b16 v[26:27], v4 offset:7168
s_waitcnt lgkmcnt(6)
v_mfma_f32_32x32x16_bf16 v[56:71], a[72:75], v[12:15], v[56:71]
ds_read_b64_tr_b16 v[28:29], v5 offset:5120
ds_read_b64_tr_b16 v[30:31], v5 offset:7168
s_add_u32 m0, s83, 114688
s_add_u32 s76, s73, 3670016
buffer_load_dwordx4 v1, s[64:67], s76 offen lds
s_waitcnt lgkmcnt(6)
v_mfma_f32_32x32x16_bf16 v[72:87], a[72:75], v[16:19], v[72:87]
ds_read_b64_tr_b16 v[32:33], v4 offset:13312
ds_read_b64_tr_b16 v[34:35], v4 offset:15360
s_waitcnt lgkmcnt(6)
v_mfma_f32_32x32x16_bf16 v[88:103], a[72:75], v[20:23], v[88:103]
ds_read_b64_tr_b16 v[36:37], v5 offset:13312
ds_read_b64_tr_b16 v[38:39], v5 offset:15360
s_add_u32 m0, s83, 115712
s_add_u32 s76, s73, 3735552
buffer_load_dwordx4 v1, s[64:67], s76 offen lds
s_waitcnt vmcnt(14)
s_barrier
s_waitcnt lgkmcnt(6)
v_mfma_f32_32x32x16_bf16 v[40:55], a[76:79], v[24:27], v[40:55]
ds_read_b64_tr_b16 v[8:9], v4 offset:16384
ds_read_b64_tr_b16 v[10:11], v4 offset:18432
s_waitcnt lgkmcnt(6)
v_mfma_f32_32x32x16_bf16 v[56:71], a[76:79], v[28:31], v[56:71]
ds_read_b64_tr_b16 v[12:13], v5 offset:16384
ds_read_b64_tr_b16 v[14:15], v5 offset:18432
s_add_u32 m0, s83, 122880
s_add_u32 s76, s73, 3670144
buffer_load_dwordx4 v1, s[64:67], s76 offen lds
s_waitcnt lgkmcnt(6)
v_mfma_f32_32x32x16_bf16 v[72:87], a[76:79], v[32:35], v[72:87]
ds_read_b64_tr_b16 v[16:17], v4 offset:24576
ds_read_b64_tr_b16 v[18:19], v4 offset:26624
s_waitcnt lgkmcnt(6)
v_mfma_f32_32x32x16_bf16 v[88:103], a[76:79], v[36:39], v[88:103]
ds_read_b64_tr_b16 v[20:21], v5 offset:24576
ds_read_b64_tr_b16 v[22:23], v5 offset:26624
s_add_u32 m0, s83, 123904
s_add_u32 s76, s73, 3735680
buffer_load_dwordx4 v1, s[64:67], s76 offen lds
s_waitcnt lgkmcnt(6)
v_mfma_f32_32x32x16_bf16 v[40:55], a[80:83], v[8:11], v[40:55]
ds_read_b64_tr_b16 v[24:25], v4 offset:17408
ds_read_b64_tr_b16 v[26:27], v4 offset:19456
s_waitcnt lgkmcnt(6)
v_mfma_f32_32x32x16_bf16 v[56:71], a[80:83], v[12:15], v[56:71]
ds_read_b64_tr_b16 v[28:29], v5 offset:17408
ds_read_b64_tr_b16 v[30:31], v5 offset:19456
s_add_u32 s76, s72, 32768
buffer_load_dwordx4 a[128:131], v0, s[8:11], s76 offen offset:0 sc1
s_waitcnt lgkmcnt(6)
v_mfma_f32_32x32x16_bf16 v[72:87], a[80:83], v[16:19], v[72:87]
ds_read_b64_tr_b16 v[32:33], v4 offset:25600
ds_read_b64_tr_b16 v[34:35], v4 offset:27648
s_waitcnt lgkmcnt(6)
v_mfma_f32_32x32x16_bf16 v[88:103], a[80:83], v[20:23], v[88:103]
ds_read_b64_tr_b16 v[36:37], v5 offset:25600
ds_read_b64_tr_b16 v[38:39], v5 offset:27648
s_add_u32 s76, s72, 32768
buffer_load_dwordx4 a[132:135], v0, s[8:11], s76 offen offset:1024 sc1
s_waitcnt lgkmcnt(6)
v_mfma_f32_32x32x16_bf16 v[40:55], a[84:87], v[24:27], v[40:55]
ds_read_b64_tr_b16 v[8:9], v4 offset:20480
ds_read_b64_tr_b16 v[10:11], v4 offset:22528
s_waitcnt lgkmcnt(6)
v_mfma_f32_32x32x16_bf16 v[56:71], a[84:87], v[28:31], v[56:71]
ds_read_b64_tr_b16 v[12:13], v5 offset:20480
ds_read_b64_tr_b16 v[14:15], v5 offset:22528
s_add_u32 s76, s72, 32768
buffer_load_dwordx4 a[136:139], v0, s[8:11], s76 offen offset:2048 sc1
s_waitcnt lgkmcnt(6)
v_mfma_f32_32x32x16_bf16 v[72:87], a[84:87], v[32:35], v[72:87]
ds_read_b64_tr_b16 v[16:17], v4 offset:28672
ds_read_b64_tr_b16 v[18:19], v4 offset:30720
s_waitcnt lgkmcnt(6)
v_mfma_f32_32x32x16_bf16 v[88:103], a[84:87], v[36:39], v[88:103]
ds_read_b64_tr_b16 v[20:21], v5 offset:28672
ds_read_b64_tr_b16 v[22:23], v5 offset:30720
s_add_u32 s76, s72, 32768
buffer_load_dwordx4 a[140:143], v0, s[8:11], s76 offen offset:3072 sc1
s_waitcnt lgkmcnt(6)
v_mfma_f32_32x32x16_bf16 v[40:55], a[88:91], v[8:11], v[40:55]
ds_read_b64_tr_b16 v[24:25], v4 offset:21504
ds_read_b64_tr_b16 v[26:27], v4 offset:23552
s_waitcnt lgkmcnt(6)
v_mfma_f32_32x32x16_bf16 v[56:71], a[88:91], v[12:15], v[56:71]
ds_read_b64_tr_b16 v[28:29], v5 offset:21504
ds_read_b64_tr_b16 v[30:31], v5 offset:23552
s_add_u32 m0, s83, 131072
s_add_u32 s76, s73, 4194304
buffer_load_dwordx4 v1, s[64:67], s76 offen lds
s_waitcnt lgkmcnt(6)
v_mfma_f32_32x32x16_bf16 v[72:87], a[88:91], v[16:19], v[72:87]
ds_read_b64_tr_b16 v[32:33], v4 offset:29696
ds_read_b64_tr_b16 v[34:35], v4 offset:31744
s_waitcnt lgkmcnt(6)
v_mfma_f32_32x32x16_bf16 v[88:103], a[88:91], v[20:23], v[88:103]
ds_read_b64_tr_b16 v[36:37], v5 offset:29696
ds_read_b64_tr_b16 v[38:39], v5 offset:31744
s_add_u32 m0, s83, 132096
s_add_u32 s76, s73, 4259840
buffer_load_dwordx4 v1, s[64:67], s76 offen lds
s_waitcnt vmcnt(10)
s_barrier
s_waitcnt lgkmcnt(6)
v_mfma_f32_32x32x16_bf16 v[40:55], a[92:95], v[24:27], v[40:55]
ds_read_b64_tr_b16 v[8:9], v4 offset:32768
ds_read_b64_tr_b16 v[10:11], v4 offset:34816
s_waitcnt lgkmcnt(6)
v_mfma_f32_32x32x16_bf16 v[56:71], a[92:95], v[28:31], v[56:71]
ds_read_b64_tr_b16 v[12:13], v5 offset:32768
ds_read_b64_tr_b16 v[14:15], v5 offset:34816
s_add_u32 m0, s83, 139264
s_add_u32 s76, s73, 4194432
buffer_load_dwordx4 v1, s[64:67], s76 offen lds
s_waitcnt lgkmcnt(6)
v_mfma_f32_32x32x16_bf16 v[72:87], a[92:95], v[32:35], v[72:87]
ds_read_b64_tr_b16 v[16:17], v4 offset:40960
ds_read_b64_tr_b16 v[18:19], v4 offset:43008
s_waitcnt lgkmcnt(6)
v_mfma_f32_32x32x16_bf16 v[88:103], a[92:95], v[36:39], v[88:103]
ds_read_b64_tr_b16 v[20:21], v5 offset:40960
ds_read_b64_tr_b16 v[22:23], v5 offset:43008
s_add_u32 m0, s83, 140288
s_add_u32 s76, s73, 4259968
buffer_load_dwordx4 v1, s[64:67], s76 offen lds
s_waitcnt lgkmcnt(6)
v_mfma_f32_32x32x16_bf16 v[40:55], a[96:99], v[8:11], v[40:55]
ds_read_b64_tr_b16 v[24:25], v4 offset:33792
ds_read_b64_tr_b16 v[26:27], v4 offset:35840
s_waitcnt lgkmcnt(6)
v_mfma_f32_32x32x16_bf16 v[56:71], a[96:99], v[12:15], v[56:71]
ds_read_b64_tr_b16 v[28:29], v5 offset:33792
ds_read_b64_tr_b16 v[30:31], v5 offset:35840
s_add_u32 m0, s83, 0
s_add_u32 s76, s73, 256
buffer_load_dwordx4 v1, s[64:67], s76 offen lds
s_waitcnt lgkmcnt(6)
v_mfma_f32_32x32x16_bf16 v[72:87], a[96:99], v[16:19], v[72:87]
ds_read_b64_tr_b16 v[32:33], v4 offset:41984
ds_read_b64_tr_b16 v[34:35], v4 offset:44032
s_waitcnt lgkmcnt(6)
v_mfma_f32_32x32x16_bf16 v[88:103], a[96:99], v[20:23], v[88:103]
ds_read_b64_tr_b16 v[36:37], v5 offset:41984
ds_read_b64_tr_b16 v[38:39], v5 offset:44032
s_add_u32 m0, s83, 1024
s_add_u32 s76, s73, 65792
buffer_load_dwordx4 v1, s[64:67], s76 offen lds
s_waitcnt lgkmcnt(6)
v_mfma_f32_32x32x16_bf16 v[40:55], a[100:103], v[24:27], v[40:55]
ds_read_b64_tr_b16 v[8:9], v4 offset:36864
ds_read_b64_tr_b16 v[10:11], v4 offset:38912
s_waitcnt lgkmcnt(6)
v_mfma_f32_32x32x16_bf16 v[56:71], a[100:103], v[28:31], v[56:71]
ds_read_b64_tr_b16 v[12:13], v5 offset:36864
ds_read_b64_tr_b16 v[14:15], v5 offset:38912
s_add_u32 m0, s83, 8192
s_add_u32 s76, s73, 384
buffer_load_dwordx4 v1, s[64:67], s76 offen lds
s_waitcnt lgkmcnt(6)
v_mfma_f32_32x32x16_bf16 v[72:87], a[100:103], v[32:35], v[72:87]
ds_read_b64_tr_b16 v[16:17], v4 offset:45056
ds_read_b64_tr_b16 v[18:19], v4 offset:47104
s_waitcnt lgkmcnt(6)
v_mfma_f32_32x32x16_bf16 v[88:103], a[100:103], v[36:39], v[88:103]
ds_read_b64_tr_b16 v[20:21], v5 offset:45056
ds_read_b64_tr_b16 v[22:23], v5 offset:47104
s_add_u32 m0, s83, 9216
s_add_u32 s76, s73, 65920
buffer_load_dwordx4 v1, s[64:67], s76 offen lds
s_waitcnt lgkmcnt(6)
v_mfma_f32_32x32x16_bf16 v[40:55], a[104:107], v[8:11], v[40:55]
ds_read_b64_tr_b16 v[24:25], v4 offset:37888
ds_read_b64_tr_b16 v[26:27], v4 offset:39936
s_waitcnt lgkmcnt(6)
v_mfma_f32_32x32x16_bf16 v[56:71], a[104:107], v[12:15], v[56:71]
ds_read_b64_tr_b16 v[28:29], v5 offset:37888
ds_read_b64_tr_b16 v[30:31], v5 offset:39936
s_add_u32 m0, s83, 16384
s_add_u32 s76, s73, 524544
buffer_load_dwordx4 v1, s[64:67], s76 offen lds
s_waitcnt lgkmcnt(6)
v_mfma_f32_32x32x16_bf16 v[72:87], a[104:107], v[16:19], v[72:87]
ds_read_b64_tr_b16 v[32:33], v4 offset:46080
ds_read_b64_tr_b16 v[34:35], v4 offset:48128
s_waitcnt lgkmcnt(6)
v_mfma_f32_32x32x16_bf16 v[88:103], a[104:107], v[20:23], v[88:103]
ds_read_b64_tr_b16 v[36:37], v5 offset:46080
ds_read_b64_tr_b16 v[38:39], v5 offset:48128
s_add_u32 m0, s83, 17408
s_add_u32 s76, s73, 590080
buffer_load_dwordx4 v1, s[64:67], s76 offen lds
s_waitcnt vmcnt(14)
s_barrier
s_waitcnt lgkmcnt(6)
v_mfma_f32_32x32x16_bf16 v[40:55], a[108:111], v[24:27], v[40:55]
ds_read_b64_tr_b16 v[8:9], v4 offset:49152
ds_read_b64_tr_b16 v[10:11], v4 offset:51200
s_waitcnt lgkmcnt(6)
v_mfma_f32_32x32x16_bf16 v[56:71], a[108:111], v[28:31], v[56:71]
ds_read_b64_tr_b16 v[12:13], v5 offset:49152
ds_read_b64_tr_b16 v[14:15], v5 offset:51200
s_add_u32 m0, s83, 24576
s_add_u32 s76, s73, 524672
buffer_load_dwordx4 v1, s[64:67], s76 offen lds
s_waitcnt lgkmcnt(6)
v_mfma_f32_32x32x16_bf16 v[72:87], a[108:111], v[32:35], v[72:87]
ds_read_b64_tr_b16 v[16:17], v4 offset:57344
ds_read_b64_tr_b16 v[18:19], v4 offset:59392
s_waitcnt lgkmcnt(6)
v_mfma_f32_32x32x16_bf16 v[88:103], a[108:111], v[36:39], v[88:103]
ds_read_b64_tr_b16 v[20:21], v5 offset:57344
ds_read_b64_tr_b16 v[22:23], v5 offset:59392
s_add_u32 m0, s83, 25600
s_add_u32 s76, s73, 590208
buffer_load_dwordx4 v1, s[64:67], s76 offen lds
s_waitcnt lgkmcnt(6)
v_mfma_f32_32x32x16_bf16 v[40:55], a[112:115], v[8:11], v[40:55]
ds_read_b64_tr_b16 v[24:25], v4 offset:50176
ds_read_b64_tr_b16 v[26:27], v4 offset:52224
s_waitcnt lgkmcnt(6)
v_mfma_f32_32x32x16_bf16 v[56:71], a[112:115], v[12:15], v[56:71]
ds_read_b64_tr_b16 v[28:29], v5 offset:50176
ds_read_b64_tr_b16 v[30:31], v5 offset:52224
s_add_u32 m0, s83, 32768
s_add_u32 s76, s73, 1048832
buffer_load_dwordx4 v1, s[64:67], s76 offen lds
s_waitcnt lgkmcnt(6)
v_mfma_f32_32x32x16_bf16 v[72:87], a[112:115], v[16:19], v[72:87]
ds_read_b64_tr_b16 v[32:33], v4 offset:58368
ds_read_b64_tr_b16 v[34:35], v4 offset:60416
s_waitcnt lgkmcnt(6)
v_mfma_f32_32x32x16_bf16 v[88:103], a[112:115], v[20:23], v[88:103]
ds_read_b64_tr_b16 v[36:37], v5 offset:58368
ds_read_b64_tr_b16 v[38:39], v5 offset:60416
s_add_u32 m0, s83, 33792
s_add_u32 s76, s73, 1114368
buffer_load_dwordx4 v1, s[64:67], s76 offen lds
s_waitcnt lgkmcnt(6)
v_mfma_f32_32x32x16_bf16 v[40:55], a[116:119], v[24:27], v[40:55]
ds_read_b64_tr_b16 v[8:9], v4 offset:53248
ds_read_b64_tr_b16 v[10:11], v4 offset:55296
s_waitcnt lgkmcnt(6)
v_mfma_f32_32x32x16_bf16 v[56:71], a[116:119], v[28:31], v[56:71]
ds_read_b64_tr_b16 v[12:13], v5 offset:53248
ds_read_b64_tr_b16 v[14:15], v5 offset:55296
s_add_u32 m0, s83, 40960
s_add_u32 s76, s73, 1048960
buffer_load_dwordx4 v1, s[64:67], s76 offen lds
s_waitcnt lgkmcnt(6)
v_mfma_f32_32x32x16_bf16 v[72:87], a[116:119], v[32:35], v[72:87]
ds_read_b64_tr_b16 v[16:17], v4 offset:61440
ds_read_b64_tr_b16 v[18:19], v4 offset:63488
s_waitcnt lgkmcnt(6)
v_mfma_f32_32x32x16_bf16 v[88:103], a[116:119], v[36:39], v[88:103]
ds_read_b64_tr_b16 v[20:21], v5 offset:61440
ds_read_b64_tr_b16 v[22:23], v5 offset:63488
s_add_u32 m0, s83, 41984
s_add_u32 s76, s73, 1114496
buffer_load_dwordx4 v1, s[64:67], s76 offen lds
s_waitcnt lgkmcnt(6)
v_mfma_f32_32x32x16_bf16 v[40:55], a[120:123], v[8:11], v[40:55]
ds_read_b64_tr_b16 v[24:25], v4 offset:54272
ds_read_b64_tr_b16 v[26:27], v4 offset:56320
s_waitcnt lgkmcnt(6)
v_mfma_f32_32x32x16_bf16 v[56:71], a[120:123], v[12:15], v[56:71]
ds_read_b64_tr_b16 v[28:29], v5 offset:54272
ds_read_b64_tr_b16 v[30:31], v5 offset:56320
s_add_u32 m0, s83, 49152
s_add_u32 s76, s73, 1573120
buffer_load_dwordx4 v1, s[64:67], s76 offen lds
s_waitcnt lgkmcnt(6)
v_mfma_f32_32x32x16_bf16 v[72:87], a[120:123], v[16:19], v[72:87]
ds_read_b64_tr_b16 v[32:33], v4 offset:62464
ds_read_b64_tr_b16 v[34:35], v4 offset:64512
s_waitcnt lgkmcnt(6)
v_mfma_f32_32x32x16_bf16 v[88:103], a[120:123], v[20:23], v[88:103]
ds_read_b64_tr_b16 v[36:37], v5 offset:62464
ds_read_b64_tr_b16 v[38:39], v5 offset:64512
s_add_u32 m0, s83, 50176
s_add_u32 s76, s73, 1638656
buffer_load_dwordx4 v1, s[64:67], s76 offen lds
s_waitcnt vmcnt(14)
s_barrier
s_waitcnt lgkmcnt(6)
v_mfma_f32_32x32x16_bf16 v[40:55], a[124:127], v[24:27], v[40:55]
ds_read_b64_tr_b16 v[8:9], v6 offset:0
ds_read_b64_tr_b16 v[10:11], v6 offset:2048
s_waitcnt lgkmcnt(6)
v_mfma_f32_32x32x16_bf16 v[56:71], a[124:127], v[28:31], v[56:71]
ds_read_b64_tr_b16 v[12:13], v7 offset:0
ds_read_b64_tr_b16 v[14:15], v7 offset:2048
s_add_u32 m0, s83, 57344
s_add_u32 s76, s73, 1573248
buffer_load_dwordx4 v1, s[64:67], s76 offen lds
s_waitcnt lgkmcnt(6)
v_mfma_f32_32x32x16_bf16 v[72:87], a[124:127], v[32:35], v[72:87]
ds_read_b64_tr_b16 v[16:17], v6 offset:8192
ds_read_b64_tr_b16 v[18:19], v6 offset:10240
s_waitcnt lgkmcnt(6)
v_mfma_f32_32x32x16_bf16 v[88:103], a[124:127], v[36:39], v[88:103]
ds_read_b64_tr_b16 v[20:21], v7 offset:8192
ds_read_b64_tr_b16 v[22:23], v7 offset:10240
s_add_u32 m0, s83, 58368
s_add_u32 s76, s73, 1638784
buffer_load_dwordx4 v1, s[64:67], s76 offen lds
s_waitcnt lgkmcnt(6)
v_mfma_f32_32x32x16_bf16 v[40:55], a[128:131], v[8:11], v[40:55]
ds_read_b64_tr_b16 v[24:25], v6 offset:1024
ds_read_b64_tr_b16 v[26:27], v6 offset:3072
s_waitcnt lgkmcnt(6)
v_mfma_f32_32x32x16_bf16 v[56:71], a[128:131], v[12:15], v[56:71]
ds_read_b64_tr_b16 v[28:29], v7 offset:1024
ds_read_b64_tr_b16 v[30:31], v7 offset:3072
s_add_u32 m0, s83, 65536
s_add_u32 s76, s73, 2097408
buffer_load_dwordx4 v1, s[64:67], s76 offen lds
s_waitcnt lgkmcnt(6)
v_mfma_f32_32x32x16_bf16 v[72:87], a[128:131], v[16:19], v[72:87]
ds_read_b64_tr_b16 v[32:33], v6 offset:9216
ds_read_b64_tr_b16 v[34:35], v6 offset:11264
s_waitcnt lgkmcnt(6)
v_mfma_f32_32x32x16_bf16 v[88:103], a[128:131], v[20:23], v[88:103]
ds_read_b64_tr_b16 v[36:37], v7 offset:9216
ds_read_b64_tr_b16 v[38:39], v7 offset:11264
s_add_u32 m0, s83, 66560
s_add_u32 s76, s73, 2162944
buffer_load_dwordx4 v1, s[64:67], s76 offen lds
s_waitcnt lgkmcnt(6)
v_mfma_f32_32x32x16_bf16 v[40:55], a[132:135], v[24:27], v[40:55]
ds_read_b64_tr_b16 v[8:9], v6 offset:4096
ds_read_b64_tr_b16 v[10:11], v6 offset:6144
s_waitcnt lgkmcnt(6)
v_mfma_f32_32x32x16_bf16 v[56:71], a[132:135], v[28:31], v[56:71]
ds_read_b64_tr_b16 v[12:13], v7 offset:4096
ds_read_b64_tr_b16 v[14:15], v7 offset:6144
s_add_u32 m0, s83, 73728
s_add_u32 s76, s73, 2097536
buffer_load_dwordx4 v1, s[64:67], s76 offen lds
s_waitcnt lgkmcnt(6)
v_mfma_f32_32x32x16_bf16 v[72:87], a[132:135], v[32:35], v[72:87]
ds_read_b64_tr_b16 v[16:17], v6 offset:12288
ds_read_b64_tr_b16 v[18:19], v6 offset:14336
s_waitcnt lgkmcnt(6)
v_mfma_f32_32x32x16_bf16 v[88:103], a[132:135], v[36:39], v[88:103]
ds_read_b64_tr_b16 v[20:21], v7 offset:12288
ds_read_b64_tr_b16 v[22:23], v7 offset:14336
s_add_u32 m0, s83, 74752
s_add_u32 s76, s73, 2163072
buffer_load_dwordx4 v1, s[64:67], s76 offen lds
s_waitcnt lgkmcnt(6)
v_mfma_f32_32x32x16_bf16 v[40:55], a[136:139], v[8:11], v[40:55]
ds_read_b64_tr_b16 v[24:25], v6 offset:5120
ds_read_b64_tr_b16 v[26:27], v6 offset:7168
s_waitcnt lgkmcnt(6)
v_mfma_f32_32x32x16_bf16 v[56:71], a[136:139], v[12:15], v[56:71]
ds_read_b64_tr_b16 v[28:29], v7 offset:5120
ds_read_b64_tr_b16 v[30:31], v7 offset:7168
s_add_u32 m0, s83, 81920
s_add_u32 s76, s73, 2621696
buffer_load_dwordx4 v1, s[64:67], s76 offen lds
s_waitcnt lgkmcnt(6)
v_mfma_f32_32x32x16_bf16 v[72:87], a[136:139], v[16:19], v[72:87]
ds_read_b64_tr_b16 v[32:33], v6 offset:13312
ds_read_b64_tr_b16 v[34:35], v6 offset:15360
s_waitcnt lgkmcnt(6)
v_mfma_f32_32x32x16_bf16 v[88:103], a[136:139], v[20:23], v[88:103]
ds_read_b64_tr_b16 v[36:37], v7 offset:13312
ds_read_b64_tr_b16 v[38:39], v7 offset:15360
s_add_u32 m0, s83, 82944
s_add_u32 s76, s73, 2687232
buffer_load_dwordx4 v1, s[64:67], s76 offen lds
s_waitcnt vmcnt(18)
s_barrier
s_waitcnt lgkmcnt(6)
v_mfma_f32_32x32x16_bf16 v[40:55], a[140:143], v[24:27], v[40:55]
ds_read_b64_tr_b16 v[8:9], v2 offset:0
ds_read_b64_tr_b16 v[10:11], v2 offset:2048
s_waitcnt lgkmcnt(6)
v_mfma_f32_32x32x16_bf16 v[56:71], a[140:143], v[28:31], v[56:71]
ds_read_b64_tr_b16 v[12:13], v3 offset:0
ds_read_b64_tr_b16 v[14:15], v3 offset:2048
s_add_u32 m0, s83, 90112
s_add_u32 s76, s73, 2621824
buffer_load_dwordx4 v1, s[64:67], s76 offen lds
s_waitcnt lgkmcnt(6)
v_mfma_f32_32x32x16_bf16 v[72:87], a[140:143], v[32:35], v[72:87]
ds_read_b64_tr_b16 v[16:17], v2 offset:8192
ds_read_b64_tr_b16 v[18:19], v2 offset:10240
s_waitcnt lgkmcnt(6)
v_mfma_f32_32x32x16_bf16 v[88:103], a[140:143], v[36:39], v[88:103]
ds_read_b64_tr_b16 v[20:21], v3 offset:8192
ds_read_b64_tr_b16 v[22:23], v3 offset:10240
s_add_u32 m0, s83, 91136
s_add_u32 s76, s73, 2687360
buffer_load_dwordx4 v1, s[64:67], s76 offen lds
s_nop 11
s_add_u32 s77, s82, 0
v_cvt_pk_bf16_f32 v106, v40, v41
v_cvt_pk_bf16_f32 v107, v42, v43
v_cvt_pk_bf16_f32 v108, v48, v49
v_cvt_pk_bf16_f32 v109, v50, v51
buffer_store_dwordx4 v[106:109], v104, s[8:11], s77 offen offset:0 sc1
v_cvt_pk_bf16_f32 v110, v44, v45
v_cvt_pk_bf16_f32 v111, v46, v47
v_cvt_pk_bf16_f32 v112, v52, v53
v_cvt_pk_bf16_f32 v113, v54, v55
buffer_store_dwordx4 v[110:113], v104, s[8:11], s77 offen offset:512 sc1
s_add_u32 s77, s82, 2048
v_cvt_pk_bf16_f32 v114, v56, v57
v_cvt_pk_bf16_f32 v115, v58, v59
v_cvt_pk_bf16_f32 v116, v64, v65
v_cvt_pk_bf16_f32 v117, v66, v67
buffer_store_dwordx4 v[114:117], v104, s[8:11], s77 offen offset:0 sc1
v_cvt_pk_bf16_f32 v118, v60, v61
v_cvt_pk_bf16_f32 v119, v62, v63
v_cvt_pk_bf16_f32 v120, v68, v69
v_cvt_pk_bf16_f32 v121, v70, v71
buffer_store_dwordx4 v[118:121], v104, s[8:11], s77 offen offset:512 sc1
s_add_u32 s77, s82, 4096
v_cvt_pk_bf16_f32 v106, v72, v73
v_cvt_pk_bf16_f32 v107, v74, v75
v_cvt_pk_bf16_f32 v108, v80, v81
v_cvt_pk_bf16_f32 v109, v82, v83
buffer_store_dwordx4 v[106:109], v104, s[8:11], s77 offen offset:0 sc1
v_cvt_pk_bf16_f32 v110, v76, v77
v_cvt_pk_bf16_f32 v111, v78, v79
v_cvt_pk_bf16_f32 v112, v84, v85
v_cvt_pk_bf16_f32 v113, v86, v87
buffer_store_dwordx4 v[110:113], v104, s[8:11], s77 offen offset:512 sc1
s_add_u32 s77, s82, 6144
v_cvt_pk_bf16_f32 v114, v88, v89
v_cvt_pk_bf16_f32 v115, v90, v91
v_cvt_pk_bf16_f32 v116, v96, v97
v_cvt_pk_bf16_f32 v117, v98, v99
buffer_store_dwordx4 v[114:117], v104, s[8:11], s77 offen offset:0 sc1
v_cvt_pk_bf16_f32 v118, v92, v93
v_cvt_pk_bf16_f32 v119, v94, v95
v_cvt_pk_bf16_f32 v120, v100, v101
v_cvt_pk_bf16_f32 v121, v102, v103
buffer_store_dwordx4 v[118:121], v104, s[8:11], s77 offen offset:512 sc1
s_waitcnt lgkmcnt(6)
v_mfma_f32_32x32x16_bf16 v[40:55], a[0:3], v[8:11], 0
ds_read_b64_tr_b16 v[24:25], v2 offset:1024
ds_read_b64_tr_b16 v[26:27], v2 offset:3072
s_waitcnt lgkmcnt(6)
v_mfma_f32_32x32x16_bf16 v[56:71], a[0:3], v[12:15], 0
ds_read_b64_tr_b16 v[28:29], v3 offset:1024
ds_read_b64_tr_b16 v[30:31], v3 offset:3072
s_add_u32 m0, s83, 98304
s_add_u32 s76, s73, 3145984
buffer_load_dwordx4 v1, s[64:67], s76 offen lds
s_waitcnt lgkmcnt(6)
v_mfma_f32_32x32x16_bf16 v[72:87], a[0:3], v[16:19], 0
ds_read_b64_tr_b16 v[32:33], v2 offset:9216
ds_read_b64_tr_b16 v[34:35], v2 offset:11264
s_waitcnt lgkmcnt(6)
v_mfma_f32_32x32x16_bf16 v[88:103], a[0:3], v[20:23], 0
ds_read_b64_tr_b16 v[36:37], v3 offset:9216
ds_read_b64_tr_b16 v[38:39], v3 offset:11264
s_add_u32 m0, s83, 99328
s_add_u32 s76, s73, 3211520
buffer_load_dwordx4 v1, s[64:67], s76 offen lds
s_waitcnt lgkmcnt(6)
v_mfma_f32_32x32x16_bf16 v[40:55], a[4:7], v[24:27], v[40:55]
ds_read_b64_tr_b16 v[8:9], v2 offset:4096
ds_read_b64_tr_b16 v[10:11], v2 offset:6144
s_waitcnt lgkmcnt(6)
v_mfma_f32_32x32x16_bf16 v[56:71], a[4:7], v[28:31], v[56:71]
ds_read_b64_tr_b16 v[12:13], v3 offset:4096
ds_read_b64_tr_b16 v[14:15], v3 offset:6144
s_add_u32 m0, s83, 106496
s_add_u32 s76, s73, 3146112
buffer_load_dwordx4 v1, s[64:67], s76 offen lds
s_waitcnt lgkmcnt(6)
v_mfma_f32_32x32x16_bf16 v[72:87], a[4:7], v[32:35], v[72:87]
ds_read_b64_tr_b16 v[16:17], v2 offset:12288
ds_read_b64_tr_b16 v[18:19], v2 offset:14336
s_waitcnt lgkmcnt(6)
v_mfma_f32_32x32x16_bf16 v[88:103], a[4:7], v[36:39], v[88:103]
ds_read_b64_tr_b16 v[20:21], v3 offset:12288
ds_read_b64_tr_b16 v[22:23], v3 offset:14336
s_add_u32 m0, s83, 107520
s_add_u32 s76, s73, 3211648
buffer_load_dwordx4 v1, s[64:67], s76 offen lds
s_waitcnt lgkmcnt(6)
v_mfma_f32_32x32x16_bf16 v[40:55], a[8:11], v[8:11], v[40:55]
ds_read_b64_tr_b16 v[24:25], v2 offset:5120
ds_read_b64_tr_b16 v[26:27], v2 offset:7168
s_waitcnt lgkmcnt(6)
v_mfma_f32_32x32x16_bf16 v[56:71], a[8:11], v[12:15], v[56:71]
ds_read_b64_tr_b16 v[28:29], v3 offset:5120
ds_read_b64_tr_b16 v[30:31], v3 offset:7168
s_add_u32 m0, s83, 114688
s_add_u32 s76, s73, 3670272
buffer_load_dwordx4 v1, s[64:67], s76 offen lds
s_waitcnt lgkmcnt(6)
v_mfma_f32_32x32x16_bf16 v[72:87], a[8:11], v[16:19], v[72:87]
ds_read_b64_tr_b16 v[32:33], v2 offset:13312
ds_read_b64_tr_b16 v[34:35], v2 offset:15360
s_waitcnt lgkmcnt(6)
v_mfma_f32_32x32x16_bf16 v[88:103], a[8:11], v[20:23], v[88:103]
ds_read_b64_tr_b16 v[36:37], v3 offset:13312
ds_read_b64_tr_b16 v[38:39], v3 offset:15360
s_add_u32 m0, s83, 115712
s_add_u32 s76, s73, 3735808
buffer_load_dwordx4 v1, s[64:67], s76 offen lds
s_waitcnt vmcnt(30)
s_barrier
s_waitcnt lgkmcnt(6)
v_mfma_f32_32x32x16_bf16 v[40:55], a[12:15], v[24:27], v[40:55]
ds_read_b64_tr_b16 v[8:9], v2 offset:16384
ds_read_b64_tr_b16 v[10:11], v2 offset:18432
s_waitcnt lgkmcnt(6)
v_mfma_f32_32x32x16_bf16 v[56:71], a[12:15], v[28:31], v[56:71]
ds_read_b64_tr_b16 v[12:13], v3 offset:16384
ds_read_b64_tr_b16 v[14:15], v3 offset:18432
s_add_u32 m0, s83, 122880
s_add_u32 s76, s73, 3670400
buffer_load_dwordx4 v1, s[64:67], s76 offen lds
s_waitcnt lgkmcnt(6)
v_mfma_f32_32x32x16_bf16 v[72:87], a[12:15], v[32:35], v[72:87]
ds_read_b64_tr_b16 v[16:17], v2 offset:24576
ds_read_b64_tr_b16 v[18:19], v2 offset:26624
s_waitcnt lgkmcnt(6)
v_mfma_f32_32x32x16_bf16 v[88:103], a[12:15], v[36:39], v[88:103]
ds_read_b64_tr_b16 v[20:21], v3 offset:24576
ds_read_b64_tr_b16 v[22:23], v3 offset:26624
s_add_u32 m0, s83, 123904
s_add_u32 s76, s73, 3735936
buffer_load_dwordx4 v1, s[64:67], s76 offen lds
s_waitcnt lgkmcnt(6)
v_mfma_f32_32x32x16_bf16 v[40:55], a[16:19], v[8:11], v[40:55]
ds_read_b64_tr_b16 v[24:25], v2 offset:17408
ds_read_b64_tr_b16 v[26:27], v2 offset:19456
s_waitcnt lgkmcnt(6)
v_mfma_f32_32x32x16_bf16 v[56:71], a[16:19], v[12:15], v[56:71]
ds_read_b64_tr_b16 v[28:29], v3 offset:17408
ds_read_b64_tr_b16 v[30:31], v3 offset:19456
s_add_u32 m0, s83, 131072
s_add_u32 s76, s73, 4194560
buffer_load_dwordx4 v1, s[64:67], s76 offen lds
s_waitcnt lgkmcnt(6)
v_mfma_f32_32x32x16_bf16 v[72:87], a[16:19], v[16:19], v[72:87]
ds_read_b64_tr_b16 v[32:33], v2 offset:25600
ds_read_b64_tr_b16 v[34:35], v2 offset:27648
s_waitcnt lgkmcnt(6)
v_mfma_f32_32x32x16_bf16 v[88:103], a[16:19], v[20:23], v[88:103]
ds_read_b64_tr_b16 v[36:37], v3 offset:25600
ds_read_b64_tr_b16 v[38:39], v3 offset:27648
s_add_u32 m0, s83, 132096
s_add_u32 s76, s73, 4260096
buffer_load_dwordx4 v1, s[64:67], s76 offen lds
s_waitcnt lgkmcnt(6)
v_mfma_f32_32x32x16_bf16 v[40:55], a[20:23], v[24:27], v[40:55]
ds_read_b64_tr_b16 v[8:9], v2 offset:20480
ds_read_b64_tr_b16 v[10:11], v2 offset:22528
s_waitcnt lgkmcnt(6)
v_mfma_f32_32x32x16_bf16 v[56:71], a[20:23], v[28:31], v[56:71]
ds_read_b64_tr_b16 v[12:13], v3 offset:20480
ds_read_b64_tr_b16 v[14:15], v3 offset:22528
s_add_u32 m0, s83, 139264
s_add_u32 s76, s73, 4194688
buffer_load_dwordx4 v1, s[64:67], s76 offen lds
s_waitcnt lgkmcnt(6)
v_mfma_f32_32x32x16_bf16 v[72:87], a[20:23], v[32:35], v[72:87]
ds_read_b64_tr_b16 v[16:17], v2 offset:28672
ds_read_b64_tr_b16 v[18:19], v2 offset:30720
s_waitcnt lgkmcnt(6)
v_mfma_f32_32x32x16_bf16 v[88:103], a[20:23], v[36:39], v[88:103]
ds_read_b64_tr_b16 v[20:21], v3 offset:28672
ds_read_b64_tr_b16 v[22:23], v3 offset:30720
s_add_u32 m0, s83, 140288
s_add_u32 s76, s73, 4260224
buffer_load_dwordx4 v1, s[64:67], s76 offen lds
s_waitcnt lgkmcnt(6)
v_mfma_f32_32x32x16_bf16 v[40:55], a[24:27], v[8:11], v[40:55]
ds_read_b64_tr_b16 v[24:25], v2 offset:21504
ds_read_b64_tr_b16 v[26:27], v2 offset:23552
s_waitcnt lgkmcnt(6)
v_mfma_f32_32x32x16_bf16 v[56:71], a[24:27], v[12:15], v[56:71]
ds_read_b64_tr_b16 v[28:29], v3 offset:21504
ds_read_b64_tr_b16 v[30:31], v3 offset:23552
s_waitcnt lgkmcnt(6)
v_mfma_f32_32x32x16_bf16 v[72:87], a[24:27], v[16:19], v[72:87]
ds_read_b64_tr_b16 v[32:33], v2 offset:29696
ds_read_b64_tr_b16 v[34:35], v2 offset:31744
s_waitcnt lgkmcnt(6)
v_mfma_f32_32x32x16_bf16 v[88:103], a[24:27], v[20:23], v[88:103]
ds_read_b64_tr_b16 v[36:37], v3 offset:29696
ds_read_b64_tr_b16 v[38:39], v3 offset:31744
s_waitcnt vmcnt(32)
s_barrier
s_waitcnt lgkmcnt(6)
v_mfma_f32_32x32x16_bf16 v[40:55], a[28:31], v[24:27], v[40:55]
ds_read_b64_tr_b16 v[8:9], v2 offset:32768
ds_read_b64_tr_b16 v[10:11], v2 offset:34816
s_waitcnt lgkmcnt(6)
v_mfma_f32_32x32x16_bf16 v[56:71], a[28:31], v[28:31], v[56:71]
ds_read_b64_tr_b16 v[12:13], v3 offset:32768
ds_read_b64_tr_b16 v[14:15], v3 offset:34816
s_waitcnt lgkmcnt(6)
v_mfma_f32_32x32x16_bf16 v[72:87], a[28:31], v[32:35], v[72:87]
ds_read_b64_tr_b16 v[16:17], v2 offset:40960
ds_read_b64_tr_b16 v[18:19], v2 offset:43008
s_waitcnt lgkmcnt(6)
v_mfma_f32_32x32x16_bf16 v[88:103], a[28:31], v[36:39], v[88:103]
ds_read_b64_tr_b16 v[20:21], v3 offset:40960
ds_read_b64_tr_b16 v[22:23], v3 offset:43008
s_waitcnt lgkmcnt(6)
v_mfma_f32_32x32x16_bf16 v[40:55], a[32:35], v[8:11], v[40:55]
ds_read_b64_tr_b16 v[24:25], v2 offset:33792
ds_read_b64_tr_b16 v[26:27], v2 offset:35840
s_waitcnt lgkmcnt(6)
v_mfma_f32_32x32x16_bf16 v[56:71], a[32:35], v[12:15], v[56:71]
ds_read_b64_tr_b16 v[28:29], v3 offset:33792
ds_read_b64_tr_b16 v[30:31], v3 offset:35840
s_add_u32 m0, s83, 0
s_add_u32 s76, s73, 512
buffer_load_dwordx4 v1, s[64:67], s76 offen lds
s_waitcnt lgkmcnt(6)
v_mfma_f32_32x32x16_bf16 v[72:87], a[32:35], v[16:19], v[72:87]
ds_read_b64_tr_b16 v[32:33], v2 offset:41984
ds_read_b64_tr_b16 v[34:35], v2 offset:44032
s_waitcnt lgkmcnt(6)
v_mfma_f32_32x32x16_bf16 v[88:103], a[32:35], v[20:23], v[88:103]
ds_read_b64_tr_b16 v[36:37], v3 offset:41984
ds_read_b64_tr_b16 v[38:39], v3 offset:44032
s_add_u32 m0, s83, 1024
s_add_u32 s76, s73, 66048
buffer_load_dwordx4 v1, s[64:67], s76 offen lds
s_waitcnt lgkmcnt(6)
v_mfma_f32_32x32x16_bf16 v[40:55], a[36:39], v[24:27], v[40:55]
ds_read_b64_tr_b16 v[8:9], v2 offset:36864
ds_read_b64_tr_b16 v[10:11], v2 offset:38912
s_waitcnt lgkmcnt(6)
v_mfma_f32_32x32x16_bf16 v[56:71], a[36:39], v[28:31], v[56:71]
ds_read_b64_tr_b16 v[12:13], v3 offset:36864
ds_read_b64_tr_b16 v[14:15], v3 offset:38912
s_add_u32 m0, s83, 8192
s_add_u32 s76, s73, 640
buffer_load_dwordx4 v1, s[64:67], s76 offen lds
s_waitcnt lgkmcnt(6)
v_mfma_f32_32x32x16_bf16 v[72:87], a[36:39], v[32:35], v[72:87]
ds_read_b64_tr_b16 v[16:17], v2 offset:45056
ds_read_b64_tr_b16 v[18:19], v2 offset:47104
s_waitcnt lgkmcnt(6)
v_mfma_f32_32x32x16_bf16 v[88:103], a[36:39], v[36:39], v[88:103]
ds_read_b64_tr_b16 v[20:21], v3 offset:45056
ds_read_b64_tr_b16 v[22:23], v3 offset:47104
s_add_u32 m0, s83, 9216
s_add_u32 s76, s73, 66176
buffer_load_dwordx4 v1, s[64:67], s76 offen lds
s_waitcnt lgkmcnt(6)
v_mfma_f32_32x32x16_bf16 v[40:55], a[40:43], v[8:11], v[40:55]
ds_read_b64_tr_b16 v[24:25], v2 offset:37888
ds_read_b64_tr_b16 v[26:27], v2 offset:39936
s_waitcnt lgkmcnt(6)
v_mfma_f32_32x32x16_bf16 v[56:71], a[40:43], v[12:15], v[56:71]
ds_read_b64_tr_b16 v[28:29], v3 offset:37888
ds_read_b64_tr_b16 v[30:31], v3 offset:39936
s_waitcnt lgkmcnt(6)
v_mfma_f32_32x32x16_bf16 v[72:87], a[40:43], v[16:19], v[72:87]
ds_read_b64_tr_b16 v[32:33], v2 offset:46080
ds_read_b64_tr_b16 v[34:35], v2 offset:48128
s_waitcnt lgkmcnt(6)
v_mfma_f32_32x32x16_bf16 v[88:103], a[40:43], v[20:23], v[88:103]
ds_read_b64_tr_b16 v[36:37], v3 offset:46080
ds_read_b64_tr_b16 v[38:39], v3 offset:48128
s_waitcnt vmcnt(32)
s_barrier
s_waitcnt lgkmcnt(6)
v_mfma_f32_32x32x16_bf16 v[40:55], a[44:47], v[24:27], v[40:55]
ds_read_b64_tr_b16 v[8:9], v2 offset:49152
ds_read_b64_tr_b16 v[10:11], v2 offset:51200
s_waitcnt lgkmcnt(6)
v_mfma_f32_32x32x16_bf16 v[56:71], a[44:47], v[28:31], v[56:71]
ds_read_b64_tr_b16 v[12:13], v3 offset:49152
ds_read_b64_tr_b16 v[14:15], v3 offset:51200
s_waitcnt lgkmcnt(6)
v_mfma_f32_32x32x16_bf16 v[72:87], a[44:47], v[32:35], v[72:87]
ds_read_b64_tr_b16 v[16:17], v2 offset:57344
ds_read_b64_tr_b16 v[18:19], v2 offset:59392
s_waitcnt lgkmcnt(6)
v_mfma_f32_32x32x16_bf16 v[88:103], a[44:47], v[36:39], v[88:103]
ds_read_b64_tr_b16 v[20:21], v3 offset:57344
ds_read_b64_tr_b16 v[22:23], v3 offset:59392
s_waitcnt lgkmcnt(6)
v_mfma_f32_32x32x16_bf16 v[40:55], a[48:51], v[8:11], v[40:55]
ds_read_b64_tr_b16 v[24:25], v2 offset:50176
ds_read_b64_tr_b16 v[26:27], v2 offset:52224
s_waitcnt lgkmcnt(6)
v_mfma_f32_32x32x16_bf16 v[56:71], a[48:51], v[12:15], v[56:71]
ds_read_b64_tr_b16 v[28:29], v3 offset:50176
ds_read_b64_tr_b16 v[30:31], v3 offset:52224
s_add_u32 m0, s83, 16384
s_add_u32 s76, s73, 524800
buffer_load_dwordx4 v1, s[64:67], s76 offen lds
s_waitcnt lgkmcnt(6)
v_mfma_f32_32x32x16_bf16 v[72:87], a[48:51], v[16:19], v[72:87]
ds_read_b64_tr_b16 v[32:33], v2 offset:58368
ds_read_b64_tr_b16 v[34:35], v2 offset:60416
s_waitcnt lgkmcnt(6)
v_mfma_f32_32x32x16_bf16 v[88:103], a[48:51], v[20:23], v[88:103]
ds_read_b64_tr_b16 v[36:37], v3 offset:58368
ds_read_b64_tr_b16 v[38:39], v3 offset:60416
s_add_u32 m0, s83, 17408
s_add_u32 s76, s73, 590336
buffer_load_dwordx4 v1, s[64:67], s76 offen lds
s_waitcnt lgkmcnt(6)
v_mfma_f32_32x32x16_bf16 v[40:55], a[52:55], v[24:27], v[40:55]
ds_read_b64_tr_b16 v[8:9], v2 offset:53248
ds_read_b64_tr_b16 v[10:11], v2 offset:55296
s_waitcnt lgkmcnt(6)
v_mfma_f32_32x32x16_bf16 v[56:71], a[52:55], v[28:31], v[56:71]
ds_read_b64_tr_b16 v[12:13], v3 offset:53248
ds_read_b64_tr_b16 v[14:15], v3 offset:55296
s_add_u32 m0, s83, 24576
s_add_u32 s76, s73, 524928
buffer_load_dwordx4 v1, s[64:67], s76 offen lds
s_waitcnt lgkmcnt(6)
v_mfma_f32_32x32x16_bf16 v[72:87], a[52:55], v[32:35], v[72:87]
ds_read_b64_tr_b16 v[16:17], v2 offset:61440
ds_read_b64_tr_b16 v[18:19], v2 offset:63488
s_waitcnt lgkmcnt(6)
v_mfma_f32_32x32x16_bf16 v[88:103], a[52:55], v[36:39], v[88:103]
ds_read_b64_tr_b16 v[20:21], v3 offset:61440
ds_read_b64_tr_b16 v[22:23], v3 offset:63488
s_add_u32 m0, s83, 25600
s_add_u32 s76, s73, 590464
buffer_load_dwordx4 v1, s[64:67], s76 offen lds
s_waitcnt lgkmcnt(6)
v_mfma_f32_32x32x16_bf16 v[40:55], a[56:59], v[8:11], v[40:55]
ds_read_b64_tr_b16 v[24:25], v2 offset:54272
ds_read_b64_tr_b16 v[26:27], v2 offset:56320
s_waitcnt lgkmcnt(6)
v_mfma_f32_32x32x16_bf16 v[56:71], a[56:59], v[12:15], v[56:71]
ds_read_b64_tr_b16 v[28:29], v3 offset:54272
ds_read_b64_tr_b16 v[30:31], v3 offset:56320
s_waitcnt lgkmcnt(6)
v_mfma_f32_32x32x16_bf16 v[72:87], a[56:59], v[16:19], v[72:87]
ds_read_b64_tr_b16 v[32:33], v2 offset:62464
ds_read_b64_tr_b16 v[34:35], v2 offset:64512
s_waitcnt lgkmcnt(6)
v_mfma_f32_32x32x16_bf16 v[88:103], a[56:59], v[20:23], v[88:103]
ds_read_b64_tr_b16 v[36:37], v3 offset:62464
ds_read_b64_tr_b16 v[38:39], v3 offset:64512
s_waitcnt vmcnt(32)
s_barrier
s_waitcnt lgkmcnt(6)
v_mfma_f32_32x32x16_bf16 v[40:55], a[60:63], v[24:27], v[40:55]
ds_read_b64_tr_b16 v[8:9], v4 offset:0
ds_read_b64_tr_b16 v[10:11], v4 offset:2048
s_waitcnt lgkmcnt(6)
v_mfma_f32_32x32x16_bf16 v[56:71], a[60:63], v[28:31], v[56:71]
ds_read_b64_tr_b16 v[12:13], v5 offset:0
ds_read_b64_tr_b16 v[14:15], v5 offset:2048
s_waitcnt lgkmcnt(6)
v_mfma_f32_32x32x16_bf16 v[72:87], a[60:63], v[32:35], v[72:87]
ds_read_b64_tr_b16 v[16:17], v4 offset:8192
ds_read_b64_tr_b16 v[18:19], v4 offset:10240
s_waitcnt lgkmcnt(6)
v_mfma_f32_32x32x16_bf16 v[88:103], a[60:63], v[36:39], v[88:103]
ds_read_b64_tr_b16 v[20:21], v5 offset:8192
ds_read_b64_tr_b16 v[22:23], v5 offset:10240
s_waitcnt lgkmcnt(6)
v_mfma_f32_32x32x16_bf16 v[40:55], a[64:67], v[8:11], v[40:55]
ds_read_b64_tr_b16 v[24:25], v4 offset:1024
ds_read_b64_tr_b16 v[26:27], v4 offset:3072
s_waitcnt lgkmcnt(6)
v_mfma_f32_32x32x16_bf16 v[56:71], a[64:67], v[12:15], v[56:71]
ds_read_b64_tr_b16 v[28:29], v5 offset:1024
ds_read_b64_tr_b16 v[30:31], v5 offset:3072
s_add_u32 m0, s83, 32768
s_add_u32 s76, s73, 1049088
buffer_load_dwordx4 v1, s[64:67], s76 offen lds
s_waitcnt lgkmcnt(6)
v_mfma_f32_32x32x16_bf16 v[72:87], a[64:67], v[16:19], v[72:87]
ds_read_b64_tr_b16 v[32:33], v4 offset:9216
ds_read_b64_tr_b16 v[34:35], v4 offset:11264
s_waitcnt lgkmcnt(6)
v_mfma_f32_32x32x16_bf16 v[88:103], a[64:67], v[20:23], v[88:103]
ds_read_b64_tr_b16 v[36:37], v5 offset:9216
ds_read_b64_tr_b16 v[38:39], v5 offset:11264
s_add_u32 m0, s83, 33792
s_add_u32 s76, s73, 1114624
buffer_load_dwordx4 v1, s[64:67], s76 offen lds
s_waitcnt lgkmcnt(6)
v_mfma_f32_32x32x16_bf16 v[40:55], a[68:71], v[24:27], v[40:55]
ds_read_b64_tr_b16 v[8:9], v4 offset:4096
ds_read_b64_tr_b16 v[10:11], v4 offset:6144
s_waitcnt lgkmcnt(6)
v_mfma_f32_32x32x16_bf16 v[56:71], a[68:71], v[28:31], v[56:71]
ds_read_b64_tr_b16 v[12:13], v5 offset:4096
ds_read_b64_tr_b16 v[14:15], v5 offset:6144
s_add_u32 m0, s83, 40960
s_add_u32 s76, s73, 1049216
buffer_load_dwordx4 v1, s[64:67], s76 offen lds
s_waitcnt lgkmcnt(6)
v_mfma_f32_32x32x16_bf16 v[72:87], a[68:71], v[32:35], v[72:87]
ds_read_b64_tr_b16 v[16:17], v4 offset:12288
ds_read_b64_tr_b16 v[18:19], v4 offset:14336
s_waitcnt lgkmcnt(6)
v_mfma_f32_32x32x16_bf16 v[88:103], a[68:71], v[36:39], v[88:103]
ds_read_b64_tr_b16 v[20:21], v5 offset:12288
ds_read_b64_tr_b16 v[22:23], v5 offset:14336
s_add_u32 m0, s83, 41984
s_add_u32 s76, s73, 1114752
buffer_load_dwordx4 v1, s[64:67], s76 offen lds
s_waitcnt lgkmcnt(6)
v_mfma_f32_32x32x16_bf16 v[40:55], a[72:75], v[8:11], v[40:55]
ds_read_b64_tr_b16 v[24:25], v4 offset:5120
ds_read_b64_tr_b16 v[26:27], v4 offset:7168
s_waitcnt lgkmcnt(6)
v_mfma_f32_32x32x16_bf16 v[56:71], a[72:75], v[12:15], v[56:71]
ds_read_b64_tr_b16 v[28:29], v5 offset:5120
ds_read_b64_tr_b16 v[30:31], v5 offset:7168
s_waitcnt lgkmcnt(6)
v_mfma_f32_32x32x16_bf16 v[72:87], a[72:75], v[16:19], v[72:87]
ds_read_b64_tr_b16 v[32:33], v4 offset:13312
ds_read_b64_tr_b16 v[34:35], v4 offset:15360
s_waitcnt lgkmcnt(6)
v_mfma_f32_32x32x16_bf16 v[88:103], a[72:75], v[20:23], v[88:103]
ds_read_b64_tr_b16 v[36:37], v5 offset:13312
ds_read_b64_tr_b16 v[38:39], v5 offset:15360
s_waitcnt vmcnt(32)
s_barrier
s_waitcnt lgkmcnt(6)
v_mfma_f32_32x32x16_bf16 v[40:55], a[76:79], v[24:27], v[40:55]
ds_read_b64_tr_b16 v[8:9], v4 offset:16384
ds_read_b64_tr_b16 v[10:11], v4 offset:18432
s_waitcnt lgkmcnt(6)
v_mfma_f32_32x32x16_bf16 v[56:71], a[76:79], v[28:31], v[56:71]
ds_read_b64_tr_b16 v[12:13], v5 offset:16384
ds_read_b64_tr_b16 v[14:15], v5 offset:18432
s_waitcnt lgkmcnt(6)
v_mfma_f32_32x32x16_bf16 v[72:87], a[76:79], v[32:35], v[72:87]
ds_read_b64_tr_b16 v[16:17], v4 offset:24576
ds_read_b64_tr_b16 v[18:19], v4 offset:26624
s_waitcnt lgkmcnt(6)
v_mfma_f32_32x32x16_bf16 v[88:103], a[76:79], v[36:39], v[88:103]
ds_read_b64_tr_b16 v[20:21], v5 offset:24576
ds_read_b64_tr_b16 v[22:23], v5 offset:26624
s_waitcnt lgkmcnt(6)
v_mfma_f32_32x32x16_bf16 v[40:55], a[80:83], v[8:11], v[40:55]
ds_read_b64_tr_b16 v[24:25], v4 offset:17408
ds_read_b64_tr_b16 v[26:27], v4 offset:19456
s_waitcnt lgkmcnt(6)
v_mfma_f32_32x32x16_bf16 v[56:71], a[80:83], v[12:15], v[56:71]
ds_read_b64_tr_b16 v[28:29], v5 offset:17408
ds_read_b64_tr_b16 v[30:31], v5 offset:19456
s_add_u32 m0, s83, 49152
s_add_u32 s76, s73, 1573376
buffer_load_dwordx4 v1, s[64:67], s76 offen lds
s_waitcnt lgkmcnt(6)
v_mfma_f32_32x32x16_bf16 v[72:87], a[80:83], v[16:19], v[72:87]
ds_read_b64_tr_b16 v[32:33], v4 offset:25600
ds_read_b64_tr_b16 v[34:35], v4 offset:27648
s_waitcnt lgkmcnt(6)
v_mfma_f32_32x32x16_bf16 v[88:103], a[80:83], v[20:23], v[88:103]
ds_read_b64_tr_b16 v[36:37], v5 offset:25600
ds_read_b64_tr_b16 v[38:39], v5 offset:27648
s_add_u32 m0, s83, 50176
s_add_u32 s76, s73, 1638912
buffer_load_dwordx4 v1, s[64:67], s76 offen lds
s_waitcnt lgkmcnt(6)
v_mfma_f32_32x32x16_bf16 v[40:55], a[84:87], v[24:27], v[40:55]
ds_read_b64_tr_b16 v[8:9], v4 offset:20480
ds_read_b64_tr_b16 v[10:11], v4 offset:22528
s_waitcnt lgkmcnt(6)
v_mfma_f32_32x32x16_bf16 v[56:71], a[84:87], v[28:31], v[56:71]
ds_read_b64_tr_b16 v[12:13], v5 offset:20480
ds_read_b64_tr_b16 v[14:15], v5 offset:22528
s_add_u32 m0, s83, 57344
s_add_u32 s76, s73, 1573504
buffer_load_dwordx4 v1, s[64:67], s76 offen lds
s_waitcnt lgkmcnt(6)
v_mfma_f32_32x32x16_bf16 v[72:87], a[84:87], v[32:35], v[72:87]
ds_read_b64_tr_b16 v[16:17], v4 offset:28672
ds_read_b64_tr_b16 v[18:19], v4 offset:30720
s_waitcnt lgkmcnt(6)
v_mfma_f32_32x32x16_bf16 v[88:103], a[84:87], v[36:39], v[88:103]
ds_read_b64_tr_b16 v[20:21], v5 offset:28672
ds_read_b64_tr_b16 v[22:23], v5 offset:30720
s_add_u32 m0, s83, 58368
s_add_u32 s76, s73, 1639040
buffer_load_dwordx4 v1, s[64:67], s76 offen lds
s_waitcnt lgkmcnt(6)
v_mfma_f32_32x32x16_bf16 v[40:55], a[88:91], v[8:11], v[40:55]
ds_read_b64_tr_b16 v[24:25], v4 offset:21504
ds_read_b64_tr_b16 v[26:27], v4 offset:23552
s_waitcnt lgkmcnt(6)
v_mfma_f32_32x32x16_bf16 v[56:71], a[88:91], v[12:15], v[56:71]
ds_read_b64_tr_b16 v[28:29], v5 offset:21504
ds_read_b64_tr_b16 v[30:31], v5 offset:23552
s_waitcnt lgkmcnt(6)
v_mfma_f32_32x32x16_bf16 v[72:87], a[88:91], v[16:19], v[72:87]
ds_read_b64_tr_b16 v[32:33], v4 offset:29696
ds_read_b64_tr_b16 v[34:35], v4 offset:31744
s_waitcnt lgkmcnt(6)
v_mfma_f32_32x32x16_bf16 v[88:103], a[88:91], v[20:23], v[88:103]
ds_read_b64_tr_b16 v[36:37], v5 offset:29696
ds_read_b64_tr_b16 v[38:39], v5 offset:31744
s_waitcnt vmcnt(24)
s_barrier
s_waitcnt lgkmcnt(6)
v_mfma_f32_32x32x16_bf16 v[40:55], a[92:95], v[24:27], v[40:55]
ds_read_b64_tr_b16 v[8:9], v4 offset:32768
ds_read_b64_tr_b16 v[10:11], v4 offset:34816
s_waitcnt lgkmcnt(6)
v_mfma_f32_32x32x16_bf16 v[56:71], a[92:95], v[28:31], v[56:71]
ds_read_b64_tr_b16 v[12:13], v5 offset:32768
ds_read_b64_tr_b16 v[14:15], v5 offset:34816
s_waitcnt lgkmcnt(6)
v_mfma_f32_32x32x16_bf16 v[72:87], a[92:95], v[32:35], v[72:87]
ds_read_b64_tr_b16 v[16:17], v4 offset:40960
ds_read_b64_tr_b16 v[18:19], v4 offset:43008
s_waitcnt lgkmcnt(6)
v_mfma_f32_32x32x16_bf16 v[88:103], a[92:95], v[36:39], v[88:103]
ds_read_b64_tr_b16 v[20:21], v5 offset:40960
ds_read_b64_tr_b16 v[22:23], v5 offset:43008
s_waitcnt lgkmcnt(6)
v_mfma_f32_32x32x16_bf16 v[40:55], a[96:99], v[8:11], v[40:55]
ds_read_b64_tr_b16 v[24:25], v4 offset:33792
ds_read_b64_tr_b16 v[26:27], v4 offset:35840
s_waitcnt lgkmcnt(6)
v_mfma_f32_32x32x16_bf16 v[56:71], a[96:99], v[12:15], v[56:71]
ds_read_b64_tr_b16 v[28:29], v5 offset:33792
ds_read_b64_tr_b16 v[30:31], v5 offset:35840
s_add_u32 m0, s83, 65536
s_add_u32 s76, s73, 2097664
buffer_load_dwordx4 v1, s[64:67], s76 offen lds
s_waitcnt lgkmcnt(6)
v_mfma_f32_32x32x16_bf16 v[72:87], a[96:99], v[16:19], v[72:87]
ds_read_b64_tr_b16 v[32:33], v4 offset:41984
ds_read_b64_tr_b16 v[34:35], v4 offset:44032
s_waitcnt lgkmcnt(6)
v_mfma_f32_32x32x16_bf16 v[88:103], a[96:99], v[20:23], v[88:103]
ds_read_b64_tr_b16 v[36:37], v5 offset:41984
ds_read_b64_tr_b16 v[38:39], v5 offset:44032
s_add_u32 m0, s83, 66560
s_add_u32 s76, s73, 2163200
buffer_load_dwordx4 v1, s[64:67], s76 offen lds
s_waitcnt lgkmcnt(6)
v_mfma_f32_32x32x16_bf16 v[40:55], a[100:103], v[24:27], v[40:55]
ds_read_b64_tr_b16 v[8:9], v4 offset:36864
ds_read_b64_tr_b16 v[10:11], v4 offset:38912
s_waitcnt lgkmcnt(6)
v_mfma_f32_32x32x16_bf16 v[56:71], a[100:103], v[28:31], v[56:71]
ds_read_b64_tr_b16 v[12:13], v5 offset:36864
ds_read_b64_tr_b16 v[14:15], v5 offset:38912
s_add_u32 m0, s83, 73728
s_add_u32 s76, s73, 2097792
buffer_load_dwordx4 v1, s[64:67], s76 offen lds
s_waitcnt lgkmcnt(6)
v_mfma_f32_32x32x16_bf16 v[72:87], a[100:103], v[32:35], v[72:87]
ds_read_b64_tr_b16 v[16:17], v4 offset:45056
ds_read_b64_tr_b16 v[18:19], v4 offset:47104
s_waitcnt lgkmcnt(6)
v_mfma_f32_32x32x16_bf16 v[88:103], a[100:103], v[36:39], v[88:103]
ds_read_b64_tr_b16 v[20:21], v5 offset:45056
ds_read_b64_tr_b16 v[22:23], v5 offset:47104
s_add_u32 m0, s83, 74752
s_add_u32 s76, s73, 2163328
buffer_load_dwordx4 v1, s[64:67], s76 offen lds
s_waitcnt lgkmcnt(6)
v_mfma_f32_32x32x16_bf16 v[40:55], a[104:107], v[8:11], v[40:55]
ds_read_b64_tr_b16 v[24:25], v4 offset:37888
ds_read_b64_tr_b16 v[26:27], v4 offset:39936
s_waitcnt lgkmcnt(6)
v_mfma_f32_32x32x16_bf16 v[56:71], a[104:107], v[12:15], v[56:71]
ds_read_b64_tr_b16 v[28:29], v5 offset:37888
ds_read_b64_tr_b16 v[30:31], v5 offset:39936
s_waitcnt lgkmcnt(6)
v_mfma_f32_32x32x16_bf16 v[72:87], a[104:107], v[16:19], v[72:87]
ds_read_b64_tr_b16 v[32:33], v4 offset:46080
ds_read_b64_tr_b16 v[34:35], v4 offset:48128
s_waitcnt lgkmcnt(6)
v_mfma_f32_32x32x16_bf16 v[88:103], a[104:107], v[20:23], v[88:103]
ds_read_b64_tr_b16 v[36:37], v5 offset:46080
ds_read_b64_tr_b16 v[38:39], v5 offset:48128
s_waitcnt vmcnt(24)
s_barrier
s_waitcnt lgkmcnt(6)
v_mfma_f32_32x32x16_bf16 v[40:55], a[108:111], v[24:27], v[40:55]
ds_read_b64_tr_b16 v[8:9], v4 offset:49152
ds_read_b64_tr_b16 v[10:11], v4 offset:51200
s_waitcnt lgkmcnt(6)
v_mfma_f32_32x32x16_bf16 v[56:71], a[108:111], v[28:31], v[56:71]
ds_read_b64_tr_b16 v[12:13], v5 offset:49152
ds_read_b64_tr_b16 v[14:15], v5 offset:51200
s_waitcnt lgkmcnt(6)
v_mfma_f32_32x32x16_bf16 v[72:87], a[108:111], v[32:35], v[72:87]
ds_read_b64_tr_b16 v[16:17], v4 offset:57344
ds_read_b64_tr_b16 v[18:19], v4 offset:59392
s_waitcnt lgkmcnt(6)
v_mfma_f32_32x32x16_bf16 v[88:103], a[108:111], v[36:39], v[88:103]
ds_read_b64_tr_b16 v[20:21], v5 offset:57344
ds_read_b64_tr_b16 v[22:23], v5 offset:59392
s_waitcnt lgkmcnt(6)
v_mfma_f32_32x32x16_bf16 v[40:55], a[112:115], v[8:11], v[40:55]
ds_read_b64_tr_b16 v[24:25], v4 offset:50176
ds_read_b64_tr_b16 v[26:27], v4 offset:52224
s_waitcnt lgkmcnt(6)
v_mfma_f32_32x32x16_bf16 v[56:71], a[112:115], v[12:15], v[56:71]
ds_read_b64_tr_b16 v[28:29], v5 offset:50176
ds_read_b64_tr_b16 v[30:31], v5 offset:52224
s_add_u32 m0, s83, 81920
s_add_u32 s76, s73, 2621952
buffer_load_dwordx4 v1, s[64:67], s76 offen lds
s_waitcnt lgkmcnt(6)
v_mfma_f32_32x32x16_bf16 v[72:87], a[112:115], v[16:19], v[72:87]
ds_read_b64_tr_b16 v[32:33], v4 offset:58368
ds_read_b64_tr_b16 v[34:35], v4 offset:60416
s_waitcnt lgkmcnt(6)
v_mfma_f32_32x32x16_bf16 v[88:103], a[112:115], v[20:23], v[88:103]
ds_read_b64_tr_b16 v[36:37], v5 offset:58368
ds_read_b64_tr_b16 v[38:39], v5 offset:60416
s_add_u32 m0, s83, 82944
s_add_u32 s76, s73, 2687488
buffer_load_dwordx4 v1, s[64:67], s76 offen lds
s_waitcnt lgkmcnt(6)
v_mfma_f32_32x32x16_bf16 v[40:55], a[116:119], v[24:27], v[40:55]
ds_read_b64_tr_b16 v[8:9], v4 offset:53248
ds_read_b64_tr_b16 v[10:11], v4 offset:55296
s_waitcnt lgkmcnt(6)
v_mfma_f32_32x32x16_bf16 v[56:71], a[116:119], v[28:31], v[56:71]
ds_read_b64_tr_b16 v[12:13], v5 offset:53248
ds_read_b64_tr_b16 v[14:15], v5 offset:55296
s_add_u32 m0, s83, 90112
s_add_u32 s76, s73, 2622080
buffer_load_dwordx4 v1, s[64:67], s76 offen lds
s_waitcnt lgkmcnt(6)
v_mfma_f32_32x32x16_bf16 v[72:87], a[116:119], v[32:35], v[72:87]
ds_read_b64_tr_b16 v[16:17], v4 offset:61440
ds_read_b64_tr_b16 v[18:19], v4 offset:63488
s_waitcnt lgkmcnt(6)
v_mfma_f32_32x32x16_bf16 v[88:103], a[116:119], v[36:39], v[88:103]
ds_read_b64_tr_b16 v[20:21], v5 offset:61440
ds_read_b64_tr_b16 v[22:23], v5 offset:63488
s_add_u32 m0, s83, 91136
s_add_u32 s76, s73, 2687616
buffer_load_dwordx4 v1, s[64:67], s76 offen lds
s_waitcnt lgkmcnt(6)
v_mfma_f32_32x32x16_bf16 v[40:55], a[120:123], v[8:11], v[40:55]
ds_read_b64_tr_b16 v[24:25], v4 offset:54272
ds_read_b64_tr_b16 v[26:27], v4 offset:56320
s_waitcnt lgkmcnt(6)
v_mfma_f32_32x32x16_bf16 v[56:71], a[120:123], v[12:15], v[56:71]
ds_read_b64_tr_b16 v[28:29], v5 offset:54272
ds_read_b64_tr_b16 v[30:31], v5 offset:56320
s_waitcnt lgkmcnt(6)
v_mfma_f32_32x32x16_bf16 v[72:87], a[120:123], v[16:19], v[72:87]
ds_read_b64_tr_b16 v[32:33], v4 offset:62464
ds_read_b64_tr_b16 v[34:35], v4 offset:64512
s_waitcnt lgkmcnt(6)
v_mfma_f32_32x32x16_bf16 v[88:103], a[120:123], v[20:23], v[88:103]
ds_read_b64_tr_b16 v[36:37], v5 offset:62464
ds_read_b64_tr_b16 v[38:39], v5 offset:64512
s_waitcnt vmcnt(24)
s_barrier
s_waitcnt lgkmcnt(6)
v_mfma_f32_32x32x16_bf16 v[40:55], a[124:127], v[24:27], v[40:55]
ds_read_b64_tr_b16 v[8:9], v6 offset:0
ds_read_b64_tr_b16 v[10:11], v6 offset:2048
s_waitcnt lgkmcnt(6)
v_mfma_f32_32x32x16_bf16 v[56:71], a[124:127], v[28:31], v[56:71]
ds_read_b64_tr_b16 v[12:13], v7 offset:0
ds_read_b64_tr_b16 v[14:15], v7 offset:2048
s_waitcnt lgkmcnt(6)
v_mfma_f32_32x32x16_bf16 v[72:87], a[124:127], v[32:35], v[72:87]
ds_read_b64_tr_b16 v[16:17], v6 offset:8192
ds_read_b64_tr_b16 v[18:19], v6 offset:10240
s_waitcnt lgkmcnt(6)
v_mfma_f32_32x32x16_bf16 v[88:103], a[124:127], v[36:39], v[88:103]
ds_read_b64_tr_b16 v[20:21], v7 offset:8192
ds_read_b64_tr_b16 v[22:23], v7 offset:10240
s_waitcnt lgkmcnt(6)
v_mfma_f32_32x32x16_bf16 v[40:55], a[128:131], v[8:11], v[40:55]
ds_read_b64_tr_b16 v[24:25], v6 offset:1024
ds_read_b64_tr_b16 v[26:27], v6 offset:3072
s_waitcnt lgkmcnt(6)
v_mfma_f32_32x32x16_bf16 v[56:71], a[128:131], v[12:15], v[56:71]
ds_read_b64_tr_b16 v[28:29], v7 offset:1024
ds_read_b64_tr_b16 v[30:31], v7 offset:3072
s_add_u32 m0, s83, 98304
s_add_u32 s76, s73, 3146240
buffer_load_dwordx4 v1, s[64:67], s76 offen lds
s_waitcnt lgkmcnt(6)
v_mfma_f32_32x32x16_bf16 v[72:87], a[128:131], v[16:19], v[72:87]
ds_read_b64_tr_b16 v[32:33], v6 offset:9216
ds_read_b64_tr_b16 v[34:35], v6 offset:11264
s_waitcnt lgkmcnt(6)
v_mfma_f32_32x32x16_bf16 v[88:103], a[128:131], v[20:23], v[88:103]
ds_read_b64_tr_b16 v[36:37], v7 offset:9216
ds_read_b64_tr_b16 v[38:39], v7 offset:11264
s_add_u32 m0, s83, 99328
s_add_u32 s76, s73, 3211776
buffer_load_dwordx4 v1, s[64:67], s76 offen lds
s_waitcnt lgkmcnt(6)
v_mfma_f32_32x32x16_bf16 v[40:55], a[132:135], v[24:27], v[40:55]
ds_read_b64_tr_b16 v[8:9], v6 offset:4096
ds_read_b64_tr_b16 v[10:11], v6 offset:6144
s_waitcnt lgkmcnt(6)
v_mfma_f32_32x32x16_bf16 v[56:71], a[132:135], v[28:31], v[56:71]
ds_read_b64_tr_b16 v[12:13], v7 offset:4096
ds_read_b64_tr_b16 v[14:15], v7 offset:6144
s_add_u32 m0, s83, 106496
s_add_u32 s76, s73, 3146368
buffer_load_dwordx4 v1, s[64:67], s76 offen lds
s_waitcnt lgkmcnt(6)
v_mfma_f32_32x32x16_bf16 v[72:87], a[132:135], v[32:35], v[72:87]
ds_read_b64_tr_b16 v[16:17], v6 offset:12288
ds_read_b64_tr_b16 v[18:19], v6 offset:14336
s_waitcnt lgkmcnt(6)
v_mfma_f32_32x32x16_bf16 v[88:103], a[132:135], v[36:39], v[88:103]
ds_read_b64_tr_b16 v[20:21], v7 offset:12288
ds_read_b64_tr_b16 v[22:23], v7 offset:14336
s_add_u32 m0, s83, 107520
s_add_u32 s76, s73, 3211904
buffer_load_dwordx4 v1, s[64:67], s76 offen lds
s_waitcnt lgkmcnt(6)
v_mfma_f32_32x32x16_bf16 v[40:55], a[136:139], v[8:11], v[40:55]
ds_read_b64_tr_b16 v[24:25], v6 offset:5120
ds_read_b64_tr_b16 v[26:27], v6 offset:7168
s_waitcnt lgkmcnt(6)
v_mfma_f32_32x32x16_bf16 v[56:71], a[136:139], v[12:15], v[56:71]
ds_read_b64_tr_b16 v[28:29], v7 offset:5120
ds_read_b64_tr_b16 v[30:31], v7 offset:7168
s_waitcnt lgkmcnt(6)
v_mfma_f32_32x32x16_bf16 v[72:87], a[136:139], v[16:19], v[72:87]
ds_read_b64_tr_b16 v[32:33], v6 offset:13312
ds_read_b64_tr_b16 v[34:35], v6 offset:15360
s_waitcnt lgkmcnt(6)
v_mfma_f32_32x32x16_bf16 v[88:103], a[136:139], v[20:23], v[88:103]
ds_read_b64_tr_b16 v[36:37], v7 offset:13312
ds_read_b64_tr_b16 v[38:39], v7 offset:15360
s_waitcnt vmcnt(24)
s_barrier
s_waitcnt lgkmcnt(6)
v_mfma_f32_32x32x16_bf16 v[40:55], a[140:143], v[24:27], v[40:55]
ds_read_b64_tr_b16 v[8:9], v2 offset:0
ds_read_b64_tr_b16 v[10:11], v2 offset:2048
s_waitcnt lgkmcnt(6)
v_mfma_f32_32x32x16_bf16 v[56:71], a[140:143], v[28:31], v[56:71]
ds_read_b64_tr_b16 v[12:13], v3 offset:0
ds_read_b64_tr_b16 v[14:15], v3 offset:2048
s_waitcnt lgkmcnt(6)
v_mfma_f32_32x32x16_bf16 v[72:87], a[140:143], v[32:35], v[72:87]
ds_read_b64_tr_b16 v[16:17], v2 offset:8192
ds_read_b64_tr_b16 v[18:19], v2 offset:10240
s_waitcnt lgkmcnt(6)
v_mfma_f32_32x32x16_bf16 v[88:103], a[140:143], v[36:39], v[88:103]
ds_read_b64_tr_b16 v[20:21], v3 offset:8192
ds_read_b64_tr_b16 v[22:23], v3 offset:10240
s_nop 11
s_add_u32 s77, s82, 8192
v_cvt_pk_bf16_f32 v106, v40, v41
v_cvt_pk_bf16_f32 v107, v42, v43
v_cvt_pk_bf16_f32 v108, v48, v49
v_cvt_pk_bf16_f32 v109, v50, v51
buffer_store_dwordx4 v[106:109], v104, s[8:11], s77 offen offset:0 sc1
v_cvt_pk_bf16_f32 v110, v44, v45
v_cvt_pk_bf16_f32 v111, v46, v47
v_cvt_pk_bf16_f32 v112, v52, v53
v_cvt_pk_bf16_f32 v113, v54, v55
buffer_store_dwordx4 v[110:113], v104, s[8:11], s77 offen offset:512 sc1
s_add_u32 s77, s82, 10240
v_cvt_pk_bf16_f32 v114, v56, v57
v_cvt_pk_bf16_f32 v115, v58, v59
v_cvt_pk_bf16_f32 v116, v64, v65
v_cvt_pk_bf16_f32 v117, v66, v67
buffer_store_dwordx4 v[114:117], v104, s[8:11], s77 offen offset:0 sc1
v_cvt_pk_bf16_f32 v118, v60, v61
v_cvt_pk_bf16_f32 v119, v62, v63
v_cvt_pk_bf16_f32 v120, v68, v69
v_cvt_pk_bf16_f32 v121, v70, v71
buffer_store_dwordx4 v[118:121], v104, s[8:11], s77 offen offset:512 sc1
s_add_u32 s77, s82, 12288
v_cvt_pk_bf16_f32 v106, v72, v73
v_cvt_pk_bf16_f32 v107, v74, v75
v_cvt_pk_bf16_f32 v108, v80, v81
v_cvt_pk_bf16_f32 v109, v82, v83
buffer_store_dwordx4 v[106:109], v104, s[8:11], s77 offen offset:0 sc1
v_cvt_pk_bf16_f32 v110, v76, v77
v_cvt_pk_bf16_f32 v111, v78, v79
v_cvt_pk_bf16_f32 v112, v84, v85
v_cvt_pk_bf16_f32 v113, v86, v87
buffer_store_dwordx4 v[110:113], v104, s[8:11], s77 offen offset:512 sc1
s_add_u32 s77, s82, 14336
v_cvt_pk_bf16_f32 v114, v88, v89
v_cvt_pk_bf16_f32 v115, v90, v91
v_cvt_pk_bf16_f32 v116, v96, v97
v_cvt_pk_bf16_f32 v117, v98, v99
buffer_store_dwordx4 v[114:117], v104, s[8:11], s77 offen offset:0 sc1
v_cvt_pk_bf16_f32 v118, v92, v93
v_cvt_pk_bf16_f32 v119, v94, v95
v_cvt_pk_bf16_f32 v120, v100, v101
v_cvt_pk_bf16_f32 v121, v102, v103
buffer_store_dwordx4 v[118:121], v104, s[8:11], s77 offen offset:512 sc1
s_waitcnt lgkmcnt(6)
v_mfma_f32_32x32x16_bf16 v[40:55], a[0:3], v[8:11], 0
ds_read_b64_tr_b16 v[24:25], v2 offset:1024
ds_read_b64_tr_b16 v[26:27], v2 offset:3072
s_waitcnt lgkmcnt(6)
v_mfma_f32_32x32x16_bf16 v[56:71], a[0:3], v[12:15], 0
ds_read_b64_tr_b16 v[28:29], v3 offset:1024
ds_read_b64_tr_b16 v[30:31], v3 offset:3072
s_add_u32 m0, s83, 114688
s_add_u32 s76, s73, 3670528
buffer_load_dwordx4 v1, s[64:67], s76 offen lds
s_waitcnt lgkmcnt(6)
v_mfma_f32_32x32x16_bf16 v[72:87], a[0:3], v[16:19], 0
ds_read_b64_tr_b16 v[32:33], v2 offset:9216
ds_read_b64_tr_b16 v[34:35], v2 offset:11264
s_waitcnt lgkmcnt(6)
v_mfma_f32_32x32x16_bf16 v[88:103], a[0:3], v[20:23], 0
ds_read_b64_tr_b16 v[36:37], v3 offset:9216
ds_read_b64_tr_b16 v[38:39], v3 offset:11264
s_add_u32 m0, s83, 115712
s_add_u32 s76, s73, 3736064
buffer_load_dwordx4 v1, s[64:67], s76 offen lds
s_waitcnt lgkmcnt(6)
v_mfma_f32_32x32x16_bf16 v[40:55], a[4:7], v[24:27], v[40:55]
ds_read_b64_tr_b16 v[8:9], v2 offset:4096
ds_read_b64_tr_b16 v[10:11], v2 offset:6144
s_waitcnt lgkmcnt(6)
v_mfma_f32_32x32x16_bf16 v[56:71], a[4:7], v[28:31], v[56:71]
ds_read_b64_tr_b16 v[12:13], v3 offset:4096
ds_read_b64_tr_b16 v[14:15], v3 offset:6144
s_add_u32 m0, s83, 122880
s_add_u32 s76, s73, 3670656
buffer_load_dwordx4 v1, s[64:67], s76 offen lds
s_waitcnt lgkmcnt(6)
v_mfma_f32_32x32x16_bf16 v[72:87], a[4:7], v[32:35], v[72:87]
ds_read_b64_tr_b16 v[16:17], v2 offset:12288
ds_read_b64_tr_b16 v[18:19], v2 offset:14336
s_waitcnt lgkmcnt(6)
v_mfma_f32_32x32x16_bf16 v[88:103], a[4:7], v[36:39], v[88:103]
ds_read_b64_tr_b16 v[20:21], v3 offset:12288
ds_read_b64_tr_b16 v[22:23], v3 offset:14336
s_add_u32 m0, s83, 123904
s_add_u32 s76, s73, 3736192
buffer_load_dwordx4 v1, s[64:67], s76 offen lds
s_waitcnt lgkmcnt(6)
v_mfma_f32_32x32x16_bf16 v[40:55], a[8:11], v[8:11], v[40:55]
ds_read_b64_tr_b16 v[24:25], v2 offset:5120
ds_read_b64_tr_b16 v[26:27], v2 offset:7168
s_waitcnt lgkmcnt(6)
v_mfma_f32_32x32x16_bf16 v[56:71], a[8:11], v[12:15], v[56:71]
ds_read_b64_tr_b16 v[28:29], v3 offset:5120
ds_read_b64_tr_b16 v[30:31], v3 offset:7168
s_waitcnt lgkmcnt(6)
v_mfma_f32_32x32x16_bf16 v[72:87], a[8:11], v[16:19], v[72:87]
ds_read_b64_tr_b16 v[32:33], v2 offset:13312
ds_read_b64_tr_b16 v[34:35], v2 offset:15360
s_waitcnt lgkmcnt(6)
v_mfma_f32_32x32x16_bf16 v[88:103], a[8:11], v[20:23], v[88:103]
ds_read_b64_tr_b16 v[36:37], v3 offset:13312
ds_read_b64_tr_b16 v[38:39], v3 offset:15360
s_waitcnt vmcnt(32)
s_barrier
s_waitcnt lgkmcnt(6)
v_mfma_f32_32x32x16_bf16 v[40:55], a[12:15], v[24:27], v[40:55]
ds_read_b64_tr_b16 v[8:9], v2 offset:16384
ds_read_b64_tr_b16 v[10:11], v2 offset:18432
s_waitcnt lgkmcnt(6)
v_mfma_f32_32x32x16_bf16 v[56:71], a[12:15], v[28:31], v[56:71]
ds_read_b64_tr_b16 v[12:13], v3 offset:16384
ds_read_b64_tr_b16 v[14:15], v3 offset:18432
s_waitcnt lgkmcnt(6)
v_mfma_f32_32x32x16_bf16 v[72:87], a[12:15], v[32:35], v[72:87]
ds_read_b64_tr_b16 v[16:17], v2 offset:24576
ds_read_b64_tr_b16 v[18:19], v2 offset:26624
s_waitcnt lgkmcnt(6)
v_mfma_f32_32x32x16_bf16 v[88:103], a[12:15], v[36:39], v[88:103]
ds_read_b64_tr_b16 v[20:21], v3 offset:24576
ds_read_b64_tr_b16 v[22:23], v3 offset:26624
s_waitcnt lgkmcnt(6)
v_mfma_f32_32x32x16_bf16 v[40:55], a[16:19], v[8:11], v[40:55]
ds_read_b64_tr_b16 v[24:25], v2 offset:17408
ds_read_b64_tr_b16 v[26:27], v2 offset:19456
s_waitcnt lgkmcnt(6)
v_mfma_f32_32x32x16_bf16 v[56:71], a[16:19], v[12:15], v[56:71]
ds_read_b64_tr_b16 v[28:29], v3 offset:17408
ds_read_b64_tr_b16 v[30:31], v3 offset:19456
s_add_u32 m0, s83, 131072
s_add_u32 s76, s73, 4194816
buffer_load_dwordx4 v1, s[64:67], s76 offen lds
s_waitcnt lgkmcnt(6)
v_mfma_f32_32x32x16_bf16 v[72:87], a[16:19], v[16:19], v[72:87]
ds_read_b64_tr_b16 v[32:33], v2 offset:25600
ds_read_b64_tr_b16 v[34:35], v2 offset:27648
s_waitcnt lgkmcnt(6)
v_mfma_f32_32x32x16_bf16 v[88:103], a[16:19], v[20:23], v[88:103]
ds_read_b64_tr_b16 v[36:37], v3 offset:25600
ds_read_b64_tr_b16 v[38:39], v3 offset:27648
s_add_u32 m0, s83, 132096
s_add_u32 s76, s73, 4260352
buffer_load_dwordx4 v1, s[64:67], s76 offen lds
s_waitcnt lgkmcnt(6)
v_mfma_f32_32x32x16_bf16 v[40:55], a[20:23], v[24:27], v[40:55]
ds_read_b64_tr_b16 v[8:9], v2 offset:20480
ds_read_b64_tr_b16 v[10:11], v2 offset:22528
s_waitcnt lgkmcnt(6)
v_mfma_f32_32x32x16_bf16 v[56:71], a[20:23], v[28:31], v[56:71]
ds_read_b64_tr_b16 v[12:13], v3 offset:20480
ds_read_b64_tr_b16 v[14:15], v3 offset:22528
s_add_u32 m0, s83, 139264
s_add_u32 s76, s73, 4194944
buffer_load_dwordx4 v1, s[64:67], s76 offen lds
s_waitcnt lgkmcnt(6)
v_mfma_f32_32x32x16_bf16 v[72:87], a[20:23], v[32:35], v[72:87]
ds_read_b64_tr_b16 v[16:17], v2 offset:28672
ds_read_b64_tr_b16 v[18:19], v2 offset:30720
s_waitcnt lgkmcnt(6)
v_mfma_f32_32x32x16_bf16 v[88:103], a[20:23], v[36:39], v[88:103]
ds_read_b64_tr_b16 v[20:21], v3 offset:28672
ds_read_b64_tr_b16 v[22:23], v3 offset:30720
s_add_u32 m0, s83, 140288
s_add_u32 s76, s73, 4260480
buffer_load_dwordx4 v1, s[64:67], s76 offen lds
s_waitcnt lgkmcnt(6)
v_mfma_f32_32x32x16_bf16 v[40:55], a[24:27], v[8:11], v[40:55]
ds_read_b64_tr_b16 v[24:25], v2 offset:21504
ds_read_b64_tr_b16 v[26:27], v2 offset:23552
s_waitcnt lgkmcnt(6)
v_mfma_f32_32x32x16_bf16 v[56:71], a[24:27], v[12:15], v[56:71]
ds_read_b64_tr_b16 v[28:29], v3 offset:21504
ds_read_b64_tr_b16 v[30:31], v3 offset:23552
s_waitcnt lgkmcnt(6)
v_mfma_f32_32x32x16_bf16 v[72:87], a[24:27], v[16:19], v[72:87]
ds_read_b64_tr_b16 v[32:33], v2 offset:29696
ds_read_b64_tr_b16 v[34:35], v2 offset:31744
s_waitcnt lgkmcnt(6)
v_mfma_f32_32x32x16_bf16 v[88:103], a[24:27], v[20:23], v[88:103]
ds_read_b64_tr_b16 v[36:37], v3 offset:29696
ds_read_b64_tr_b16 v[38:39], v3 offset:31744
s_waitcnt vmcnt(32)
s_barrier
s_waitcnt lgkmcnt(6)
v_mfma_f32_32x32x16_bf16 v[40:55], a[28:31], v[24:27], v[40:55]
ds_read_b64_tr_b16 v[8:9], v2 offset:32768
ds_read_b64_tr_b16 v[10:11], v2 offset:34816
s_waitcnt lgkmcnt(6)
v_mfma_f32_32x32x16_bf16 v[56:71], a[28:31], v[28:31], v[56:71]
ds_read_b64_tr_b16 v[12:13], v3 offset:32768
ds_read_b64_tr_b16 v[14:15], v3 offset:34816
s_waitcnt lgkmcnt(6)
v_mfma_f32_32x32x16_bf16 v[72:87], a[28:31], v[32:35], v[72:87]
ds_read_b64_tr_b16 v[16:17], v2 offset:40960
ds_read_b64_tr_b16 v[18:19], v2 offset:43008
s_waitcnt lgkmcnt(6)
v_mfma_f32_32x32x16_bf16 v[88:103], a[28:31], v[36:39], v[88:103]
ds_read_b64_tr_b16 v[20:21], v3 offset:40960
ds_read_b64_tr_b16 v[22:23], v3 offset:43008
s_waitcnt lgkmcnt(6)
v_mfma_f32_32x32x16_bf16 v[40:55], a[32:35], v[8:11], v[40:55]
ds_read_b64_tr_b16 v[24:25], v2 offset:33792
ds_read_b64_tr_b16 v[26:27], v2 offset:35840
s_waitcnt lgkmcnt(6)
v_mfma_f32_32x32x16_bf16 v[56:71], a[32:35], v[12:15], v[56:71]
ds_read_b64_tr_b16 v[28:29], v3 offset:33792
ds_read_b64_tr_b16 v[30:31], v3 offset:35840
s_add_u32 m0, s83, 0
s_add_u32 s76, s73, 768
buffer_load_dwordx4 v1, s[64:67], s76 offen lds
s_waitcnt lgkmcnt(6)
v_mfma_f32_32x32x16_bf16 v[72:87], a[32:35], v[16:19], v[72:87]
ds_read_b64_tr_b16 v[32:33], v2 offset:41984
ds_read_b64_tr_b16 v[34:35], v2 offset:44032
s_waitcnt lgkmcnt(6)
v_mfma_f32_32x32x16_bf16 v[88:103], a[32:35], v[20:23], v[88:103]
ds_read_b64_tr_b16 v[36:37], v3 offset:41984
ds_read_b64_tr_b16 v[38:39], v3 offset:44032
s_add_u32 m0, s83, 1024
s_add_u32 s76, s73, 66304
buffer_load_dwordx4 v1, s[64:67], s76 offen lds
s_waitcnt lgkmcnt(6)
v_mfma_f32_32x32x16_bf16 v[40:55], a[36:39], v[24:27], v[40:55]
ds_read_b64_tr_b16 v[8:9], v2 offset:36864
ds_read_b64_tr_b16 v[10:11], v2 offset:38912
s_waitcnt lgkmcnt(6)
v_mfma_f32_32x32x16_bf16 v[56:71], a[36:39], v[28:31], v[56:71]
ds_read_b64_tr_b16 v[12:13], v3 offset:36864
ds_read_b64_tr_b16 v[14:15], v3 offset:38912
s_add_u32 m0, s83, 8192
s_add_u32 s76, s73, 896
buffer_load_dwordx4 v1, s[64:67], s76 offen lds
s_waitcnt lgkmcnt(6)
v_mfma_f32_32x32x16_bf16 v[72:87], a[36:39], v[32:35], v[72:87]
ds_read_b64_tr_b16 v[16:17], v2 offset:45056
ds_read_b64_tr_b16 v[18:19], v2 offset:47104
s_waitcnt lgkmcnt(6)
v_mfma_f32_32x32x16_bf16 v[88:103], a[36:39], v[36:39], v[88:103]
ds_read_b64_tr_b16 v[20:21], v3 offset:45056
ds_read_b64_tr_b16 v[22:23], v3 offset:47104
s_add_u32 m0, s83, 9216
s_add_u32 s76, s73, 66432
buffer_load_dwordx4 v1, s[64:67], s76 offen lds
s_waitcnt lgkmcnt(6)
v_mfma_f32_32x32x16_bf16 v[40:55], a[40:43], v[8:11], v[40:55]
ds_read_b64_tr_b16 v[24:25], v2 offset:37888
ds_read_b64_tr_b16 v[26:27], v2 offset:39936
s_waitcnt lgkmcnt(6)
v_mfma_f32_32x32x16_bf16 v[56:71], a[40:43], v[12:15], v[56:71]
ds_read_b64_tr_b16 v[28:29], v3 offset:37888
ds_read_b64_tr_b16 v[30:31], v3 offset:39936
s_waitcnt lgkmcnt(6)
v_mfma_f32_32x32x16_bf16 v[72:87], a[40:43], v[16:19], v[72:87]
ds_read_b64_tr_b16 v[32:33], v2 offset:46080
ds_read_b64_tr_b16 v[34:35], v2 offset:48128
s_waitcnt lgkmcnt(6)
v_mfma_f32_32x32x16_bf16 v[88:103], a[40:43], v[20:23], v[88:103]
ds_read_b64_tr_b16 v[36:37], v3 offset:46080
ds_read_b64_tr_b16 v[38:39], v3 offset:48128
s_waitcnt vmcnt(32)
s_barrier
s_waitcnt lgkmcnt(6)
v_mfma_f32_32x32x16_bf16 v[40:55], a[44:47], v[24:27], v[40:55]
ds_read_b64_tr_b16 v[8:9], v2 offset:49152
ds_read_b64_tr_b16 v[10:11], v2 offset:51200
s_waitcnt lgkmcnt(6)
v_mfma_f32_32x32x16_bf16 v[56:71], a[44:47], v[28:31], v[56:71]
ds_read_b64_tr_b16 v[12:13], v3 offset:49152
ds_read_b64_tr_b16 v[14:15], v3 offset:51200
s_waitcnt lgkmcnt(6)
v_mfma_f32_32x32x16_bf16 v[72:87], a[44:47], v[32:35], v[72:87]
ds_read_b64_tr_b16 v[16:17], v2 offset:57344
ds_read_b64_tr_b16 v[18:19], v2 offset:59392
s_waitcnt lgkmcnt(6)
v_mfma_f32_32x32x16_bf16 v[88:103], a[44:47], v[36:39], v[88:103]
ds_read_b64_tr_b16 v[20:21], v3 offset:57344
ds_read_b64_tr_b16 v[22:23], v3 offset:59392
s_waitcnt lgkmcnt(6)
v_mfma_f32_32x32x16_bf16 v[40:55], a[48:51], v[8:11], v[40:55]
ds_read_b64_tr_b16 v[24:25], v2 offset:50176
ds_read_b64_tr_b16 v[26:27], v2 offset:52224
s_waitcnt lgkmcnt(6)
v_mfma_f32_32x32x16_bf16 v[56:71], a[48:51], v[12:15], v[56:71]
ds_read_b64_tr_b16 v[28:29], v3 offset:50176
ds_read_b64_tr_b16 v[30:31], v3 offset:52224
s_add_u32 m0, s83, 16384
s_add_u32 s76, s73, 525056
buffer_load_dwordx4 v1, s[64:67], s76 offen lds
s_waitcnt lgkmcnt(6)
v_mfma_f32_32x32x16_bf16 v[72:87], a[48:51], v[16:19], v[72:87]
ds_read_b64_tr_b16 v[32:33], v2 offset:58368
ds_read_b64_tr_b16 v[34:35], v2 offset:60416
s_waitcnt lgkmcnt(6)
v_mfma_f32_32x32x16_bf16 v[88:103], a[48:51], v[20:23], v[88:103]
ds_read_b64_tr_b16 v[36:37], v3 offset:58368
ds_read_b64_tr_b16 v[38:39], v3 offset:60416
s_add_u32 m0, s83, 17408
s_add_u32 s76, s73, 590592
buffer_load_dwordx4 v1, s[64:67], s76 offen lds
s_waitcnt lgkmcnt(6)
v_mfma_f32_32x32x16_bf16 v[40:55], a[52:55], v[24:27], v[40:55]
ds_read_b64_tr_b16 v[8:9], v2 offset:53248
ds_read_b64_tr_b16 v[10:11], v2 offset:55296
s_waitcnt lgkmcnt(6)
v_mfma_f32_32x32x16_bf16 v[56:71], a[52:55], v[28:31], v[56:71]
ds_read_b64_tr_b16 v[12:13], v3 offset:53248
ds_read_b64_tr_b16 v[14:15], v3 offset:55296
s_add_u32 m0, s83, 24576
s_add_u32 s76, s73, 525184
buffer_load_dwordx4 v1, s[64:67], s76 offen lds
s_waitcnt lgkmcnt(6)
v_mfma_f32_32x32x16_bf16 v[72:87], a[52:55], v[32:35], v[72:87]
ds_read_b64_tr_b16 v[16:17], v2 offset:61440
ds_read_b64_tr_b16 v[18:19], v2 offset:63488
s_waitcnt lgkmcnt(6)
v_mfma_f32_32x32x16_bf16 v[88:103], a[52:55], v[36:39], v[88:103]
ds_read_b64_tr_b16 v[20:21], v3 offset:61440
ds_read_b64_tr_b16 v[22:23], v3 offset:63488
s_add_u32 m0, s83, 25600
s_add_u32 s76, s73, 590720
buffer_load_dwordx4 v1, s[64:67], s76 offen lds
s_waitcnt lgkmcnt(6)
v_mfma_f32_32x32x16_bf16 v[40:55], a[56:59], v[8:11], v[40:55]
ds_read_b64_tr_b16 v[24:25], v2 offset:54272
ds_read_b64_tr_b16 v[26:27], v2 offset:56320
s_waitcnt lgkmcnt(6)
v_mfma_f32_32x32x16_bf16 v[56:71], a[56:59], v[12:15], v[56:71]
ds_read_b64_tr_b16 v[28:29], v3 offset:54272
ds_read_b64_tr_b16 v[30:31], v3 offset:56320
s_waitcnt lgkmcnt(6)
v_mfma_f32_32x32x16_bf16 v[72:87], a[56:59], v[16:19], v[72:87]
ds_read_b64_tr_b16 v[32:33], v2 offset:62464
ds_read_b64_tr_b16 v[34:35], v2 offset:64512
s_waitcnt lgkmcnt(6)
v_mfma_f32_32x32x16_bf16 v[88:103], a[56:59], v[20:23], v[88:103]
ds_read_b64_tr_b16 v[36:37], v3 offset:62464
ds_read_b64_tr_b16 v[38:39], v3 offset:64512
s_waitcnt vmcnt(32)
s_barrier
s_waitcnt lgkmcnt(6)
v_mfma_f32_32x32x16_bf16 v[40:55], a[60:63], v[24:27], v[40:55]
ds_read_b64_tr_b16 v[8:9], v4 offset:0
ds_read_b64_tr_b16 v[10:11], v4 offset:2048
s_waitcnt lgkmcnt(6)
v_mfma_f32_32x32x16_bf16 v[56:71], a[60:63], v[28:31], v[56:71]
ds_read_b64_tr_b16 v[12:13], v5 offset:0
ds_read_b64_tr_b16 v[14:15], v5 offset:2048
s_waitcnt lgkmcnt(6)
v_mfma_f32_32x32x16_bf16 v[72:87], a[60:63], v[32:35], v[72:87]
ds_read_b64_tr_b16 v[16:17], v4 offset:8192
ds_read_b64_tr_b16 v[18:19], v4 offset:10240
s_waitcnt lgkmcnt(6)
v_mfma_f32_32x32x16_bf16 v[88:103], a[60:63], v[36:39], v[88:103]
ds_read_b64_tr_b16 v[20:21], v5 offset:8192
ds_read_b64_tr_b16 v[22:23], v5 offset:10240
s_waitcnt lgkmcnt(6)
v_mfma_f32_32x32x16_bf16 v[40:55], a[64:67], v[8:11], v[40:55]
ds_read_b64_tr_b16 v[24:25], v4 offset:1024
ds_read_b64_tr_b16 v[26:27], v4 offset:3072
s_waitcnt lgkmcnt(6)
v_mfma_f32_32x32x16_bf16 v[56:71], a[64:67], v[12:15], v[56:71]
ds_read_b64_tr_b16 v[28:29], v5 offset:1024
ds_read_b64_tr_b16 v[30:31], v5 offset:3072
s_add_u32 m0, s83, 32768
s_add_u32 s76, s73, 1049344
buffer_load_dwordx4 v1, s[64:67], s76 offen lds
s_waitcnt lgkmcnt(6)
v_mfma_f32_32x32x16_bf16 v[72:87], a[64:67], v[16:19], v[72:87]
ds_read_b64_tr_b16 v[32:33], v4 offset:9216
ds_read_b64_tr_b16 v[34:35], v4 offset:11264
s_waitcnt lgkmcnt(6)
v_mfma_f32_32x32x16_bf16 v[88:103], a[64:67], v[20:23], v[88:103]
ds_read_b64_tr_b16 v[36:37], v5 offset:9216
ds_read_b64_tr_b16 v[38:39], v5 offset:11264
s_add_u32 m0, s83, 33792
s_add_u32 s76, s73, 1114880
buffer_load_dwordx4 v1, s[64:67], s76 offen lds
s_waitcnt lgkmcnt(6)
v_mfma_f32_32x32x16_bf16 v[40:55], a[68:71], v[24:27], v[40:55]
ds_read_b64_tr_b16 v[8:9], v4 offset:4096
ds_read_b64_tr_b16 v[10:11], v4 offset:6144
s_waitcnt lgkmcnt(6)
v_mfma_f32_32x32x16_bf16 v[56:71], a[68:71], v[28:31], v[56:71]
ds_read_b64_tr_b16 v[12:13], v5 offset:4096
ds_read_b64_tr_b16 v[14:15], v5 offset:6144
s_add_u32 m0, s83, 40960
s_add_u32 s76, s73, 1049472
buffer_load_dwordx4 v1, s[64:67], s76 offen lds
s_waitcnt lgkmcnt(6)
v_mfma_f32_32x32x16_bf16 v[72:87], a[68:71], v[32:35], v[72:87]
ds_read_b64_tr_b16 v[16:17], v4 offset:12288
ds_read_b64_tr_b16 v[18:19], v4 offset:14336
s_waitcnt lgkmcnt(6)
v_mfma_f32_32x32x16_bf16 v[88:103], a[68:71], v[36:39], v[88:103]
ds_read_b64_tr_b16 v[20:21], v5 offset:12288
ds_read_b64_tr_b16 v[22:23], v5 offset:14336
s_add_u32 m0, s83, 41984
s_add_u32 s76, s73, 1115008
buffer_load_dwordx4 v1, s[64:67], s76 offen lds
s_waitcnt lgkmcnt(6)
v_mfma_f32_32x32x16_bf16 v[40:55], a[72:75], v[8:11], v[40:55]
ds_read_b64_tr_b16 v[24:25], v4 offset:5120
ds_read_b64_tr_b16 v[26:27], v4 offset:7168
s_waitcnt lgkmcnt(6)
v_mfma_f32_32x32x16_bf16 v[56:71], a[72:75], v[12:15], v[56:71]
ds_read_b64_tr_b16 v[28:29], v5 offset:5120
ds_read_b64_tr_b16 v[30:31], v5 offset:7168
s_waitcnt lgkmcnt(6)
v_mfma_f32_32x32x16_bf16 v[72:87], a[72:75], v[16:19], v[72:87]
ds_read_b64_tr_b16 v[32:33], v4 offset:13312
ds_read_b64_tr_b16 v[34:35], v4 offset:15360
s_waitcnt lgkmcnt(6)
v_mfma_f32_32x32x16_bf16 v[88:103], a[72:75], v[20:23], v[88:103]
ds_read_b64_tr_b16 v[36:37], v5 offset:13312
ds_read_b64_tr_b16 v[38:39], v5 offset:15360
s_waitcnt vmcnt(32)
s_barrier
s_waitcnt lgkmcnt(6)
v_mfma_f32_32x32x16_bf16 v[40:55], a[76:79], v[24:27], v[40:55]
ds_read_b64_tr_b16 v[8:9], v4 offset:16384
ds_read_b64_tr_b16 v[10:11], v4 offset:18432
s_waitcnt lgkmcnt(6)
v_mfma_f32_32x32x16_bf16 v[56:71], a[76:79], v[28:31], v[56:71]
ds_read_b64_tr_b16 v[12:13], v5 offset:16384
ds_read_b64_tr_b16 v[14:15], v5 offset:18432
s_waitcnt lgkmcnt(6)
v_mfma_f32_32x32x16_bf16 v[72:87], a[76:79], v[32:35], v[72:87]
ds_read_b64_tr_b16 v[16:17], v4 offset:24576
ds_read_b64_tr_b16 v[18:19], v4 offset:26624
s_waitcnt lgkmcnt(6)
v_mfma_f32_32x32x16_bf16 v[88:103], a[76:79], v[36:39], v[88:103]
ds_read_b64_tr_b16 v[20:21], v5 offset:24576
ds_read_b64_tr_b16 v[22:23], v5 offset:26624
s_waitcnt lgkmcnt(6)
v_mfma_f32_32x32x16_bf16 v[40:55], a[80:83], v[8:11], v[40:55]
ds_read_b64_tr_b16 v[24:25], v4 offset:17408
ds_read_b64_tr_b16 v[26:27], v4 offset:19456
s_waitcnt lgkmcnt(6)
v_mfma_f32_32x32x16_bf16 v[56:71], a[80:83], v[12:15], v[56:71]
ds_read_b64_tr_b16 v[28:29], v5 offset:17408
ds_read_b64_tr_b16 v[30:31], v5 offset:19456
s_add_u32 m0, s83, 49152
s_add_u32 s76, s73, 1573632
buffer_load_dwordx4 v1, s[64:67], s76 offen lds
s_waitcnt lgkmcnt(6)
v_mfma_f32_32x32x16_bf16 v[72:87], a[80:83], v[16:19], v[72:87]
ds_read_b64_tr_b16 v[32:33], v4 offset:25600
ds_read_b64_tr_b16 v[34:35], v4 offset:27648
s_waitcnt lgkmcnt(6)
v_mfma_f32_32x32x16_bf16 v[88:103], a[80:83], v[20:23], v[88:103]
ds_read_b64_tr_b16 v[36:37], v5 offset:25600
ds_read_b64_tr_b16 v[38:39], v5 offset:27648
s_add_u32 m0, s83, 50176
s_add_u32 s76, s73, 1639168
buffer_load_dwordx4 v1, s[64:67], s76 offen lds
s_waitcnt lgkmcnt(6)
v_mfma_f32_32x32x16_bf16 v[40:55], a[84:87], v[24:27], v[40:55]
ds_read_b64_tr_b16 v[8:9], v4 offset:20480
ds_read_b64_tr_b16 v[10:11], v4 offset:22528
s_waitcnt lgkmcnt(6)
v_mfma_f32_32x32x16_bf16 v[56:71], a[84:87], v[28:31], v[56:71]
ds_read_b64_tr_b16 v[12:13], v5 offset:20480
ds_read_b64_tr_b16 v[14:15], v5 offset:22528
s_add_u32 m0, s83, 57344
s_add_u32 s76, s73, 1573760
buffer_load_dwordx4 v1, s[64:67], s76 offen lds
s_waitcnt lgkmcnt(6)
v_mfma_f32_32x32x16_bf16 v[72:87], a[84:87], v[32:35], v[72:87]
ds_read_b64_tr_b16 v[16:17], v4 offset:28672
ds_read_b64_tr_b16 v[18:19], v4 offset:30720
s_waitcnt lgkmcnt(6)
v_mfma_f32_32x32x16_bf16 v[88:103], a[84:87], v[36:39], v[88:103]
ds_read_b64_tr_b16 v[20:21], v5 offset:28672
ds_read_b64_tr_b16 v[22:23], v5 offset:30720
s_add_u32 m0, s83, 58368
s_add_u32 s76, s73, 1639296
buffer_load_dwordx4 v1, s[64:67], s76 offen lds
s_waitcnt lgkmcnt(6)
v_mfma_f32_32x32x16_bf16 v[40:55], a[88:91], v[8:11], v[40:55]
ds_read_b64_tr_b16 v[24:25], v4 offset:21504
ds_read_b64_tr_b16 v[26:27], v4 offset:23552
s_waitcnt lgkmcnt(6)
v_mfma_f32_32x32x16_bf16 v[56:71], a[88:91], v[12:15], v[56:71]
ds_read_b64_tr_b16 v[28:29], v5 offset:21504
ds_read_b64_tr_b16 v[30:31], v5 offset:23552
s_waitcnt lgkmcnt(6)
v_mfma_f32_32x32x16_bf16 v[72:87], a[88:91], v[16:19], v[72:87]
ds_read_b64_tr_b16 v[32:33], v4 offset:29696
ds_read_b64_tr_b16 v[34:35], v4 offset:31744
s_waitcnt lgkmcnt(6)
v_mfma_f32_32x32x16_bf16 v[88:103], a[88:91], v[20:23], v[88:103]
ds_read_b64_tr_b16 v[36:37], v5 offset:29696
ds_read_b64_tr_b16 v[38:39], v5 offset:31744
s_waitcnt vmcnt(32)
s_barrier
s_waitcnt lgkmcnt(6)
v_mfma_f32_32x32x16_bf16 v[40:55], a[92:95], v[24:27], v[40:55]
ds_read_b64_tr_b16 v[8:9], v4 offset:32768
ds_read_b64_tr_b16 v[10:11], v4 offset:34816
s_waitcnt lgkmcnt(6)
v_mfma_f32_32x32x16_bf16 v[56:71], a[92:95], v[28:31], v[56:71]
ds_read_b64_tr_b16 v[12:13], v5 offset:32768
ds_read_b64_tr_b16 v[14:15], v5 offset:34816
s_waitcnt lgkmcnt(6)
v_mfma_f32_32x32x16_bf16 v[72:87], a[92:95], v[32:35], v[72:87]
ds_read_b64_tr_b16 v[16:17], v4 offset:40960
ds_read_b64_tr_b16 v[18:19], v4 offset:43008
s_waitcnt lgkmcnt(6)
v_mfma_f32_32x32x16_bf16 v[88:103], a[92:95], v[36:39], v[88:103]
ds_read_b64_tr_b16 v[20:21], v5 offset:40960
ds_read_b64_tr_b16 v[22:23], v5 offset:43008
s_waitcnt lgkmcnt(6)
v_mfma_f32_32x32x16_bf16 v[40:55], a[96:99], v[8:11], v[40:55]
ds_read_b64_tr_b16 v[24:25], v4 offset:33792
ds_read_b64_tr_b16 v[26:27], v4 offset:35840
s_waitcnt lgkmcnt(6)
v_mfma_f32_32x32x16_bf16 v[56:71], a[96:99], v[12:15], v[56:71]
ds_read_b64_tr_b16 v[28:29], v5 offset:33792
ds_read_b64_tr_b16 v[30:31], v5 offset:35840
s_add_u32 m0, s83, 65536
s_add_u32 s76, s73, 2097920
buffer_load_dwordx4 v1, s[64:67], s76 offen lds
s_waitcnt lgkmcnt(6)
v_mfma_f32_32x32x16_bf16 v[72:87], a[96:99], v[16:19], v[72:87]
ds_read_b64_tr_b16 v[32:33], v4 offset:41984
ds_read_b64_tr_b16 v[34:35], v4 offset:44032
s_waitcnt lgkmcnt(6)
v_mfma_f32_32x32x16_bf16 v[88:103], a[96:99], v[20:23], v[88:103]
ds_read_b64_tr_b16 v[36:37], v5 offset:41984
ds_read_b64_tr_b16 v[38:39], v5 offset:44032
s_add_u32 m0, s83, 66560
s_add_u32 s76, s73, 2163456
buffer_load_dwordx4 v1, s[64:67], s76 offen lds
s_waitcnt lgkmcnt(6)
v_mfma_f32_32x32x16_bf16 v[40:55], a[100:103], v[24:27], v[40:55]
ds_read_b64_tr_b16 v[8:9], v4 offset:36864
ds_read_b64_tr_b16 v[10:11], v4 offset:38912
s_waitcnt lgkmcnt(6)
v_mfma_f32_32x32x16_bf16 v[56:71], a[100:103], v[28:31], v[56:71]
ds_read_b64_tr_b16 v[12:13], v5 offset:36864
ds_read_b64_tr_b16 v[14:15], v5 offset:38912
s_add_u32 m0, s83, 73728
s_add_u32 s76, s73, 2098048
buffer_load_dwordx4 v1, s[64:67], s76 offen lds
s_waitcnt lgkmcnt(6)
v_mfma_f32_32x32x16_bf16 v[72:87], a[100:103], v[32:35], v[72:87]
ds_read_b64_tr_b16 v[16:17], v4 offset:45056
ds_read_b64_tr_b16 v[18:19], v4 offset:47104
s_waitcnt lgkmcnt(6)
v_mfma_f32_32x32x16_bf16 v[88:103], a[100:103], v[36:39], v[88:103]
ds_read_b64_tr_b16 v[20:21], v5 offset:45056
ds_read_b64_tr_b16 v[22:23], v5 offset:47104
s_add_u32 m0, s83, 74752
s_add_u32 s76, s73, 2163584
buffer_load_dwordx4 v1, s[64:67], s76 offen lds
s_waitcnt lgkmcnt(6)
v_mfma_f32_32x32x16_bf16 v[40:55], a[104:107], v[8:11], v[40:55]
ds_read_b64_tr_b16 v[24:25], v4 offset:37888
ds_read_b64_tr_b16 v[26:27], v4 offset:39936
s_waitcnt lgkmcnt(6)
v_mfma_f32_32x32x16_bf16 v[56:71], a[104:107], v[12:15], v[56:71]
ds_read_b64_tr_b16 v[28:29], v5 offset:37888
ds_read_b64_tr_b16 v[30:31], v5 offset:39936
s_waitcnt lgkmcnt(6)
v_mfma_f32_32x32x16_bf16 v[72:87], a[104:107], v[16:19], v[72:87]
ds_read_b64_tr_b16 v[32:33], v4 offset:46080
ds_read_b64_tr_b16 v[34:35], v4 offset:48128
s_waitcnt lgkmcnt(6)
v_mfma_f32_32x32x16_bf16 v[88:103], a[104:107], v[20:23], v[88:103]
ds_read_b64_tr_b16 v[36:37], v5 offset:46080
ds_read_b64_tr_b16 v[38:39], v5 offset:48128
s_waitcnt vmcnt(24)
s_barrier
s_waitcnt lgkmcnt(6)
v_mfma_f32_32x32x16_bf16 v[40:55], a[108:111], v[24:27], v[40:55]
ds_read_b64_tr_b16 v[8:9], v4 offset:49152
ds_read_b64_tr_b16 v[10:11], v4 offset:51200
s_waitcnt lgkmcnt(6)
v_mfma_f32_32x32x16_bf16 v[56:71], a[108:111], v[28:31], v[56:71]
ds_read_b64_tr_b16 v[12:13], v5 offset:49152
ds_read_b64_tr_b16 v[14:15], v5 offset:51200
s_waitcnt lgkmcnt(6)
v_mfma_f32_32x32x16_bf16 v[72:87], a[108:111], v[32:35], v[72:87]
ds_read_b64_tr_b16 v[16:17], v4 offset:57344
ds_read_b64_tr_b16 v[18:19], v4 offset:59392
s_waitcnt lgkmcnt(6)
v_mfma_f32_32x32x16_bf16 v[88:103], a[108:111], v[36:39], v[88:103]
ds_read_b64_tr_b16 v[20:21], v5 offset:57344
ds_read_b64_tr_b16 v[22:23], v5 offset:59392
s_waitcnt lgkmcnt(6)
v_mfma_f32_32x32x16_bf16 v[40:55], a[112:115], v[8:11], v[40:55]
ds_read_b64_tr_b16 v[24:25], v4 offset:50176
ds_read_b64_tr_b16 v[26:27], v4 offset:52224
s_waitcnt lgkmcnt(6)
v_mfma_f32_32x32x16_bf16 v[56:71], a[112:115], v[12:15], v[56:71]
ds_read_b64_tr_b16 v[28:29], v5 offset:50176
ds_read_b64_tr_b16 v[30:31], v5 offset:52224
s_add_u32 m0, s83, 81920
s_add_u32 s76, s73, 2622208
buffer_load_dwordx4 v1, s[64:67], s76 offen lds
s_waitcnt lgkmcnt(6)
v_mfma_f32_32x32x16_bf16 v[72:87], a[112:115], v[16:19], v[72:87]
ds_read_b64_tr_b16 v[32:33], v4 offset:58368
ds_read_b64_tr_b16 v[34:35], v4 offset:60416
s_waitcnt lgkmcnt(6)
v_mfma_f32_32x32x16_bf16 v[88:103], a[112:115], v[20:23], v[88:103]
ds_read_b64_tr_b16 v[36:37], v5 offset:58368
ds_read_b64_tr_b16 v[38:39], v5 offset:60416
s_add_u32 m0, s83, 82944
s_add_u32 s76, s73, 2687744
buffer_load_dwordx4 v1, s[64:67], s76 offen lds
s_waitcnt lgkmcnt(6)
v_mfma_f32_32x32x16_bf16 v[40:55], a[116:119], v[24:27], v[40:55]
ds_read_b64_tr_b16 v[8:9], v4 offset:53248
ds_read_b64_tr_b16 v[10:11], v4 offset:55296
s_waitcnt lgkmcnt(6)
v_mfma_f32_32x32x16_bf16 v[56:71], a[116:119], v[28:31], v[56:71]
ds_read_b64_tr_b16 v[12:13], v5 offset:53248
ds_read_b64_tr_b16 v[14:15], v5 offset:55296
s_add_u32 m0, s83, 90112
s_add_u32 s76, s73, 2622336
buffer_load_dwordx4 v1, s[64:67], s76 offen lds
s_waitcnt lgkmcnt(6)
v_mfma_f32_32x32x16_bf16 v[72:87], a[116:119], v[32:35], v[72:87]
ds_read_b64_tr_b16 v[16:17], v4 offset:61440
ds_read_b64_tr_b16 v[18:19], v4 offset:63488
s_waitcnt lgkmcnt(6)
v_mfma_f32_32x32x16_bf16 v[88:103], a[116:119], v[36:39], v[88:103]
ds_read_b64_tr_b16 v[20:21], v5 offset:61440
ds_read_b64_tr_b16 v[22:23], v5 offset:63488
s_add_u32 m0, s83, 91136
s_add_u32 s76, s73, 2687872
buffer_load_dwordx4 v1, s[64:67], s76 offen lds
s_waitcnt lgkmcnt(6)
v_mfma_f32_32x32x16_bf16 v[40:55], a[120:123], v[8:11], v[40:55]
ds_read_b64_tr_b16 v[24:25], v4 offset:54272
ds_read_b64_tr_b16 v[26:27], v4 offset:56320
s_waitcnt lgkmcnt(6)
v_mfma_f32_32x32x16_bf16 v[56:71], a[120:123], v[12:15], v[56:71]
ds_read_b64_tr_b16 v[28:29], v5 offset:54272
ds_read_b64_tr_b16 v[30:31], v5 offset:56320
s_waitcnt lgkmcnt(6)
v_mfma_f32_32x32x16_bf16 v[72:87], a[120:123], v[16:19], v[72:87]
ds_read_b64_tr_b16 v[32:33], v4 offset:62464
ds_read_b64_tr_b16 v[34:35], v4 offset:64512
s_waitcnt lgkmcnt(6)
v_mfma_f32_32x32x16_bf16 v[88:103], a[120:123], v[20:23], v[88:103]
ds_read_b64_tr_b16 v[36:37], v5 offset:62464
ds_read_b64_tr_b16 v[38:39], v5 offset:64512
s_waitcnt vmcnt(24)
s_barrier
s_waitcnt lgkmcnt(6)
v_mfma_f32_32x32x16_bf16 v[40:55], a[124:127], v[24:27], v[40:55]
ds_read_b64_tr_b16 v[8:9], v6 offset:0
ds_read_b64_tr_b16 v[10:11], v6 offset:2048
s_waitcnt lgkmcnt(6)
v_mfma_f32_32x32x16_bf16 v[56:71], a[124:127], v[28:31], v[56:71]
ds_read_b64_tr_b16 v[12:13], v7 offset:0
ds_read_b64_tr_b16 v[14:15], v7 offset:2048
s_waitcnt lgkmcnt(6)
v_mfma_f32_32x32x16_bf16 v[72:87], a[124:127], v[32:35], v[72:87]
ds_read_b64_tr_b16 v[16:17], v6 offset:8192
ds_read_b64_tr_b16 v[18:19], v6 offset:10240
s_waitcnt lgkmcnt(6)
v_mfma_f32_32x32x16_bf16 v[88:103], a[124:127], v[36:39], v[88:103]
ds_read_b64_tr_b16 v[20:21], v7 offset:8192
ds_read_b64_tr_b16 v[22:23], v7 offset:10240
s_waitcnt lgkmcnt(6)
v_mfma_f32_32x32x16_bf16 v[40:55], a[128:131], v[8:11], v[40:55]
ds_read_b64_tr_b16 v[24:25], v6 offset:1024
ds_read_b64_tr_b16 v[26:27], v6 offset:3072
s_waitcnt lgkmcnt(6)
v_mfma_f32_32x32x16_bf16 v[56:71], a[128:131], v[12:15], v[56:71]
ds_read_b64_tr_b16 v[28:29], v7 offset:1024
ds_read_b64_tr_b16 v[30:31], v7 offset:3072
s_add_u32 m0, s83, 98304
s_add_u32 s76, s73, 3146496
buffer_load_dwordx4 v1, s[64:67], s76 offen lds
s_waitcnt lgkmcnt(6)
v_mfma_f32_32x32x16_bf16 v[72:87], a[128:131], v[16:19], v[72:87]
ds_read_b64_tr_b16 v[32:33], v6 offset:9216
ds_read_b64_tr_b16 v[34:35], v6 offset:11264
s_waitcnt lgkmcnt(6)
v_mfma_f32_32x32x16_bf16 v[88:103], a[128:131], v[20:23], v[88:103]
ds_read_b64_tr_b16 v[36:37], v7 offset:9216
ds_read_b64_tr_b16 v[38:39], v7 offset:11264
s_add_u32 m0, s83, 99328
s_add_u32 s76, s73, 3212032
buffer_load_dwordx4 v1, s[64:67], s76 offen lds
s_waitcnt lgkmcnt(6)
v_mfma_f32_32x32x16_bf16 v[40:55], a[132:135], v[24:27], v[40:55]
ds_read_b64_tr_b16 v[8:9], v6 offset:4096
ds_read_b64_tr_b16 v[10:11], v6 offset:6144
s_waitcnt lgkmcnt(6)
v_mfma_f32_32x32x16_bf16 v[56:71], a[132:135], v[28:31], v[56:71]
ds_read_b64_tr_b16 v[12:13], v7 offset:4096
ds_read_b64_tr_b16 v[14:15], v7 offset:6144
s_add_u32 m0, s83, 106496
s_add_u32 s76, s73, 3146624
buffer_load_dwordx4 v1, s[64:67], s76 offen lds
s_waitcnt lgkmcnt(6)
v_mfma_f32_32x32x16_bf16 v[72:87], a[132:135], v[32:35], v[72:87]
ds_read_b64_tr_b16 v[16:17], v6 offset:12288
ds_read_b64_tr_b16 v[18:19], v6 offset:14336
s_waitcnt lgkmcnt(6)
v_mfma_f32_32x32x16_bf16 v[88:103], a[132:135], v[36:39], v[88:103]
ds_read_b64_tr_b16 v[20:21], v7 offset:12288
ds_read_b64_tr_b16 v[22:23], v7 offset:14336
s_add_u32 m0, s83, 107520
s_add_u32 s76, s73, 3212160
buffer_load_dwordx4 v1, s[64:67], s76 offen lds
s_waitcnt lgkmcnt(6)
v_mfma_f32_32x32x16_bf16 v[40:55], a[136:139], v[8:11], v[40:55]
ds_read_b64_tr_b16 v[24:25], v6 offset:5120
ds_read_b64_tr_b16 v[26:27], v6 offset:7168
s_waitcnt lgkmcnt(6)
v_mfma_f32_32x32x16_bf16 v[56:71], a[136:139], v[12:15], v[56:71]
ds_read_b64_tr_b16 v[28:29], v7 offset:5120
ds_read_b64_tr_b16 v[30:31], v7 offset:7168
s_waitcnt lgkmcnt(6)
v_mfma_f32_32x32x16_bf16 v[72:87], a[136:139], v[16:19], v[72:87]
ds_read_b64_tr_b16 v[32:33], v6 offset:13312
ds_read_b64_tr_b16 v[34:35], v6 offset:15360
s_waitcnt lgkmcnt(6)
v_mfma_f32_32x32x16_bf16 v[88:103], a[136:139], v[20:23], v[88:103]
ds_read_b64_tr_b16 v[36:37], v7 offset:13312
ds_read_b64_tr_b16 v[38:39], v7 offset:15360
s_waitcnt vmcnt(24)
s_barrier
s_waitcnt lgkmcnt(6)
v_mfma_f32_32x32x16_bf16 v[40:55], a[140:143], v[24:27], v[40:55]
ds_read_b64_tr_b16 v[8:9], v2 offset:0
ds_read_b64_tr_b16 v[10:11], v2 offset:2048
s_waitcnt lgkmcnt(6)
v_mfma_f32_32x32x16_bf16 v[56:71], a[140:143], v[28:31], v[56:71]
ds_read_b64_tr_b16 v[12:13], v3 offset:0
ds_read_b64_tr_b16 v[14:15], v3 offset:2048
s_waitcnt lgkmcnt(6)
v_mfma_f32_32x32x16_bf16 v[72:87], a[140:143], v[32:35], v[72:87]
ds_read_b64_tr_b16 v[16:17], v2 offset:8192
ds_read_b64_tr_b16 v[18:19], v2 offset:10240
s_waitcnt lgkmcnt(6)
v_mfma_f32_32x32x16_bf16 v[88:103], a[140:143], v[36:39], v[88:103]
ds_read_b64_tr_b16 v[20:21], v3 offset:8192
ds_read_b64_tr_b16 v[22:23], v3 offset:10240
s_nop 11
s_add_u32 s77, s82, 16384
v_cvt_pk_bf16_f32 v106, v40, v41
v_cvt_pk_bf16_f32 v107, v42, v43
v_cvt_pk_bf16_f32 v108, v48, v49
v_cvt_pk_bf16_f32 v109, v50, v51
buffer_store_dwordx4 v[106:109], v104, s[8:11], s77 offen offset:0 sc1
v_cvt_pk_bf16_f32 v110, v44, v45
v_cvt_pk_bf16_f32 v111, v46, v47
v_cvt_pk_bf16_f32 v112, v52, v53
v_cvt_pk_bf16_f32 v113, v54, v55
buffer_store_dwordx4 v[110:113], v104, s[8:11], s77 offen offset:512 sc1
s_add_u32 s77, s82, 18432
v_cvt_pk_bf16_f32 v114, v56, v57
v_cvt_pk_bf16_f32 v115, v58, v59
v_cvt_pk_bf16_f32 v116, v64, v65
v_cvt_pk_bf16_f32 v117, v66, v67
buffer_store_dwordx4 v[114:117], v104, s[8:11], s77 offen offset:0 sc1
v_cvt_pk_bf16_f32 v118, v60, v61
v_cvt_pk_bf16_f32 v119, v62, v63
v_cvt_pk_bf16_f32 v120, v68, v69
v_cvt_pk_bf16_f32 v121, v70, v71
buffer_store_dwordx4 v[118:121], v104, s[8:11], s77 offen offset:512 sc1
s_add_u32 s77, s82, 20480
v_cvt_pk_bf16_f32 v106, v72, v73
v_cvt_pk_bf16_f32 v107, v74, v75
v_cvt_pk_bf16_f32 v108, v80, v81
v_cvt_pk_bf16_f32 v109, v82, v83
buffer_store_dwordx4 v[106:109], v104, s[8:11], s77 offen offset:0 sc1
v_cvt_pk_bf16_f32 v110, v76, v77
v_cvt_pk_bf16_f32 v111, v78, v79
v_cvt_pk_bf16_f32 v112, v84, v85
v_cvt_pk_bf16_f32 v113, v86, v87
buffer_store_dwordx4 v[110:113], v104, s[8:11], s77 offen offset:512 sc1
s_add_u32 s77, s82, 22528
v_cvt_pk_bf16_f32 v114, v88, v89
v_cvt_pk_bf16_f32 v115, v90, v91
v_cvt_pk_bf16_f32 v116, v96, v97
v_cvt_pk_bf16_f32 v117, v98, v99
buffer_store_dwordx4 v[114:117], v104, s[8:11], s77 offen offset:0 sc1
v_cvt_pk_bf16_f32 v118, v92, v93
v_cvt_pk_bf16_f32 v119, v94, v95
v_cvt_pk_bf16_f32 v120, v100, v101
v_cvt_pk_bf16_f32 v121, v102, v103
buffer_store_dwordx4 v[118:121], v104, s[8:11], s77 offen offset:512 sc1
s_waitcnt lgkmcnt(6)
v_mfma_f32_32x32x16_bf16 v[40:55], a[0:3], v[8:11], 0
ds_read_b64_tr_b16 v[24:25], v2 offset:1024
ds_read_b64_tr_b16 v[26:27], v2 offset:3072
s_waitcnt lgkmcnt(6)
v_mfma_f32_32x32x16_bf16 v[56:71], a[0:3], v[12:15], 0
ds_read_b64_tr_b16 v[28:29], v3 offset:1024
ds_read_b64_tr_b16 v[30:31], v3 offset:3072
s_add_u32 m0, s83, 114688
s_add_u32 s76, s73, 3670784
buffer_load_dwordx4 v1, s[64:67], s76 offen lds
s_waitcnt lgkmcnt(6)
v_mfma_f32_32x32x16_bf16 v[72:87], a[0:3], v[16:19], 0
ds_read_b64_tr_b16 v[32:33], v2 offset:9216
ds_read_b64_tr_b16 v[34:35], v2 offset:11264
s_waitcnt lgkmcnt(6)
v_mfma_f32_32x32x16_bf16 v[88:103], a[0:3], v[20:23], 0
ds_read_b64_tr_b16 v[36:37], v3 offset:9216
ds_read_b64_tr_b16 v[38:39], v3 offset:11264
s_add_u32 m0, s83, 115712
s_add_u32 s76, s73, 3736320
buffer_load_dwordx4 v1, s[64:67], s76 offen lds
s_waitcnt lgkmcnt(6)
v_mfma_f32_32x32x16_bf16 v[40:55], a[4:7], v[24:27], v[40:55]
ds_read_b64_tr_b16 v[8:9], v2 offset:4096
ds_read_b64_tr_b16 v[10:11], v2 offset:6144
s_waitcnt lgkmcnt(6)
v_mfma_f32_32x32x16_bf16 v[56:71], a[4:7], v[28:31], v[56:71]
ds_read_b64_tr_b16 v[12:13], v3 offset:4096
ds_read_b64_tr_b16 v[14:15], v3 offset:6144
s_add_u32 m0, s83, 122880
s_add_u32 s76, s73, 3670912
buffer_load_dwordx4 v1, s[64:67], s76 offen lds
s_waitcnt lgkmcnt(6)
v_mfma_f32_32x32x16_bf16 v[72:87], a[4:7], v[32:35], v[72:87]
ds_read_b64_tr_b16 v[16:17], v2 offset:12288
ds_read_b64_tr_b16 v[18:19], v2 offset:14336
s_waitcnt lgkmcnt(6)
v_mfma_f32_32x32x16_bf16 v[88:103], a[4:7], v[36:39], v[88:103]
ds_read_b64_tr_b16 v[20:21], v3 offset:12288
ds_read_b64_tr_b16 v[22:23], v3 offset:14336
s_add_u32 m0, s83, 123904
s_add_u32 s76, s73, 3736448
buffer_load_dwordx4 v1, s[64:67], s76 offen lds
s_waitcnt lgkmcnt(6)
v_mfma_f32_32x32x16_bf16 v[40:55], a[8:11], v[8:11], v[40:55]
ds_read_b64_tr_b16 v[24:25], v2 offset:5120
ds_read_b64_tr_b16 v[26:27], v2 offset:7168
s_waitcnt lgkmcnt(6)
v_mfma_f32_32x32x16_bf16 v[56:71], a[8:11], v[12:15], v[56:71]
ds_read_b64_tr_b16 v[28:29], v3 offset:5120
ds_read_b64_tr_b16 v[30:31], v3 offset:7168
s_waitcnt lgkmcnt(6)
v_mfma_f32_32x32x16_bf16 v[72:87], a[8:11], v[16:19], v[72:87]
ds_read_b64_tr_b16 v[32:33], v2 offset:13312
ds_read_b64_tr_b16 v[34:35], v2 offset:15360
s_waitcnt lgkmcnt(6)
v_mfma_f32_32x32x16_bf16 v[88:103], a[8:11], v[20:23], v[88:103]
ds_read_b64_tr_b16 v[36:37], v3 offset:13312
ds_read_b64_tr_b16 v[38:39], v3 offset:15360
s_waitcnt vmcnt(32)
s_barrier
s_waitcnt lgkmcnt(6)
v_mfma_f32_32x32x16_bf16 v[40:55], a[12:15], v[24:27], v[40:55]
ds_read_b64_tr_b16 v[8:9], v2 offset:16384
ds_read_b64_tr_b16 v[10:11], v2 offset:18432
s_waitcnt lgkmcnt(6)
v_mfma_f32_32x32x16_bf16 v[56:71], a[12:15], v[28:31], v[56:71]
ds_read_b64_tr_b16 v[12:13], v3 offset:16384
ds_read_b64_tr_b16 v[14:15], v3 offset:18432
s_waitcnt lgkmcnt(6)
v_mfma_f32_32x32x16_bf16 v[72:87], a[12:15], v[32:35], v[72:87]
ds_read_b64_tr_b16 v[16:17], v2 offset:24576
ds_read_b64_tr_b16 v[18:19], v2 offset:26624
s_waitcnt lgkmcnt(6)
v_mfma_f32_32x32x16_bf16 v[88:103], a[12:15], v[36:39], v[88:103]
ds_read_b64_tr_b16 v[20:21], v3 offset:24576
ds_read_b64_tr_b16 v[22:23], v3 offset:26624
s_waitcnt lgkmcnt(6)
v_mfma_f32_32x32x16_bf16 v[40:55], a[16:19], v[8:11], v[40:55]
ds_read_b64_tr_b16 v[24:25], v2 offset:17408
ds_read_b64_tr_b16 v[26:27], v2 offset:19456
s_waitcnt lgkmcnt(6)
v_mfma_f32_32x32x16_bf16 v[56:71], a[16:19], v[12:15], v[56:71]
ds_read_b64_tr_b16 v[28:29], v3 offset:17408
ds_read_b64_tr_b16 v[30:31], v3 offset:19456
s_add_u32 m0, s83, 131072
s_add_u32 s76, s73, 4195072
buffer_load_dwordx4 v1, s[64:67], s76 offen lds
s_waitcnt lgkmcnt(6)
v_mfma_f32_32x32x16_bf16 v[72:87], a[16:19], v[16:19], v[72:87]
ds_read_b64_tr_b16 v[32:33], v2 offset:25600
ds_read_b64_tr_b16 v[34:35], v2 offset:27648
s_waitcnt lgkmcnt(6)
v_mfma_f32_32x32x16_bf16 v[88:103], a[16:19], v[20:23], v[88:103]
ds_read_b64_tr_b16 v[36:37], v3 offset:25600
ds_read_b64_tr_b16 v[38:39], v3 offset:27648
s_add_u32 m0, s83, 132096
s_add_u32 s76, s73, 4260608
buffer_load_dwordx4 v1, s[64:67], s76 offen lds
s_waitcnt lgkmcnt(6)
v_mfma_f32_32x32x16_bf16 v[40:55], a[20:23], v[24:27], v[40:55]
ds_read_b64_tr_b16 v[8:9], v2 offset:20480
ds_read_b64_tr_b16 v[10:11], v2 offset:22528
s_waitcnt lgkmcnt(6)
v_mfma_f32_32x32x16_bf16 v[56:71], a[20:23], v[28:31], v[56:71]
ds_read_b64_tr_b16 v[12:13], v3 offset:20480
ds_read_b64_tr_b16 v[14:15], v3 offset:22528
s_add_u32 m0, s83, 139264
s_add_u32 s76, s73, 4195200
buffer_load_dwordx4 v1, s[64:67], s76 offen lds
s_waitcnt lgkmcnt(6)
v_mfma_f32_32x32x16_bf16 v[72:87], a[20:23], v[32:35], v[72:87]
ds_read_b64_tr_b16 v[16:17], v2 offset:28672
ds_read_b64_tr_b16 v[18:19], v2 offset:30720
s_waitcnt lgkmcnt(6)
v_mfma_f32_32x32x16_bf16 v[88:103], a[20:23], v[36:39], v[88:103]
ds_read_b64_tr_b16 v[20:21], v3 offset:28672
ds_read_b64_tr_b16 v[22:23], v3 offset:30720
s_add_u32 m0, s83, 140288
s_add_u32 s76, s73, 4260736
buffer_load_dwordx4 v1, s[64:67], s76 offen lds
s_waitcnt lgkmcnt(6)
v_mfma_f32_32x32x16_bf16 v[40:55], a[24:27], v[8:11], v[40:55]
ds_read_b64_tr_b16 v[24:25], v2 offset:21504
ds_read_b64_tr_b16 v[26:27], v2 offset:23552
s_waitcnt lgkmcnt(6)
v_mfma_f32_32x32x16_bf16 v[56:71], a[24:27], v[12:15], v[56:71]
ds_read_b64_tr_b16 v[28:29], v3 offset:21504
ds_read_b64_tr_b16 v[30:31], v3 offset:23552
s_waitcnt lgkmcnt(6)
v_mfma_f32_32x32x16_bf16 v[72:87], a[24:27], v[16:19], v[72:87]
ds_read_b64_tr_b16 v[32:33], v2 offset:29696
ds_read_b64_tr_b16 v[34:35], v2 offset:31744
s_waitcnt lgkmcnt(6)
v_mfma_f32_32x32x16_bf16 v[88:103], a[24:27], v[20:23], v[88:103]
ds_read_b64_tr_b16 v[36:37], v3 offset:29696
ds_read_b64_tr_b16 v[38:39], v3 offset:31744
s_waitcnt vmcnt(32)
s_barrier
s_waitcnt lgkmcnt(6)
v_mfma_f32_32x32x16_bf16 v[40:55], a[28:31], v[24:27], v[40:55]
ds_read_b64_tr_b16 v[8:9], v2 offset:32768
ds_read_b64_tr_b16 v[10:11], v2 offset:34816
s_waitcnt lgkmcnt(6)
v_mfma_f32_32x32x16_bf16 v[56:71], a[28:31], v[28:31], v[56:71]
ds_read_b64_tr_b16 v[12:13], v3 offset:32768
ds_read_b64_tr_b16 v[14:15], v3 offset:34816
s_waitcnt lgkmcnt(6)
v_mfma_f32_32x32x16_bf16 v[72:87], a[28:31], v[32:35], v[72:87]
ds_read_b64_tr_b16 v[16:17], v2 offset:40960
ds_read_b64_tr_b16 v[18:19], v2 offset:43008
s_waitcnt lgkmcnt(6)
v_mfma_f32_32x32x16_bf16 v[88:103], a[28:31], v[36:39], v[88:103]
ds_read_b64_tr_b16 v[20:21], v3 offset:40960
ds_read_b64_tr_b16 v[22:23], v3 offset:43008
s_waitcnt lgkmcnt(6)
v_mfma_f32_32x32x16_bf16 v[40:55], a[32:35], v[8:11], v[40:55]
ds_read_b64_tr_b16 v[24:25], v2 offset:33792
ds_read_b64_tr_b16 v[26:27], v2 offset:35840
s_waitcnt lgkmcnt(6)
v_mfma_f32_32x32x16_bf16 v[56:71], a[32:35], v[12:15], v[56:71]
ds_read_b64_tr_b16 v[28:29], v3 offset:33792
ds_read_b64_tr_b16 v[30:31], v3 offset:35840
s_waitcnt lgkmcnt(6)
v_mfma_f32_32x32x16_bf16 v[72:87], a[32:35], v[16:19], v[72:87]
ds_read_b64_tr_b16 v[32:33], v2 offset:41984
ds_read_b64_tr_b16 v[34:35], v2 offset:44032
s_waitcnt lgkmcnt(6)
v_mfma_f32_32x32x16_bf16 v[88:103], a[32:35], v[20:23], v[88:103]
ds_read_b64_tr_b16 v[36:37], v3 offset:41984
ds_read_b64_tr_b16 v[38:39], v3 offset:44032
s_waitcnt lgkmcnt(6)
v_mfma_f32_32x32x16_bf16 v[40:55], a[36:39], v[24:27], v[40:55]
ds_read_b64_tr_b16 v[8:9], v2 offset:36864
ds_read_b64_tr_b16 v[10:11], v2 offset:38912
s_waitcnt lgkmcnt(6)
v_mfma_f32_32x32x16_bf16 v[56:71], a[36:39], v[28:31], v[56:71]
ds_read_b64_tr_b16 v[12:13], v3 offset:36864
ds_read_b64_tr_b16 v[14:15], v3 offset:38912
s_waitcnt lgkmcnt(6)
v_mfma_f32_32x32x16_bf16 v[72:87], a[36:39], v[32:35], v[72:87]
ds_read_b64_tr_b16 v[16:17], v2 offset:45056
ds_read_b64_tr_b16 v[18:19], v2 offset:47104
s_waitcnt lgkmcnt(6)
v_mfma_f32_32x32x16_bf16 v[88:103], a[36:39], v[36:39], v[88:103]
ds_read_b64_tr_b16 v[20:21], v3 offset:45056
ds_read_b64_tr_b16 v[22:23], v3 offset:47104
s_waitcnt lgkmcnt(6)
v_mfma_f32_32x32x16_bf16 v[40:55], a[40:43], v[8:11], v[40:55]
ds_read_b64_tr_b16 v[24:25], v2 offset:37888
ds_read_b64_tr_b16 v[26:27], v2 offset:39936
s_waitcnt lgkmcnt(6)
v_mfma_f32_32x32x16_bf16 v[56:71], a[40:43], v[12:15], v[56:71]
ds_read_b64_tr_b16 v[28:29], v3 offset:37888
ds_read_b64_tr_b16 v[30:31], v3 offset:39936
s_waitcnt lgkmcnt(6)
v_mfma_f32_32x32x16_bf16 v[72:87], a[40:43], v[16:19], v[72:87]
ds_read_b64_tr_b16 v[32:33], v2 offset:46080
ds_read_b64_tr_b16 v[34:35], v2 offset:48128
s_waitcnt lgkmcnt(6)
v_mfma_f32_32x32x16_bf16 v[88:103], a[40:43], v[20:23], v[88:103]
ds_read_b64_tr_b16 v[36:37], v3 offset:46080
ds_read_b64_tr_b16 v[38:39], v3 offset:48128
s_waitcnt vmcnt(28)
s_barrier
s_waitcnt lgkmcnt(6)
v_mfma_f32_32x32x16_bf16 v[40:55], a[44:47], v[24:27], v[40:55]
ds_read_b64_tr_b16 v[8:9], v2 offset:49152
ds_read_b64_tr_b16 v[10:11], v2 offset:51200
s_waitcnt lgkmcnt(6)
v_mfma_f32_32x32x16_bf16 v[56:71], a[44:47], v[28:31], v[56:71]
ds_read_b64_tr_b16 v[12:13], v3 offset:49152
ds_read_b64_tr_b16 v[14:15], v3 offset:51200
s_waitcnt lgkmcnt(6)
v_mfma_f32_32x32x16_bf16 v[72:87], a[44:47], v[32:35], v[72:87]
ds_read_b64_tr_b16 v[16:17], v2 offset:57344
ds_read_b64_tr_b16 v[18:19], v2 offset:59392
s_waitcnt lgkmcnt(6)
v_mfma_f32_32x32x16_bf16 v[88:103], a[44:47], v[36:39], v[88:103]
ds_read_b64_tr_b16 v[20:21], v3 offset:57344
ds_read_b64_tr_b16 v[22:23], v3 offset:59392
s_waitcnt lgkmcnt(6)
v_mfma_f32_32x32x16_bf16 v[40:55], a[48:51], v[8:11], v[40:55]
ds_read_b64_tr_b16 v[24:25], v2 offset:50176
ds_read_b64_tr_b16 v[26:27], v2 offset:52224
s_waitcnt lgkmcnt(6)
v_mfma_f32_32x32x16_bf16 v[56:71], a[48:51], v[12:15], v[56:71]
ds_read_b64_tr_b16 v[28:29], v3 offset:50176
ds_read_b64_tr_b16 v[30:31], v3 offset:52224
s_waitcnt lgkmcnt(6)
v_mfma_f32_32x32x16_bf16 v[72:87], a[48:51], v[16:19], v[72:87]
ds_read_b64_tr_b16 v[32:33], v2 offset:58368
ds_read_b64_tr_b16 v[34:35], v2 offset:60416
s_waitcnt lgkmcnt(6)
v_mfma_f32_32x32x16_bf16 v[88:103], a[48:51], v[20:23], v[88:103]
ds_read_b64_tr_b16 v[36:37], v3 offset:58368
ds_read_b64_tr_b16 v[38:39], v3 offset:60416
s_waitcnt lgkmcnt(6)
v_mfma_f32_32x32x16_bf16 v[40:55], a[52:55], v[24:27], v[40:55]
ds_read_b64_tr_b16 v[8:9], v2 offset:53248
ds_read_b64_tr_b16 v[10:11], v2 offset:55296
s_waitcnt lgkmcnt(6)
v_mfma_f32_32x32x16_bf16 v[56:71], a[52:55], v[28:31], v[56:71]
ds_read_b64_tr_b16 v[12:13], v3 offset:53248
ds_read_b64_tr_b16 v[14:15], v3 offset:55296
s_waitcnt lgkmcnt(6)
v_mfma_f32_32x32x16_bf16 v[72:87], a[52:55], v[32:35], v[72:87]
ds_read_b64_tr_b16 v[16:17], v2 offset:61440
ds_read_b64_tr_b16 v[18:19], v2 offset:63488
s_waitcnt lgkmcnt(6)
v_mfma_f32_32x32x16_bf16 v[88:103], a[52:55], v[36:39], v[88:103]
ds_read_b64_tr_b16 v[20:21], v3 offset:61440
ds_read_b64_tr_b16 v[22:23], v3 offset:63488
s_waitcnt lgkmcnt(6)
v_mfma_f32_32x32x16_bf16 v[40:55], a[56:59], v[8:11], v[40:55]
ds_read_b64_tr_b16 v[24:25], v2 offset:54272
ds_read_b64_tr_b16 v[26:27], v2 offset:56320
s_waitcnt lgkmcnt(6)
v_mfma_f32_32x32x16_bf16 v[56:71], a[56:59], v[12:15], v[56:71]
ds_read_b64_tr_b16 v[28:29], v3 offset:54272
ds_read_b64_tr_b16 v[30:31], v3 offset:56320
s_waitcnt lgkmcnt(6)
v_mfma_f32_32x32x16_bf16 v[72:87], a[56:59], v[16:19], v[72:87]
ds_read_b64_tr_b16 v[32:33], v2 offset:62464
ds_read_b64_tr_b16 v[34:35], v2 offset:64512
s_waitcnt lgkmcnt(6)
v_mfma_f32_32x32x16_bf16 v[88:103], a[56:59], v[20:23], v[88:103]
ds_read_b64_tr_b16 v[36:37], v3 offset:62464
ds_read_b64_tr_b16 v[38:39], v3 offset:64512
s_waitcnt vmcnt(24)
s_barrier
s_waitcnt lgkmcnt(6)
v_mfma_f32_32x32x16_bf16 v[40:55], a[60:63], v[24:27], v[40:55]
ds_read_b64_tr_b16 v[8:9], v4 offset:0
ds_read_b64_tr_b16 v[10:11], v4 offset:2048
s_waitcnt lgkmcnt(6)
v_mfma_f32_32x32x16_bf16 v[56:71], a[60:63], v[28:31], v[56:71]
ds_read_b64_tr_b16 v[12:13], v5 offset:0
ds_read_b64_tr_b16 v[14:15], v5 offset:2048
s_waitcnt lgkmcnt(6)
v_mfma_f32_32x32x16_bf16 v[72:87], a[60:63], v[32:35], v[72:87]
ds_read_b64_tr_b16 v[16:17], v4 offset:8192
ds_read_b64_tr_b16 v[18:19], v4 offset:10240
s_waitcnt lgkmcnt(6)
v_mfma_f32_32x32x16_bf16 v[88:103], a[60:63], v[36:39], v[88:103]
ds_read_b64_tr_b16 v[20:21], v5 offset:8192
ds_read_b64_tr_b16 v[22:23], v5 offset:10240
s_waitcnt lgkmcnt(6)
v_mfma_f32_32x32x16_bf16 v[40:55], a[64:67], v[8:11], v[40:55]
ds_read_b64_tr_b16 v[24:25], v4 offset:1024
ds_read_b64_tr_b16 v[26:27], v4 offset:3072
s_waitcnt lgkmcnt(6)
v_mfma_f32_32x32x16_bf16 v[56:71], a[64:67], v[12:15], v[56:71]
ds_read_b64_tr_b16 v[28:29], v5 offset:1024
ds_read_b64_tr_b16 v[30:31], v5 offset:3072
s_waitcnt lgkmcnt(6)
v_mfma_f32_32x32x16_bf16 v[72:87], a[64:67], v[16:19], v[72:87]
ds_read_b64_tr_b16 v[32:33], v4 offset:9216
ds_read_b64_tr_b16 v[34:35], v4 offset:11264
s_waitcnt lgkmcnt(6)
v_mfma_f32_32x32x16_bf16 v[88:103], a[64:67], v[20:23], v[88:103]
ds_read_b64_tr_b16 v[36:37], v5 offset:9216
ds_read_b64_tr_b16 v[38:39], v5 offset:11264
s_waitcnt lgkmcnt(6)
v_mfma_f32_32x32x16_bf16 v[40:55], a[68:71], v[24:27], v[40:55]
ds_read_b64_tr_b16 v[8:9], v4 offset:4096
ds_read_b64_tr_b16 v[10:11], v4 offset:6144
s_waitcnt lgkmcnt(6)
v_mfma_f32_32x32x16_bf16 v[56:71], a[68:71], v[28:31], v[56:71]
ds_read_b64_tr_b16 v[12:13], v5 offset:4096
ds_read_b64_tr_b16 v[14:15], v5 offset:6144
s_waitcnt lgkmcnt(6)
v_mfma_f32_32x32x16_bf16 v[72:87], a[68:71], v[32:35], v[72:87]
ds_read_b64_tr_b16 v[16:17], v4 offset:12288
ds_read_b64_tr_b16 v[18:19], v4 offset:14336
s_waitcnt lgkmcnt(6)
v_mfma_f32_32x32x16_bf16 v[88:103], a[68:71], v[36:39], v[88:103]
ds_read_b64_tr_b16 v[20:21], v5 offset:12288
ds_read_b64_tr_b16 v[22:23], v5 offset:14336
s_waitcnt lgkmcnt(6)
v_mfma_f32_32x32x16_bf16 v[40:55], a[72:75], v[8:11], v[40:55]
ds_read_b64_tr_b16 v[24:25], v4 offset:5120
ds_read_b64_tr_b16 v[26:27], v4 offset:7168
s_waitcnt lgkmcnt(6)
v_mfma_f32_32x32x16_bf16 v[56:71], a[72:75], v[12:15], v[56:71]
ds_read_b64_tr_b16 v[28:29], v5 offset:5120
ds_read_b64_tr_b16 v[30:31], v5 offset:7168
s_waitcnt lgkmcnt(6)
v_mfma_f32_32x32x16_bf16 v[72:87], a[72:75], v[16:19], v[72:87]
ds_read_b64_tr_b16 v[32:33], v4 offset:13312
ds_read_b64_tr_b16 v[34:35], v4 offset:15360
s_waitcnt lgkmcnt(6)
v_mfma_f32_32x32x16_bf16 v[88:103], a[72:75], v[20:23], v[88:103]
ds_read_b64_tr_b16 v[36:37], v5 offset:13312
ds_read_b64_tr_b16 v[38:39], v5 offset:15360
s_waitcnt vmcnt(20)
s_barrier
s_waitcnt lgkmcnt(6)
v_mfma_f32_32x32x16_bf16 v[40:55], a[76:79], v[24:27], v[40:55]
ds_read_b64_tr_b16 v[8:9], v4 offset:16384
ds_read_b64_tr_b16 v[10:11], v4 offset:18432
s_waitcnt lgkmcnt(6)
v_mfma_f32_32x32x16_bf16 v[56:71], a[76:79], v[28:31], v[56:71]
ds_read_b64_tr_b16 v[12:13], v5 offset:16384
ds_read_b64_tr_b16 v[14:15], v5 offset:18432
s_waitcnt lgkmcnt(6)
v_mfma_f32_32x32x16_bf16 v[72:87], a[76:79], v[32:35], v[72:87]
ds_read_b64_tr_b16 v[16:17], v4 offset:24576
ds_read_b64_tr_b16 v[18:19], v4 offset:26624
s_waitcnt lgkmcnt(6)
v_mfma_f32_32x32x16_bf16 v[88:103], a[76:79], v[36:39], v[88:103]
ds_read_b64_tr_b16 v[20:21], v5 offset:24576
ds_read_b64_tr_b16 v[22:23], v5 offset:26624
s_waitcnt lgkmcnt(6)
v_mfma_f32_32x32x16_bf16 v[40:55], a[80:83], v[8:11], v[40:55]
ds_read_b64_tr_b16 v[24:25], v4 offset:17408
ds_read_b64_tr_b16 v[26:27], v4 offset:19456
s_waitcnt lgkmcnt(6)
v_mfma_f32_32x32x16_bf16 v[56:71], a[80:83], v[12:15], v[56:71]
ds_read_b64_tr_b16 v[28:29], v5 offset:17408
ds_read_b64_tr_b16 v[30:31], v5 offset:19456
s_waitcnt lgkmcnt(6)
v_mfma_f32_32x32x16_bf16 v[72:87], a[80:83], v[16:19], v[72:87]
ds_read_b64_tr_b16 v[32:33], v4 offset:25600
ds_read_b64_tr_b16 v[34:35], v4 offset:27648
s_waitcnt lgkmcnt(6)
v_mfma_f32_32x32x16_bf16 v[88:103], a[80:83], v[20:23], v[88:103]
ds_read_b64_tr_b16 v[36:37], v5 offset:25600
ds_read_b64_tr_b16 v[38:39], v5 offset:27648
s_waitcnt lgkmcnt(6)
v_mfma_f32_32x32x16_bf16 v[40:55], a[84:87], v[24:27], v[40:55]
ds_read_b64_tr_b16 v[8:9], v4 offset:20480
ds_read_b64_tr_b16 v[10:11], v4 offset:22528
s_waitcnt lgkmcnt(6)
v_mfma_f32_32x32x16_bf16 v[56:71], a[84:87], v[28:31], v[56:71]
ds_read_b64_tr_b16 v[12:13], v5 offset:20480
ds_read_b64_tr_b16 v[14:15], v5 offset:22528
s_waitcnt lgkmcnt(6)
v_mfma_f32_32x32x16_bf16 v[72:87], a[84:87], v[32:35], v[72:87]
ds_read_b64_tr_b16 v[16:17], v4 offset:28672
ds_read_b64_tr_b16 v[18:19], v4 offset:30720
s_waitcnt lgkmcnt(6)
v_mfma_f32_32x32x16_bf16 v[88:103], a[84:87], v[36:39], v[88:103]
ds_read_b64_tr_b16 v[20:21], v5 offset:28672
ds_read_b64_tr_b16 v[22:23], v5 offset:30720
s_waitcnt lgkmcnt(6)
v_mfma_f32_32x32x16_bf16 v[40:55], a[88:91], v[8:11], v[40:55]
ds_read_b64_tr_b16 v[24:25], v4 offset:21504
ds_read_b64_tr_b16 v[26:27], v4 offset:23552
s_waitcnt lgkmcnt(6)
v_mfma_f32_32x32x16_bf16 v[56:71], a[88:91], v[12:15], v[56:71]
ds_read_b64_tr_b16 v[28:29], v5 offset:21504
ds_read_b64_tr_b16 v[30:31], v5 offset:23552
s_waitcnt lgkmcnt(6)
v_mfma_f32_32x32x16_bf16 v[72:87], a[88:91], v[16:19], v[72:87]
ds_read_b64_tr_b16 v[32:33], v4 offset:29696
ds_read_b64_tr_b16 v[34:35], v4 offset:31744
s_waitcnt lgkmcnt(6)
v_mfma_f32_32x32x16_bf16 v[88:103], a[88:91], v[20:23], v[88:103]
ds_read_b64_tr_b16 v[36:37], v5 offset:29696
ds_read_b64_tr_b16 v[38:39], v5 offset:31744
s_waitcnt vmcnt(16)
s_barrier
s_waitcnt lgkmcnt(6)
v_mfma_f32_32x32x16_bf16 v[40:55], a[92:95], v[24:27], v[40:55]
ds_read_b64_tr_b16 v[8:9], v4 offset:32768
ds_read_b64_tr_b16 v[10:11], v4 offset:34816
s_waitcnt lgkmcnt(6)
v_mfma_f32_32x32x16_bf16 v[56:71], a[92:95], v[28:31], v[56:71]
ds_read_b64_tr_b16 v[12:13], v5 offset:32768
ds_read_b64_tr_b16 v[14:15], v5 offset:34816
s_waitcnt lgkmcnt(6)
v_mfma_f32_32x32x16_bf16 v[72:87], a[92:95], v[32:35], v[72:87]
ds_read_b64_tr_b16 v[16:17], v4 offset:40960
ds_read_b64_tr_b16 v[18:19], v4 offset:43008
s_waitcnt lgkmcnt(6)
v_mfma_f32_32x32x16_bf16 v[88:103], a[92:95], v[36:39], v[88:103]
ds_read_b64_tr_b16 v[20:21], v5 offset:40960
ds_read_b64_tr_b16 v[22:23], v5 offset:43008
s_waitcnt lgkmcnt(6)
v_mfma_f32_32x32x16_bf16 v[40:55], a[96:99], v[8:11], v[40:55]
ds_read_b64_tr_b16 v[24:25], v4 offset:33792
ds_read_b64_tr_b16 v[26:27], v4 offset:35840
s_waitcnt lgkmcnt(6)
v_mfma_f32_32x32x16_bf16 v[56:71], a[96:99], v[12:15], v[56:71]
ds_read_b64_tr_b16 v[28:29], v5 offset:33792
ds_read_b64_tr_b16 v[30:31], v5 offset:35840
s_waitcnt lgkmcnt(6)
v_mfma_f32_32x32x16_bf16 v[72:87], a[96:99], v[16:19], v[72:87]
ds_read_b64_tr_b16 v[32:33], v4 offset:41984
ds_read_b64_tr_b16 v[34:35], v4 offset:44032
s_waitcnt lgkmcnt(6)
v_mfma_f32_32x32x16_bf16 v[88:103], a[96:99], v[20:23], v[88:103]
ds_read_b64_tr_b16 v[36:37], v5 offset:41984
ds_read_b64_tr_b16 v[38:39], v5 offset:44032
s_waitcnt lgkmcnt(6)
v_mfma_f32_32x32x16_bf16 v[40:55], a[100:103], v[24:27], v[40:55]
ds_read_b64_tr_b16 v[8:9], v4 offset:36864
ds_read_b64_tr_b16 v[10:11], v4 offset:38912
s_waitcnt lgkmcnt(6)
v_mfma_f32_32x32x16_bf16 v[56:71], a[100:103], v[28:31], v[56:71]
ds_read_b64_tr_b16 v[12:13], v5 offset:36864
ds_read_b64_tr_b16 v[14:15], v5 offset:38912
s_waitcnt lgkmcnt(6)
v_mfma_f32_32x32x16_bf16 v[72:87], a[100:103], v[32:35], v[72:87]
ds_read_b64_tr_b16 v[16:17], v4 offset:45056
ds_read_b64_tr_b16 v[18:19], v4 offset:47104
s_waitcnt lgkmcnt(6)
v_mfma_f32_32x32x16_bf16 v[88:103], a[100:103], v[36:39], v[88:103]
ds_read_b64_tr_b16 v[20:21], v5 offset:45056
ds_read_b64_tr_b16 v[22:23], v5 offset:47104
s_waitcnt lgkmcnt(6)
v_mfma_f32_32x32x16_bf16 v[40:55], a[104:107], v[8:11], v[40:55]
ds_read_b64_tr_b16 v[24:25], v4 offset:37888
ds_read_b64_tr_b16 v[26:27], v4 offset:39936
s_waitcnt lgkmcnt(6)
v_mfma_f32_32x32x16_bf16 v[56:71], a[104:107], v[12:15], v[56:71]
ds_read_b64_tr_b16 v[28:29], v5 offset:37888
ds_read_b64_tr_b16 v[30:31], v5 offset:39936
s_waitcnt lgkmcnt(6)
v_mfma_f32_32x32x16_bf16 v[72:87], a[104:107], v[16:19], v[72:87]
ds_read_b64_tr_b16 v[32:33], v4 offset:46080
ds_read_b64_tr_b16 v[34:35], v4 offset:48128
s_waitcnt lgkmcnt(6)
v_mfma_f32_32x32x16_bf16 v[88:103], a[104:107], v[20:23], v[88:103]
ds_read_b64_tr_b16 v[36:37], v5 offset:46080
ds_read_b64_tr_b16 v[38:39], v5 offset:48128
s_waitcnt vmcnt(4)
s_barrier
s_waitcnt lgkmcnt(6)
v_mfma_f32_32x32x16_bf16 v[40:55], a[108:111], v[24:27], v[40:55]
ds_read_b64_tr_b16 v[8:9], v4 offset:49152
ds_read_b64_tr_b16 v[10:11], v4 offset:51200
s_waitcnt lgkmcnt(6)
v_mfma_f32_32x32x16_bf16 v[56:71], a[108:111], v[28:31], v[56:71]
ds_read_b64_tr_b16 v[12:13], v5 offset:49152
ds_read_b64_tr_b16 v[14:15], v5 offset:51200
s_waitcnt lgkmcnt(6)
v_mfma_f32_32x32x16_bf16 v[72:87], a[108:111], v[32:35], v[72:87]
ds_read_b64_tr_b16 v[16:17], v4 offset:57344
ds_read_b64_tr_b16 v[18:19], v4 offset:59392
s_waitcnt lgkmcnt(6)
v_mfma_f32_32x32x16_bf16 v[88:103], a[108:111], v[36:39], v[88:103]
ds_read_b64_tr_b16 v[20:21], v5 offset:57344
ds_read_b64_tr_b16 v[22:23], v5 offset:59392
s_waitcnt lgkmcnt(6)
v_mfma_f32_32x32x16_bf16 v[40:55], a[112:115], v[8:11], v[40:55]
ds_read_b64_tr_b16 v[24:25], v4 offset:50176
ds_read_b64_tr_b16 v[26:27], v4 offset:52224
s_waitcnt lgkmcnt(6)
v_mfma_f32_32x32x16_bf16 v[56:71], a[112:115], v[12:15], v[56:71]
ds_read_b64_tr_b16 v[28:29], v5 offset:50176
ds_read_b64_tr_b16 v[30:31], v5 offset:52224
s_waitcnt lgkmcnt(6)
v_mfma_f32_32x32x16_bf16 v[72:87], a[112:115], v[16:19], v[72:87]
ds_read_b64_tr_b16 v[32:33], v4 offset:58368
ds_read_b64_tr_b16 v[34:35], v4 offset:60416
s_waitcnt lgkmcnt(6)
v_mfma_f32_32x32x16_bf16 v[88:103], a[112:115], v[20:23], v[88:103]
ds_read_b64_tr_b16 v[36:37], v5 offset:58368
ds_read_b64_tr_b16 v[38:39], v5 offset:60416
s_waitcnt lgkmcnt(6)
v_mfma_f32_32x32x16_bf16 v[40:55], a[116:119], v[24:27], v[40:55]
ds_read_b64_tr_b16 v[8:9], v4 offset:53248
ds_read_b64_tr_b16 v[10:11], v4 offset:55296
s_waitcnt lgkmcnt(6)
v_mfma_f32_32x32x16_bf16 v[56:71], a[116:119], v[28:31], v[56:71]
ds_read_b64_tr_b16 v[12:13], v5 offset:53248
ds_read_b64_tr_b16 v[14:15], v5 offset:55296
s_waitcnt lgkmcnt(6)
v_mfma_f32_32x32x16_bf16 v[72:87], a[116:119], v[32:35], v[72:87]
ds_read_b64_tr_b16 v[16:17], v4 offset:61440
ds_read_b64_tr_b16 v[18:19], v4 offset:63488
s_waitcnt lgkmcnt(6)
v_mfma_f32_32x32x16_bf16 v[88:103], a[116:119], v[36:39], v[88:103]
ds_read_b64_tr_b16 v[20:21], v5 offset:61440
ds_read_b64_tr_b16 v[22:23], v5 offset:63488
s_waitcnt lgkmcnt(6)
v_mfma_f32_32x32x16_bf16 v[40:55], a[120:123], v[8:11], v[40:55]
ds_read_b64_tr_b16 v[24:25], v4 offset:54272
ds_read_b64_tr_b16 v[26:27], v4 offset:56320
s_waitcnt lgkmcnt(6)
v_mfma_f32_32x32x16_bf16 v[56:71], a[120:123], v[12:15], v[56:71]
ds_read_b64_tr_b16 v[28:29], v5 offset:54272
ds_read_b64_tr_b16 v[30:31], v5 offset:56320
s_waitcnt lgkmcnt(6)
v_mfma_f32_32x32x16_bf16 v[72:87], a[120:123], v[16:19], v[72:87]
ds_read_b64_tr_b16 v[32:33], v4 offset:62464
ds_read_b64_tr_b16 v[34:35], v4 offset:64512
s_waitcnt lgkmcnt(6)
v_mfma_f32_32x32x16_bf16 v[88:103], a[120:123], v[20:23], v[88:103]
ds_read_b64_tr_b16 v[36:37], v5 offset:62464
ds_read_b64_tr_b16 v[38:39], v5 offset:64512
s_waitcnt vmcnt(0)
s_barrier
s_waitcnt lgkmcnt(6)
v_mfma_f32_32x32x16_bf16 v[40:55], a[124:127], v[24:27], v[40:55]
ds_read_b64_tr_b16 v[8:9], v6 offset:0
ds_read_b64_tr_b16 v[10:11], v6 offset:2048
s_waitcnt lgkmcnt(6)
v_mfma_f32_32x32x16_bf16 v[56:71], a[124:127], v[28:31], v[56:71]
ds_read_b64_tr_b16 v[12:13], v7 offset:0
ds_read_b64_tr_b16 v[14:15], v7 offset:2048
s_waitcnt lgkmcnt(6)
v_mfma_f32_32x32x16_bf16 v[72:87], a[124:127], v[32:35], v[72:87]
ds_read_b64_tr_b16 v[16:17], v6 offset:8192
ds_read_b64_tr_b16 v[18:19], v6 offset:10240
s_waitcnt lgkmcnt(6)
v_mfma_f32_32x32x16_bf16 v[88:103], a[124:127], v[36:39], v[88:103]
ds_read_b64_tr_b16 v[20:21], v7 offset:8192
ds_read_b64_tr_b16 v[22:23], v7 offset:10240
s_waitcnt lgkmcnt(6)
v_mfma_f32_32x32x16_bf16 v[40:55], a[128:131], v[8:11], v[40:55]
ds_read_b64_tr_b16 v[24:25], v6 offset:1024
ds_read_b64_tr_b16 v[26:27], v6 offset:3072
s_waitcnt lgkmcnt(6)
v_mfma_f32_32x32x16_bf16 v[56:71], a[128:131], v[12:15], v[56:71]
ds_read_b64_tr_b16 v[28:29], v7 offset:1024
ds_read_b64_tr_b16 v[30:31], v7 offset:3072
s_waitcnt lgkmcnt(6)
v_mfma_f32_32x32x16_bf16 v[72:87], a[128:131], v[16:19], v[72:87]
ds_read_b64_tr_b16 v[32:33], v6 offset:9216
ds_read_b64_tr_b16 v[34:35], v6 offset:11264
s_waitcnt lgkmcnt(6)
v_mfma_f32_32x32x16_bf16 v[88:103], a[128:131], v[20:23], v[88:103]
ds_read_b64_tr_b16 v[36:37], v7 offset:9216
ds_read_b64_tr_b16 v[38:39], v7 offset:11264
s_waitcnt lgkmcnt(6)
v_mfma_f32_32x32x16_bf16 v[40:55], a[132:135], v[24:27], v[40:55]
ds_read_b64_tr_b16 v[8:9], v6 offset:4096
ds_read_b64_tr_b16 v[10:11], v6 offset:6144
s_waitcnt lgkmcnt(6)
v_mfma_f32_32x32x16_bf16 v[56:71], a[132:135], v[28:31], v[56:71]
ds_read_b64_tr_b16 v[12:13], v7 offset:4096
ds_read_b64_tr_b16 v[14:15], v7 offset:6144
s_waitcnt lgkmcnt(6)
v_mfma_f32_32x32x16_bf16 v[72:87], a[132:135], v[32:35], v[72:87]
ds_read_b64_tr_b16 v[16:17], v6 offset:12288
ds_read_b64_tr_b16 v[18:19], v6 offset:14336
s_waitcnt lgkmcnt(6)
v_mfma_f32_32x32x16_bf16 v[88:103], a[132:135], v[36:39], v[88:103]
ds_read_b64_tr_b16 v[20:21], v7 offset:12288
ds_read_b64_tr_b16 v[22:23], v7 offset:14336
s_waitcnt lgkmcnt(6)
v_mfma_f32_32x32x16_bf16 v[40:55], a[136:139], v[8:11], v[40:55]
ds_read_b64_tr_b16 v[24:25], v6 offset:5120
ds_read_b64_tr_b16 v[26:27], v6 offset:7168
s_waitcnt lgkmcnt(6)
v_mfma_f32_32x32x16_bf16 v[56:71], a[136:139], v[12:15], v[56:71]
ds_read_b64_tr_b16 v[28:29], v7 offset:5120
ds_read_b64_tr_b16 v[30:31], v7 offset:7168
s_waitcnt lgkmcnt(6)
v_mfma_f32_32x32x16_bf16 v[72:87], a[136:139], v[16:19], v[72:87]
ds_read_b64_tr_b16 v[32:33], v6 offset:13312
ds_read_b64_tr_b16 v[34:35], v6 offset:15360
s_waitcnt lgkmcnt(6)
v_mfma_f32_32x32x16_bf16 v[88:103], a[136:139], v[20:23], v[88:103]
ds_read_b64_tr_b16 v[36:37], v7 offset:13312
ds_read_b64_tr_b16 v[38:39], v7 offset:15360
s_waitcnt lgkmcnt(6)
v_mfma_f32_32x32x16_bf16 v[40:55], a[140:143], v[24:27], v[40:55]
s_waitcnt lgkmcnt(4)
v_mfma_f32_32x32x16_bf16 v[56:71], a[140:143], v[28:31], v[56:71]
s_waitcnt lgkmcnt(2)
v_mfma_f32_32x32x16_bf16 v[72:87], a[140:143], v[32:35], v[72:87]
s_waitcnt lgkmcnt(0)
v_mfma_f32_32x32x16_bf16 v[88:103], a[140:143], v[36:39], v[88:103]
s_nop 11
s_add_u32 s77, s82, 24576
v_cvt_pk_bf16_f32 v106, v40, v41
v_cvt_pk_bf16_f32 v107, v42, v43
v_cvt_pk_bf16_f32 v108, v48, v49
v_cvt_pk_bf16_f32 v109, v50, v51
buffer_store_dwordx4 v[106:109], v104, s[8:11], s77 offen offset:0 sc1
v_cvt_pk_bf16_f32 v110, v44, v45
v_cvt_pk_bf16_f32 v111, v46, v47
v_cvt_pk_bf16_f32 v112, v52, v53
v_cvt_pk_bf16_f32 v113, v54, v55
buffer_store_dwordx4 v[110:113], v104, s[8:11], s77 offen offset:512 sc1
s_add_u32 s77, s82, 26624
v_cvt_pk_bf16_f32 v114, v56, v57
v_cvt_pk_bf16_f32 v115, v58, v59
v_cvt_pk_bf16_f32 v116, v64, v65
v_cvt_pk_bf16_f32 v117, v66, v67
buffer_store_dwordx4 v[114:117], v104, s[8:11], s77 offen offset:0 sc1
v_cvt_pk_bf16_f32 v118, v60, v61
v_cvt_pk_bf16_f32 v119, v62, v63
v_cvt_pk_bf16_f32 v120, v68, v69
v_cvt_pk_bf16_f32 v121, v70, v71
buffer_store_dwordx4 v[118:121], v104, s[8:11], s77 offen offset:512 sc1
s_add_u32 s77, s82, 28672
v_cvt_pk_bf16_f32 v106, v72, v73
v_cvt_pk_bf16_f32 v107, v74, v75
v_cvt_pk_bf16_f32 v108, v80, v81
v_cvt_pk_bf16_f32 v109, v82, v83
buffer_store_dwordx4 v[106:109], v104, s[8:11], s77 offen offset:0 sc1
v_cvt_pk_bf16_f32 v110, v76, v77
v_cvt_pk_bf16_f32 v111, v78, v79
v_cvt_pk_bf16_f32 v112, v84, v85
v_cvt_pk_bf16_f32 v113, v86, v87
buffer_store_dwordx4 v[110:113], v104, s[8:11], s77 offen offset:512 sc1
s_add_u32 s77, s82, 30720
v_cvt_pk_bf16_f32 v114, v88, v89
v_cvt_pk_bf16_f32 v115, v90, v91
v_cvt_pk_bf16_f32 v116, v96, v97
v_cvt_pk_bf16_f32 v117, v98, v99
buffer_store_dwordx4 v[114:117], v104, s[8:11], s77 offen offset:0 sc1
v_cvt_pk_bf16_f32 v118, v92, v93
v_cvt_pk_bf16_f32 v119, v94, v95
v_cvt_pk_bf16_f32 v120, v100, v101
v_cvt_pk_bf16_f32 v121, v102, v103
buffer_store_dwordx4 v[118:121], v104, s[8:11], s77 offen offset:512 sc1
L_a2e_9:
s_branch K_sig
K_st12:
v_lshrrev_b32 v10, 3, v0
v_and_b32 v11, 7, v0
v_bfe_u32 v12, v0, 4, 1
v_lshlrev_b32 v12, 2, v12
v_xor_b32 v11, v11, v12
s_mov_b32 s76, 8192
v_mul_lo_u32 v1, v10, s76
v_lshl_add_u32 v1, v11, 4, v1
v_lshrrev_b32 v10, 5, v0
v_bfe_u32 v11, v0, 2, 2
v_lshl_add_u32 v10, v10, 2, v11
v_lshlrev_b32 v10, 7, v10
v_bfe_u32 v12, v0, 4, 1
v_lshl_add_u32 v10, v12, 5, v10
v_and_b32 v12, 3, v0
v_lshl_add_u32 v10, v12, 3, v10
v_lshrrev_b32 v11, 1, v11
v_lshlrev_b32 v11, 6, v11
v_add_u32 v2, v10, v11
v_xor_b32 v11, 64, v11
v_add_u32 v3, v10, v11
v_add_u32 v4, 0x10000, v2
v_add_u32 v5, 0x10000, v3
v_add_u32 v6, 0x20000, v2
v_add_u32 v7, 0x20000, v3
v_lshlrev_b32 v0, 4, v0
s_cmp_eq_u32 s21, 0
s_cselect_b32 s76, s88, s86
s_cselect_b32 s77, s89, s87
s_cmp_eq_u32 s21, 1
s_cselect_b32 s76, s90, s76
s_cselect_b32 s77, s91, s77
s_mov_b32 s64, s76
s_and_b32 s65, s77, 0xffff
s_mov_b32 s66, 4718592
s_mov_b32 s67, 0x20000
s_mul_i32 s23, s22, 1
s_lshl_b32 s73, s23, 8
s_mul_i32 s76, s13, 131072
s_add_u32 s73, s73, s76
s_lshl_b32 s83, s13, 11
s_lshl_b32 s24, s20, 2
s_add_u32 s24, s24, s13
s_mul_i32 s72, s24, 36864
s_add_u32 s72, s72, 71303168
s_cmp_eq_u32 s21, 0
s_cselect_b32 s82, 0, 33554432
s_cmp_eq_u32 s21, 1
s_cselect_b32 s82, 16777216, s82
s_lshl_b32 s81, s24, 5
s_add_u32 s81, s81, s23
s_lshl_b32 s81, s81, 13
s_add_u32 s82, s82, s81
v_bfe_u32 v104, v0, 8, 1
v_lshlrev_b32 v104, 10, v104
v_lshrrev_b32 v105, 9, v0
v_lshl_add_u32 v104, v105, 8, v104
v_and_b32 v105, 0xf0, v0
v_add_u32 v104, v104, v105
s_cmp_eq_u32 s21, 1
s_cbranch_scc1 L_a2v_10
s_add_u32 m0, s83, 0
s_add_u32 s76, s73, 0
buffer_load_dwordx4 v1, s[64:67], s76 offen lds
s_add_u32 m0, s83, 1024
s_add_u32 s76, s73, 65536
buffer_load_dwordx4 v1, s[64:67], s76 offen lds
s_add_u32 m0, s83, 8192
s_add_u32 s76, s73, 128
buffer_load_dwordx4 v1, s[64:67], s76 offen lds
s_add_u32 m0, s83, 9216
s_add_u32 s76, s73, 65664
buffer_load_dwordx4 v1, s[64:67], s76 offen lds
s_add_u32 s76, s72, 0
buffer_load_dwordx4 a[0:3], v0, s[8:11], s76 offen offset:0 sc1
s_add_u32 s76, s72, 0
buffer_load_dwordx4 a[4:7], v0, s[8:11], s76 offen offset:1024 sc1
s_add_u32 s76, s72, 0
buffer_load_dwordx4 a[8:11], v0, s[8:11], s76 offen offset:2048 sc1
s_add_u32 s76, s72, 0
buffer_load_dwordx4 a[12:15], v0, s[8:11], s76 offen offset:3072 sc1
s_add_u32 m0, s83, 16384
s_add_u32 s76, s73, 524288
buffer_load_dwordx4 v1, s[64:67], s76 offen lds
s_add_u32 m0, s83, 17408
s_add_u32 s76, s73, 589824
buffer_load_dwordx4 v1, s[64:67], s76 offen lds
s_add_u32 m0, s83, 24576
s_add_u32 s76, s73, 524416
buffer_load_dwordx4 v1, s[64:67], s76 offen lds
s_add_u32 m0, s83, 25600
s_add_u32 s76, s73, 589952
buffer_load_dwordx4 v1, s[64:67], s76 offen lds
s_add_u32 s76, s72, 4096
buffer_load_dwordx4 a[16:19], v0, s[8:11], s76 offen offset:0 sc1
s_add_u32 s76, s72, 4096
buffer_load_dwordx4 a[20:23], v0, s[8:11], s76 offen offset:1024 sc1
s_add_u32 s76, s72, 4096
buffer_load_dwordx4 a[24:27], v0, s[8:11], s76 offen offset:2048 sc1
s_add_u32 s76, s72, 4096
buffer_load_dwordx4 a[28:31], v0, s[8:11], s76 offen offset:3072 sc1
s_add_u32 m0, s83, 32768
s_add_u32 s76, s73, 1048576
buffer_load_dwordx4 v1, s[64:67], s76 offen lds
s_add_u32 m0, s83, 33792
s_add_u32 s76, s73, 1114112
buffer_load_dwordx4 v1, s[64:67], s76 offen lds
s_add_u32 m0, s83, 40960
s_add_u32 s76, s73, 1048704
buffer_load_dwordx4 v1, s[64:67], s76 offen lds
s_add_u32 m0, s83, 41984
s_add_u32 s76, s73, 1114240
buffer_load_dwordx4 v1, s[64:67], s76 offen lds
s_add_u32 s76, s72, 8192
buffer_load_dwordx4 a[32:35], v0, s[8:11], s76 offen offset:0 sc1
s_add_u32 s76, s72, 8192
buffer_load_dwordx4 a[36:39], v0, s[8:11], s76 offen offset:1024 sc1
s_add_u32 s76, s72, 8192
buffer_load_dwordx4 a[40:43], v0, s[8:11], s76 offen offset:2048 sc1
s_add_u32 s76, s72, 8192
buffer_load_dwordx4 a[44:47], v0, s[8:11], s76 offen offset:3072 sc1
s_add_u32 m0, s83, 49152
s_add_u32 s76, s73, 1572864
buffer_load_dwordx4 v1, s[64:67], s76 offen lds
s_add_u32 m0, s83, 50176
s_add_u32 s76, s73, 1638400
buffer_load_dwordx4 v1, s[64:67], s76 offen lds
s_add_u32 m0, s83, 57344
s_add_u32 s76, s73, 1572992
buffer_load_dwordx4 v1, s[64:67], s76 offen lds
s_add_u32 m0, s83, 58368
s_add_u32 s76, s73, 1638528
buffer_load_dwordx4 v1, s[64:67], s76 offen lds
s_add_u32 s76, s72, 12288
buffer_load_dwordx4 a[48:51], v0, s[8:11], s76 offen offset:0 sc1
s_add_u32 s76, s72, 12288
buffer_load_dwordx4 a[52:55], v0, s[8:11], s76 offen offset:1024 sc1
s_add_u32 s76, s72, 12288
buffer_load_dwordx4 a[56:59], v0, s[8:11], s76 offen offset:2048 sc1
s_add_u32 s76, s72, 12288
buffer_load_dwordx4 a[60:63], v0, s[8:11], s76 offen offset:3072 sc1
s_waitcnt vmcnt(24)
s_barrier
ds_read_b64_tr_b16 v[8:9], v2 offset:0
ds_read_b64_tr_b16 v[10:11], v2 offset:2048
ds_read_b64_tr_b16 v[12:13], v3 offset:0
ds_read_b64_tr_b16 v[14:15], v3 offset:2048
ds_read_b64_tr_b16 v[16:17], v2 offset:8192
ds_read_b64_tr_b16 v[18:19], v2 offset:10240
ds_read_b64_tr_b16 v[20:21], v3 offset:8192
ds_read_b64_tr_b16 v[22:23], v3 offset:10240
s_waitcnt lgkmcnt(6)
v_mfma_f32_32x32x16_bf16 v[40:55], v[8:11], a[0:3], 0
ds_read_b64_tr_b16 v[24:25], v2 offset:1024
ds_read_b64_tr_b16 v[26:27], v2 offset:3072
s_waitcnt lgkmcnt(6)
v_mfma_f32_32x32x16_bf16 v[56:71], v[12:15], a[0:3], 0
ds_read_b64_tr_b16 v[28:29], v3 offset:1024
ds_read_b64_tr_b16 v[30:31], v3 offset:3072
s_waitcnt lgkmcnt(6)
v_mfma_f32_32x32x16_bf16 v[72:87], v[16:19], a[0:3], 0
ds_read_b64_tr_b16 v[32:33], v2 offset:9216
ds_read_b64_tr_b16 v[34:35], v2 offset:11264
s_waitcnt lgkmcnt(6)
v_mfma_f32_32x32x16_bf16 v[88:103], v[20:23], a[0:3], 0
ds_read_b64_tr_b16 v[36:37], v3 offset:9216
ds_read_b64_tr_b16 v[38:39], v3 offset:11264
s_waitcnt lgkmcnt(6)
v_mfma_f32_32x32x16_bf16 v[40:55], v[24:27], a[4:7], v[40:55]
ds_read_b64_tr_b16 v[8:9], v2 offset:4096
ds_read_b64_tr_b16 v[10:11], v2 offset:6144
s_waitcnt lgkmcnt(6)
v_mfma_f32_32x32x16_bf16 v[56:71], v[28:31], a[4:7], v[56:71]
ds_read_b64_tr_b16 v[12:13], v3 offset:4096
ds_read_b64_tr_b16 v[14:15], v3 offset:6144
s_waitcnt lgkmcnt(6)
v_mfma_f32_32x32x16_bf16 v[72:87], v[32:35], a[4:7], v[72:87]
ds_read_b64_tr_b16 v[16:17], v2 offset:12288
ds_read_b64_tr_b16 v[18:19], v2 offset:14336
s_waitcnt lgkmcnt(6)
v_mfma_f32_32x32x16_bf16 v[88:103], v[36:39], a[4:7], v[88:103]
ds_read_b64_tr_b16 v[20:21], v3 offset:12288
ds_read_b64_tr_b16 v[22:23], v3 offset:14336
s_waitcnt lgkmcnt(6)
v_mfma_f32_32x32x16_bf16 v[40:55], v[8:11], a[8:11], v[40:55]
ds_read_b64_tr_b16 v[24:25], v2 offset:5120
ds_read_b64_tr_b16 v[26:27], v2 offset:7168
s_waitcnt lgkmcnt(6)
v_mfma_f32_32x32x16_bf16 v[56:71], v[12:15], a[8:11], v[56:71]
ds_read_b64_tr_b16 v[28:29], v3 offset:5120
ds_read_b64_tr_b16 v[30:31], v3 offset:7168
s_waitcnt lgkmcnt(6)
v_mfma_f32_32x32x16_bf16 v[72:87], v[16:19], a[8:11], v[72:87]
ds_read_b64_tr_b16 v[32:33], v2 offset:13312
ds_read_b64_tr_b16 v[34:35], v2 offset:15360
s_waitcnt lgkmcnt(6)
v_mfma_f32_32x32x16_bf16 v[88:103], v[20:23], a[8:11], v[88:103]
ds_read_b64_tr_b16 v[36:37], v3 offset:13312
ds_read_b64_tr_b16 v[38:39], v3 offset:15360
s_waitcnt vmcnt(20)
s_waitcnt vmcnt(16)
s_barrier
s_waitcnt lgkmcnt(6)
v_mfma_f32_32x32x16_bf16 v[40:55], v[24:27], a[12:15], v[40:55]
ds_read_b64_tr_b16 v[8:9], v2 offset:16384
ds_read_b64_tr_b16 v[10:11], v2 offset:18432
s_waitcnt lgkmcnt(6)
v_mfma_f32_32x32x16_bf16 v[56:71], v[28:31], a[12:15], v[56:71]
ds_read_b64_tr_b16 v[12:13], v3 offset:16384
ds_read_b64_tr_b16 v[14:15], v3 offset:18432
s_waitcnt lgkmcnt(6)
v_mfma_f32_32x32x16_bf16 v[72:87], v[32:35], a[12:15], v[72:87]
ds_read_b64_tr_b16 v[16:17], v2 offset:24576
ds_read_b64_tr_b16 v[18:19], v2 offset:26624
s_waitcnt lgkmcnt(6)
v_mfma_f32_32x32x16_bf16 v[88:103], v[36:39], a[12:15], v[88:103]
ds_read_b64_tr_b16 v[20:21], v3 offset:24576
ds_read_b64_tr_b16 v[22:23], v3 offset:26624
s_waitcnt lgkmcnt(6)
v_mfma_f32_32x32x16_bf16 v[40:55], v[8:11], a[16:19], v[40:55]
ds_read_b64_tr_b16 v[24:25], v2 offset:17408
ds_read_b64_tr_b16 v[26:27], v2 offset:19456
s_waitcnt lgkmcnt(6)
v_mfma_f32_32x32x16_bf16 v[56:71], v[12:15], a[16:19], v[56:71]
ds_read_b64_tr_b16 v[28:29], v3 offset:17408
ds_read_b64_tr_b16 v[30:31], v3 offset:19456
s_add_u32 s76, s72, 16384
buffer_load_dwordx4 a[64:67], v0, s[8:11], s76 offen offset:0 sc1
s_waitcnt lgkmcnt(6)
v_mfma_f32_32x32x16_bf16 v[72:87], v[16:19], a[16:19], v[72:87]
ds_read_b64_tr_b16 v[32:33], v2 offset:25600
ds_read_b64_tr_b16 v[34:35], v2 offset:27648
s_waitcnt lgkmcnt(6)
v_mfma_f32_32x32x16_bf16 v[88:103], v[20:23], a[16:19], v[88:103]
ds_read_b64_tr_b16 v[36:37], v3 offset:25600
ds_read_b64_tr_b16 v[38:39], v3 offset:27648
s_add_u32 s76, s72, 16384
buffer_load_dwordx4 a[68:71], v0, s[8:11], s76 offen offset:1024 sc1
s_waitcnt lgkmcnt(6)
v_mfma_f32_32x32x16_bf16 v[40:55], v[24:27], a[20:23], v[40:55]
ds_read_b64_tr_b16 v[8:9], v2 offset:20480
ds_read_b64_tr_b16 v[10:11], v2 offset:22528
s_waitcnt lgkmcnt(6)
v_mfma_f32_32x32x16_bf16 v[56:71], v[28:31], a[20:23], v[56:71]
ds_read_b64_tr_b16 v[12:13], v3 offset:20480
ds_read_b64_tr_b16 v[14:15], v3 offset:22528
s_add_u32 s76, s72, 16384
buffer_load_dwordx4 a[72:75], v0, s[8:11], s76 offen offset:2048 sc1
s_waitcnt lgkmcnt(6)
v_mfma_f32_32x32x16_bf16 v[72:87], v[32:35], a[20:23], v[72:87]
ds_read_b64_tr_b16 v[16:17], v2 offset:28672
ds_read_b64_tr_b16 v[18:19], v2 offset:30720
s_waitcnt lgkmcnt(6)
v_mfma_f32_32x32x16_bf16 v[88:103], v[36:39], a[20:23], v[88:103]
ds_read_b64_tr_b16 v[20:21], v3 offset:28672
ds_read_b64_tr_b16 v[22:23], v3 offset:30720
s_add_u32 s76, s72, 16384
buffer_load_dwordx4 a[76:79], v0, s[8:11], s76 offen offset:3072 sc1
s_waitcnt lgkmcnt(6)
v_mfma_f32_32x32x16_bf16 v[40:55], v[8:11], a[24:27], v[40:55]
ds_read_b64_tr_b16 v[24:25], v2 offset:21504
ds_read_b64_tr_b16 v[26:27], v2 offset:23552
s_waitcnt lgkmcnt(6)
v_mfma_f32_32x32x16_bf16 v[56:71], v[12:15], a[24:27], v[56:71]
ds_read_b64_tr_b16 v[28:29], v3 offset:21504
ds_read_b64_tr_b16 v[30:31], v3 offset:23552
s_add_u32 s76, s72, 20480
buffer_load_dwordx4 a[80:83], v0, s[8:11], s76 offen offset:0 sc1
s_waitcnt lgkmcnt(6)
v_mfma_f32_32x32x16_bf16 v[72:87], v[16:19], a[24:27], v[72:87]
ds_read_b64_tr_b16 v[32:33], v2 offset:29696
ds_read_b64_tr_b16 v[34:35], v2 offset:31744
s_waitcnt lgkmcnt(6)
v_mfma_f32_32x32x16_bf16 v[88:103], v[20:23], a[24:27], v[88:103]
ds_read_b64_tr_b16 v[36:37], v3 offset:29696
ds_read_b64_tr_b16 v[38:39], v3 offset:31744
s_add_u32 s76, s72, 20480
buffer_load_dwordx4 a[84:87], v0, s[8:11], s76 offen offset:1024 sc1
s_waitcnt vmcnt(18)
s_waitcnt vmcnt(14)
s_barrier
s_waitcnt lgkmcnt(6)
v_mfma_f32_32x32x16_bf16 v[40:55], v[24:27], a[28:31], v[40:55]
ds_read_b64_tr_b16 v[8:9], v2 offset:32768
ds_read_b64_tr_b16 v[10:11], v2 offset:34816
s_waitcnt lgkmcnt(6)
v_mfma_f32_32x32x16_bf16 v[56:71], v[28:31], a[28:31], v[56:71]
ds_read_b64_tr_b16 v[12:13], v3 offset:32768
ds_read_b64_tr_b16 v[14:15], v3 offset:34816
s_add_u32 s76, s72, 20480
buffer_load_dwordx4 a[88:91], v0, s[8:11], s76 offen offset:2048 sc1
s_waitcnt lgkmcnt(6)
v_mfma_f32_32x32x16_bf16 v[72:87], v[32:35], a[28:31], v[72:87]
ds_read_b64_tr_b16 v[16:17], v2 offset:40960
ds_read_b64_tr_b16 v[18:19], v2 offset:43008
s_waitcnt lgkmcnt(6)
v_mfma_f32_32x32x16_bf16 v[88:103], v[36:39], a[28:31], v[88:103]
ds_read_b64_tr_b16 v[20:21], v3 offset:40960
ds_read_b64_tr_b16 v[22:23], v3 offset:43008
s_add_u32 s76, s72, 20480
buffer_load_dwordx4 a[92:95], v0, s[8:11], s76 offen offset:3072 sc1
s_waitcnt lgkmcnt(6)
v_mfma_f32_32x32x16_bf16 v[40:55], v[8:11], a[32:35], v[40:55]
ds_read_b64_tr_b16 v[24:25], v2 offset:33792
ds_read_b64_tr_b16 v[26:27], v2 offset:35840
s_waitcnt lgkmcnt(6)
v_mfma_f32_32x32x16_bf16 v[56:71], v[12:15], a[32:35], v[56:71]
ds_read_b64_tr_b16 v[28:29], v3 offset:33792
ds_read_b64_tr_b16 v[30:31], v3 offset:35840
s_add_u32 m0, s83, 65536
s_add_u32 s76, s73, 2097152
buffer_load_dwordx4 v1, s[64:67], s76 offen lds
s_waitcnt lgkmcnt(6)
v_mfma_f32_32x32x16_bf16 v[72:87], v[16:19], a[32:35], v[72:87]
ds_read_b64_tr_b16 v[32:33], v2 offset:41984
ds_read_b64_tr_b16 v[34:35], v2 offset:44032
s_waitcnt lgkmcnt(6)
v_mfma_f32_32x32x16_bf16 v[88:103], v[20:23], a[32:35], v[88:103]
ds_read_b64_tr_b16 v[36:37], v3 offset:41984
ds_read_b64_tr_b16 v[38:39], v3 offset:44032
s_add_u32 m0, s83, 66560
s_add_u32 s76, s73, 2162688
buffer_load_dwordx4 v1, s[64:67], s76 offen lds
s_waitcnt lgkmcnt(6)
v_mfma_f32_32x32x16_bf16 v[40:55], v[24:27], a[36:39], v[40:55]
ds_read_b64_tr_b16 v[8:9], v2 offset:36864
ds_read_b64_tr_b16 v[10:11], v2 offset:38912
s_waitcnt lgkmcnt(6)
v_mfma_f32_32x32x16_bf16 v[56:71], v[28:31], a[36:39], v[56:71]
ds_read_b64_tr_b16 v[12:13], v3 offset:36864
ds_read_b64_tr_b16 v[14:15], v3 offset:38912
s_add_u32 m0, s83, 73728
s_add_u32 s76, s73, 2097280
buffer_load_dwordx4 v1, s[64:67], s76 offen lds
s_waitcnt lgkmcnt(6)
v_mfma_f32_32x32x16_bf16 v[72:87], v[32:35], a[36:39], v[72:87]
ds_read_b64_tr_b16 v[16:17], v2 offset:45056
ds_read_b64_tr_b16 v[18:19], v2 offset:47104
s_waitcnt lgkmcnt(6)
v_mfma_f32_32x32x16_bf16 v[88:103], v[36:39], a[36:39], v[88:103]
ds_read_b64_tr_b16 v[20:21], v3 offset:45056
ds_read_b64_tr_b16 v[22:23], v3 offset:47104
s_add_u32 m0, s83, 74752
s_add_u32 s76, s73, 2162816
buffer_load_dwordx4 v1, s[64:67], s76 offen lds
s_waitcnt lgkmcnt(6)
v_mfma_f32_32x32x16_bf16 v[40:55], v[8:11], a[40:43], v[40:55]
ds_read_b64_tr_b16 v[24:25], v2 offset:37888
ds_read_b64_tr_b16 v[26:27], v2 offset:39936
s_waitcnt lgkmcnt(6)
v_mfma_f32_32x32x16_bf16 v[56:71], v[12:15], a[40:43], v[56:71]
ds_read_b64_tr_b16 v[28:29], v3 offset:37888
ds_read_b64_tr_b16 v[30:31], v3 offset:39936
s_add_u32 m0, s83, 81920
s_add_u32 s76, s73, 2621440
buffer_load_dwordx4 v1, s[64:67], s76 offen lds
s_waitcnt lgkmcnt(6)
v_mfma_f32_32x32x16_bf16 v[72:87], v[16:19], a[40:43], v[72:87]
ds_read_b64_tr_b16 v[32:33], v2 offset:46080
ds_read_b64_tr_b16 v[34:35], v2 offset:48128
s_waitcnt lgkmcnt(6)
v_mfma_f32_32x32x16_bf16 v[88:103], v[20:23], a[40:43], v[88:103]
ds_read_b64_tr_b16 v[36:37], v3 offset:46080
ds_read_b64_tr_b16 v[38:39], v3 offset:48128
s_add_u32 m0, s83, 82944
s_add_u32 s76, s73, 2686976
buffer_load_dwordx4 v1, s[64:67], s76 offen lds
s_waitcnt vmcnt(18)
s_waitcnt vmcnt(14)
s_barrier
s_waitcnt lgkmcnt(6)
v_mfma_f32_32x32x16_bf16 v[40:55], v[24:27], a[44:47], v[40:55]
ds_read_b64_tr_b16 v[8:9], v2 offset:49152
ds_read_b64_tr_b16 v[10:11], v2 offset:51200
s_waitcnt lgkmcnt(6)
v_mfma_f32_32x32x16_bf16 v[56:71], v[28:31], a[44:47], v[56:71]
ds_read_b64_tr_b16 v[12:13], v3 offset:49152
ds_read_b64_tr_b16 v[14:15], v3 offset:51200
s_add_u32 m0, s83, 90112
s_add_u32 s76, s73, 2621568
buffer_load_dwordx4 v1, s[64:67], s76 offen lds
s_waitcnt lgkmcnt(6)
v_mfma_f32_32x32x16_bf16 v[72:87], v[32:35], a[44:47], v[72:87]
ds_read_b64_tr_b16 v[16:17], v2 offset:57344
ds_read_b64_tr_b16 v[18:19], v2 offset:59392
s_waitcnt lgkmcnt(6)
v_mfma_f32_32x32x16_bf16 v[88:103], v[36:39], a[44:47], v[88:103]
ds_read_b64_tr_b16 v[20:21], v3 offset:57344
ds_read_b64_tr_b16 v[22:23], v3 offset:59392
s_add_u32 m0, s83, 91136
s_add_u32 s76, s73, 2687104
buffer_load_dwordx4 v1, s[64:67], s76 offen lds
s_waitcnt lgkmcnt(6)
v_mfma_f32_32x32x16_bf16 v[40:55], v[8:11], a[48:51], v[40:55]
ds_read_b64_tr_b16 v[24:25], v2 offset:50176
ds_read_b64_tr_b16 v[26:27], v2 offset:52224
s_waitcnt lgkmcnt(6)
v_mfma_f32_32x32x16_bf16 v[56:71], v[12:15], a[48:51], v[56:71]
ds_read_b64_tr_b16 v[28:29], v3 offset:50176
ds_read_b64_tr_b16 v[30:31], v3 offset:52224
s_add_u32 s76, s72, 24576
buffer_load_dwordx4 a[96:99], v0, s[8:11], s76 offen offset:0 sc1
s_waitcnt lgkmcnt(6)
v_mfma_f32_32x32x16_bf16 v[72:87], v[16:19], a[48:51], v[72:87]
ds_read_b64_tr_b16 v[32:33], v2 offset:58368
ds_read_b64_tr_b16 v[34:35], v2 offset:60416
s_waitcnt lgkmcnt(6)
v_mfma_f32_32x32x16_bf16 v[88:103], v[20:23], a[48:51], v[88:103]
ds_read_b64_tr_b16 v[36:37], v3 offset:58368
ds_read_b64_tr_b16 v[38:39], v3 offset:60416
s_add_u32 s76, s72, 24576
buffer_load_dwordx4 a[100:103], v0, s[8:11], s76 offen offset:1024 sc1
s_waitcnt lgkmcnt(6)
v_mfma_f32_32x32x16_bf16 v[40:55], v[24:27], a[52:55], v[40:55]
ds_read_b64_tr_b16 v[8:9], v2 offset:53248
ds_read_b64_tr_b16 v[10:11], v2 offset:55296
s_waitcnt lgkmcnt(6)
v_mfma_f32_32x32x16_bf16 v[56:71], v[28:31], a[52:55], v[56:71]
ds_read_b64_tr_b16 v[12:13], v3 offset:53248
ds_read_b64_tr_b16 v[14:15], v3 offset:55296
s_add_u32 s76, s72, 24576
buffer_load_dwordx4 a[104:107], v0, s[8:11], s76 offen offset:2048 sc1
s_waitcnt lgkmcnt(6)
v_mfma_f32_32x32x16_bf16 v[72:87], v[32:35], a[52:55], v[72:87]
ds_read_b64_tr_b16 v[16:17], v2 offset:61440
ds_read_b64_tr_b16 v[18:19], v2 offset:63488
s_waitcnt lgkmcnt(6)
v_mfma_f32_32x32x16_bf16 v[88:103], v[36:39], a[52:55], v[88:103]
ds_read_b64_tr_b16 v[20:21], v3 offset:61440
ds_read_b64_tr_b16 v[22:23], v3 offset:63488
s_add_u32 s76, s72, 24576
buffer_load_dwordx4 a[108:111], v0, s[8:11], s76 offen offset:3072 sc1
s_waitcnt lgkmcnt(6)
v_mfma_f32_32x32x16_bf16 v[40:55], v[8:11], a[56:59], v[40:55]
ds_read_b64_tr_b16 v[24:25], v2 offset:54272
ds_read_b64_tr_b16 v[26:27], v2 offset:56320
s_waitcnt lgkmcnt(6)
v_mfma_f32_32x32x16_bf16 v[56:71], v[12:15], a[56:59], v[56:71]
ds_read_b64_tr_b16 v[28:29], v3 offset:54272
ds_read_b64_tr_b16 v[30:31], v3 offset:56320
s_add_u32 s76, s72, 28672
buffer_load_dwordx4 a[112:115], v0, s[8:11], s76 offen offset:0 sc1
s_waitcnt lgkmcnt(6)
v_mfma_f32_32x32x16_bf16 v[72:87], v[16:19], a[56:59], v[72:87]
ds_read_b64_tr_b16 v[32:33], v2 offset:62464
ds_read_b64_tr_b16 v[34:35], v2 offset:64512
s_waitcnt lgkmcnt(6)
v_mfma_f32_32x32x16_bf16 v[88:103], v[20:23], a[56:59], v[88:103]
ds_read_b64_tr_b16 v[36:37], v3 offset:62464
ds_read_b64_tr_b16 v[38:39], v3 offset:64512
s_add_u32 s76, s72, 28672
buffer_load_dwordx4 a[116:119], v0, s[8:11], s76 offen offset:1024 sc1
s_waitcnt vmcnt(10)
s_barrier
s_waitcnt lgkmcnt(6)
v_mfma_f32_32x32x16_bf16 v[40:55], v[24:27], a[60:63], v[40:55]
ds_read_b64_tr_b16 v[8:9], v4 offset:0
ds_read_b64_tr_b16 v[10:11], v4 offset:2048
s_waitcnt lgkmcnt(6)
v_mfma_f32_32x32x16_bf16 v[56:71], v[28:31], a[60:63], v[56:71]
ds_read_b64_tr_b16 v[12:13], v5 offset:0
ds_read_b64_tr_b16 v[14:15], v5 offset:2048
s_add_u32 s76, s72, 28672
buffer_load_dwordx4 a[120:123], v0, s[8:11], s76 offen offset:2048 sc1
s_waitcnt lgkmcnt(6)
v_mfma_f32_32x32x16_bf16 v[72:87], v[32:35], a[60:63], v[72:87]
ds_read_b64_tr_b16 v[16:17], v4 offset:8192
ds_read_b64_tr_b16 v[18:19], v4 offset:10240
s_waitcnt lgkmcnt(6)
v_mfma_f32_32x32x16_bf16 v[88:103], v[36:39], a[60:63], v[88:103]
ds_read_b64_tr_b16 v[20:21], v5 offset:8192
ds_read_b64_tr_b16 v[22:23], v5 offset:10240
s_add_u32 s76, s72, 28672
buffer_load_dwordx4 a[124:127], v0, s[8:11], s76 offen offset:3072 sc1
s_waitcnt lgkmcnt(6)
v_mfma_f32_32x32x16_bf16 v[40:55], v[8:11], a[64:67], v[40:55]
ds_read_b64_tr_b16 v[24:25], v4 offset:1024
ds_read_b64_tr_b16 v[26:27], v4 offset:3072
s_waitcnt lgkmcnt(6)
v_mfma_f32_32x32x16_bf16 v[56:71], v[12:15], a[64:67], v[56:71]
ds_read_b64_tr_b16 v[28:29], v5 offset:1024
ds_read_b64_tr_b16 v[30:31], v5 offset:3072
s_add_u32 m0, s83, 98304
s_add_u32 s76, s73, 3145728
buffer_load_dwordx4 v1, s[64:67], s76 offen lds
s_waitcnt lgkmcnt(6)
v_mfma_f32_32x32x16_bf16 v[72:87], v[16:19], a[64:67], v[72:87]
ds_read_b64_tr_b16 v[32:33], v4 offset:9216
ds_read_b64_tr_b16 v[34:35], v4 offset:11264
s_waitcnt lgkmcnt(6)
v_mfma_f32_32x32x16_bf16 v[88:103], v[20:23], a[64:67], v[88:103]
ds_read_b64_tr_b16 v[36:37], v5 offset:9216
ds_read_b64_tr_b16 v[38:39], v5 offset:11264
s_add_u32 m0, s83, 99328
s_add_u32 s76, s73, 3211264
buffer_load_dwordx4 v1, s[64:67], s76 offen lds
s_waitcnt lgkmcnt(6)
v_mfma_f32_32x32x16_bf16 v[40:55], v[24:27], a[68:71], v[40:55]
ds_read_b64_tr_b16 v[8:9], v4 offset:4096
ds_read_b64_tr_b16 v[10:11], v4 offset:6144
s_waitcnt lgkmcnt(6)
v_mfma_f32_32x32x16_bf16 v[56:71], v[28:31], a[68:71], v[56:71]
ds_read_b64_tr_b16 v[12:13], v5 offset:4096
ds_read_b64_tr_b16 v[14:15], v5 offset:6144
s_add_u32 m0, s83, 106496
s_add_u32 s76, s73, 3145856
buffer_load_dwordx4 v1, s[64:67], s76 offen lds
s_waitcnt lgkmcnt(6)
v_mfma_f32_32x32x16_bf16 v[72:87], v[32:35], a[68:71], v[72:87]
ds_read_b64_tr_b16 v[16:17], v4 offset:12288
ds_read_b64_tr_b16 v[18:19], v4 offset:14336
s_waitcnt lgkmcnt(6)
v_mfma_f32_32x32x16_bf16 v[88:103], v[36:39], a[68:71], v[88:103]
ds_read_b64_tr_b16 v[20:21], v5 offset:12288
ds_read_b64_tr_b16 v[22:23], v5 offset:14336
s_add_u32 m0, s83, 107520
s_add_u32 s76, s73, 3211392
buffer_load_dwordx4 v1, s[64:67], s76 offen lds
s_waitcnt lgkmcnt(6)
v_mfma_f32_32x32x16_bf16 v[40:55], v[8:11], a[72:75], v[40:55]
ds_read_b64_tr_b16 v[24:25], v4 offset:5120
ds_read_b64_tr_b16 v[26:27], v4 offset:7168
s_waitcnt lgkmcnt(6)
v_mfma_f32_32x32x16_bf16 v[56:71], v[12:15], a[72:75], v[56:71]
ds_read_b64_tr_b16 v[28:29], v5 offset:5120
ds_read_b64_tr_b16 v[30:31], v5 offset:7168
s_add_u32 m0, s83, 114688
s_add_u32 s76, s73, 3670016
buffer_load_dwordx4 v1, s[64:67], s76 offen lds
s_waitcnt lgkmcnt(6)
v_mfma_f32_32x32x16_bf16 v[72:87], v[16:19], a[72:75], v[72:87]
ds_read_b64_tr_b16 v[32:33], v4 offset:13312
ds_read_b64_tr_b16 v[34:35], v4 offset:15360
s_waitcnt lgkmcnt(6)
v_mfma_f32_32x32x16_bf16 v[88:103], v[20:23], a[72:75], v[88:103]
ds_read_b64_tr_b16 v[36:37], v5 offset:13312
ds_read_b64_tr_b16 v[38:39], v5 offset:15360
s_add_u32 m0, s83, 115712
s_add_u32 s76, s73, 3735552
buffer_load_dwordx4 v1, s[64:67], s76 offen lds
s_waitcnt vmcnt(14)
s_barrier
s_waitcnt lgkmcnt(6)
v_mfma_f32_32x32x16_bf16 v[40:55], v[24:27], a[76:79], v[40:55]
ds_read_b64_tr_b16 v[8:9], v4 offset:16384
ds_read_b64_tr_b16 v[10:11], v4 offset:18432
s_waitcnt lgkmcnt(6)
v_mfma_f32_32x32x16_bf16 v[56:71], v[28:31], a[76:79], v[56:71]
ds_read_b64_tr_b16 v[12:13], v5 offset:16384
ds_read_b64_tr_b16 v[14:15], v5 offset:18432
s_add_u32 m0, s83, 122880
s_add_u32 s76, s73, 3670144
buffer_load_dwordx4 v1, s[64:67], s76 offen lds
s_waitcnt lgkmcnt(6)
v_mfma_f32_32x32x16_bf16 v[72:87], v[32:35], a[76:79], v[72:87]
ds_read_b64_tr_b16 v[16:17], v4 offset:24576
ds_read_b64_tr_b16 v[18:19], v4 offset:26624
s_waitcnt lgkmcnt(6)
v_mfma_f32_32x32x16_bf16 v[88:103], v[36:39], a[76:79], v[88:103]
ds_read_b64_tr_b16 v[20:21], v5 offset:24576
ds_read_b64_tr_b16 v[22:23], v5 offset:26624
s_add_u32 m0, s83, 123904
s_add_u32 s76, s73, 3735680
buffer_load_dwordx4 v1, s[64:67], s76 offen lds
s_waitcnt lgkmcnt(6)
v_mfma_f32_32x32x16_bf16 v[40:55], v[8:11], a[80:83], v[40:55]
ds_read_b64_tr_b16 v[24:25], v4 offset:17408
ds_read_b64_tr_b16 v[26:27], v4 offset:19456
s_waitcnt lgkmcnt(6)
v_mfma_f32_32x32x16_bf16 v[56:71], v[12:15], a[80:83], v[56:71]
ds_read_b64_tr_b16 v[28:29], v5 offset:17408
ds_read_b64_tr_b16 v[30:31], v5 offset:19456
s_add_u32 s76, s72, 32768
buffer_load_dwordx4 a[128:131], v0, s[8:11], s76 offen offset:0 sc1
s_waitcnt lgkmcnt(6)
v_mfma_f32_32x32x16_bf16 v[72:87], v[16:19], a[80:83], v[72:87]
ds_read_b64_tr_b16 v[32:33], v4 offset:25600
ds_read_b64_tr_b16 v[34:35], v4 offset:27648
s_waitcnt lgkmcnt(6)
v_mfma_f32_32x32x16_bf16 v[88:103], v[20:23], a[80:83], v[88:103]
ds_read_b64_tr_b16 v[36:37], v5 offset:25600
ds_read_b64_tr_b16 v[38:39], v5 offset:27648
s_add_u32 s76, s72, 32768
buffer_load_dwordx4 a[132:135], v0, s[8:11], s76 offen offset:1024 sc1
s_waitcnt lgkmcnt(6)
v_mfma_f32_32x32x16_bf16 v[40:55], v[24:27], a[84:87], v[40:55]
ds_read_b64_tr_b16 v[8:9], v4 offset:20480
ds_read_b64_tr_b16 v[10:11], v4 offset:22528
s_waitcnt lgkmcnt(6)
v_mfma_f32_32x32x16_bf16 v[56:71], v[28:31], a[84:87], v[56:71]
ds_read_b64_tr_b16 v[12:13], v5 offset:20480
ds_read_b64_tr_b16 v[14:15], v5 offset:22528
s_add_u32 s76, s72, 32768
buffer_load_dwordx4 a[136:139], v0, s[8:11], s76 offen offset:2048 sc1
s_waitcnt lgkmcnt(6)
v_mfma_f32_32x32x16_bf16 v[72:87], v[32:35], a[84:87], v[72:87]
ds_read_b64_tr_b16 v[16:17], v4 offset:28672
ds_read_b64_tr_b16 v[18:19], v4 offset:30720
s_waitcnt lgkmcnt(6)
v_mfma_f32_32x32x16_bf16 v[88:103], v[36:39], a[84:87], v[88:103]
ds_read_b64_tr_b16 v[20:21], v5 offset:28672
ds_read_b64_tr_b16 v[22:23], v5 offset:30720
s_add_u32 s76, s72, 32768
buffer_load_dwordx4 a[140:143], v0, s[8:11], s76 offen offset:3072 sc1
s_waitcnt lgkmcnt(6)
v_mfma_f32_32x32x16_bf16 v[40:55], v[8:11], a[88:91], v[40:55]
ds_read_b64_tr_b16 v[24:25], v4 offset:21504
ds_read_b64_tr_b16 v[26:27], v4 offset:23552
s_waitcnt lgkmcnt(6)
v_mfma_f32_32x32x16_bf16 v[56:71], v[12:15], a[88:91], v[56:71]
ds_read_b64_tr_b16 v[28:29], v5 offset:21504
ds_read_b64_tr_b16 v[30:31], v5 offset:23552
s_add_u32 m0, s83, 131072
s_add_u32 s76, s73, 4194304
buffer_load_dwordx4 v1, s[64:67], s76 offen lds
s_waitcnt lgkmcnt(6)
v_mfma_f32_32x32x16_bf16 v[72:87], v[16:19], a[88:91], v[72:87]
ds_read_b64_tr_b16 v[32:33], v4 offset:29696
ds_read_b64_tr_b16 v[34:35], v4 offset:31744
s_waitcnt lgkmcnt(6)
v_mfma_f32_32x32x16_bf16 v[88:103], v[20:23], a[88:91], v[88:103]
ds_read_b64_tr_b16 v[36:37], v5 offset:29696
ds_read_b64_tr_b16 v[38:39], v5 offset:31744
s_add_u32 m0, s83, 132096
s_add_u32 s76, s73, 4259840
buffer_load_dwordx4 v1, s[64:67], s76 offen lds
s_waitcnt vmcnt(10)
s_barrier
s_waitcnt lgkmcnt(6)
v_mfma_f32_32x32x16_bf16 v[40:55], v[24:27], a[92:95], v[40:55]
ds_read_b64_tr_b16 v[8:9], v4 offset:32768
ds_read_b64_tr_b16 v[10:11], v4 offset:34816
s_waitcnt lgkmcnt(6)
v_mfma_f32_32x32x16_bf16 v[56:71], v[28:31], a[92:95], v[56:71]
ds_read_b64_tr_b16 v[12:13], v5 offset:32768
ds_read_b64_tr_b16 v[14:15], v5 offset:34816
s_add_u32 m0, s83, 139264
s_add_u32 s76, s73, 4194432
buffer_load_dwordx4 v1, s[64:67], s76 offen lds
s_waitcnt lgkmcnt(6)
v_mfma_f32_32x32x16_bf16 v[72:87], v[32:35], a[92:95], v[72:87]
ds_read_b64_tr_b16 v[16:17], v4 offset:40960
ds_read_b64_tr_b16 v[18:19], v4 offset:43008
s_waitcnt lgkmcnt(6)
v_mfma_f32_32x32x16_bf16 v[88:103], v[36:39], a[92:95], v[88:103]
ds_read_b64_tr_b16 v[20:21], v5 offset:40960
ds_read_b64_tr_b16 v[22:23], v5 offset:43008
s_add_u32 m0, s83, 140288
s_add_u32 s76, s73, 4259968
buffer_load_dwordx4 v1, s[64:67], s76 offen lds
s_waitcnt lgkmcnt(6)
v_mfma_f32_32x32x16_bf16 v[40:55], v[8:11], a[96:99], v[40:55]
ds_read_b64_tr_b16 v[24:25], v4 offset:33792
ds_read_b64_tr_b16 v[26:27], v4 offset:35840
s_waitcnt lgkmcnt(6)
v_mfma_f32_32x32x16_bf16 v[56:71], v[12:15], a[96:99], v[56:71]
ds_read_b64_tr_b16 v[28:29], v5 offset:33792
ds_read_b64_tr_b16 v[30:31], v5 offset:35840
s_waitcnt lgkmcnt(6)
v_mfma_f32_32x32x16_bf16 v[72:87], v[16:19], a[96:99], v[72:87]
ds_read_b64_tr_b16 v[32:33], v4 offset:41984
ds_read_b64_tr_b16 v[34:35], v4 offset:44032
s_waitcnt lgkmcnt(6)
v_mfma_f32_32x32x16_bf16 v[88:103], v[20:23], a[96:99], v[88:103]
ds_read_b64_tr_b16 v[36:37], v5 offset:41984
ds_read_b64_tr_b16 v[38:39], v5 offset:44032
s_waitcnt lgkmcnt(6)
v_mfma_f32_32x32x16_bf16 v[40:55], v[24:27], a[100:103], v[40:55]
ds_read_b64_tr_b16 v[8:9], v4 offset:36864
ds_read_b64_tr_b16 v[10:11], v4 offset:38912
s_waitcnt lgkmcnt(6)
v_mfma_f32_32x32x16_bf16 v[56:71], v[28:31], a[100:103], v[56:71]
ds_read_b64_tr_b16 v[12:13], v5 offset:36864
ds_read_b64_tr_b16 v[14:15], v5 offset:38912
s_waitcnt lgkmcnt(6)
v_mfma_f32_32x32x16_bf16 v[72:87], v[32:35], a[100:103], v[72:87]
ds_read_b64_tr_b16 v[16:17], v4 offset:45056
ds_read_b64_tr_b16 v[18:19], v4 offset:47104
s_waitcnt lgkmcnt(6)
v_mfma_f32_32x32x16_bf16 v[88:103], v[36:39], a[100:103], v[88:103]
ds_read_b64_tr_b16 v[20:21], v5 offset:45056
ds_read_b64_tr_b16 v[22:23], v5 offset:47104
s_waitcnt lgkmcnt(6)
v_mfma_f32_32x32x16_bf16 v[40:55], v[8:11], a[104:107], v[40:55]
ds_read_b64_tr_b16 v[24:25], v4 offset:37888
ds_read_b64_tr_b16 v[26:27], v4 offset:39936
s_waitcnt lgkmcnt(6)
v_mfma_f32_32x32x16_bf16 v[56:71], v[12:15], a[104:107], v[56:71]
ds_read_b64_tr_b16 v[28:29], v5 offset:37888
ds_read_b64_tr_b16 v[30:31], v5 offset:39936
s_waitcnt lgkmcnt(6)
v_mfma_f32_32x32x16_bf16 v[72:87], v[16:19], a[104:107], v[72:87]
ds_read_b64_tr_b16 v[32:33], v4 offset:46080
ds_read_b64_tr_b16 v[34:35], v4 offset:48128
s_waitcnt lgkmcnt(6)
v_mfma_f32_32x32x16_bf16 v[88:103], v[20:23], a[104:107], v[88:103]
ds_read_b64_tr_b16 v[36:37], v5 offset:46080
ds_read_b64_tr_b16 v[38:39], v5 offset:48128
s_waitcnt vmcnt(8)
s_barrier
s_waitcnt lgkmcnt(6)
v_mfma_f32_32x32x16_bf16 v[40:55], v[24:27], a[108:111], v[40:55]
ds_read_b64_tr_b16 v[8:9], v4 offset:49152
ds_read_b64_tr_b16 v[10:11], v4 offset:51200
s_waitcnt lgkmcnt(6)
v_mfma_f32_32x32x16_bf16 v[56:71], v[28:31], a[108:111], v[56:71]
ds_read_b64_tr_b16 v[12:13], v5 offset:49152
ds_read_b64_tr_b16 v[14:15], v5 offset:51200
s_waitcnt lgkmcnt(6)
v_mfma_f32_32x32x16_bf16 v[72:87], v[32:35], a[108:111], v[72:87]
ds_read_b64_tr_b16 v[16:17], v4 offset:57344
ds_read_b64_tr_b16 v[18:19], v4 offset:59392
s_waitcnt lgkmcnt(6)
v_mfma_f32_32x32x16_bf16 v[88:103], v[36:39], a[108:111], v[88:103]
ds_read_b64_tr_b16 v[20:21], v5 offset:57344
ds_read_b64_tr_b16 v[22:23], v5 offset:59392
s_waitcnt lgkmcnt(6)
v_mfma_f32_32x32x16_bf16 v[40:55], v[8:11], a[112:115], v[40:55]
ds_read_b64_tr_b16 v[24:25], v4 offset:50176
ds_read_b64_tr_b16 v[26:27], v4 offset:52224
s_waitcnt lgkmcnt(6)
v_mfma_f32_32x32x16_bf16 v[56:71], v[12:15], a[112:115], v[56:71]
ds_read_b64_tr_b16 v[28:29], v5 offset:50176
ds_read_b64_tr_b16 v[30:31], v5 offset:52224
s_waitcnt lgkmcnt(6)
v_mfma_f32_32x32x16_bf16 v[72:87], v[16:19], a[112:115], v[72:87]
ds_read_b64_tr_b16 v[32:33], v4 offset:58368
ds_read_b64_tr_b16 v[34:35], v4 offset:60416
s_waitcnt lgkmcnt(6)
v_mfma_f32_32x32x16_bf16 v[88:103], v[20:23], a[112:115], v[88:103]
ds_read_b64_tr_b16 v[36:37], v5 offset:58368
ds_read_b64_tr_b16 v[38:39], v5 offset:60416
s_waitcnt lgkmcnt(6)
v_mfma_f32_32x32x16_bf16 v[40:55], v[24:27], a[116:119], v[40:55]
ds_read_b64_tr_b16 v[8:9], v4 offset:53248
ds_read_b64_tr_b16 v[10:11], v4 offset:55296
s_waitcnt lgkmcnt(6)
v_mfma_f32_32x32x16_bf16 v[56:71], v[28:31], a[116:119], v[56:71]
ds_read_b64_tr_b16 v[12:13], v5 offset:53248
ds_read_b64_tr_b16 v[14:15], v5 offset:55296
s_waitcnt lgkmcnt(6)
v_mfma_f32_32x32x16_bf16 v[72:87], v[32:35], a[116:119], v[72:87]
ds_read_b64_tr_b16 v[16:17], v4 offset:61440
ds_read_b64_tr_b16 v[18:19], v4 offset:63488
s_waitcnt lgkmcnt(6)
v_mfma_f32_32x32x16_bf16 v[88:103], v[36:39], a[116:119], v[88:103]
ds_read_b64_tr_b16 v[20:21], v5 offset:61440
ds_read_b64_tr_b16 v[22:23], v5 offset:63488
s_waitcnt lgkmcnt(6)
v_mfma_f32_32x32x16_bf16 v[40:55], v[8:11], a[120:123], v[40:55]
ds_read_b64_tr_b16 v[24:25], v4 offset:54272
ds_read_b64_tr_b16 v[26:27], v4 offset:56320
s_waitcnt lgkmcnt(6)
v_mfma_f32_32x32x16_bf16 v[56:71], v[12:15], a[120:123], v[56:71]
ds_read_b64_tr_b16 v[28:29], v5 offset:54272
ds_read_b64_tr_b16 v[30:31], v5 offset:56320
s_waitcnt lgkmcnt(6)
v_mfma_f32_32x32x16_bf16 v[72:87], v[16:19], a[120:123], v[72:87]
ds_read_b64_tr_b16 v[32:33], v4 offset:62464
ds_read_b64_tr_b16 v[34:35], v4 offset:64512
s_waitcnt lgkmcnt(6)
v_mfma_f32_32x32x16_bf16 v[88:103], v[20:23], a[120:123], v[88:103]
ds_read_b64_tr_b16 v[36:37], v5 offset:62464
ds_read_b64_tr_b16 v[38:39], v5 offset:64512
s_waitcnt vmcnt(0)
s_barrier
s_waitcnt lgkmcnt(6)
v_mfma_f32_32x32x16_bf16 v[40:55], v[24:27], a[124:127], v[40:55]
ds_read_b64_tr_b16 v[8:9], v6 offset:0
ds_read_b64_tr_b16 v[10:11], v6 offset:2048
s_waitcnt lgkmcnt(6)
v_mfma_f32_32x32x16_bf16 v[56:71], v[28:31], a[124:127], v[56:71]
ds_read_b64_tr_b16 v[12:13], v7 offset:0
ds_read_b64_tr_b16 v[14:15], v7 offset:2048
s_waitcnt lgkmcnt(6)
v_mfma_f32_32x32x16_bf16 v[72:87], v[32:35], a[124:127], v[72:87]
ds_read_b64_tr_b16 v[16:17], v6 offset:8192
ds_read_b64_tr_b16 v[18:19], v6 offset:10240
s_waitcnt lgkmcnt(6)
v_mfma_f32_32x32x16_bf16 v[88:103], v[36:39], a[124:127], v[88:103]
ds_read_b64_tr_b16 v[20:21], v7 offset:8192
ds_read_b64_tr_b16 v[22:23], v7 offset:10240
s_waitcnt lgkmcnt(6)
v_mfma_f32_32x32x16_bf16 v[40:55], v[8:11], a[128:131], v[40:55]
ds_read_b64_tr_b16 v[24:25], v6 offset:1024
ds_read_b64_tr_b16 v[26:27], v6 offset:3072
s_waitcnt lgkmcnt(6)
v_mfma_f32_32x32x16_bf16 v[56:71], v[12:15], a[128:131], v[56:71]
ds_read_b64_tr_b16 v[28:29], v7 offset:1024
ds_read_b64_tr_b16 v[30:31], v7 offset:3072
s_waitcnt lgkmcnt(6)
v_mfma_f32_32x32x16_bf16 v[72:87], v[16:19], a[128:131], v[72:87]
ds_read_b64_tr_b16 v[32:33], v6 offset:9216
ds_read_b64_tr_b16 v[34:35], v6 offset:11264
s_waitcnt lgkmcnt(6)
v_mfma_f32_32x32x16_bf16 v[88:103], v[20:23], a[128:131], v[88:103]
ds_read_b64_tr_b16 v[36:37], v7 offset:9216
ds_read_b64_tr_b16 v[38:39], v7 offset:11264
s_waitcnt lgkmcnt(6)
v_mfma_f32_32x32x16_bf16 v[40:55], v[24:27], a[132:135], v[40:55]
ds_read_b64_tr_b16 v[8:9], v6 offset:4096
ds_read_b64_tr_b16 v[10:11], v6 offset:6144
s_waitcnt lgkmcnt(6)
v_mfma_f32_32x32x16_bf16 v[56:71], v[28:31], a[132:135], v[56:71]
ds_read_b64_tr_b16 v[12:13], v7 offset:4096
ds_read_b64_tr_b16 v[14:15], v7 offset:6144
s_waitcnt lgkmcnt(6)
v_mfma_f32_32x32x16_bf16 v[72:87], v[32:35], a[132:135], v[72:87]
ds_read_b64_tr_b16 v[16:17], v6 offset:12288
ds_read_b64_tr_b16 v[18:19], v6 offset:14336
s_waitcnt lgkmcnt(6)
v_mfma_f32_32x32x16_bf16 v[88:103], v[36:39], a[132:135], v[88:103]
ds_read_b64_tr_b16 v[20:21], v7 offset:12288
ds_read_b64_tr_b16 v[22:23], v7 offset:14336
s_waitcnt lgkmcnt(6)
v_mfma_f32_32x32x16_bf16 v[40:55], v[8:11], a[136:139], v[40:55]
ds_read_b64_tr_b16 v[24:25], v6 offset:5120
ds_read_b64_tr_b16 v[26:27], v6 offset:7168
s_waitcnt lgkmcnt(6)
v_mfma_f32_32x32x16_bf16 v[56:71], v[12:15], a[136:139], v[56:71]
ds_read_b64_tr_b16 v[28:29], v7 offset:5120
ds_read_b64_tr_b16 v[30:31], v7 offset:7168
s_waitcnt lgkmcnt(6)
v_mfma_f32_32x32x16_bf16 v[72:87], v[16:19], a[136:139], v[72:87]
ds_read_b64_tr_b16 v[32:33], v6 offset:13312
ds_read_b64_tr_b16 v[34:35], v6 offset:15360
s_waitcnt lgkmcnt(6)
v_mfma_f32_32x32x16_bf16 v[88:103], v[20:23], a[136:139], v[88:103]
ds_read_b64_tr_b16 v[36:37], v7 offset:13312
ds_read_b64_tr_b16 v[38:39], v7 offset:15360
s_waitcnt lgkmcnt(6)
v_mfma_f32_32x32x16_bf16 v[40:55], v[24:27], a[140:143], v[40:55]
s_waitcnt lgkmcnt(4)
v_mfma_f32_32x32x16_bf16 v[56:71], v[28:31], a[140:143], v[56:71]
s_waitcnt lgkmcnt(2)
v_mfma_f32_32x32x16_bf16 v[72:87], v[32:35], a[140:143], v[72:87]
s_waitcnt lgkmcnt(0)
v_mfma_f32_32x32x16_bf16 v[88:103], v[36:39], a[140:143], v[88:103]
s_nop 11
s_add_u32 s77, s82, 0
v_cvt_pk_bf16_f32 v106, v40, v41
v_cvt_pk_bf16_f32 v107, v42, v43
v_cvt_pk_bf16_f32 v108, v48, v49
v_cvt_pk_bf16_f32 v109, v50, v51
buffer_store_dwordx4 v[106:109], v104, s[8:11], s77 offen offset:0 sc1
v_cvt_pk_bf16_f32 v110, v44, v45
v_cvt_pk_bf16_f32 v111, v46, v47
v_cvt_pk_bf16_f32 v112, v52, v53
v_cvt_pk_bf16_f32 v113, v54, v55
buffer_store_dwordx4 v[110:113], v104, s[8:11], s77 offen offset:512 sc1
s_add_u32 s77, s82, 2048
v_cvt_pk_bf16_f32 v114, v56, v57
v_cvt_pk_bf16_f32 v115, v58, v59
v_cvt_pk_bf16_f32 v116, v64, v65
v_cvt_pk_bf16_f32 v117, v66, v67
buffer_store_dwordx4 v[114:117], v104, s[8:11], s77 offen offset:0 sc1
v_cvt_pk_bf16_f32 v118, v60, v61
v_cvt_pk_bf16_f32 v119, v62, v63
v_cvt_pk_bf16_f32 v120, v68, v69
v_cvt_pk_bf16_f32 v121, v70, v71
buffer_store_dwordx4 v[118:121], v104, s[8:11], s77 offen offset:512 sc1
s_add_u32 s77, s82, 4096
v_cvt_pk_bf16_f32 v106, v72, v73
v_cvt_pk_bf16_f32 v107, v74, v75
v_cvt_pk_bf16_f32 v108, v80, v81
v_cvt_pk_bf16_f32 v109, v82, v83
buffer_store_dwordx4 v[106:109], v104, s[8:11], s77 offen offset:0 sc1
v_cvt_pk_bf16_f32 v110, v76, v77
v_cvt_pk_bf16_f32 v111, v78, v79
v_cvt_pk_bf16_f32 v112, v84, v85
v_cvt_pk_bf16_f32 v113, v86, v87
buffer_store_dwordx4 v[110:113], v104, s[8:11], s77 offen offset:512 sc1
s_add_u32 s77, s82, 6144
v_cvt_pk_bf16_f32 v114, v88, v89
v_cvt_pk_bf16_f32 v115, v90, v91
v_cvt_pk_bf16_f32 v116, v96, v97
v_cvt_pk_bf16_f32 v117, v98, v99
buffer_store_dwordx4 v[114:117], v104, s[8:11], s77 offen offset:0 sc1
v_cvt_pk_bf16_f32 v118, v92, v93
v_cvt_pk_bf16_f32 v119, v94, v95
v_cvt_pk_bf16_f32 v120, v100, v101
v_cvt_pk_bf16_f32 v121, v102, v103
buffer_store_dwordx4 v[118:121], v104, s[8:11], s77 offen offset:512 sc1
s_branch L_a2e_11
L_a2v_10:
s_add_u32 m0, s83, 0
s_add_u32 s76, s73, 0
buffer_load_dwordx4 v1, s[64:67], s76 offen lds
s_add_u32 m0, s83, 1024
s_add_u32 s76, s73, 65536
buffer_load_dwordx4 v1, s[64:67], s76 offen lds
s_add_u32 m0, s83, 8192
s_add_u32 s76, s73, 128
buffer_load_dwordx4 v1, s[64:67], s76 offen lds
s_add_u32 m0, s83, 9216
s_add_u32 s76, s73, 65664
buffer_load_dwordx4 v1, s[64:67], s76 offen lds
s_add_u32 s76, s72, 0
buffer_load_dwordx4 a[0:3], v0, s[8:11], s76 offen offset:0 sc1
s_add_u32 s76, s72, 0
buffer_load_dwordx4 a[4:7], v0, s[8:11], s76 offen offset:1024 sc1
s_add_u32 s76, s72, 0
buffer_load_dwordx4 a[8:11], v0, s[8:11], s76 offen offset:2048 sc1
s_add_u32 s76, s72, 0
buffer_load_dwordx4 a[12:15], v0, s[8:11], s76 offen offset:3072 sc1
s_add_u32 m0, s83, 16384
s_add_u32 s76, s73, 524288
buffer_load_dwordx4 v1, s[64:67], s76 offen lds
s_add_u32 m0, s83, 17408
s_add_u32 s76, s73, 589824
buffer_load_dwordx4 v1, s[64:67], s76 offen lds
s_add_u32 m0, s83, 24576
s_add_u32 s76, s73, 524416
buffer_load_dwordx4 v1, s[64:67], s76 offen lds
s_add_u32 m0, s83, 25600
s_add_u32 s76, s73, 589952
buffer_load_dwordx4 v1, s[64:67], s76 offen lds
s_add_u32 s76, s72, 4096
buffer_load_dwordx4 a[16:19], v0, s[8:11], s76 offen offset:0 sc1
s_add_u32 s76, s72, 4096
buffer_load_dwordx4 a[20:23], v0, s[8:11], s76 offen offset:1024 sc1
s_add_u32 s76, s72, 4096
buffer_load_dwordx4 a[24:27], v0, s[8:11], s76 offen offset:2048 sc1
s_add_u32 s76, s72, 4096
buffer_load_dwordx4 a[28:31], v0, s[8:11], s76 offen offset:3072 sc1
s_add_u32 m0, s83, 32768
s_add_u32 s76, s73, 1048576
buffer_load_dwordx4 v1, s[64:67], s76 offen lds
s_add_u32 m0, s83, 33792
s_add_u32 s76, s73, 1114112
buffer_load_dwordx4 v1, s[64:67], s76 offen lds
s_add_u32 m0, s83, 40960
s_add_u32 s76, s73, 1048704
buffer_load_dwordx4 v1, s[64:67], s76 offen lds
s_add_u32 m0, s83, 41984
s_add_u32 s76, s73, 1114240
buffer_load_dwordx4 v1, s[64:67], s76 offen lds
s_add_u32 s76, s72, 8192
buffer_load_dwordx4 a[32:35], v0, s[8:11], s76 offen offset:0 sc1
s_add_u32 s76, s72, 8192
buffer_load_dwordx4 a[36:39], v0, s[8:11], s76 offen offset:1024 sc1
s_add_u32 s76, s72, 8192
buffer_load_dwordx4 a[40:43], v0, s[8:11], s76 offen offset:2048 sc1
s_add_u32 s76, s72, 8192
buffer_load_dwordx4 a[44:47], v0, s[8:11], s76 offen offset:3072 sc1
s_add_u32 m0, s83, 49152
s_add_u32 s76, s73, 1572864
buffer_load_dwordx4 v1, s[64:67], s76 offen lds
s_add_u32 m0, s83, 50176
s_add_u32 s76, s73, 1638400
buffer_load_dwordx4 v1, s[64:67], s76 offen lds
s_add_u32 m0, s83, 57344
s_add_u32 s76, s73, 1572992
buffer_load_dwordx4 v1, s[64:67], s76 offen lds
s_add_u32 m0, s83, 58368
s_add_u32 s76, s73, 1638528
buffer_load_dwordx4 v1, s[64:67], s76 offen lds
s_add_u32 s76, s72, 12288
buffer_load_dwordx4 a[48:51], v0, s[8:11], s76 offen offset:0 sc1
s_add_u32 s76, s72, 12288
buffer_load_dwordx4 a[52:55], v0, s[8:11], s76 offen offset:1024 sc1
s_add_u32 s76, s72, 12288
buffer_load_dwordx4 a[56:59], v0, s[8:11], s76 offen offset:2048 sc1
s_add_u32 s76, s72, 12288
buffer_load_dwordx4 a[60:63], v0, s[8:11], s76 offen offset:3072 sc1
s_waitcnt vmcnt(24)
s_barrier
ds_read_b64_tr_b16 v[8:9], v2 offset:0
ds_read_b64_tr_b16 v[10:11], v2 offset:2048
ds_read_b64_tr_b16 v[12:13], v3 offset:0
ds_read_b64_tr_b16 v[14:15], v3 offset:2048
ds_read_b64_tr_b16 v[16:17], v2 offset:8192
ds_read_b64_tr_b16 v[18:19], v2 offset:10240
ds_read_b64_tr_b16 v[20:21], v3 offset:8192
ds_read_b64_tr_b16 v[22:23], v3 offset:10240
s_waitcnt lgkmcnt(6)
v_mfma_f32_32x32x16_bf16 v[40:55], a[0:3], v[8:11], 0
ds_read_b64_tr_b16 v[24:25], v2 offset:1024
ds_read_b64_tr_b16 v[26:27], v2 offset:3072
s_waitcnt lgkmcnt(6)
v_mfma_f32_32x32x16_bf16 v[56:71], a[0:3], v[12:15], 0
ds_read_b64_tr_b16 v[28:29], v3 offset:1024
ds_read_b64_tr_b16 v[30:31], v3 offset:3072
s_waitcnt lgkmcnt(6)
v_mfma_f32_32x32x16_bf16 v[72:87], a[0:3], v[16:19], 0
ds_read_b64_tr_b16 v[32:33], v2 offset:9216
ds_read_b64_tr_b16 v[34:35], v2 offset:11264
s_waitcnt lgkmcnt(6)
v_mfma_f32_32x32x16_bf16 v[88:103], a[0:3], v[20:23], 0
ds_read_b64_tr_b16 v[36:37], v3 offset:9216
ds_read_b64_tr_b16 v[38:39], v3 offset:11264
s_waitcnt lgkmcnt(6)
v_mfma_f32_32x32x16_bf16 v[40:55], a[4:7], v[24:27], v[40:55]
ds_read_b64_tr_b16 v[8:9], v2 offset:4096
ds_read_b64_tr_b16 v[10:11], v2 offset:6144
s_waitcnt lgkmcnt(6)
v_mfma_f32_32x32x16_bf16 v[56:71], a[4:7], v[28:31], v[56:71]
ds_read_b64_tr_b16 v[12:13], v3 offset:4096
ds_read_b64_tr_b16 v[14:15], v3 offset:6144
s_waitcnt lgkmcnt(6)
v_mfma_f32_32x32x16_bf16 v[72:87], a[4:7], v[32:35], v[72:87]
ds_read_b64_tr_b16 v[16:17], v2 offset:12288
ds_read_b64_tr_b16 v[18:19], v2 offset:14336
s_waitcnt lgkmcnt(6)
v_mfma_f32_32x32x16_bf16 v[88:103], a[4:7], v[36:39], v[88:103]
ds_read_b64_tr_b16 v[20:21], v3 offset:12288
ds_read_b64_tr_b16 v[22:23], v3 offset:14336
s_waitcnt lgkmcnt(6)
v_mfma_f32_32x32x16_bf16 v[40:55], a[8:11], v[8:11], v[40:55]
ds_read_b64_tr_b16 v[24:25], v2 offset:5120
ds_read_b64_tr_b16 v[26:27], v2 offset:7168
s_waitcnt lgkmcnt(6)
v_mfma_f32_32x32x16_bf16 v[56:71], a[8:11], v[12:15], v[56:71]
ds_read_b64_tr_b16 v[28:29], v3 offset:5120
ds_read_b64_tr_b16 v[30:31], v3 offset:7168
s_waitcnt lgkmcnt(6)
v_mfma_f32_32x32x16_bf16 v[72:87], a[8:11], v[16:19], v[72:87]
ds_read_b64_tr_b16 v[32:33], v2 offset:13312
ds_read_b64_tr_b16 v[34:35], v2 offset:15360
s_waitcnt lgkmcnt(6)
v_mfma_f32_32x32x16_bf16 v[88:103], a[8:11], v[20:23], v[88:103]
ds_read_b64_tr_b16 v[36:37], v3 offset:13312
ds_read_b64_tr_b16 v[38:39], v3 offset:15360
s_waitcnt vmcnt(20)
s_waitcnt vmcnt(16)
s_barrier
s_waitcnt lgkmcnt(6)
v_mfma_f32_32x32x16_bf16 v[40:55], a[12:15], v[24:27], v[40:55]
ds_read_b64_tr_b16 v[8:9], v2 offset:16384
ds_read_b64_tr_b16 v[10:11], v2 offset:18432
s_waitcnt lgkmcnt(6)
v_mfma_f32_32x32x16_bf16 v[56:71], a[12:15], v[28:31], v[56:71]
ds_read_b64_tr_b16 v[12:13], v3 offset:16384
ds_read_b64_tr_b16 v[14:15], v3 offset:18432
s_waitcnt lgkmcnt(6)
v_mfma_f32_32x32x16_bf16 v[72:87], a[12:15], v[32:35], v[72:87]
ds_read_b64_tr_b16 v[16:17], v2 offset:24576
ds_read_b64_tr_b16 v[18:19], v2 offset:26624
s_waitcnt lgkmcnt(6)
v_mfma_f32_32x32x16_bf16 v[88:103], a[12:15], v[36:39], v[88:103]
ds_read_b64_tr_b16 v[20:21], v3 offset:24576
ds_read_b64_tr_b16 v[22:23], v3 offset:26624
s_waitcnt lgkmcnt(6)
v_mfma_f32_32x32x16_bf16 v[40:55], a[16:19], v[8:11], v[40:55]
ds_read_b64_tr_b16 v[24:25], v2 offset:17408
ds_read_b64_tr_b16 v[26:27], v2 offset:19456
s_waitcnt lgkmcnt(6)
v_mfma_f32_32x32x16_bf16 v[56:71], a[16:19], v[12:15], v[56:71]
ds_read_b64_tr_b16 v[28:29], v3 offset:17408
ds_read_b64_tr_b16 v[30:31], v3 offset:19456
s_add_u32 s76, s72, 16384
buffer_load_dwordx4 a[64:67], v0, s[8:11], s76 offen offset:0 sc1
s_waitcnt lgkmcnt(6)
v_mfma_f32_32x32x16_bf16 v[72:87], a[16:19], v[16:19], v[72:87]
ds_read_b64_tr_b16 v[32:33], v2 offset:25600
ds_read_b64_tr_b16 v[34:35], v2 offset:27648
s_waitcnt lgkmcnt(6)
v_mfma_f32_32x32x16_bf16 v[88:103], a[16:19], v[20:23], v[88:103]
ds_read_b64_tr_b16 v[36:37], v3 offset:25600
ds_read_b64_tr_b16 v[38:39], v3 offset:27648
s_add_u32 s76, s72, 16384
buffer_load_dwordx4 a[68:71], v0, s[8:11], s76 offen offset:1024 sc1
s_waitcnt lgkmcnt(6)
v_mfma_f32_32x32x16_bf16 v[40:55], a[20:23], v[24:27], v[40:55]
ds_read_b64_tr_b16 v[8:9], v2 offset:20480
ds_read_b64_tr_b16 v[10:11], v2 offset:22528
s_waitcnt lgkmcnt(6)
v_mfma_f32_32x32x16_bf16 v[56:71], a[20:23], v[28:31], v[56:71]
ds_read_b64_tr_b16 v[12:13], v3 offset:20480
ds_read_b64_tr_b16 v[14:15], v3 offset:22528
s_add_u32 s76, s72, 16384
buffer_load_dwordx4 a[72:75], v0, s[8:11], s76 offen offset:2048 sc1
s_waitcnt lgkmcnt(6)
v_mfma_f32_32x32x16_bf16 v[72:87], a[20:23], v[32:35], v[72:87]
ds_read_b64_tr_b16 v[16:17], v2 offset:28672
ds_read_b64_tr_b16 v[18:19], v2 offset:30720
s_waitcnt lgkmcnt(6)
v_mfma_f32_32x32x16_bf16 v[88:103], a[20:23], v[36:39], v[88:103]
ds_read_b64_tr_b16 v[20:21], v3 offset:28672
ds_read_b64_tr_b16 v[22:23], v3 offset:30720
s_add_u32 s76, s72, 16384
buffer_load_dwordx4 a[76:79], v0, s[8:11], s76 offen offset:3072 sc1
s_waitcnt lgkmcnt(6)
v_mfma_f32_32x32x16_bf16 v[40:55], a[24:27], v[8:11], v[40:55]
ds_read_b64_tr_b16 v[24:25], v2 offset:21504
ds_read_b64_tr_b16 v[26:27], v2 offset:23552
s_waitcnt lgkmcnt(6)
v_mfma_f32_32x32x16_bf16 v[56:71], a[24:27], v[12:15], v[56:71]
ds_read_b64_tr_b16 v[28:29], v3 offset:21504
ds_read_b64_tr_b16 v[30:31], v3 offset:23552
s_add_u32 s76, s72, 20480
buffer_load_dwordx4 a[80:83], v0, s[8:11], s76 offen offset:0 sc1
s_waitcnt lgkmcnt(6)
v_mfma_f32_32x32x16_bf16 v[72:87], a[24:27], v[16:19], v[72:87]
ds_read_b64_tr_b16 v[32:33], v2 offset:29696
ds_read_b64_tr_b16 v[34:35], v2 offset:31744
s_waitcnt lgkmcnt(6)
v_mfma_f32_32x32x16_bf16 v[88:103], a[24:27], v[20:23], v[88:103]
ds_read_b64_tr_b16 v[36:37], v3 offset:29696
ds_read_b64_tr_b16 v[38:39], v3 offset:31744
s_add_u32 s76, s72, 20480
buffer_load_dwordx4 a[84:87], v0, s[8:11], s76 offen offset:1024 sc1
s_waitcnt vmcnt(18)
s_waitcnt vmcnt(14)
s_barrier
s_waitcnt lgkmcnt(6)
v_mfma_f32_32x32x16_bf16 v[40:55], a[28:31], v[24:27], v[40:55]
ds_read_b64_tr_b16 v[8:9], v2 offset:32768
ds_read_b64_tr_b16 v[10:11], v2 offset:34816
s_waitcnt lgkmcnt(6)
v_mfma_f32_32x32x16_bf16 v[56:71], a[28:31], v[28:31], v[56:71]
ds_read_b64_tr_b16 v[12:13], v3 offset:32768
ds_read_b64_tr_b16 v[14:15], v3 offset:34816
s_add_u32 s76, s72, 20480
buffer_load_dwordx4 a[88:91], v0, s[8:11], s76 offen offset:2048 sc1
s_waitcnt lgkmcnt(6)
v_mfma_f32_32x32x16_bf16 v[72:87], a[28:31], v[32:35], v[72:87]
ds_read_b64_tr_b16 v[16:17], v2 offset:40960
ds_read_b64_tr_b16 v[18:19], v2 offset:43008
s_waitcnt lgkmcnt(6)
v_mfma_f32_32x32x16_bf16 v[88:103], a[28:31], v[36:39], v[88:103]
ds_read_b64_tr_b16 v[20:21], v3 offset:40960
ds_read_b64_tr_b16 v[22:23], v3 offset:43008
s_add_u32 s76, s72, 20480
buffer_load_dwordx4 a[92:95], v0, s[8:11], s76 offen offset:3072 sc1
s_waitcnt lgkmcnt(6)
v_mfma_f32_32x32x16_bf16 v[40:55], a[32:35], v[8:11], v[40:55]
ds_read_b64_tr_b16 v[24:25], v2 offset:33792
ds_read_b64_tr_b16 v[26:27], v2 offset:35840
s_waitcnt lgkmcnt(6)
v_mfma_f32_32x32x16_bf16 v[56:71], a[32:35], v[12:15], v[56:71]
ds_read_b64_tr_b16 v[28:29], v3 offset:33792
ds_read_b64_tr_b16 v[30:31], v3 offset:35840
s_add_u32 m0, s83, 65536
s_add_u32 s76, s73, 2097152
buffer_load_dwordx4 v1, s[64:67], s76 offen lds
s_waitcnt lgkmcnt(6)
v_mfma_f32_32x32x16_bf16 v[72:87], a[32:35], v[16:19], v[72:87]
ds_read_b64_tr_b16 v[32:33], v2 offset:41984
ds_read_b64_tr_b16 v[34:35], v2 offset:44032
s_waitcnt lgkmcnt(6)
v_mfma_f32_32x32x16_bf16 v[88:103], a[32:35], v[20:23], v[88:103]
ds_read_b64_tr_b16 v[36:37], v3 offset:41984
ds_read_b64_tr_b16 v[38:39], v3 offset:44032
s_add_u32 m0, s83, 66560
s_add_u32 s76, s73, 2162688
buffer_load_dwordx4 v1, s[64:67], s76 offen lds
s_waitcnt lgkmcnt(6)
v_mfma_f32_32x32x16_bf16 v[40:55], a[36:39], v[24:27], v[40:55]
ds_read_b64_tr_b16 v[8:9], v2 offset:36864
ds_read_b64_tr_b16 v[10:11], v2 offset:38912
s_waitcnt lgkmcnt(6)
v_mfma_f32_32x32x16_bf16 v[56:71], a[36:39], v[28:31], v[56:71]
ds_read_b64_tr_b16 v[12:13], v3 offset:36864
ds_read_b64_tr_b16 v[14:15], v3 offset:38912
s_add_u32 m0, s83, 73728
s_add_u32 s76, s73, 2097280
buffer_load_dwordx4 v1, s[64:67], s76 offen lds
s_waitcnt lgkmcnt(6)
v_mfma_f32_32x32x16_bf16 v[72:87], a[36:39], v[32:35], v[72:87]
ds_read_b64_tr_b16 v[16:17], v2 offset:45056
ds_read_b64_tr_b16 v[18:19], v2 offset:47104
s_waitcnt lgkmcnt(6)
v_mfma_f32_32x32x16_bf16 v[88:103], a[36:39], v[36:39], v[88:103]
ds_read_b64_tr_b16 v[20:21], v3 offset:45056
ds_read_b64_tr_b16 v[22:23], v3 offset:47104
s_add_u32 m0, s83, 74752
s_add_u32 s76, s73, 2162816
buffer_load_dwordx4 v1, s[64:67], s76 offen lds
s_waitcnt lgkmcnt(6)
v_mfma_f32_32x32x16_bf16 v[40:55], a[40:43], v[8:11], v[40:55]
ds_read_b64_tr_b16 v[24:25], v2 offset:37888
ds_read_b64_tr_b16 v[26:27], v2 offset:39936
s_waitcnt lgkmcnt(6)
v_mfma_f32_32x32x16_bf16 v[56:71], a[40:43], v[12:15], v[56:71]
ds_read_b64_tr_b16 v[28:29], v3 offset:37888
ds_read_b64_tr_b16 v[30:31], v3 offset:39936
s_add_u32 m0, s83, 81920
s_add_u32 s76, s73, 2621440
buffer_load_dwordx4 v1, s[64:67], s76 offen lds
s_waitcnt lgkmcnt(6)
v_mfma_f32_32x32x16_bf16 v[72:87], a[40:43], v[16:19], v[72:87]
ds_read_b64_tr_b16 v[32:33], v2 offset:46080
ds_read_b64_tr_b16 v[34:35], v2 offset:48128
s_waitcnt lgkmcnt(6)
v_mfma_f32_32x32x16_bf16 v[88:103], a[40:43], v[20:23], v[88:103]
ds_read_b64_tr_b16 v[36:37], v3 offset:46080
ds_read_b64_tr_b16 v[38:39], v3 offset:48128
s_add_u32 m0, s83, 82944
s_add_u32 s76, s73, 2686976
buffer_load_dwordx4 v1, s[64:67], s76 offen lds
s_waitcnt vmcnt(18)
s_waitcnt vmcnt(14)
s_barrier
s_waitcnt lgkmcnt(6)
v_mfma_f32_32x32x16_bf16 v[40:55], a[44:47], v[24:27], v[40:55]
ds_read_b64_tr_b16 v[8:9], v2 offset:49152
ds_read_b64_tr_b16 v[10:11], v2 offset:51200
s_waitcnt lgkmcnt(6)
v_mfma_f32_32x32x16_bf16 v[56:71], a[44:47], v[28:31], v[56:71]
ds_read_b64_tr_b16 v[12:13], v3 offset:49152
ds_read_b64_tr_b16 v[14:15], v3 offset:51200
s_add_u32 m0, s83, 90112
s_add_u32 s76, s73, 2621568
buffer_load_dwordx4 v1, s[64:67], s76 offen lds
s_waitcnt lgkmcnt(6)
v_mfma_f32_32x32x16_bf16 v[72:87], a[44:47], v[32:35], v[72:87]
ds_read_b64_tr_b16 v[16:17], v2 offset:57344
ds_read_b64_tr_b16 v[18:19], v2 offset:59392
s_waitcnt lgkmcnt(6)
v_mfma_f32_32x32x16_bf16 v[88:103], a[44:47], v[36:39], v[88:103]
ds_read_b64_tr_b16 v[20:21], v3 offset:57344
ds_read_b64_tr_b16 v[22:23], v3 offset:59392
s_add_u32 m0, s83, 91136
s_add_u32 s76, s73, 2687104
buffer_load_dwordx4 v1, s[64:67], s76 offen lds
s_waitcnt lgkmcnt(6)
v_mfma_f32_32x32x16_bf16 v[40:55], a[48:51], v[8:11], v[40:55]
ds_read_b64_tr_b16 v[24:25], v2 offset:50176
ds_read_b64_tr_b16 v[26:27], v2 offset:52224
s_waitcnt lgkmcnt(6)
v_mfma_f32_32x32x16_bf16 v[56:71], a[48:51], v[12:15], v[56:71]
ds_read_b64_tr_b16 v[28:29], v3 offset:50176
ds_read_b64_tr_b16 v[30:31], v3 offset:52224
s_add_u32 s76, s72, 24576
buffer_load_dwordx4 a[96:99], v0, s[8:11], s76 offen offset:0 sc1
s_waitcnt lgkmcnt(6)
v_mfma_f32_32x32x16_bf16 v[72:87], a[48:51], v[16:19], v[72:87]
ds_read_b64_tr_b16 v[32:33], v2 offset:58368
ds_read_b64_tr_b16 v[34:35], v2 offset:60416
s_waitcnt lgkmcnt(6)
v_mfma_f32_32x32x16_bf16 v[88:103], a[48:51], v[20:23], v[88:103]
ds_read_b64_tr_b16 v[36:37], v3 offset:58368
ds_read_b64_tr_b16 v[38:39], v3 offset:60416
s_add_u32 s76, s72, 24576
buffer_load_dwordx4 a[100:103], v0, s[8:11], s76 offen offset:1024 sc1
s_waitcnt lgkmcnt(6)
v_mfma_f32_32x32x16_bf16 v[40:55], a[52:55], v[24:27], v[40:55]
ds_read_b64_tr_b16 v[8:9], v2 offset:53248
ds_read_b64_tr_b16 v[10:11], v2 offset:55296
s_waitcnt lgkmcnt(6)
v_mfma_f32_32x32x16_bf16 v[56:71], a[52:55], v[28:31], v[56:71]
ds_read_b64_tr_b16 v[12:13], v3 offset:53248
ds_read_b64_tr_b16 v[14:15], v3 offset:55296
s_add_u32 s76, s72, 24576
buffer_load_dwordx4 a[104:107], v0, s[8:11], s76 offen offset:2048 sc1
s_waitcnt lgkmcnt(6)
v_mfma_f32_32x32x16_bf16 v[72:87], a[52:55], v[32:35], v[72:87]
ds_read_b64_tr_b16 v[16:17], v2 offset:61440
ds_read_b64_tr_b16 v[18:19], v2 offset:63488
s_waitcnt lgkmcnt(6)
v_mfma_f32_32x32x16_bf16 v[88:103], a[52:55], v[36:39], v[88:103]
ds_read_b64_tr_b16 v[20:21], v3 offset:61440
ds_read_b64_tr_b16 v[22:23], v3 offset:63488
s_add_u32 s76, s72, 24576
buffer_load_dwordx4 a[108:111], v0, s[8:11], s76 offen offset:3072 sc1
s_waitcnt lgkmcnt(6)
v_mfma_f32_32x32x16_bf16 v[40:55], a[56:59], v[8:11], v[40:55]
ds_read_b64_tr_b16 v[24:25], v2 offset:54272
ds_read_b64_tr_b16 v[26:27], v2 offset:56320
s_waitcnt lgkmcnt(6)
v_mfma_f32_32x32x16_bf16 v[56:71], a[56:59], v[12:15], v[56:71]
ds_read_b64_tr_b16 v[28:29], v3 offset:54272
ds_read_b64_tr_b16 v[30:31], v3 offset:56320
s_add_u32 s76, s72, 28672
buffer_load_dwordx4 a[112:115], v0, s[8:11], s76 offen offset:0 sc1
s_waitcnt lgkmcnt(6)
v_mfma_f32_32x32x16_bf16 v[72:87], a[56:59], v[16:19], v[72:87]
ds_read_b64_tr_b16 v[32:33], v2 offset:62464
ds_read_b64_tr_b16 v[34:35], v2 offset:64512
s_waitcnt lgkmcnt(6)
v_mfma_f32_32x32x16_bf16 v[88:103], a[56:59], v[20:23], v[88:103]
ds_read_b64_tr_b16 v[36:37], v3 offset:62464
ds_read_b64_tr_b16 v[38:39], v3 offset:64512
s_add_u32 s76, s72, 28672
buffer_load_dwordx4 a[116:119], v0, s[8:11], s76 offen offset:1024 sc1
s_waitcnt vmcnt(10)
s_barrier
s_waitcnt lgkmcnt(6)
v_mfma_f32_32x32x16_bf16 v[40:55], a[60:63], v[24:27], v[40:55]
ds_read_b64_tr_b16 v[8:9], v4 offset:0
ds_read_b64_tr_b16 v[10:11], v4 offset:2048
s_waitcnt lgkmcnt(6)
v_mfma_f32_32x32x16_bf16 v[56:71], a[60:63], v[28:31], v[56:71]
ds_read_b64_tr_b16 v[12:13], v5 offset:0
ds_read_b64_tr_b16 v[14:15], v5 offset:2048
s_add_u32 s76, s72, 28672
buffer_load_dwordx4 a[120:123], v0, s[8:11], s76 offen offset:2048 sc1
s_waitcnt lgkmcnt(6)
v_mfma_f32_32x32x16_bf16 v[72:87], a[60:63], v[32:35], v[72:87]
ds_read_b64_tr_b16 v[16:17], v4 offset:8192
ds_read_b64_tr_b16 v[18:19], v4 offset:10240
s_waitcnt lgkmcnt(6)
v_mfma_f32_32x32x16_bf16 v[88:103], a[60:63], v[36:39], v[88:103]
ds_read_b64_tr_b16 v[20:21], v5 offset:8192
ds_read_b64_tr_b16 v[22:23], v5 offset:10240
s_add_u32 s76, s72, 28672
buffer_load_dwordx4 a[124:127], v0, s[8:11], s76 offen offset:3072 sc1
s_waitcnt lgkmcnt(6)
v_mfma_f32_32x32x16_bf16 v[40:55], a[64:67], v[8:11], v[40:55]
ds_read_b64_tr_b16 v[24:25], v4 offset:1024
ds_read_b64_tr_b16 v[26:27], v4 offset:3072
s_waitcnt lgkmcnt(6)
v_mfma_f32_32x32x16_bf16 v[56:71], a[64:67], v[12:15], v[56:71]
ds_read_b64_tr_b16 v[28:29], v5 offset:1024
ds_read_b64_tr_b16 v[30:31], v5 offset:3072
s_add_u32 m0, s83, 98304
s_add_u32 s76, s73, 3145728
buffer_load_dwordx4 v1, s[64:67], s76 offen lds
s_waitcnt lgkmcnt(6)
v_mfma_f32_32x32x16_bf16 v[72:87], a[64:67], v[16:19], v[72:87]
ds_read_b64_tr_b16 v[32:33], v4 offset:9216
ds_read_b64_tr_b16 v[34:35], v4 offset:11264
s_waitcnt lgkmcnt(6)
v_mfma_f32_32x32x16_bf16 v[88:103], a[64:67], v[20:23], v[88:103]
ds_read_b64_tr_b16 v[36:37], v5 offset:9216
ds_read_b64_tr_b16 v[38:39], v5 offset:11264
s_add_u32 m0, s83, 99328
s_add_u32 s76, s73, 3211264
buffer_load_dwordx4 v1, s[64:67], s76 offen lds
s_waitcnt lgkmcnt(6)
v_mfma_f32_32x32x16_bf16 v[40:55], a[68:71], v[24:27], v[40:55]
ds_read_b64_tr_b16 v[8:9], v4 offset:4096
ds_read_b64_tr_b16 v[10:11], v4 offset:6144
s_waitcnt lgkmcnt(6)
v_mfma_f32_32x32x16_bf16 v[56:71], a[68:71], v[28:31], v[56:71]
ds_read_b64_tr_b16 v[12:13], v5 offset:4096
ds_read_b64_tr_b16 v[14:15], v5 offset:6144
s_add_u32 m0, s83, 106496
s_add_u32 s76, s73, 3145856
buffer_load_dwordx4 v1, s[64:67], s76 offen lds
s_waitcnt lgkmcnt(6)
v_mfma_f32_32x32x16_bf16 v[72:87], a[68:71], v[32:35], v[72:87]
ds_read_b64_tr_b16 v[16:17], v4 offset:12288
ds_read_b64_tr_b16 v[18:19], v4 offset:14336
s_waitcnt lgkmcnt(6)
v_mfma_f32_32x32x16_bf16 v[88:103], a[68:71], v[36:39], v[88:103]
ds_read_b64_tr_b16 v[20:21], v5 offset:12288
ds_read_b64_tr_b16 v[22:23], v5 offset:14336
s_add_u32 m0, s83, 107520
s_add_u32 s76, s73, 3211392
buffer_load_dwordx4 v1, s[64:67], s76 offen lds
s_waitcnt lgkmcnt(6)
v_mfma_f32_32x32x16_bf16 v[40:55], a[72:75], v[8:11], v[40:55]
ds_read_b64_tr_b16 v[24:25], v4 offset:5120
ds_read_b64_tr_b16 v[26:27], v4 offset:7168
s_waitcnt lgkmcnt(6)
v_mfma_f32_32x32x16_bf16 v[56:71], a[72:75], v[12:15], v[56:71]
ds_read_b64_tr_b16 v[28:29], v5 offset:5120
ds_read_b64_tr_b16 v[30:31], v5 offset:7168
s_add_u32 m0, s83, 114688
s_add_u32 s76, s73, 3670016
buffer_load_dwordx4 v1, s[64:67], s76 offen lds
s_waitcnt lgkmcnt(6)
v_mfma_f32_32x32x16_bf16 v[72:87], a[72:75], v[16:19], v[72:87]
ds_read_b64_tr_b16 v[32:33], v4 offset:13312
ds_read_b64_tr_b16 v[34:35], v4 offset:15360
s_waitcnt lgkmcnt(6)
v_mfma_f32_32x32x16_bf16 v[88:103], a[72:75], v[20:23], v[88:103]
ds_read_b64_tr_b16 v[36:37], v5 offset:13312
ds_read_b64_tr_b16 v[38:39], v5 offset:15360
s_add_u32 m0, s83, 115712
s_add_u32 s76, s73, 3735552
buffer_load_dwordx4 v1, s[64:67], s76 offen lds
s_waitcnt vmcnt(14)
s_barrier
s_waitcnt lgkmcnt(6)
v_mfma_f32_32x32x16_bf16 v[40:55], a[76:79], v[24:27], v[40:55]
ds_read_b64_tr_b16 v[8:9], v4 offset:16384
ds_read_b64_tr_b16 v[10:11], v4 offset:18432
s_waitcnt lgkmcnt(6)
v_mfma_f32_32x32x16_bf16 v[56:71], a[76:79], v[28:31], v[56:71]
ds_read_b64_tr_b16 v[12:13], v5 offset:16384
ds_read_b64_tr_b16 v[14:15], v5 offset:18432
s_add_u32 m0, s83, 122880
s_add_u32 s76, s73, 3670144
buffer_load_dwordx4 v1, s[64:67], s76 offen lds
s_waitcnt lgkmcnt(6)
v_mfma_f32_32x32x16_bf16 v[72:87], a[76:79], v[32:35], v[72:87]
ds_read_b64_tr_b16 v[16:17], v4 offset:24576
ds_read_b64_tr_b16 v[18:19], v4 offset:26624
s_waitcnt lgkmcnt(6)
v_mfma_f32_32x32x16_bf16 v[88:103], a[76:79], v[36:39], v[88:103]
ds_read_b64_tr_b16 v[20:21], v5 offset:24576
ds_read_b64_tr_b16 v[22:23], v5 offset:26624
s_add_u32 m0, s83, 123904
s_add_u32 s76, s73, 3735680
buffer_load_dwordx4 v1, s[64:67], s76 offen lds
s_waitcnt lgkmcnt(6)
v_mfma_f32_32x32x16_bf16 v[40:55], a[80:83], v[8:11], v[40:55]
ds_read_b64_tr_b16 v[24:25], v4 offset:17408
ds_read_b64_tr_b16 v[26:27], v4 offset:19456
s_waitcnt lgkmcnt(6)
v_mfma_f32_32x32x16_bf16 v[56:71], a[80:83], v[12:15], v[56:71]
ds_read_b64_tr_b16 v[28:29], v5 offset:17408
ds_read_b64_tr_b16 v[30:31], v5 offset:19456
s_add_u32 s76, s72, 32768
buffer_load_dwordx4 a[128:131], v0, s[8:11], s76 offen offset:0 sc1
s_waitcnt lgkmcnt(6)
v_mfma_f32_32x32x16_bf16 v[72:87], a[80:83], v[16:19], v[72:87]
ds_read_b64_tr_b16 v[32:33], v4 offset:25600
ds_read_b64_tr_b16 v[34:35], v4 offset:27648
s_waitcnt lgkmcnt(6)
v_mfma_f32_32x32x16_bf16 v[88:103], a[80:83], v[20:23], v[88:103]
ds_read_b64_tr_b16 v[36:37], v5 offset:25600
ds_read_b64_tr_b16 v[38:39], v5 offset:27648
s_add_u32 s76, s72, 32768
buffer_load_dwordx4 a[132:135], v0, s[8:11], s76 offen offset:1024 sc1
s_waitcnt lgkmcnt(6)
v_mfma_f32_32x32x16_bf16 v[40:55], a[84:87], v[24:27], v[40:55]
ds_read_b64_tr_b16 v[8:9], v4 offset:20480
ds_read_b64_tr_b16 v[10:11], v4 offset:22528
s_waitcnt lgkmcnt(6)
v_mfma_f32_32x32x16_bf16 v[56:71], a[84:87], v[28:31], v[56:71]
ds_read_b64_tr_b16 v[12:13], v5 offset:20480
ds_read_b64_tr_b16 v[14:15], v5 offset:22528
s_add_u32 s76, s72, 32768
buffer_load_dwordx4 a[136:139], v0, s[8:11], s76 offen offset:2048 sc1
s_waitcnt lgkmcnt(6)
v_mfma_f32_32x32x16_bf16 v[72:87], a[84:87], v[32:35], v[72:87]
ds_read_b64_tr_b16 v[16:17], v4 offset:28672
ds_read_b64_tr_b16 v[18:19], v4 offset:30720
s_waitcnt lgkmcnt(6)
v_mfma_f32_32x32x16_bf16 v[88:103], a[84:87], v[36:39], v[88:103]
ds_read_b64_tr_b16 v[20:21], v5 offset:28672
ds_read_b64_tr_b16 v[22:23], v5 offset:30720
s_add_u32 s76, s72, 32768
buffer_load_dwordx4 a[140:143], v0, s[8:11], s76 offen offset:3072 sc1
s_waitcnt lgkmcnt(6)
v_mfma_f32_32x32x16_bf16 v[40:55], a[88:91], v[8:11], v[40:55]
ds_read_b64_tr_b16 v[24:25], v4 offset:21504
ds_read_b64_tr_b16 v[26:27], v4 offset:23552
s_waitcnt lgkmcnt(6)
v_mfma_f32_32x32x16_bf16 v[56:71], a[88:91], v[12:15], v[56:71]
ds_read_b64_tr_b16 v[28:29], v5 offset:21504
ds_read_b64_tr_b16 v[30:31], v5 offset:23552
s_add_u32 m0, s83, 131072
s_add_u32 s76, s73, 4194304
buffer_load_dwordx4 v1, s[64:67], s76 offen lds
s_waitcnt lgkmcnt(6)
v_mfma_f32_32x32x16_bf16 v[72:87], a[88:91], v[16:19], v[72:87]
ds_read_b64_tr_b16 v[32:33], v4 offset:29696
ds_read_b64_tr_b16 v[34:35], v4 offset:31744
s_waitcnt lgkmcnt(6)
v_mfma_f32_32x32x16_bf16 v[88:103], a[88:91], v[20:23], v[88:103]
ds_read_b64_tr_b16 v[36:37], v5 offset:29696
ds_read_b64_tr_b16 v[38:39], v5 offset:31744
s_add_u32 m0, s83, 132096
s_add_u32 s76, s73, 4259840
buffer_load_dwordx4 v1, s[64:67], s76 offen lds
s_waitcnt vmcnt(10)
s_barrier
s_waitcnt lgkmcnt(6)
v_mfma_f32_32x32x16_bf16 v[40:55], a[92:95], v[24:27], v[40:55]
ds_read_b64_tr_b16 v[8:9], v4 offset:32768
ds_read_b64_tr_b16 v[10:11], v4 offset:34816
s_waitcnt lgkmcnt(6)
v_mfma_f32_32x32x16_bf16 v[56:71], a[92:95], v[28:31], v[56:71]
ds_read_b64_tr_b16 v[12:13], v5 offset:32768
ds_read_b64_tr_b16 v[14:15], v5 offset:34816
s_add_u32 m0, s83, 139264
s_add_u32 s76, s73, 4194432
buffer_load_dwordx4 v1, s[64:67], s76 offen lds
s_waitcnt lgkmcnt(6)
v_mfma_f32_32x32x16_bf16 v[72:87], a[92:95], v[32:35], v[72:87]
ds_read_b64_tr_b16 v[16:17], v4 offset:40960
ds_read_b64_tr_b16 v[18:19], v4 offset:43008
s_waitcnt lgkmcnt(6)
v_mfma_f32_32x32x16_bf16 v[88:103], a[92:95], v[36:39], v[88:103]
ds_read_b64_tr_b16 v[20:21], v5 offset:40960
ds_read_b64_tr_b16 v[22:23], v5 offset:43008
s_add_u32 m0, s83, 140288
s_add_u32 s76, s73, 4259968
buffer_load_dwordx4 v1, s[64:67], s76 offen lds
s_waitcnt lgkmcnt(6)
v_mfma_f32_32x32x16_bf16 v[40:55], a[96:99], v[8:11], v[40:55]
ds_read_b64_tr_b16 v[24:25], v4 offset:33792
ds_read_b64_tr_b16 v[26:27], v4 offset:35840
s_waitcnt lgkmcnt(6)
v_mfma_f32_32x32x16_bf16 v[56:71], a[96:99], v[12:15], v[56:71]
ds_read_b64_tr_b16 v[28:29], v5 offset:33792
ds_read_b64_tr_b16 v[30:31], v5 offset:35840
s_waitcnt lgkmcnt(6)
v_mfma_f32_32x32x16_bf16 v[72:87], a[96:99], v[16:19], v[72:87]
ds_read_b64_tr_b16 v[32:33], v4 offset:41984
ds_read_b64_tr_b16 v[34:35], v4 offset:44032
s_waitcnt lgkmcnt(6)
v_mfma_f32_32x32x16_bf16 v[88:103], a[96:99], v[20:23], v[88:103]
ds_read_b64_tr_b16 v[36:37], v5 offset:41984
ds_read_b64_tr_b16 v[38:39], v5 offset:44032
s_waitcnt lgkmcnt(6)
v_mfma_f32_32x32x16_bf16 v[40:55], a[100:103], v[24:27], v[40:55]
ds_read_b64_tr_b16 v[8:9], v4 offset:36864
ds_read_b64_tr_b16 v[10:11], v4 offset:38912
s_waitcnt lgkmcnt(6)
v_mfma_f32_32x32x16_bf16 v[56:71], a[100:103], v[28:31], v[56:71]
ds_read_b64_tr_b16 v[12:13], v5 offset:36864
ds_read_b64_tr_b16 v[14:15], v5 offset:38912
s_waitcnt lgkmcnt(6)
v_mfma_f32_32x32x16_bf16 v[72:87], a[100:103], v[32:35], v[72:87]
ds_read_b64_tr_b16 v[16:17], v4 offset:45056
ds_read_b64_tr_b16 v[18:19], v4 offset:47104
s_waitcnt lgkmcnt(6)
v_mfma_f32_32x32x16_bf16 v[88:103], a[100:103], v[36:39], v[88:103]
ds_read_b64_tr_b16 v[20:21], v5 offset:45056
ds_read_b64_tr_b16 v[22:23], v5 offset:47104
s_waitcnt lgkmcnt(6)
v_mfma_f32_32x32x16_bf16 v[40:55], a[104:107], v[8:11], v[40:55]
ds_read_b64_tr_b16 v[24:25], v4 offset:37888
ds_read_b64_tr_b16 v[26:27], v4 offset:39936
s_waitcnt lgkmcnt(6)
v_mfma_f32_32x32x16_bf16 v[56:71], a[104:107], v[12:15], v[56:71]
ds_read_b64_tr_b16 v[28:29], v5 offset:37888
ds_read_b64_tr_b16 v[30:31], v5 offset:39936
s_waitcnt lgkmcnt(6)
v_mfma_f32_32x32x16_bf16 v[72:87], a[104:107], v[16:19], v[72:87]
ds_read_b64_tr_b16 v[32:33], v4 offset:46080
ds_read_b64_tr_b16 v[34:35], v4 offset:48128
s_waitcnt lgkmcnt(6)
v_mfma_f32_32x32x16_bf16 v[88:103], a[104:107], v[20:23], v[88:103]
ds_read_b64_tr_b16 v[36:37], v5 offset:46080
ds_read_b64_tr_b16 v[38:39], v5 offset:48128
s_waitcnt vmcnt(8)
s_barrier
s_waitcnt lgkmcnt(6)
v_mfma_f32_32x32x16_bf16 v[40:55], a[108:111], v[24:27], v[40:55]
ds_read_b64_tr_b16 v[8:9], v4 offset:49152
ds_read_b64_tr_b16 v[10:11], v4 offset:51200
s_waitcnt lgkmcnt(6)
v_mfma_f32_32x32x16_bf16 v[56:71], a[108:111], v[28:31], v[56:71]
ds_read_b64_tr_b16 v[12:13], v5 offset:49152
ds_read_b64_tr_b16 v[14:15], v5 offset:51200
s_waitcnt lgkmcnt(6)
v_mfma_f32_32x32x16_bf16 v[72:87], a[108:111], v[32:35], v[72:87]
ds_read_b64_tr_b16 v[16:17], v4 offset:57344
ds_read_b64_tr_b16 v[18:19], v4 offset:59392
s_waitcnt lgkmcnt(6)
v_mfma_f32_32x32x16_bf16 v[88:103], a[108:111], v[36:39], v[88:103]
ds_read_b64_tr_b16 v[20:21], v5 offset:57344
ds_read_b64_tr_b16 v[22:23], v5 offset:59392
s_waitcnt lgkmcnt(6)
v_mfma_f32_32x32x16_bf16 v[40:55], a[112:115], v[8:11], v[40:55]
ds_read_b64_tr_b16 v[24:25], v4 offset:50176
ds_read_b64_tr_b16 v[26:27], v4 offset:52224
s_waitcnt lgkmcnt(6)
v_mfma_f32_32x32x16_bf16 v[56:71], a[112:115], v[12:15], v[56:71]
ds_read_b64_tr_b16 v[28:29], v5 offset:50176
ds_read_b64_tr_b16 v[30:31], v5 offset:52224
s_waitcnt lgkmcnt(6)
v_mfma_f32_32x32x16_bf16 v[72:87], a[112:115], v[16:19], v[72:87]
ds_read_b64_tr_b16 v[32:33], v4 offset:58368
ds_read_b64_tr_b16 v[34:35], v4 offset:60416
s_waitcnt lgkmcnt(6)
v_mfma_f32_32x32x16_bf16 v[88:103], a[112:115], v[20:23], v[88:103]
ds_read_b64_tr_b16 v[36:37], v5 offset:58368
ds_read_b64_tr_b16 v[38:39], v5 offset:60416
s_waitcnt lgkmcnt(6)
v_mfma_f32_32x32x16_bf16 v[40:55], a[116:119], v[24:27], v[40:55]
ds_read_b64_tr_b16 v[8:9], v4 offset:53248
ds_read_b64_tr_b16 v[10:11], v4 offset:55296
s_waitcnt lgkmcnt(6)
v_mfma_f32_32x32x16_bf16 v[56:71], a[116:119], v[28:31], v[56:71]
ds_read_b64_tr_b16 v[12:13], v5 offset:53248
ds_read_b64_tr_b16 v[14:15], v5 offset:55296
s_waitcnt lgkmcnt(6)
v_mfma_f32_32x32x16_bf16 v[72:87], a[116:119], v[32:35], v[72:87]
ds_read_b64_tr_b16 v[16:17], v4 offset:61440
ds_read_b64_tr_b16 v[18:19], v4 offset:63488
s_waitcnt lgkmcnt(6)
v_mfma_f32_32x32x16_bf16 v[88:103], a[116:119], v[36:39], v[88:103]
ds_read_b64_tr_b16 v[20:21], v5 offset:61440
ds_read_b64_tr_b16 v[22:23], v5 offset:63488
s_waitcnt lgkmcnt(6)
v_mfma_f32_32x32x16_bf16 v[40:55], a[120:123], v[8:11], v[40:55]
ds_read_b64_tr_b16 v[24:25], v4 offset:54272
ds_read_b64_tr_b16 v[26:27], v4 offset:56320
s_waitcnt lgkmcnt(6)
v_mfma_f32_32x32x16_bf16 v[56:71], a[120:123], v[12:15], v[56:71]
ds_read_b64_tr_b16 v[28:29], v5 offset:54272
ds_read_b64_tr_b16 v[30:31], v5 offset:56320
s_waitcnt lgkmcnt(6)
v_mfma_f32_32x32x16_bf16 v[72:87], a[120:123], v[16:19], v[72:87]
ds_read_b64_tr_b16 v[32:33], v4 offset:62464
ds_read_b64_tr_b16 v[34:35], v4 offset:64512
s_waitcnt lgkmcnt(6)
v_mfma_f32_32x32x16_bf16 v[88:103], a[120:123], v[20:23], v[88:103]
ds_read_b64_tr_b16 v[36:37], v5 offset:62464
ds_read_b64_tr_b16 v[38:39], v5 offset:64512
s_waitcnt vmcnt(0)
s_barrier
s_waitcnt lgkmcnt(6)
v_mfma_f32_32x32x16_bf16 v[40:55], a[124:127], v[24:27], v[40:55]
ds_read_b64_tr_b16 v[8:9], v6 offset:0
ds_read_b64_tr_b16 v[10:11], v6 offset:2048
s_waitcnt lgkmcnt(6)
v_mfma_f32_32x32x16_bf16 v[56:71], a[124:127], v[28:31], v[56:71]
ds_read_b64_tr_b16 v[12:13], v7 offset:0
ds_read_b64_tr_b16 v[14:15], v7 offset:2048
s_waitcnt lgkmcnt(6)
v_mfma_f32_32x32x16_bf16 v[72:87], a[124:127], v[32:35], v[72:87]
ds_read_b64_tr_b16 v[16:17], v6 offset:8192
ds_read_b64_tr_b16 v[18:19], v6 offset:10240
s_waitcnt lgkmcnt(6)
v_mfma_f32_32x32x16_bf16 v[88:103], a[124:127], v[36:39], v[88:103]
ds_read_b64_tr_b16 v[20:21], v7 offset:8192
ds_read_b64_tr_b16 v[22:23], v7 offset:10240
s_waitcnt lgkmcnt(6)
v_mfma_f32_32x32x16_bf16 v[40:55], a[128:131], v[8:11], v[40:55]
ds_read_b64_tr_b16 v[24:25], v6 offset:1024
ds_read_b64_tr_b16 v[26:27], v6 offset:3072
s_waitcnt lgkmcnt(6)
v_mfma_f32_32x32x16_bf16 v[56:71], a[128:131], v[12:15], v[56:71]
ds_read_b64_tr_b16 v[28:29], v7 offset:1024
ds_read_b64_tr_b16 v[30:31], v7 offset:3072
s_waitcnt lgkmcnt(6)
v_mfma_f32_32x32x16_bf16 v[72:87], a[128:131], v[16:19], v[72:87]
ds_read_b64_tr_b16 v[32:33], v6 offset:9216
ds_read_b64_tr_b16 v[34:35], v6 offset:11264
s_waitcnt lgkmcnt(6)
v_mfma_f32_32x32x16_bf16 v[88:103], a[128:131], v[20:23], v[88:103]
ds_read_b64_tr_b16 v[36:37], v7 offset:9216
ds_read_b64_tr_b16 v[38:39], v7 offset:11264
s_waitcnt lgkmcnt(6)
v_mfma_f32_32x32x16_bf16 v[40:55], a[132:135], v[24:27], v[40:55]
ds_read_b64_tr_b16 v[8:9], v6 offset:4096
ds_read_b64_tr_b16 v[10:11], v6 offset:6144
s_waitcnt lgkmcnt(6)
v_mfma_f32_32x32x16_bf16 v[56:71], a[132:135], v[28:31], v[56:71]
ds_read_b64_tr_b16 v[12:13], v7 offset:4096
ds_read_b64_tr_b16 v[14:15], v7 offset:6144
s_waitcnt lgkmcnt(6)
v_mfma_f32_32x32x16_bf16 v[72:87], a[132:135], v[32:35], v[72:87]
ds_read_b64_tr_b16 v[16:17], v6 offset:12288
ds_read_b64_tr_b16 v[18:19], v6 offset:14336
s_waitcnt lgkmcnt(6)
v_mfma_f32_32x32x16_bf16 v[88:103], a[132:135], v[36:39], v[88:103]
ds_read_b64_tr_b16 v[20:21], v7 offset:12288
ds_read_b64_tr_b16 v[22:23], v7 offset:14336
s_waitcnt lgkmcnt(6)
v_mfma_f32_32x32x16_bf16 v[40:55], a[136:139], v[8:11], v[40:55]
ds_read_b64_tr_b16 v[24:25], v6 offset:5120
ds_read_b64_tr_b16 v[26:27], v6 offset:7168
s_waitcnt lgkmcnt(6)
v_mfma_f32_32x32x16_bf16 v[56:71], a[136:139], v[12:15], v[56:71]
ds_read_b64_tr_b16 v[28:29], v7 offset:5120
ds_read_b64_tr_b16 v[30:31], v7 offset:7168
s_waitcnt lgkmcnt(6)
v_mfma_f32_32x32x16_bf16 v[72:87], a[136:139], v[16:19], v[72:87]
ds_read_b64_tr_b16 v[32:33], v6 offset:13312
ds_read_b64_tr_b16 v[34:35], v6 offset:15360
s_waitcnt lgkmcnt(6)
v_mfma_f32_32x32x16_bf16 v[88:103], a[136:139], v[20:23], v[88:103]
ds_read_b64_tr_b16 v[36:37], v7 offset:13312
ds_read_b64_tr_b16 v[38:39], v7 offset:15360
s_waitcnt lgkmcnt(6)
v_mfma_f32_32x32x16_bf16 v[40:55], a[140:143], v[24:27], v[40:55]
s_waitcnt lgkmcnt(4)
v_mfma_f32_32x32x16_bf16 v[56:71], a[140:143], v[28:31], v[56:71]
s_waitcnt lgkmcnt(2)
v_mfma_f32_32x32x16_bf16 v[72:87], a[140:143], v[32:35], v[72:87]
s_waitcnt lgkmcnt(0)
v_mfma_f32_32x32x16_bf16 v[88:103], a[140:143], v[36:39], v[88:103]
s_nop 11
s_add_u32 s77, s82, 0
v_cvt_pk_bf16_f32 v106, v40, v41
v_cvt_pk_bf16_f32 v107, v42, v43
v_cvt_pk_bf16_f32 v108, v48, v49
v_cvt_pk_bf16_f32 v109, v50, v51
buffer_store_dwordx4 v[106:109], v104, s[8:11], s77 offen offset:0 sc1
v_cvt_pk_bf16_f32 v110, v44, v45
v_cvt_pk_bf16_f32 v111, v46, v47
v_cvt_pk_bf16_f32 v112, v52, v53
v_cvt_pk_bf16_f32 v113, v54, v55
buffer_store_dwordx4 v[110:113], v104, s[8:11], s77 offen offset:512 sc1
s_add_u32 s77, s82, 2048
v_cvt_pk_bf16_f32 v114, v56, v57
v_cvt_pk_bf16_f32 v115, v58, v59
v_cvt_pk_bf16_f32 v116, v64, v65
v_cvt_pk_bf16_f32 v117, v66, v67
buffer_store_dwordx4 v[114:117], v104, s[8:11], s77 offen offset:0 sc1
v_cvt_pk_bf16_f32 v118, v60, v61
v_cvt_pk_bf16_f32 v119, v62, v63
v_cvt_pk_bf16_f32 v120, v68, v69
v_cvt_pk_bf16_f32 v121, v70, v71
buffer_store_dwordx4 v[118:121], v104, s[8:11], s77 offen offset:512 sc1
s_add_u32 s77, s82, 4096
v_cvt_pk_bf16_f32 v106, v72, v73
v_cvt_pk_bf16_f32 v107, v74, v75
v_cvt_pk_bf16_f32 v108, v80, v81
v_cvt_pk_bf16_f32 v109, v82, v83
buffer_store_dwordx4 v[106:109], v104, s[8:11], s77 offen offset:0 sc1
v_cvt_pk_bf16_f32 v110, v76, v77
v_cvt_pk_bf16_f32 v111, v78, v79
v_cvt_pk_bf16_f32 v112, v84, v85
v_cvt_pk_bf16_f32 v113, v86, v87
buffer_store_dwordx4 v[110:113], v104, s[8:11], s77 offen offset:512 sc1
s_add_u32 s77, s82, 6144
v_cvt_pk_bf16_f32 v114, v88, v89
v_cvt_pk_bf16_f32 v115, v90, v91
v_cvt_pk_bf16_f32 v116, v96, v97
v_cvt_pk_bf16_f32 v117, v98, v99
buffer_store_dwordx4 v[114:117], v104, s[8:11], s77 offen offset:0 sc1
v_cvt_pk_bf16_f32 v118, v92, v93
v_cvt_pk_bf16_f32 v119, v94, v95
v_cvt_pk_bf16_f32 v120, v100, v101
v_cvt_pk_bf16_f32 v121, v102, v103
buffer_store_dwordx4 v[118:121], v104, s[8:11], s77 offen offset:512 sc1
L_a2e_11:
s_branch K_sig
K_warm:
s_sub_u32 s25, s33, 68
s_mul_i32 s25, s25, 30720
s_lshl_b32 s26, s13, 10
s_add_u32 s25, s25, s26
v_lshlrev_b32 v1, 4, v0
s_mov_b32 s64, s86
s_and_b32 s65, s87, 0xffff
s_mov_b32 s66, 4718592
s_mov_b32 s67, 0x20000
s_add_u32 s26, s25, 0
buffer_load_dwordx4 v[16:19], v1, s[64:67], s26 offen
s_add_u32 s26, s25, 4096
buffer_load_dwordx4 v[20:23], v1, s[64:67], s26 offen
s_add_u32 s26, s25, 8192
buffer_load_dwordx4 v[24:27], v1, s[64:67], s26 offen
s_add_u32 s26, s25, 12288
buffer_load_dwordx4 v[28:31], v1, s[64:67], s26 offen
s_add_u32 s26, s25, 16384
buffer_load_dwordx4 v[32:35], v1, s[64:67], s26 offen
s_add_u32 s26, s25, 20480
buffer_load_dwordx4 v[36:39], v1, s[64:67], s26 offen
s_add_u32 s26, s25, 24576
buffer_load_dwordx4 v[40:43], v1, s[64:67], s26 offen
s_add_u32 s26, s25, 28672
buffer_load_dwordx4 v[44:47], v1, s[64:67], s26 offen
s_mov_b32 s64, s88
s_and_b32 s65, s89, 0xffff
s_mov_b32 s66, 4718592
s_mov_b32 s67, 0x20000
s_add_u32 s26, s25, 0
buffer_load_dwordx4 v[16:19], v1, s[64:67], s26 offen
s_add_u32 s26, s25, 4096
buffer_load_dwordx4 v[20:23], v1, s[64:67], s26 offen
s_add_u32 s26, s25, 8192
buffer_load_dwordx4 v[24:27], v1, s[64:67], s26 offen
s_add_u32 s26, s25, 12288
buffer_load_dwordx4 v[28:31], v1, s[64:67], s26 offen
s_add_u32 s26, s25, 16384
buffer_load_dwordx4 v[32:35], v1, s[64:67], s26 offen
s_add_u32 s26, s25, 20480
buffer_load_dwordx4 v[36:39], v1, s[64:67], s26 offen
s_add_u32 s26, s25, 24576
buffer_load_dwordx4 v[40:43], v1, s[64:67], s26 offen
s_add_u32 s26, s25, 28672
buffer_load_dwordx4 v[44:47], v1, s[64:67], s26 offen
s_mov_b32 s64, s92
s_and_b32 s65, s93, 0xffff
s_mov_b32 s66, 4718592
s_mov_b32 s67, 0x20000
s_add_u32 s26, s25, 0
buffer_load_dwordx4 v[16:19], v1, s[64:67], s26 offen
s_add_u32 s26, s25, 4096
buffer_load_dwordx4 v[20:23], v1, s[64:67], s26 offen
s_add_u32 s26, s25, 8192
buffer_load_dwordx4 v[24:27], v1, s[64:67], s26 offen
s_add_u32 s26, s25, 12288
buffer_load_dwordx4 v[28:31], v1, s[64:67], s26 offen
s_add_u32 s26, s25, 16384
buffer_load_dwordx4 v[32:35], v1, s[64:67], s26 offen
s_add_u32 s26, s25, 20480
buffer_load_dwordx4 v[36:39], v1, s[64:67], s26 offen
s_add_u32 s26, s25, 24576
buffer_load_dwordx4 v[40:43], v1, s[64:67], s26 offen
s_add_u32 s26, s25, 28672
buffer_load_dwordx4 v[44:47], v1, s[64:67], s26 offen
s_mov_b32 s64, s90
s_and_b32 s65, s91, 0xffff
s_mov_b32 s66, 4718592
s_mov_b32 s67, 0x20000
s_add_u32 s26, s25, 0
buffer_load_dwordx4 v[16:19], v1, s[64:67], s26 offen
s_add_u32 s26, s25, 4096
buffer_load_dwordx4 v[20:23], v1, s[64:67], s26 offen
s_add_u32 s26, s25, 8192
buffer_load_dwordx4 v[24:27], v1, s[64:67], s26 offen
s_add_u32 s26, s25, 12288
buffer_load_dwordx4 v[28:31], v1, s[64:67], s26 offen
s_add_u32 s26, s25, 16384
buffer_load_dwordx4 v[32:35], v1, s[64:67], s26 offen
s_add_u32 s26, s25, 20480
buffer_load_dwordx4 v[36:39], v1, s[64:67], s26 offen
s_add_u32 s26, s25, 24576
buffer_load_dwordx4 v[40:43], v1, s[64:67], s26 offen
s_add_u32 s26, s25, 28672
buffer_load_dwordx4 v[44:47], v1, s[64:67], s26 offen
s_branch K_pop
K_sig:
s_mov_b32 s50, s47
s_branch K_pop
K_roles:
K_ri:
s_cmp_lt_u32 s33, 32
s_cbranch_scc1 K_rB
s_cmp_lt_u32 s33, 64
s_cbranch_scc1 K_rC4
s_cmp_lt_u32 s33, 72
s_cbranch_scc1 K_rC2
s_cmp_lt_u32 s33, 88
s_cbranch_scc1 K_rL
s_cmp_lt_u32 s33, 160
s_cbranch_scc1 K_rD
s_cmp_lt_u32 s33, 192
s_cbranch_scc1 K_rE4
s_cmp_lt_u32 s33, 200
s_cbranch_scc1 K_rE2
s_cmp_lt_u32 s33, 216
s_cbranch_scc1 K_rF
s_branch K_end
K_rB:
s_mov_b32 s32, 0
RB_g:
s_cmp_eq_u32 s13, 0
s_cbranch_scc0 L_rd_12_b
s_lshl_b32 s25, s32, 7
s_add_u32 s25, s25, 70273024
v_mov_b32 v250, s25
s_mov_b32 s24, 0
L_rd_12:
buffer_load_dword v251, v250, s[8:11], 0 offen sc1
s_waitcnt vmcnt(0)
v_readfirstlane_b32 s25, v251
s_cmp_ge_u32 s25, 128
s_cbranch_scc1 L_rd_12_b
s_cmp_lt_u32 s32, 14
s_cbranch_scc0 L_rd_12_ns
s_sleep 8
L_rd_12_ns:
s_add_u32 s24, s24, 1
s_cmp_lt_u32 s24, 1200000
s_cbranch_scc1 L_rd_12
s_endpgm
L_rd_12_b:
s_barrier
v_mbcnt_lo_u32_b32 v0, -1, 0
v_mbcnt_hi_u32_b32 v0, -1, v0
s_lshl_b32 s25, s32, 7
s_add_u32 s25, s25, 70275072
v_mov_b32 v250, s25
s_mov_b32 s24, 0
L_bq_13:
buffer_load_dword v251, v250, s[8:11], 0 offen sc1
s_waitcnt vmcnt(0)
v_readfirstlane_b32 s25, v251
s_cmp_ge_u32 s25, 32
s_cbranch_scc1 L_bq_13_ok
s_add_u32 s24, s24, 1
s_cmp_lt_u32 s24, 1200000
s_cbranch_scc1 L_bq_13
s_endpgm
L_bq_13_ok:
s_lshr_b32 s20, s33, 3
s_lshl_b32 s25, s32, 2
s_add_u32 s20, s20, s25
s_and_b32 s21, s33, 7
s_lshl_b32 s21, s21, 2
s_add_u32 s21, s21, s13
v_lshlrev_b32 v0, 4, v0
v_bfe_u32 v1, v0, 8, 1
v_lshlrev_b32 v1, 10, v1
v_lshrrev_b32 v2, 9, v0
v_lshl_add_u32 v1, v2, 8, v1
v_and_b32 v2, 0xf0, v0
v_add_u32 v1, v1, v2
v_lshrrev_b32 v3, 9, v0
v_bfe_u32 v4, v0, 4, 5
v_lshlrev_b32 v5, 8, v3
v_lshl_add_u32 v5, v4, 4, v5
v_mov_b32 v6, 0x80000000
v_cmp_gt_u32 vcc, 8, v4
s_nop 1
v_cndmask_b32 v5, v6, v5, vcc
v_lshlrev_b32 v6, 8, v3
v_and_b32 v7, 0xf0, v0
v_add_u32 v6, v6, v7
v_bfe_u32 v7, v0, 8, 1
v_lshl_add_u32 v6, v7, 3, v6
v_lshlrev_b32 v7, 2, v3
v_sub_u32 v7, v4, v7
s_lshl_b32 s76, s20, 5
s_add_u32 s76, s76, s21
s_lshl_b32 s77, s76, 13
s_lshl_b32 s78, s76, 12
s_add_u32 s79, s77, 33554432
s_add_u32 s80, s77, 16777216
s_add_u32 s81, s78, 50331648
s_add_u32 s82, s78, 58720256
s_mov_b32 s22, s79
s_mov_b32 s23, s77
s_mov_b32 s25, s80
buffer_load_dwordx4 v[16:19], v1, s[8:11], s22 offen offset:0 sc1
buffer_load_dwordx4 v[48:51], v1, s[8:11], s23 offen offset:0 sc1
buffer_load_dwordx4 v[112:115], v1, s[8:11], s25 offen offset:0 sc1
s_mov_b32 s22, s79
s_mov_b32 s23, s77
s_mov_b32 s25, s80
buffer_load_dwordx4 v[20:23], v1, s[8:11], s22 offen offset:512 sc1
buffer_load_dwordx4 v[52:55], v1, s[8:11], s23 offen offset:512 sc1
buffer_load_dwordx4 v[116:119], v1, s[8:11], s25 offen offset:512 sc1
s_mov_b32 s22, s79
s_mov_b32 s23, s77
s_mov_b32 s25, s80
buffer_load_dwordx4 v[24:27], v1, s[8:11], s22 offen offset:2048 sc1
buffer_load_dwordx4 v[56:59], v1, s[8:11], s23 offen offset:2048 sc1
buffer_load_dwordx4 v[120:123], v1, s[8:11], s25 offen offset:2048 sc1
s_mov_b32 s22, s79
s_mov_b32 s23, s77
s_mov_b32 s25, s80
buffer_load_dwordx4 v[28:31], v1, s[8:11], s22 offen offset:2560 sc1
buffer_load_dwordx4 v[60:63], v1, s[8:11], s23 offen offset:2560 sc1
buffer_load_dwordx4 v[124:127], v1, s[8:11], s25 offen offset:2560 sc1
s_add_u32 s22, s79, 4096
s_add_u32 s23, s77, 4096
s_add_u32 s25, s80, 4096
buffer_load_dwordx4 v[32:35], v1, s[8:11], s22 offen offset:0 sc1
buffer_load_dwordx4 v[64:67], v1, s[8:11], s23 offen offset:0 sc1
buffer_load_dwordx4 v[128:131], v1, s[8:11], s25 offen offset:0 sc1
s_add_u32 s22, s79, 4096
s_add_u32 s23, s77, 4096
s_add_u32 s25, s80, 4096
buffer_load_dwordx4 v[36:39], v1, s[8:11], s22 offen offset:512 sc1
buffer_load_dwordx4 v[68:71], v1, s[8:11], s23 offen offset:512 sc1
buffer_load_dwordx4 v[132:135], v1, s[8:11], s25 offen offset:512 sc1
s_add_u32 s22, s79, 4096
s_add_u32 s23, s77, 4096
s_add_u32 s25, s80, 4096
buffer_load_dwordx4 v[40:43], v1, s[8:11], s22 offen offset:2048 sc1
buffer_load_dwordx4 v[72:75], v1, s[8:11], s23 offen offset:2048 sc1
buffer_load_dwordx4 v[136:139], v1, s[8:11], s25 offen offset:2048 sc1
s_add_u32 s22, s79, 4096
s_add_u32 s23, s77, 4096
s_add_u32 s25, s80, 4096
buffer_load_dwordx4 v[44:47], v1, s[8:11], s22 offen offset:2560 sc1
buffer_load_dwordx4 v[76:79], v1, s[8:11], s23 offen offset:2560 sc1
buffer_load_dwordx4 v[140:143], v1, s[8:11], s25 offen offset:2560 sc1
s_lshl_b32 s22, s21, 7
s_add_u32 s22, s22, 70385664
v_mov_b32 v8, s22
s_mov_b32 s24, 0
L_rw_14:
buffer_load_dword v9, v8, s[8:11], 0 offen sc1
s_waitcnt vmcnt(0)
v_readfirstlane_b32 s23, v9
s_cmp_gt_u32 s23, s20
s_cbranch_scc1 L_rw_14_ok
s_sleep 8
s_add_u32 s24, s24, 1
s_cmp_lt_u32 s24, 1000000
s_cbranch_scc1 L_rw_14
s_endpgm
L_rw_14_ok:
buffer_load_dwordx4 v[80:83], v5, s[8:11], s81 offen offset:0 sc1
buffer_load_dwordx2 v[144:145], v6, s[8:11], s82 offen offset:0 sc1
buffer_load_dwordx4 v[84:87], v5, s[8:11], s81 offen offset:512 sc1
buffer_load_dwordx2 v[146:147], v6, s[8:11], s82 offen offset:512 sc1
buffer_load_dwordx4 v[88:91], v5, s[8:11], s81 offen offset:1024 sc1
buffer_load_dwordx2 v[148:149], v6, s[8:11], s82 offen offset:1024 sc1
buffer_load_dwordx4 v[92:95], v5, s[8:11], s81 offen offset:1536 sc1
buffer_load_dwordx2 v[150:151], v6, s[8:11], s82 offen offset:1536 sc1
buffer_load_dwordx4 v[96:99], v5, s[8:11], s81 offen offset:2048 sc1
buffer_load_dwordx2 v[152:153], v6, s[8:11], s82 offen offset:2048 sc1
buffer_load_dwordx4 v[100:103], v5, s[8:11], s81 offen offset:2560 sc1
buffer_load_dwordx2 v[154:155], v6, s[8:11], s82 offen offset:2560 sc1
buffer_load_dwordx4 v[104:107], v5, s[8:11], s81 offen offset:3072 sc1
buffer_load_dwordx2 v[156:157], v6, s[8:11], s82 offen offset:3072 sc1
buffer_load_dwordx4 v[108:111], v5, s[8:11], s81 offen offset:3584 sc1
buffer_load_dwordx2 v[158:159], v6, s[8:11], s82 offen offset:3584 sc1
s_waitcnt vmcnt(16)
v_mfma_f32_32x32x16_bf16 v[160:175], v[48:51], v[16:19], 0
v_mfma_f32_32x32x16_bf16 v[160:175], v[52:55], v[20:23], v[160:175]
v_mfma_f32_32x32x16_bf16 v[160:175], v[56:59], v[24:27], v[160:175]
v_mfma_f32_32x32x16_bf16 v[160:175], v[60:63], v[28:31], v[160:175]
v_mfma_f32_32x32x16_bf16 v[160:175], v[64:67], v[32:35], v[160:175]
v_mfma_f32_32x32x16_bf16 v[160:175], v[68:71], v[36:39], v[160:175]
v_mfma_f32_32x32x16_bf16 v[160:175], v[72:75], v[40:43], v[160:175]
v_mfma_f32_32x32x16_bf16 v[160:175], v[76:79], v[44:47], v[160:175]
s_waitcnt vmcnt(0)
v_mfma_f32_32x32x16_bf16 v[176:191], v[80:83], v[16:19], 0
v_mfma_f32_32x32x16_bf16 v[176:191], v[84:87], v[20:23], v[176:191]
v_mfma_f32_32x32x16_bf16 v[176:191], v[88:91], v[24:27], v[176:191]
v_mfma_f32_32x32x16_bf16 v[176:191], v[92:95], v[28:31], v[176:191]
v_mfma_f32_32x32x16_bf16 v[176:191], v[96:99], v[32:35], v[176:191]
v_mfma_f32_32x32x16_bf16 v[176:191], v[100:103], v[36:39], v[176:191]
v_mfma_f32_32x32x16_bf16 v[176:191], v[104:107], v[40:43], v[176:191]
v_mfma_f32_32x32x16_bf16 v[176:191], v[108:111], v[44:47], v[176:191]
s_nop 15
v_mov_b32 v8, 0xff7fffff
v_cmp_gt_i32 vcc, 0, v7
s_nop 1
v_cndmask_b32 v160, v160, v8, vcc
v_cmp_gt_i32 vcc, 1, v7
s_nop 1
v_cndmask_b32 v161, v161, v8, vcc
v_cmp_gt_i32 vcc, 2, v7
s_nop 1
v_cndmask_b32 v162, v162, v8, vcc
v_cmp_gt_i32 vcc, 3, v7
s_nop 1
v_cndmask_b32 v163, v163, v8, vcc
v_cmp_gt_i32 vcc, 8, v7
s_nop 1
v_cndmask_b32 v164, v164, v8, vcc
v_cmp_gt_i32 vcc, 9, v7
s_nop 1
v_cndmask_b32 v165, v165, v8, vcc
v_cmp_gt_i32 vcc, 10, v7
s_nop 1
v_cndmask_b32 v166, v166, v8, vcc
v_cmp_gt_i32 vcc, 11, v7
s_nop 1
v_cndmask_b32 v167, v167, v8, vcc
v_cmp_gt_i32 vcc, 16, v7
s_nop 1
v_cndmask_b32 v168, v168, v8, vcc
v_cmp_gt_i32 vcc, 17, v7
s_nop 1
v_cndmask_b32 v169, v169, v8, vcc
v_cmp_gt_i32 vcc, 18, v7
s_nop 1
v_cndmask_b32 v170, v170, v8, vcc
v_cmp_gt_i32 vcc, 19, v7
s_nop 1
v_cndmask_b32 v171, v171, v8, vcc
v_cmp_gt_i32 vcc, 24, v7
s_nop 1
v_cndmask_b32 v172, v172, v8, vcc
v_cmp_gt_i32 vcc, 25, v7
s_nop 1
v_cndmask_b32 v173, v173, v8, vcc
v_cmp_gt_i32 vcc, 26, v7
s_nop 1
v_cndmask_b32 v174, v174, v8, vcc
v_cmp_gt_i32 vcc, 27, v7
s_nop 1
v_cndmask_b32 v175, v175, v8, vcc
v_max3_f32 v9, v160, v161, v162
v_max3_f32 v9, v9, v163, v164
v_max3_f32 v9, v9, v165, v166
v_max3_f32 v9, v9, v167, v168
v_max3_f32 v9, v9, v169, v170
v_max3_f32 v9, v9, v171, v172
v_max3_f32 v9, v9, v173, v174
v_max3_f32 v9, v9, v175, v176
v_max3_f32 v9, v9, v177, v178
v_max_f32 v9, v9, v179
v_mov_b32 v10, v9
s_nop 1
v_permlane32_swap_b32 v9, v10
v_max_f32 v9, v9, v10
s_mov_b32 s22, 0x3e0293ee
v_mul_f32 v9, s22, v9
v_fma_f32 v160, v160, s22, -v9
v_fma_f32 v161, v161, s22, -v9
v_fma_f32 v162, v162, s22, -v9
v_fma_f32 v163, v163, s22, -v9
v_fma_f32 v164, v164, s22, -v9
v_fma_f32 v165, v165, s22, -v9
v_fma_f32 v166, v166, s22, -v9
v_fma_f32 v167, v167, s22, -v9
v_fma_f32 v168, v168, s22, -v9
v_fma_f32 v169, v169, s22, -v9
v_fma_f32 v170, v170, s22, -v9
v_fma_f32 v171, v171, s22, -v9
v_fma_f32 v172, v172, s22, -v9
v_fma_f32 v173, v173, s22, -v9
v_fma_f32 v174, v174, s22, -v9
v_fma_f32 v175, v175, s22, -v9
v_fma_f32 v176, v176, s22, -v9
v_fma_f32 v177, v177, s22, -v9
v_fma_f32 v178, v178, s22, -v9
v_fma_f32 v179, v179, s22, -v9
v_exp_f32 v160, v160
v_exp_f32 v161, v161
v_exp_f32 v162, v162
v_exp_f32 v163, v163
v_exp_f32 v164, v164
v_exp_f32 v165, v165
v_exp_f32 v166, v166
v_exp_f32 v167, v167
v_exp_f32 v168, v168
v_exp_f32 v169, v169
v_exp_f32 v170, v170
v_exp_f32 v171, v171
v_exp_f32 v172, v172
v_exp_f32 v173, v173
v_exp_f32 v174, v174
v_exp_f32 v175, v175
v_exp_f32 v176, v176
v_exp_f32 v177, v177
v_exp_f32 v178, v178
v_exp_f32 v179, v179
s_nop 0
v_add_f32 v10, v160, v161
v_add_f32 v10, v10, v162
v_add_f32 v10, v10, v163
v_add_f32 v10, v10, v164
v_add_f32 v10, v10, v165
v_add_f32 v10, v10, v166
v_add_f32 v10, v10, v167
v_add_f32 v10, v10, v168
v_add_f32 v10, v10, v169
v_add_f32 v10, v10, v170
v_add_f32 v10, v10, v171
v_add_f32 v10, v10, v172
v_add_f32 v10, v10, v173
v_add_f32 v10, v10, v174
v_add_f32 v10, v10, v175
v_add_f32 v10, v10, v176
v_add_f32 v10, v10, v177
v_add_f32 v10, v10, v178
v_add_f32 v10, v10, v179
v_mov_b32 v11, v10
s_nop 1
v_permlane32_swap_b32 v10, v11
v_add_f32 v10, v10, v11
v_rcp_f32 v10, v10
v_cvt_pk_bf16_f32 v16, v160, v161
v_cvt_pk_bf16_f32 v17, v162, v163
v_cvt_pk_bf16_f32 v18, v168, v169
v_cvt_pk_bf16_f32 v19, v170, v171
v_cvt_pk_bf16_f32 v20, v164, v165
v_cvt_pk_bf16_f32 v21, v166, v167
v_cvt_pk_bf16_f32 v22, v172, v173
v_cvt_pk_bf16_f32 v23, v174, v175
v_cvt_pk_bf16_f32 v24, v176, v177
v_cvt_pk_bf16_f32 v25, v178, v179
s_waitcnt vmcnt(0)
s_nop 1
v_mfma_f32_32x32x8_bf16 v[192:207], v[144:145], v[24:25], 0
v_mfma_f32_32x32x8_bf16 v[208:223], v[148:149], v[24:25], 0
v_mfma_f32_32x32x8_bf16 v[224:239], v[152:153], v[24:25], 0
v_mfma_f32_32x32x8_bf16 v[240:255], v[156:157], v[24:25], 0
v_mfma_f32_32x32x8_bf16 v[192:207], v[146:147], v[24:25], v[192:207]
v_mfma_f32_32x32x8_bf16 v[208:223], v[150:151], v[24:25], v[208:223]
v_mfma_f32_32x32x8_bf16 v[224:239], v[154:155], v[24:25], v[224:239]
v_mfma_f32_32x32x8_bf16 v[240:255], v[158:159], v[24:25], v[240:255]
s_nop 7
v_mfma_f32_32x32x16_bf16 v[192:207], v[112:115], v[16:19], v[192:207]
v_mfma_f32_32x32x16_bf16 v[208:223], v[120:123], v[16:19], v[208:223]
v_mfma_f32_32x32x16_bf16 v[224:239], v[128:131], v[16:19], v[224:239]
v_mfma_f32_32x32x16_bf16 v[240:255], v[136:139], v[16:19], v[240:255]
v_mfma_f32_32x32x16_bf16 v[192:207], v[116:119], v[20:23], v[192:207]
v_mfma_f32_32x32x16_bf16 v[208:223], v[124:127], v[20:23], v[208:223]
v_mfma_f32_32x32x16_bf16 v[224:239], v[132:135], v[20:23], v[224:239]
v_mfma_f32_32x32x16_bf16 v[240:255], v[140:143], v[20:23], v[240:255]
s_nop 15
s_mul_i32 s22, s20, 262144
s_lshl_b32 s23, s21, 13
s_add_u32 s22, s22, s23
s_add_u32 s22, s22, 76546048
v_mul_f32 v192, v10, v192
v_mul_f32 v193, v10, v193
v_mul_f32 v194, v10, v194
v_mul_f32 v195, v10, v195
v_mul_f32 v196, v10, v196
v_mul_f32 v197, v10, v197
v_mul_f32 v198, v10, v198
v_mul_f32 v199, v10, v199
v_mul_f32 v200, v10, v200
v_mul_f32 v201, v10, v201
v_mul_f32 v202, v10, v202
v_mul_f32 v203, v10, v203
v_mul_f32 v204, v10, v204
v_mul_f32 v205, v10, v205
v_mul_f32 v206, v10, v206
v_mul_f32 v207, v10, v207
s_add_u32 s23, s22, 0
v_cvt_pk_bf16_f32 v48, v192, v193
v_cvt_pk_bf16_f32 v49, v194, v195
v_cvt_pk_bf16_f32 v50, v200, v201
v_cvt_pk_bf16_f32 v51, v202, v203
buffer_store_dwordx4 v[48:51], v0, s[8:11], s23 offen offset:0 sc1
v_cvt_pk_bf16_f32 v52, v196, v197
v_cvt_pk_bf16_f32 v53, v198, v199
v_cvt_pk_bf16_f32 v54, v204, v205
v_cvt_pk_bf16_f32 v55, v206, v207
buffer_store_dwordx4 v[52:55], v0, s[8:11], s23 offen offset:1024 sc1
v_mul_f32 v208, v10, v208
v_mul_f32 v209, v10, v209
v_mul_f32 v210, v10, v210
v_mul_f32 v211, v10, v211
v_mul_f32 v212, v10, v212
v_mul_f32 v213, v10, v213
v_mul_f32 v214, v10, v214
v_mul_f32 v215, v10, v215
v_mul_f32 v216, v10, v216
v_mul_f32 v217, v10, v217
v_mul_f32 v218, v10, v218
v_mul_f32 v219, v10, v219
v_mul_f32 v220, v10, v220
v_mul_f32 v221, v10, v221
v_mul_f32 v222, v10, v222
v_mul_f32 v223, v10, v223
s_add_u32 s23, s22, 2048
v_cvt_pk_bf16_f32 v56, v208, v209
v_cvt_pk_bf16_f32 v57, v210, v211
v_cvt_pk_bf16_f32 v58, v216, v217
v_cvt_pk_bf16_f32 v59, v218, v219
buffer_store_dwordx4 v[56:59], v0, s[8:11], s23 offen offset:0 sc1
v_cvt_pk_bf16_f32 v60, v212, v213
v_cvt_pk_bf16_f32 v61, v214, v215
v_cvt_pk_bf16_f32 v62, v220, v221
v_cvt_pk_bf16_f32 v63, v222, v223
buffer_store_dwordx4 v[60:63], v0, s[8:11], s23 offen offset:1024 sc1
v_mul_f32 v224, v10, v224
v_mul_f32 v225, v10, v225
v_mul_f32 v226, v10, v226
v_mul_f32 v227, v10, v227
v_mul_f32 v228, v10, v228
v_mul_f32 v229, v10, v229
v_mul_f32 v230, v10, v230
v_mul_f32 v231, v10, v231
v_mul_f32 v232, v10, v232
v_mul_f32 v233, v10, v233
v_mul_f32 v234, v10, v234
v_mul_f32 v235, v10, v235
v_mul_f32 v236, v10, v236
v_mul_f32 v237, v10, v237
v_mul_f32 v238, v10, v238
v_mul_f32 v239, v10, v239
s_add_u32 s23, s22, 4096
v_cvt_pk_bf16_f32 v64, v224, v225
v_cvt_pk_bf16_f32 v65, v226, v227
v_cvt_pk_bf16_f32 v66, v232, v233
v_cvt_pk_bf16_f32 v67, v234, v235
buffer_store_dwordx4 v[64:67], v0, s[8:11], s23 offen offset:0 sc1
v_cvt_pk_bf16_f32 v68, v228, v229
v_cvt_pk_bf16_f32 v69, v230, v231
v_cvt_pk_bf16_f32 v70, v236, v237
v_cvt_pk_bf16_f32 v71, v238, v239
buffer_store_dwordx4 v[68:71], v0, s[8:11], s23 offen offset:1024 sc1
v_mul_f32 v240, v10, v240
v_mul_f32 v241, v10, v241
v_mul_f32 v242, v10, v242
v_mul_f32 v243, v10, v243
v_mul_f32 v244, v10, v244
v_mul_f32 v245, v10, v245
v_mul_f32 v246, v10, v246
v_mul_f32 v247, v10, v247
v_mul_f32 v248, v10, v248
v_mul_f32 v249, v10, v249
v_mul_f32 v250, v10, v250
v_mul_f32 v251, v10, v251
v_mul_f32 v252, v10, v252
v_mul_f32 v253, v10, v253
v_mul_f32 v254, v10, v254
v_mul_f32 v255, v10, v255
s_add_u32 s23, s22, 6144
v_cvt_pk_bf16_f32 v72, v240, v241
v_cvt_pk_bf16_f32 v73, v242, v243
v_cvt_pk_bf16_f32 v74, v248, v249
v_cvt_pk_bf16_f32 v75, v250, v251
buffer_store_dwordx4 v[72:75], v0, s[8:11], s23 offen offset:0 sc1
v_cvt_pk_bf16_f32 v76, v244, v245
v_cvt_pk_bf16_f32 v77, v246, v247
v_cvt_pk_bf16_f32 v78, v252, v253
v_cvt_pk_bf16_f32 v79, v254, v255
buffer_store_dwordx4 v[76:79], v0, s[8:11], s23 offen offset:1024 sc1
s_waitcnt vmcnt(0) lgkmcnt(0)
s_barrier
s_cmp_eq_u32 s13, 0
s_cbranch_scc0 L_rs_15
s_lshl_b32 s25, s32, 7
s_add_u32 s25, s25, 70279168
v_mov_b32 v250, s25
v_mov_b32 v251, 1
s_mov_b64 exec, 1
buffer_atomic_add v251, v250, s[8:11], 0 offen
s_mov_b64 exec, -1
L_rs_15:
s_add_u32 s32, s32, 1
s_cmp_lt_u32 s32, 16
s_cbranch_scc1 RB_g
s_branch K_end
K_rC4:
v_mbcnt_lo_u32_b32 v0, -1, 0
v_mbcnt_hi_u32_b32 v0, -1, v0
s_sub_u32 s25, s33, 32
s_lshr_b32 s28, s25, 3
s_lshl_b32 s28, s28, 2
s_and_b32 s23, s25, 7
v_lshrrev_b32 v10, 3, v0
v_and_b32 v11, 7, v0
v_bfe_u32 v12, v0, 4, 1
v_lshlrev_b32 v12, 2, v12
v_xor_b32 v11, v11, v12
s_mov_b32 s76, 1152
v_mul_lo_u32 v1, v10, s76
v_lshl_add_u32 v1, v11, 4, v1
v_lshrrev_b32 v10, 5, v0
v_bfe_u32 v11, v0, 2, 2
v_lshl_add_u32 v10, v10, 2, v11
v_lshlrev_b32 v10, 7, v10
v_bfe_u32 v12, v0, 4, 1
v_lshl_add_u32 v10, v12, 5, v10
v_and_b32 v12, 3, v0
v_lshl_add_u32 v10, v12, 3, v10
v_lshrrev_b32 v11, 1, v11
v_lshlrev_b32 v11, 6, v11
v_add_u32 v2, v10, v11
v_xor_b32 v11, 64, v11
v_add_u32 v3, v10, v11
v_add_u32 v4, 0x10000, v2
v_add_u32 v5, 0x10000, v3
v_add_u32 v6, 0x20000, v2
v_add_u32 v7, 0x20000, v3
v_lshlrev_b32 v0, 4, v0
s_mov_b32 s64, s92
s_and_b32 s65, s93, 0xffff
s_mov_b32 s66, 4718592
s_mov_b32 s67, 0x20000
s_mul_i32 s73, s23, 589824
s_lshl_b32 s76, s28, 6
s_add_u32 s73, s73, s76
s_mul_i32 s76, s13, 18432
s_add_u32 s73, s73, s76
s_lshl_b32 s83, s13, 11
s_add_u32 m0, s83, 0
s_add_u32 s76, s73, 0
buffer_load_dwordx4 v1, s[64:67], s76 offen lds
s_add_u32 m0, s83, 1024
s_add_u32 s76, s73, 9216
buffer_load_dwordx4 v1, s[64:67], s76 offen lds
s_add_u32 m0, s83, 8192
s_add_u32 s76, s73, 128
buffer_load_dwordx4 v1, s[64:67], s76 offen lds
s_add_u32 m0, s83, 9216
s_add_u32 s76, s73, 9344
buffer_load_dwordx4 v1, s[64:67], s76 offen lds
s_add_u32 m0, s83, 16384
s_add_u32 s76, s73, 73728
buffer_load_dwordx4 v1, s[64:67], s76 offen lds
s_add_u32 m0, s83, 17408
s_add_u32 s76, s73, 82944
buffer_load_dwordx4 v1, s[64:67], s76 offen lds
s_add_u32 m0, s83, 24576
s_add_u32 s76, s73, 73856
buffer_load_dwordx4 v1, s[64:67], s76 offen lds
s_add_u32 m0, s83, 25600
s_add_u32 s76, s73, 83072
buffer_load_dwordx4 v1, s[64:67], s76 offen lds
s_add_u32 m0, s83, 32768
s_add_u32 s76, s73, 147456
buffer_load_dwordx4 v1, s[64:67], s76 offen lds
s_add_u32 m0, s83, 33792
s_add_u32 s76, s73, 156672
buffer_load_dwordx4 v1, s[64:67], s76 offen lds
s_add_u32 m0, s83, 40960
s_add_u32 s76, s73, 147584
buffer_load_dwordx4 v1, s[64:67], s76 offen lds
s_add_u32 m0, s83, 41984
s_add_u32 s76, s73, 156800
buffer_load_dwordx4 v1, s[64:67], s76 offen lds
s_add_u32 m0, s83, 49152
s_add_u32 s76, s73, 221184
buffer_load_dwordx4 v1, s[64:67], s76 offen lds
s_add_u32 m0, s83, 50176
s_add_u32 s76, s73, 230400
buffer_load_dwordx4 v1, s[64:67], s76 offen lds
s_add_u32 m0, s83, 57344
s_add_u32 s76, s73, 221312
buffer_load_dwordx4 v1, s[64:67], s76 offen lds
s_add_u32 m0, s83, 58368
s_add_u32 s76, s73, 230528
buffer_load_dwordx4 v1, s[64:67], s76 offen lds
s_add_u32 m0, s83, 65536
s_add_u32 s76, s73, 294912
buffer_load_dwordx4 v1, s[64:67], s76 offen lds
s_add_u32 m0, s83, 66560
s_add_u32 s76, s73, 304128
buffer_load_dwordx4 v1, s[64:67], s76 offen lds
s_add_u32 m0, s83, 73728
s_add_u32 s76, s73, 295040
buffer_load_dwordx4 v1, s[64:67], s76 offen lds
s_add_u32 m0, s83, 74752
s_add_u32 s76, s73, 304256
buffer_load_dwordx4 v1, s[64:67], s76 offen lds
s_add_u32 m0, s83, 81920
s_add_u32 s76, s73, 368640
buffer_load_dwordx4 v1, s[64:67], s76 offen lds
s_add_u32 m0, s83, 82944
s_add_u32 s76, s73, 377856
buffer_load_dwordx4 v1, s[64:67], s76 offen lds
s_add_u32 m0, s83, 90112
s_add_u32 s76, s73, 368768
buffer_load_dwordx4 v1, s[64:67], s76 offen lds
s_add_u32 m0, s83, 91136
s_add_u32 s76, s73, 377984
buffer_load_dwordx4 v1, s[64:67], s76 offen lds
s_add_u32 m0, s83, 98304
s_add_u32 s76, s73, 442368
buffer_load_dwordx4 v1, s[64:67], s76 offen lds
s_add_u32 m0, s83, 99328
s_add_u32 s76, s73, 451584
buffer_load_dwordx4 v1, s[64:67], s76 offen lds
s_add_u32 m0, s83, 106496
s_add_u32 s76, s73, 442496
buffer_load_dwordx4 v1, s[64:67], s76 offen lds
s_add_u32 m0, s83, 107520
s_add_u32 s76, s73, 451712
buffer_load_dwordx4 v1, s[64:67], s76 offen lds
s_add_u32 m0, s83, 114688
s_add_u32 s76, s73, 516096
buffer_load_dwordx4 v1, s[64:67], s76 offen lds
s_add_u32 m0, s83, 115712
s_add_u32 s76, s73, 525312
buffer_load_dwordx4 v1, s[64:67], s76 offen lds
s_add_u32 m0, s83, 122880
s_add_u32 s76, s73, 516224
buffer_load_dwordx4 v1, s[64:67], s76 offen lds
s_add_u32 m0, s83, 123904
s_add_u32 s76, s73, 525440
buffer_load_dwordx4 v1, s[64:67], s76 offen lds
s_waitcnt vmcnt(0)
s_barrier
s_mov_b32 s32, 0
RC4_g:
s_cmp_eq_u32 s13, 0
s_cbranch_scc0 L_rd_16_b
s_lshl_b32 s25, s32, 7
s_add_u32 s25, s25, 70279168
v_mov_b32 v250, s25
s_mov_b32 s24, 0
L_rd_16:
buffer_load_dword v251, v250, s[8:11], 0 offen sc1
s_waitcnt vmcnt(0)
v_readfirstlane_b32 s25, v251
s_cmp_ge_u32 s25, 32
s_cbranch_scc1 L_rd_16_b
s_cmp_lt_u32 s32, 14
s_cbranch_scc0 L_rd_16_ns
s_sleep 8
L_rd_16_ns:
s_add_u32 s24, s24, 1
s_cmp_lt_u32 s24, 1200000
s_cbranch_scc1 L_rd_16
s_endpgm
L_rd_16_b:
s_barrier
s_lshl_b32 s29, s32, 2
s_add_u32 s29, s29, s13
s_mul_i32 s72, s29, 262144
s_mul_i32 s76, s23, 32768
s_add_u32 s72, s72, s76
s_add_u32 s72, s72, 76546048
s_lshl_b32 s82, s23, 6
s_add_u32 s82, s82, s29
s_mul_i32 s82, s82, 18
s_add_u32 s82, s82, s28
s_lshl_b32 s82, s82, 12
s_add_u32 s82, s82, 121634816
s_add_u32 s76, s72, 0
buffer_load_dwordx4 a[0:3], v0, s[8:11], s76 offen offset:0 sc1
buffer_load_dwordx4 a[4:7], v0, s[8:11], s76 offen offset:1024 sc1
buffer_load_dwordx4 a[8:11], v0, s[8:11], s76 offen offset:2048 sc1
buffer_load_dwordx4 a[12:15], v0, s[8:11], s76 offen offset:3072 sc1
s_add_u32 s76, s72, 4096
buffer_load_dwordx4 a[16:19], v0, s[8:11], s76 offen offset:0 sc1
buffer_load_dwordx4 a[20:23], v0, s[8:11], s76 offen offset:1024 sc1
buffer_load_dwordx4 a[24:27], v0, s[8:11], s76 offen offset:2048 sc1
buffer_load_dwordx4 a[28:31], v0, s[8:11], s76 offen offset:3072 sc1
s_add_u32 s76, s72, 8192
buffer_load_dwordx4 a[32:35], v0, s[8:11], s76 offen offset:0 sc1
buffer_load_dwordx4 a[36:39], v0, s[8:11], s76 offen offset:1024 sc1
buffer_load_dwordx4 a[40:43], v0, s[8:11], s76 offen offset:2048 sc1
buffer_load_dwordx4 a[44:47], v0, s[8:11], s76 offen offset:3072 sc1
s_add_u32 s76, s72, 12288
buffer_load_dwordx4 a[48:51], v0, s[8:11], s76 offen offset:0 sc1
buffer_load_dwordx4 a[52:55], v0, s[8:11], s76 offen offset:1024 sc1
buffer_load_dwordx4 a[56:59], v0, s[8:11], s76 offen offset:2048 sc1
buffer_load_dwordx4 a[60:63], v0, s[8:11], s76 offen offset:3072 sc1
s_add_u32 s76, s72, 16384
buffer_load_dwordx4 a[64:67], v0, s[8:11], s76 offen offset:0 sc1
buffer_load_dwordx4 a[68:71], v0, s[8:11], s76 offen offset:1024 sc1
buffer_load_dwordx4 a[72:75], v0, s[8:11], s76 offen offset:2048 sc1
buffer_load_dwordx4 a[76:79], v0, s[8:11], s76 offen offset:3072 sc1
s_add_u32 s76, s72, 20480
buffer_load_dwordx4 a[80:83], v0, s[8:11], s76 offen offset:0 sc1
buffer_load_dwordx4 a[84:87], v0, s[8:11], s76 offen offset:1024 sc1
buffer_load_dwordx4 a[88:91], v0, s[8:11], s76 offen offset:2048 sc1
buffer_load_dwordx4 a[92:95], v0, s[8:11], s76 offen offset:3072 sc1
s_add_u32 s76, s72, 24576
buffer_load_dwordx4 a[96:99], v0, s[8:11], s76 offen offset:0 sc1
buffer_load_dwordx4 a[100:103], v0, s[8:11], s76 offen offset:1024 sc1
buffer_load_dwordx4 a[104:107], v0, s[8:11], s76 offen offset:2048 sc1
buffer_load_dwordx4 a[108:111], v0, s[8:11], s76 offen offset:3072 sc1
s_add_u32 s76, s72, 28672
buffer_load_dwordx4 a[112:115], v0, s[8:11], s76 offen offset:0 sc1
buffer_load_dwordx4 a[116:119], v0, s[8:11], s76 offen offset:1024 sc1
buffer_load_dwordx4 a[120:123], v0, s[8:11], s76 offen offset:2048 sc1
buffer_load_dwordx4 a[124:127], v0, s[8:11], s76 offen offset:3072 sc1
ds_read_b64_tr_b16 v[8:9], v2 offset:0
ds_read_b64_tr_b16 v[10:11], v2 offset:2048
ds_read_b64_tr_b16 v[12:13], v3 offset:0
ds_read_b64_tr_b16 v[14:15], v3 offset:2048
ds_read_b64_tr_b16 v[16:17], v2 offset:8192
ds_read_b64_tr_b16 v[18:19], v2 offset:10240
ds_read_b64_tr_b16 v[20:21], v3 offset:8192
ds_read_b64_tr_b16 v[22:23], v3 offset:10240
s_waitcnt vmcnt(31)
s_waitcnt lgkmcnt(6)
v_mfma_f32_32x32x16_bf16 v[40:55], v[8:11], a[0:3], 0
ds_read_b64_tr_b16 v[24:25], v2 offset:1024
ds_read_b64_tr_b16 v[26:27], v2 offset:3072
s_waitcnt lgkmcnt(6)
v_mfma_f32_32x32x16_bf16 v[56:71], v[12:15], a[0:3], 0
ds_read_b64_tr_b16 v[28:29], v3 offset:1024
ds_read_b64_tr_b16 v[30:31], v3 offset:3072
s_waitcnt lgkmcnt(6)
v_mfma_f32_32x32x16_bf16 v[72:87], v[16:19], a[0:3], 0
ds_read_b64_tr_b16 v[32:33], v2 offset:9216
ds_read_b64_tr_b16 v[34:35], v2 offset:11264
s_waitcnt lgkmcnt(6)
v_mfma_f32_32x32x16_bf16 v[88:103], v[20:23], a[0:3], 0
ds_read_b64_tr_b16 v[36:37], v3 offset:9216
ds_read_b64_tr_b16 v[38:39], v3 offset:11264
s_waitcnt vmcnt(30)
s_waitcnt lgkmcnt(6)
v_mfma_f32_32x32x16_bf16 v[40:55], v[24:27], a[4:7], v[40:55]
ds_read_b64_tr_b16 v[8:9], v2 offset:4096
ds_read_b64_tr_b16 v[10:11], v2 offset:6144
s_waitcnt lgkmcnt(6)
v_mfma_f32_32x32x16_bf16 v[56:71], v[28:31], a[4:7], v[56:71]
ds_read_b64_tr_b16 v[12:13], v3 offset:4096
ds_read_b64_tr_b16 v[14:15], v3 offset:6144
s_waitcnt lgkmcnt(6)
v_mfma_f32_32x32x16_bf16 v[72:87], v[32:35], a[4:7], v[72:87]
ds_read_b64_tr_b16 v[16:17], v2 offset:12288
ds_read_b64_tr_b16 v[18:19], v2 offset:14336
s_waitcnt lgkmcnt(6)
v_mfma_f32_32x32x16_bf16 v[88:103], v[36:39], a[4:7], v[88:103]
ds_read_b64_tr_b16 v[20:21], v3 offset:12288
ds_read_b64_tr_b16 v[22:23], v3 offset:14336
s_waitcnt vmcnt(29)
s_waitcnt lgkmcnt(6)
v_mfma_f32_32x32x16_bf16 v[40:55], v[8:11], a[8:11], v[40:55]
ds_read_b64_tr_b16 v[24:25], v2 offset:5120
ds_read_b64_tr_b16 v[26:27], v2 offset:7168
s_waitcnt lgkmcnt(6)
v_mfma_f32_32x32x16_bf16 v[56:71], v[12:15], a[8:11], v[56:71]
ds_read_b64_tr_b16 v[28:29], v3 offset:5120
ds_read_b64_tr_b16 v[30:31], v3 offset:7168
s_waitcnt lgkmcnt(6)
v_mfma_f32_32x32x16_bf16 v[72:87], v[16:19], a[8:11], v[72:87]
ds_read_b64_tr_b16 v[32:33], v2 offset:13312
ds_read_b64_tr_b16 v[34:35], v2 offset:15360
s_waitcnt lgkmcnt(6)
v_mfma_f32_32x32x16_bf16 v[88:103], v[20:23], a[8:11], v[88:103]
ds_read_b64_tr_b16 v[36:37], v3 offset:13312
ds_read_b64_tr_b16 v[38:39], v3 offset:15360
s_waitcnt vmcnt(28)
s_waitcnt lgkmcnt(6)
v_mfma_f32_32x32x16_bf16 v[40:55], v[24:27], a[12:15], v[40:55]
ds_read_b64_tr_b16 v[8:9], v2 offset:16384
ds_read_b64_tr_b16 v[10:11], v2 offset:18432
s_waitcnt lgkmcnt(6)
v_mfma_f32_32x32x16_bf16 v[56:71], v[28:31], a[12:15], v[56:71]
ds_read_b64_tr_b16 v[12:13], v3 offset:16384
ds_read_b64_tr_b16 v[14:15], v3 offset:18432
s_waitcnt lgkmcnt(6)
v_mfma_f32_32x32x16_bf16 v[72:87], v[32:35], a[12:15], v[72:87]
ds_read_b64_tr_b16 v[16:17], v2 offset:24576
ds_read_b64_tr_b16 v[18:19], v2 offset:26624
s_waitcnt lgkmcnt(6)
v_mfma_f32_32x32x16_bf16 v[88:103], v[36:39], a[12:15], v[88:103]
ds_read_b64_tr_b16 v[20:21], v3 offset:24576
ds_read_b64_tr_b16 v[22:23], v3 offset:26624
s_waitcnt vmcnt(27)
s_waitcnt lgkmcnt(6)
v_mfma_f32_32x32x16_bf16 v[40:55], v[8:11], a[16:19], v[40:55]
ds_read_b64_tr_b16 v[24:25], v2 offset:17408
ds_read_b64_tr_b16 v[26:27], v2 offset:19456
s_waitcnt lgkmcnt(6)
v_mfma_f32_32x32x16_bf16 v[56:71], v[12:15], a[16:19], v[56:71]
ds_read_b64_tr_b16 v[28:29], v3 offset:17408
ds_read_b64_tr_b16 v[30:31], v3 offset:19456
s_waitcnt lgkmcnt(6)
v_mfma_f32_32x32x16_bf16 v[72:87], v[16:19], a[16:19], v[72:87]
ds_read_b64_tr_b16 v[32:33], v2 offset:25600
ds_read_b64_tr_b16 v[34:35], v2 offset:27648
s_waitcnt lgkmcnt(6)
v_mfma_f32_32x32x16_bf16 v[88:103], v[20:23], a[16:19], v[88:103]
ds_read_b64_tr_b16 v[36:37], v3 offset:25600
ds_read_b64_tr_b16 v[38:39], v3 offset:27648
s_waitcnt vmcnt(26)
s_waitcnt lgkmcnt(6)
v_mfma_f32_32x32x16_bf16 v[40:55], v[24:27], a[20:23], v[40:55]
ds_read_b64_tr_b16 v[8:9], v2 offset:20480
ds_read_b64_tr_b16 v[10:11], v2 offset:22528
s_waitcnt lgkmcnt(6)
v_mfma_f32_32x32x16_bf16 v[56:71], v[28:31], a[20:23], v[56:71]
ds_read_b64_tr_b16 v[12:13], v3 offset:20480
ds_read_b64_tr_b16 v[14:15], v3 offset:22528
s_waitcnt lgkmcnt(6)
v_mfma_f32_32x32x16_bf16 v[72:87], v[32:35], a[20:23], v[72:87]
ds_read_b64_tr_b16 v[16:17], v2 offset:28672
ds_read_b64_tr_b16 v[18:19], v2 offset:30720
s_waitcnt lgkmcnt(6)
v_mfma_f32_32x32x16_bf16 v[88:103], v[36:39], a[20:23], v[88:103]
ds_read_b64_tr_b16 v[20:21], v3 offset:28672
ds_read_b64_tr_b16 v[22:23], v3 offset:30720
s_waitcnt vmcnt(25)
s_waitcnt lgkmcnt(6)
v_mfma_f32_32x32x16_bf16 v[40:55], v[8:11], a[24:27], v[40:55]
ds_read_b64_tr_b16 v[24:25], v2 offset:21504
ds_read_b64_tr_b16 v[26:27], v2 offset:23552
s_waitcnt lgkmcnt(6)
v_mfma_f32_32x32x16_bf16 v[56:71], v[12:15], a[24:27], v[56:71]
ds_read_b64_tr_b16 v[28:29], v3 offset:21504
ds_read_b64_tr_b16 v[30:31], v3 offset:23552
s_waitcnt lgkmcnt(6)
v_mfma_f32_32x32x16_bf16 v[72:87], v[16:19], a[24:27], v[72:87]
ds_read_b64_tr_b16 v[32:33], v2 offset:29696
ds_read_b64_tr_b16 v[34:35], v2 offset:31744
s_waitcnt lgkmcnt(6)
v_mfma_f32_32x32x16_bf16 v[88:103], v[20:23], a[24:27], v[88:103]
ds_read_b64_tr_b16 v[36:37], v3 offset:29696
ds_read_b64_tr_b16 v[38:39], v3 offset:31744
s_waitcnt vmcnt(24)
s_waitcnt lgkmcnt(6)
v_mfma_f32_32x32x16_bf16 v[40:55], v[24:27], a[28:31], v[40:55]
ds_read_b64_tr_b16 v[8:9], v2 offset:32768
ds_read_b64_tr_b16 v[10:11], v2 offset:34816
s_waitcnt lgkmcnt(6)
v_mfma_f32_32x32x16_bf16 v[56:71], v[28:31], a[28:31], v[56:71]
ds_read_b64_tr_b16 v[12:13], v3 offset:32768
ds_read_b64_tr_b16 v[14:15], v3 offset:34816
s_waitcnt lgkmcnt(6)
v_mfma_f32_32x32x16_bf16 v[72:87], v[32:35], a[28:31], v[72:87]
ds_read_b64_tr_b16 v[16:17], v2 offset:40960
ds_read_b64_tr_b16 v[18:19], v2 offset:43008
s_waitcnt lgkmcnt(6)
v_mfma_f32_32x32x16_bf16 v[88:103], v[36:39], a[28:31], v[88:103]
ds_read_b64_tr_b16 v[20:21], v3 offset:40960
ds_read_b64_tr_b16 v[22:23], v3 offset:43008
s_waitcnt vmcnt(23)
s_waitcnt lgkmcnt(6)
v_mfma_f32_32x32x16_bf16 v[40:55], v[8:11], a[32:35], v[40:55]
ds_read_b64_tr_b16 v[24:25], v2 offset:33792
ds_read_b64_tr_b16 v[26:27], v2 offset:35840
s_waitcnt lgkmcnt(6)
v_mfma_f32_32x32x16_bf16 v[56:71], v[12:15], a[32:35], v[56:71]
ds_read_b64_tr_b16 v[28:29], v3 offset:33792
ds_read_b64_tr_b16 v[30:31], v3 offset:35840
s_waitcnt lgkmcnt(6)
v_mfma_f32_32x32x16_bf16 v[72:87], v[16:19], a[32:35], v[72:87]
ds_read_b64_tr_b16 v[32:33], v2 offset:41984
ds_read_b64_tr_b16 v[34:35], v2 offset:44032
s_waitcnt lgkmcnt(6)
v_mfma_f32_32x32x16_bf16 v[88:103], v[20:23], a[32:35], v[88:103]
ds_read_b64_tr_b16 v[36:37], v3 offset:41984
ds_read_b64_tr_b16 v[38:39], v3 offset:44032
s_waitcnt vmcnt(22)
s_waitcnt lgkmcnt(6)
v_mfma_f32_32x32x16_bf16 v[40:55], v[24:27], a[36:39], v[40:55]
ds_read_b64_tr_b16 v[8:9], v2 offset:36864
ds_read_b64_tr_b16 v[10:11], v2 offset:38912
s_waitcnt lgkmcnt(6)
v_mfma_f32_32x32x16_bf16 v[56:71], v[28:31], a[36:39], v[56:71]
ds_read_b64_tr_b16 v[12:13], v3 offset:36864
ds_read_b64_tr_b16 v[14:15], v3 offset:38912
s_waitcnt lgkmcnt(6)
v_mfma_f32_32x32x16_bf16 v[72:87], v[32:35], a[36:39], v[72:87]
ds_read_b64_tr_b16 v[16:17], v2 offset:45056
ds_read_b64_tr_b16 v[18:19], v2 offset:47104
s_waitcnt lgkmcnt(6)
v_mfma_f32_32x32x16_bf16 v[88:103], v[36:39], a[36:39], v[88:103]
ds_read_b64_tr_b16 v[20:21], v3 offset:45056
ds_read_b64_tr_b16 v[22:23], v3 offset:47104
s_waitcnt vmcnt(21)
s_waitcnt lgkmcnt(6)
v_mfma_f32_32x32x16_bf16 v[40:55], v[8:11], a[40:43], v[40:55]
ds_read_b64_tr_b16 v[24:25], v2 offset:37888
ds_read_b64_tr_b16 v[26:27], v2 offset:39936
s_waitcnt lgkmcnt(6)
v_mfma_f32_32x32x16_bf16 v[56:71], v[12:15], a[40:43], v[56:71]
ds_read_b64_tr_b16 v[28:29], v3 offset:37888
ds_read_b64_tr_b16 v[30:31], v3 offset:39936
s_waitcnt lgkmcnt(6)
v_mfma_f32_32x32x16_bf16 v[72:87], v[16:19], a[40:43], v[72:87]
ds_read_b64_tr_b16 v[32:33], v2 offset:46080
ds_read_b64_tr_b16 v[34:35], v2 offset:48128
s_waitcnt lgkmcnt(6)
v_mfma_f32_32x32x16_bf16 v[88:103], v[20:23], a[40:43], v[88:103]
ds_read_b64_tr_b16 v[36:37], v3 offset:46080
ds_read_b64_tr_b16 v[38:39], v3 offset:48128
s_waitcnt vmcnt(20)
s_waitcnt lgkmcnt(6)
v_mfma_f32_32x32x16_bf16 v[40:55], v[24:27], a[44:47], v[40:55]
ds_read_b64_tr_b16 v[8:9], v2 offset:49152
ds_read_b64_tr_b16 v[10:11], v2 offset:51200
s_waitcnt lgkmcnt(6)
v_mfma_f32_32x32x16_bf16 v[56:71], v[28:31], a[44:47], v[56:71]
ds_read_b64_tr_b16 v[12:13], v3 offset:49152
ds_read_b64_tr_b16 v[14:15], v3 offset:51200
s_waitcnt lgkmcnt(6)
v_mfma_f32_32x32x16_bf16 v[72:87], v[32:35], a[44:47], v[72:87]
ds_read_b64_tr_b16 v[16:17], v2 offset:57344
ds_read_b64_tr_b16 v[18:19], v2 offset:59392
s_waitcnt lgkmcnt(6)
v_mfma_f32_32x32x16_bf16 v[88:103], v[36:39], a[44:47], v[88:103]
ds_read_b64_tr_b16 v[20:21], v3 offset:57344
ds_read_b64_tr_b16 v[22:23], v3 offset:59392
s_waitcnt vmcnt(19)
s_waitcnt lgkmcnt(6)
v_mfma_f32_32x32x16_bf16 v[40:55], v[8:11], a[48:51], v[40:55]
ds_read_b64_tr_b16 v[24:25], v2 offset:50176
ds_read_b64_tr_b16 v[26:27], v2 offset:52224
s_waitcnt lgkmcnt(6)
v_mfma_f32_32x32x16_bf16 v[56:71], v[12:15], a[48:51], v[56:71]
ds_read_b64_tr_b16 v[28:29], v3 offset:50176
ds_read_b64_tr_b16 v[30:31], v3 offset:52224
s_waitcnt lgkmcnt(6)
v_mfma_f32_32x32x16_bf16 v[72:87], v[16:19], a[48:51], v[72:87]
ds_read_b64_tr_b16 v[32:33], v2 offset:58368
ds_read_b64_tr_b16 v[34:35], v2 offset:60416
s_waitcnt lgkmcnt(6)
v_mfma_f32_32x32x16_bf16 v[88:103], v[20:23], a[48:51], v[88:103]
ds_read_b64_tr_b16 v[36:37], v3 offset:58368
ds_read_b64_tr_b16 v[38:39], v3 offset:60416
s_waitcnt vmcnt(18)
s_waitcnt lgkmcnt(6)
v_mfma_f32_32x32x16_bf16 v[40:55], v[24:27], a[52:55], v[40:55]
ds_read_b64_tr_b16 v[8:9], v2 offset:53248
ds_read_b64_tr_b16 v[10:11], v2 offset:55296
s_waitcnt lgkmcnt(6)
v_mfma_f32_32x32x16_bf16 v[56:71], v[28:31], a[52:55], v[56:71]
ds_read_b64_tr_b16 v[12:13], v3 offset:53248
ds_read_b64_tr_b16 v[14:15], v3 offset:55296
s_waitcnt lgkmcnt(6)
v_mfma_f32_32x32x16_bf16 v[72:87], v[32:35], a[52:55], v[72:87]
ds_read_b64_tr_b16 v[16:17], v2 offset:61440
ds_read_b64_tr_b16 v[18:19], v2 offset:63488
s_waitcnt lgkmcnt(6)
v_mfma_f32_32x32x16_bf16 v[88:103], v[36:39], a[52:55], v[88:103]
ds_read_b64_tr_b16 v[20:21], v3 offset:61440
ds_read_b64_tr_b16 v[22:23], v3 offset:63488
s_waitcnt vmcnt(17)
s_waitcnt lgkmcnt(6)
v_mfma_f32_32x32x16_bf16 v[40:55], v[8:11], a[56:59], v[40:55]
ds_read_b64_tr_b16 v[24:25], v2 offset:54272
ds_read_b64_tr_b16 v[26:27], v2 offset:56320
s_waitcnt lgkmcnt(6)
v_mfma_f32_32x32x16_bf16 v[56:71], v[12:15], a[56:59], v[56:71]
ds_read_b64_tr_b16 v[28:29], v3 offset:54272
ds_read_b64_tr_b16 v[30:31], v3 offset:56320
s_waitcnt lgkmcnt(6)
v_mfma_f32_32x32x16_bf16 v[72:87], v[16:19], a[56:59], v[72:87]
ds_read_b64_tr_b16 v[32:33], v2 offset:62464
ds_read_b64_tr_b16 v[34:35], v2 offset:64512
s_waitcnt lgkmcnt(6)
v_mfma_f32_32x32x16_bf16 v[88:103], v[20:23], a[56:59], v[88:103]
ds_read_b64_tr_b16 v[36:37], v3 offset:62464
ds_read_b64_tr_b16 v[38:39], v3 offset:64512
s_waitcnt vmcnt(16)
s_waitcnt lgkmcnt(6)
v_mfma_f32_32x32x16_bf16 v[40:55], v[24:27], a[60:63], v[40:55]
ds_read_b64_tr_b16 v[8:9], v4 offset:0
ds_read_b64_tr_b16 v[10:11], v4 offset:2048
s_waitcnt lgkmcnt(6)
v_mfma_f32_32x32x16_bf16 v[56:71], v[28:31], a[60:63], v[56:71]
ds_read_b64_tr_b16 v[12:13], v5 offset:0
ds_read_b64_tr_b16 v[14:15], v5 offset:2048
s_waitcnt lgkmcnt(6)
v_mfma_f32_32x32x16_bf16 v[72:87], v[32:35], a[60:63], v[72:87]
ds_read_b64_tr_b16 v[16:17], v4 offset:8192
ds_read_b64_tr_b16 v[18:19], v4 offset:10240
s_waitcnt lgkmcnt(6)
v_mfma_f32_32x32x16_bf16 v[88:103], v[36:39], a[60:63], v[88:103]
ds_read_b64_tr_b16 v[20:21], v5 offset:8192
ds_read_b64_tr_b16 v[22:23], v5 offset:10240
s_waitcnt vmcnt(15)
s_waitcnt lgkmcnt(6)
v_mfma_f32_32x32x16_bf16 v[40:55], v[8:11], a[64:67], v[40:55]
ds_read_b64_tr_b16 v[24:25], v4 offset:1024
ds_read_b64_tr_b16 v[26:27], v4 offset:3072
s_waitcnt lgkmcnt(6)
v_mfma_f32_32x32x16_bf16 v[56:71], v[12:15], a[64:67], v[56:71]
ds_read_b64_tr_b16 v[28:29], v5 offset:1024
ds_read_b64_tr_b16 v[30:31], v5 offset:3072
s_waitcnt lgkmcnt(6)
v_mfma_f32_32x32x16_bf16 v[72:87], v[16:19], a[64:67], v[72:87]
ds_read_b64_tr_b16 v[32:33], v4 offset:9216
ds_read_b64_tr_b16 v[34:35], v4 offset:11264
s_waitcnt lgkmcnt(6)
v_mfma_f32_32x32x16_bf16 v[88:103], v[20:23], a[64:67], v[88:103]
ds_read_b64_tr_b16 v[36:37], v5 offset:9216
ds_read_b64_tr_b16 v[38:39], v5 offset:11264
s_waitcnt vmcnt(14)
s_waitcnt lgkmcnt(6)
v_mfma_f32_32x32x16_bf16 v[40:55], v[24:27], a[68:71], v[40:55]
ds_read_b64_tr_b16 v[8:9], v4 offset:4096
ds_read_b64_tr_b16 v[10:11], v4 offset:6144
s_waitcnt lgkmcnt(6)
v_mfma_f32_32x32x16_bf16 v[56:71], v[28:31], a[68:71], v[56:71]
ds_read_b64_tr_b16 v[12:13], v5 offset:4096
ds_read_b64_tr_b16 v[14:15], v5 offset:6144
s_waitcnt lgkmcnt(6)
v_mfma_f32_32x32x16_bf16 v[72:87], v[32:35], a[68:71], v[72:87]
ds_read_b64_tr_b16 v[16:17], v4 offset:12288
ds_read_b64_tr_b16 v[18:19], v4 offset:14336
s_waitcnt lgkmcnt(6)
v_mfma_f32_32x32x16_bf16 v[88:103], v[36:39], a[68:71], v[88:103]
ds_read_b64_tr_b16 v[20:21], v5 offset:12288
ds_read_b64_tr_b16 v[22:23], v5 offset:14336
s_waitcnt vmcnt(13)
s_waitcnt lgkmcnt(6)
v_mfma_f32_32x32x16_bf16 v[40:55], v[8:11], a[72:75], v[40:55]
ds_read_b64_tr_b16 v[24:25], v4 offset:5120
ds_read_b64_tr_b16 v[26:27], v4 offset:7168
s_waitcnt lgkmcnt(6)
v_mfma_f32_32x32x16_bf16 v[56:71], v[12:15], a[72:75], v[56:71]
ds_read_b64_tr_b16 v[28:29], v5 offset:5120
ds_read_b64_tr_b16 v[30:31], v5 offset:7168
s_waitcnt lgkmcnt(6)
v_mfma_f32_32x32x16_bf16 v[72:87], v[16:19], a[72:75], v[72:87]
ds_read_b64_tr_b16 v[32:33], v4 offset:13312
ds_read_b64_tr_b16 v[34:35], v4 offset:15360
s_waitcnt lgkmcnt(6)
v_mfma_f32_32x32x16_bf16 v[88:103], v[20:23], a[72:75], v[88:103]
ds_read_b64_tr_b16 v[36:37], v5 offset:13312
ds_read_b64_tr_b16 v[38:39], v5 offset:15360
s_waitcnt vmcnt(12)
s_waitcnt lgkmcnt(6)
v_mfma_f32_32x32x16_bf16 v[40:55], v[24:27], a[76:79], v[40:55]
ds_read_b64_tr_b16 v[8:9], v4 offset:16384
ds_read_b64_tr_b16 v[10:11], v4 offset:18432
s_waitcnt lgkmcnt(6)
v_mfma_f32_32x32x16_bf16 v[56:71], v[28:31], a[76:79], v[56:71]
ds_read_b64_tr_b16 v[12:13], v5 offset:16384
ds_read_b64_tr_b16 v[14:15], v5 offset:18432
s_waitcnt lgkmcnt(6)
v_mfma_f32_32x32x16_bf16 v[72:87], v[32:35], a[76:79], v[72:87]
ds_read_b64_tr_b16 v[16:17], v4 offset:24576
ds_read_b64_tr_b16 v[18:19], v4 offset:26624
s_waitcnt lgkmcnt(6)
v_mfma_f32_32x32x16_bf16 v[88:103], v[36:39], a[76:79], v[88:103]
ds_read_b64_tr_b16 v[20:21], v5 offset:24576
ds_read_b64_tr_b16 v[22:23], v5 offset:26624
s_waitcnt vmcnt(11)
s_waitcnt lgkmcnt(6)
v_mfma_f32_32x32x16_bf16 v[40:55], v[8:11], a[80:83], v[40:55]
ds_read_b64_tr_b16 v[24:25], v4 offset:17408
ds_read_b64_tr_b16 v[26:27], v4 offset:19456
s_waitcnt lgkmcnt(6)
v_mfma_f32_32x32x16_bf16 v[56:71], v[12:15], a[80:83], v[56:71]
ds_read_b64_tr_b16 v[28:29], v5 offset:17408
ds_read_b64_tr_b16 v[30:31], v5 offset:19456
s_waitcnt lgkmcnt(6)
v_mfma_f32_32x32x16_bf16 v[72:87], v[16:19], a[80:83], v[72:87]
ds_read_b64_tr_b16 v[32:33], v4 offset:25600
ds_read_b64_tr_b16 v[34:35], v4 offset:27648
s_waitcnt lgkmcnt(6)
v_mfma_f32_32x32x16_bf16 v[88:103], v[20:23], a[80:83], v[88:103]
ds_read_b64_tr_b16 v[36:37], v5 offset:25600
ds_read_b64_tr_b16 v[38:39], v5 offset:27648
s_waitcnt vmcnt(10)
s_waitcnt lgkmcnt(6)
v_mfma_f32_32x32x16_bf16 v[40:55], v[24:27], a[84:87], v[40:55]
ds_read_b64_tr_b16 v[8:9], v4 offset:20480
ds_read_b64_tr_b16 v[10:11], v4 offset:22528
s_waitcnt lgkmcnt(6)
v_mfma_f32_32x32x16_bf16 v[56:71], v[28:31], a[84:87], v[56:71]
ds_read_b64_tr_b16 v[12:13], v5 offset:20480
ds_read_b64_tr_b16 v[14:15], v5 offset:22528
s_waitcnt lgkmcnt(6)
v_mfma_f32_32x32x16_bf16 v[72:87], v[32:35], a[84:87], v[72:87]
ds_read_b64_tr_b16 v[16:17], v4 offset:28672
ds_read_b64_tr_b16 v[18:19], v4 offset:30720
s_waitcnt lgkmcnt(6)
v_mfma_f32_32x32x16_bf16 v[88:103], v[36:39], a[84:87], v[88:103]
ds_read_b64_tr_b16 v[20:21], v5 offset:28672
ds_read_b64_tr_b16 v[22:23], v5 offset:30720
s_waitcnt vmcnt(9)
s_waitcnt lgkmcnt(6)
v_mfma_f32_32x32x16_bf16 v[40:55], v[8:11], a[88:91], v[40:55]
ds_read_b64_tr_b16 v[24:25], v4 offset:21504
ds_read_b64_tr_b16 v[26:27], v4 offset:23552
s_waitcnt lgkmcnt(6)
v_mfma_f32_32x32x16_bf16 v[56:71], v[12:15], a[88:91], v[56:71]
ds_read_b64_tr_b16 v[28:29], v5 offset:21504
ds_read_b64_tr_b16 v[30:31], v5 offset:23552
s_waitcnt lgkmcnt(6)
v_mfma_f32_32x32x16_bf16 v[72:87], v[16:19], a[88:91], v[72:87]
ds_read_b64_tr_b16 v[32:33], v4 offset:29696
ds_read_b64_tr_b16 v[34:35], v4 offset:31744
s_waitcnt lgkmcnt(6)
v_mfma_f32_32x32x16_bf16 v[88:103], v[20:23], a[88:91], v[88:103]
ds_read_b64_tr_b16 v[36:37], v5 offset:29696
ds_read_b64_tr_b16 v[38:39], v5 offset:31744
s_waitcnt vmcnt(8)
s_waitcnt lgkmcnt(6)
v_mfma_f32_32x32x16_bf16 v[40:55], v[24:27], a[92:95], v[40:55]
ds_read_b64_tr_b16 v[8:9], v4 offset:32768
ds_read_b64_tr_b16 v[10:11], v4 offset:34816
s_waitcnt lgkmcnt(6)
v_mfma_f32_32x32x16_bf16 v[56:71], v[28:31], a[92:95], v[56:71]
ds_read_b64_tr_b16 v[12:13], v5 offset:32768
ds_read_b64_tr_b16 v[14:15], v5 offset:34816
s_waitcnt lgkmcnt(6)
v_mfma_f32_32x32x16_bf16 v[72:87], v[32:35], a[92:95], v[72:87]
ds_read_b64_tr_b16 v[16:17], v4 offset:40960
ds_read_b64_tr_b16 v[18:19], v4 offset:43008
s_waitcnt lgkmcnt(6)
v_mfma_f32_32x32x16_bf16 v[88:103], v[36:39], a[92:95], v[88:103]
ds_read_b64_tr_b16 v[20:21], v5 offset:40960
ds_read_b64_tr_b16 v[22:23], v5 offset:43008
s_waitcnt vmcnt(7)
s_waitcnt lgkmcnt(6)
v_mfma_f32_32x32x16_bf16 v[40:55], v[8:11], a[96:99], v[40:55]
ds_read_b64_tr_b16 v[24:25], v4 offset:33792
ds_read_b64_tr_b16 v[26:27], v4 offset:35840
s_waitcnt lgkmcnt(6)
v_mfma_f32_32x32x16_bf16 v[56:71], v[12:15], a[96:99], v[56:71]
ds_read_b64_tr_b16 v[28:29], v5 offset:33792
ds_read_b64_tr_b16 v[30:31], v5 offset:35840
s_waitcnt lgkmcnt(6)
v_mfma_f32_32x32x16_bf16 v[72:87], v[16:19], a[96:99], v[72:87]
ds_read_b64_tr_b16 v[32:33], v4 offset:41984
ds_read_b64_tr_b16 v[34:35], v4 offset:44032
s_waitcnt lgkmcnt(6)
v_mfma_f32_32x32x16_bf16 v[88:103], v[20:23], a[96:99], v[88:103]
ds_read_b64_tr_b16 v[36:37], v5 offset:41984
ds_read_b64_tr_b16 v[38:39], v5 offset:44032
s_waitcnt vmcnt(6)
s_waitcnt lgkmcnt(6)
v_mfma_f32_32x32x16_bf16 v[40:55], v[24:27], a[100:103], v[40:55]
ds_read_b64_tr_b16 v[8:9], v4 offset:36864
ds_read_b64_tr_b16 v[10:11], v4 offset:38912
s_waitcnt lgkmcnt(6)
v_mfma_f32_32x32x16_bf16 v[56:71], v[28:31], a[100:103], v[56:71]
ds_read_b64_tr_b16 v[12:13], v5 offset:36864
ds_read_b64_tr_b16 v[14:15], v5 offset:38912
s_waitcnt lgkmcnt(6)
v_mfma_f32_32x32x16_bf16 v[72:87], v[32:35], a[100:103], v[72:87]
ds_read_b64_tr_b16 v[16:17], v4 offset:45056
ds_read_b64_tr_b16 v[18:19], v4 offset:47104
s_waitcnt lgkmcnt(6)
v_mfma_f32_32x32x16_bf16 v[88:103], v[36:39], a[100:103], v[88:103]
ds_read_b64_tr_b16 v[20:21], v5 offset:45056
ds_read_b64_tr_b16 v[22:23], v5 offset:47104
s_waitcnt vmcnt(5)
s_waitcnt lgkmcnt(6)
v_mfma_f32_32x32x16_bf16 v[40:55], v[8:11], a[104:107], v[40:55]
ds_read_b64_tr_b16 v[24:25], v4 offset:37888
ds_read_b64_tr_b16 v[26:27], v4 offset:39936
s_waitcnt lgkmcnt(6)
v_mfma_f32_32x32x16_bf16 v[56:71], v[12:15], a[104:107], v[56:71]
ds_read_b64_tr_b16 v[28:29], v5 offset:37888
ds_read_b64_tr_b16 v[30:31], v5 offset:39936
s_waitcnt lgkmcnt(6)
v_mfma_f32_32x32x16_bf16 v[72:87], v[16:19], a[104:107], v[72:87]
ds_read_b64_tr_b16 v[32:33], v4 offset:46080
ds_read_b64_tr_b16 v[34:35], v4 offset:48128
s_waitcnt lgkmcnt(6)
v_mfma_f32_32x32x16_bf16 v[88:103], v[20:23], a[104:107], v[88:103]
ds_read_b64_tr_b16 v[36:37], v5 offset:46080
ds_read_b64_tr_b16 v[38:39], v5 offset:48128
s_waitcnt vmcnt(4)
s_waitcnt lgkmcnt(6)
v_mfma_f32_32x32x16_bf16 v[40:55], v[24:27], a[108:111], v[40:55]
ds_read_b64_tr_b16 v[8:9], v4 offset:49152
ds_read_b64_tr_b16 v[10:11], v4 offset:51200
s_waitcnt lgkmcnt(6)
v_mfma_f32_32x32x16_bf16 v[56:71], v[28:31], a[108:111], v[56:71]
ds_read_b64_tr_b16 v[12:13], v5 offset:49152
ds_read_b64_tr_b16 v[14:15], v5 offset:51200
s_waitcnt lgkmcnt(6)
v_mfma_f32_32x32x16_bf16 v[72:87], v[32:35], a[108:111], v[72:87]
ds_read_b64_tr_b16 v[16:17], v4 offset:57344
ds_read_b64_tr_b16 v[18:19], v4 offset:59392
s_waitcnt lgkmcnt(6)
v_mfma_f32_32x32x16_bf16 v[88:103], v[36:39], a[108:111], v[88:103]
ds_read_b64_tr_b16 v[20:21], v5 offset:57344
ds_read_b64_tr_b16 v[22:23], v5 offset:59392
s_waitcnt vmcnt(3)
s_waitcnt lgkmcnt(6)
v_mfma_f32_32x32x16_bf16 v[40:55], v[8:11], a[112:115], v[40:55]
ds_read_b64_tr_b16 v[24:25], v4 offset:50176
ds_read_b64_tr_b16 v[26:27], v4 offset:52224
s_waitcnt lgkmcnt(6)
v_mfma_f32_32x32x16_bf16 v[56:71], v[12:15], a[112:115], v[56:71]
ds_read_b64_tr_b16 v[28:29], v5 offset:50176
ds_read_b64_tr_b16 v[30:31], v5 offset:52224
s_waitcnt lgkmcnt(6)
v_mfma_f32_32x32x16_bf16 v[72:87], v[16:19], a[112:115], v[72:87]
ds_read_b64_tr_b16 v[32:33], v4 offset:58368
ds_read_b64_tr_b16 v[34:35], v4 offset:60416
s_waitcnt lgkmcnt(6)
v_mfma_f32_32x32x16_bf16 v[88:103], v[20:23], a[112:115], v[88:103]
ds_read_b64_tr_b16 v[36:37], v5 offset:58368
ds_read_b64_tr_b16 v[38:39], v5 offset:60416
s_waitcnt vmcnt(2)
s_waitcnt lgkmcnt(6)
v_mfma_f32_32x32x16_bf16 v[40:55], v[24:27], a[116:119], v[40:55]
ds_read_b64_tr_b16 v[8:9], v4 offset:53248
ds_read_b64_tr_b16 v[10:11], v4 offset:55296
s_waitcnt lgkmcnt(6)
v_mfma_f32_32x32x16_bf16 v[56:71], v[28:31], a[116:119], v[56:71]
ds_read_b64_tr_b16 v[12:13], v5 offset:53248
ds_read_b64_tr_b16 v[14:15], v5 offset:55296
s_waitcnt lgkmcnt(6)
v_mfma_f32_32x32x16_bf16 v[72:87], v[32:35], a[116:119], v[72:87]
ds_read_b64_tr_b16 v[16:17], v4 offset:61440
ds_read_b64_tr_b16 v[18:19], v4 offset:63488
s_waitcnt lgkmcnt(6)
v_mfma_f32_32x32x16_bf16 v[88:103], v[36:39], a[116:119], v[88:103]
ds_read_b64_tr_b16 v[20:21], v5 offset:61440
ds_read_b64_tr_b16 v[22:23], v5 offset:63488
s_waitcnt vmcnt(1)
s_waitcnt lgkmcnt(6)
v_mfma_f32_32x32x16_bf16 v[40:55], v[8:11], a[120:123], v[40:55]
ds_read_b64_tr_b16 v[24:25], v4 offset:54272
ds_read_b64_tr_b16 v[26:27], v4 offset:56320
s_waitcnt lgkmcnt(6)
v_mfma_f32_32x32x16_bf16 v[56:71], v[12:15], a[120:123], v[56:71]
ds_read_b64_tr_b16 v[28:29], v5 offset:54272
ds_read_b64_tr_b16 v[30:31], v5 offset:56320
s_waitcnt lgkmcnt(6)
v_mfma_f32_32x32x16_bf16 v[72:87], v[16:19], a[120:123], v[72:87]
ds_read_b64_tr_b16 v[32:33], v4 offset:62464
ds_read_b64_tr_b16 v[34:35], v4 offset:64512
s_waitcnt lgkmcnt(6)
v_mfma_f32_32x32x16_bf16 v[88:103], v[20:23], a[120:123], v[88:103]
ds_read_b64_tr_b16 v[36:37], v5 offset:62464
ds_read_b64_tr_b16 v[38:39], v5 offset:64512
s_waitcnt vmcnt(0)
s_waitcnt lgkmcnt(6)
v_mfma_f32_32x32x16_bf16 v[40:55], v[24:27], a[124:127], v[40:55]
s_waitcnt lgkmcnt(4)
v_mfma_f32_32x32x16_bf16 v[56:71], v[28:31], a[124:127], v[56:71]
s_waitcnt lgkmcnt(2)
v_mfma_f32_32x32x16_bf16 v[72:87], v[32:35], a[124:127], v[72:87]
s_waitcnt lgkmcnt(0)
v_mfma_f32_32x32x16_bf16 v[88:103], v[36:39], a[124:127], v[88:103]
s_nop 11
s_add_u32 s77, s82, 0
buffer_store_dwordx4 v[40:43], v0, s[8:11], s77 offen offset:0 sc1
buffer_store_dwordx4 v[44:47], v0, s[8:11], s77 offen offset:1024 sc1
buffer_store_dwordx4 v[48:51], v0, s[8:11], s77 offen offset:2048 sc1
buffer_store_dwordx4 v[52:55], v0, s[8:11], s77 offen offset:3072 sc1
s_add_u32 s77, s82, 4096
buffer_store_dwordx4 v[56:59], v0, s[8:11], s77 offen offset:0 sc1
buffer_store_dwordx4 v[60:63], v0, s[8:11], s77 offen offset:1024 sc1
buffer_store_dwordx4 v[64:67], v0, s[8:11], s77 offen offset:2048 sc1
buffer_store_dwordx4 v[68:71], v0, s[8:11], s77 offen offset:3072 sc1
s_add_u32 s77, s82, 8192
buffer_store_dwordx4 v[72:75], v0, s[8:11], s77 offen offset:0 sc1
buffer_store_dwordx4 v[76:79], v0, s[8:11], s77 offen offset:1024 sc1
buffer_store_dwordx4 v[80:83], v0, s[8:11], s77 offen offset:2048 sc1
buffer_store_dwordx4 v[84:87], v0, s[8:11], s77 offen offset:3072 sc1
s_add_u32 s77, s82, 12288
buffer_store_dwordx4 v[88:91], v0, s[8:11], s77 offen offset:0 sc1
buffer_store_dwordx4 v[92:95], v0, s[8:11], s77 offen offset:1024 sc1
buffer_store_dwordx4 v[96:99], v0, s[8:11], s77 offen offset:2048 sc1
buffer_store_dwordx4 v[100:103], v0, s[8:11], s77 offen offset:3072 sc1
s_waitcnt vmcnt(0) lgkmcnt(0)
s_barrier
s_cmp_eq_u32 s13, 0
s_cbranch_scc0 L_rs_17
s_lshl_b32 s25, s32, 7
s_add_u32 s25, s25, 70281216
v_mov_b32 v250, s25
v_mov_b32 v251, 1
s_mov_b64 exec, 1
buffer_atomic_add v251, v250, s[8:11], 0 offen
s_mov_b64 exec, -1
L_rs_17:
s_add_u32 s32, s32, 1
s_cmp_lt_u32 s32, 16
s_cbranch_scc1 RC4_g
s_branch K_end
K_rC2:
v_mbcnt_lo_u32_b32 v0, -1, 0
v_mbcnt_hi_u32_b32 v0, -1, v0
s_mov_b32 s28, 16
s_sub_u32 s23, s33, 64
v_lshrrev_b32 v10, 3, v0
v_and_b32 v11, 7, v0
v_bfe_u32 v12, v0, 4, 1
v_lshlrev_b32 v12, 2, v12
v_xor_b32 v11, v11, v12
s_mov_b32 s76, 1152
v_mul_lo_u32 v1, v10, s76
v_lshl_add_u32 v1, v11, 4, v1
v_lshrrev_b32 v10, 5, v0
v_bfe_u32 v11, v0, 2, 2
v_lshl_add_u32 v10, v10, 2, v11
v_lshlrev_b32 v10, 7, v10
v_bfe_u32 v12, v0, 4, 1
v_lshl_add_u32 v10, v12, 5, v10
v_and_b32 v12, 3, v0
v_lshl_add_u32 v10, v12, 3, v10
v_lshrrev_b32 v11, 1, v11
v_lshlrev_b32 v11, 6, v11
v_add_u32 v2, v10, v11
v_xor_b32 v11, 64, v11
v_add_u32 v3, v10, v11
v_add_u32 v4, 0x10000, v2
v_add_u32 v5, 0x10000, v3
v_add_u32 v6, 0x20000, v2
v_add_u32 v7, 0x20000, v3
v_lshlrev_b32 v0, 4, v0
s_mov_b32 s64, s92
s_and_b32 s65, s93, 0xffff
s_mov_b32 s66, 4718592
s_mov_b32 s67, 0x20000
s_mul_i32 s73, s23, 589824
s_lshl_b32 s76, s28, 6
s_add_u32 s73, s73, s76
s_mul_i32 s76, s13, 18432
s_add_u32 s73, s73, s76
s_lshl_b32 s83, s13, 11
s_add_u32 m0, s83, 0
s_add_u32 s76, s73, 0
buffer_load_dwordx4 v1, s[64:67], s76 offen lds
s_add_u32 m0, s83, 1024
s_add_u32 s76, s73, 9216
buffer_load_dwordx4 v1, s[64:67], s76 offen lds
s_add_u32 m0, s83, 8192
s_add_u32 s76, s73, 73728
buffer_load_dwordx4 v1, s[64:67], s76 offen lds
s_add_u32 m0, s83, 9216
s_add_u32 s76, s73, 82944
buffer_load_dwordx4 v1, s[64:67], s76 offen lds
s_add_u32 m0, s83, 16384
s_add_u32 s76, s73, 147456
buffer_load_dwordx4 v1, s[64:67], s76 offen lds
s_add_u32 m0, s83, 17408
s_add_u32 s76, s73, 156672
buffer_load_dwordx4 v1, s[64:67], s76 offen lds
s_add_u32 m0, s83, 24576
s_add_u32 s76, s73, 221184
buffer_load_dwordx4 v1, s[64:67], s76 offen lds
s_add_u32 m0, s83, 25600
s_add_u32 s76, s73, 230400
buffer_load_dwordx4 v1, s[64:67], s76 offen lds
s_add_u32 m0, s83, 32768
s_add_u32 s76, s73, 294912
buffer_load_dwordx4 v1, s[64:67], s76 offen lds
s_add_u32 m0, s83, 33792
s_add_u32 s76, s73, 304128
buffer_load_dwordx4 v1, s[64:67], s76 offen lds
s_add_u32 m0, s83, 40960
s_add_u32 s76, s73, 368640
buffer_load_dwordx4 v1, s[64:67], s76 offen lds
s_add_u32 m0, s83, 41984
s_add_u32 s76, s73, 377856
buffer_load_dwordx4 v1, s[64:67], s76 offen lds
s_add_u32 m0, s83, 49152
s_add_u32 s76, s73, 442368
buffer_load_dwordx4 v1, s[64:67], s76 offen lds
s_add_u32 m0, s83, 50176
s_add_u32 s76, s73, 451584
buffer_load_dwordx4 v1, s[64:67], s76 offen lds
s_add_u32 m0, s83, 57344
s_add_u32 s76, s73, 516096
buffer_load_dwordx4 v1, s[64:67], s76 offen lds
s_add_u32 m0, s83, 58368
s_add_u32 s76, s73, 525312
buffer_load_dwordx4 v1, s[64:67], s76 offen lds
s_waitcnt vmcnt(0)
s_barrier
s_mov_b32 s32, 0
RC2_g:
s_cmp_eq_u32 s13, 0
s_cbranch_scc0 L_rd_18_b
s_lshl_b32 s25, s32, 7
s_add_u32 s25, s25, 70279168
v_mov_b32 v250, s25
s_mov_b32 s24, 0
L_rd_18:
buffer_load_dword v251, v250, s[8:11], 0 offen sc1
s_waitcnt vmcnt(0)
v_readfirstlane_b32 s25, v251
s_cmp_ge_u32 s25, 32
s_cbranch_scc1 L_rd_18_b
s_cmp_lt_u32 s32, 14
s_cbranch_scc0 L_rd_18_ns
s_sleep 8
L_rd_18_ns:
s_add_u32 s24, s24, 1
s_cmp_lt_u32 s24, 1200000
s_cbranch_scc1 L_rd_18
s_endpgm
L_rd_18_b:
s_barrier
s_lshl_b32 s29, s32, 2
s_add_u32 s29, s29, s13
s_mul_i32 s72, s29, 262144
s_mul_i32 s76, s23, 32768
s_add_u32 s72, s72, s76
s_add_u32 s72, s72, 76546048
s_lshl_b32 s82, s23, 6
s_add_u32 s82, s82, s29
s_mul_i32 s82, s82, 18
s_add_u32 s82, s82, s28
s_lshl_b32 s82, s82, 12
s_add_u32 s82, s82, 121634816
s_add_u32 s76, s72, 0
buffer_load_dwordx4 a[0:3], v0, s[8:11], s76 offen offset:0 sc1
buffer_load_dwordx4 a[4:7], v0, s[8:11], s76 offen offset:1024 sc1
buffer_load_dwordx4 a[8:11], v0, s[8:11], s76 offen offset:2048 sc1
buffer_load_dwordx4 a[12:15], v0, s[8:11], s76 offen offset:3072 sc1
s_add_u32 s76, s72, 4096
buffer_load_dwordx4 a[16:19], v0, s[8:11], s76 offen offset:0 sc1
buffer_load_dwordx4 a[20:23], v0, s[8:11], s76 offen offset:1024 sc1
buffer_load_dwordx4 a[24:27], v0, s[8:11], s76 offen offset:2048 sc1
buffer_load_dwordx4 a[28:31], v0, s[8:11], s76 offen offset:3072 sc1
s_add_u32 s76, s72, 8192
buffer_load_dwordx4 a[32:35], v0, s[8:11], s76 offen offset:0 sc1
buffer_load_dwordx4 a[36:39], v0, s[8:11], s76 offen offset:1024 sc1
buffer_load_dwordx4 a[40:43], v0, s[8:11], s76 offen offset:2048 sc1
buffer_load_dwordx4 a[44:47], v0, s[8:11], s76 offen offset:3072 sc1
s_add_u32 s76, s72, 12288
buffer_load_dwordx4 a[48:51], v0, s[8:11], s76 offen offset:0 sc1
buffer_load_dwordx4 a[52:55], v0, s[8:11], s76 offen offset:1024 sc1
buffer_load_dwordx4 a[56:59], v0, s[8:11], s76 offen offset:2048 sc1
buffer_load_dwordx4 a[60:63], v0, s[8:11], s76 offen offset:3072 sc1
s_add_u32 s76, s72, 16384
buffer_load_dwordx4 a[64:67], v0, s[8:11], s76 offen offset:0 sc1
buffer_load_dwordx4 a[68:71], v0, s[8:11], s76 offen offset:1024 sc1
buffer_load_dwordx4 a[72:75], v0, s[8:11], s76 offen offset:2048 sc1
buffer_load_dwordx4 a[76:79], v0, s[8:11], s76 offen offset:3072 sc1
s_add_u32 s76, s72, 20480
buffer_load_dwordx4 a[80:83], v0, s[8:11], s76 offen offset:0 sc1
buffer_load_dwordx4 a[84:87], v0, s[8:11], s76 offen offset:1024 sc1
buffer_load_dwordx4 a[88:91], v0, s[8:11], s76 offen offset:2048 sc1
buffer_load_dwordx4 a[92:95], v0, s[8:11], s76 offen offset:3072 sc1
s_add_u32 s76, s72, 24576
buffer_load_dwordx4 a[96:99], v0, s[8:11], s76 offen offset:0 sc1
buffer_load_dwordx4 a[100:103], v0, s[8:11], s76 offen offset:1024 sc1
buffer_load_dwordx4 a[104:107], v0, s[8:11], s76 offen offset:2048 sc1
buffer_load_dwordx4 a[108:111], v0, s[8:11], s76 offen offset:3072 sc1
s_add_u32 s76, s72, 28672
buffer_load_dwordx4 a[112:115], v0, s[8:11], s76 offen offset:0 sc1
buffer_load_dwordx4 a[116:119], v0, s[8:11], s76 offen offset:1024 sc1
buffer_load_dwordx4 a[120:123], v0, s[8:11], s76 offen offset:2048 sc1
buffer_load_dwordx4 a[124:127], v0, s[8:11], s76 offen offset:3072 sc1
ds_read_b64_tr_b16 v[8:9], v2 offset:0
ds_read_b64_tr_b16 v[10:11], v2 offset:2048
ds_read_b64_tr_b16 v[12:13], v3 offset:0
ds_read_b64_tr_b16 v[14:15], v3 offset:2048
s_waitcnt vmcnt(31)
s_waitcnt lgkmcnt(2)
v_mfma_f32_32x32x16_bf16 v[24:39], v[8:11], a[0:3], 0
ds_read_b64_tr_b16 v[16:17], v2 offset:1024
ds_read_b64_tr_b16 v[18:19], v2 offset:3072
s_waitcnt lgkmcnt(2)
v_mfma_f32_32x32x16_bf16 v[40:55], v[12:15], a[0:3], 0
ds_read_b64_tr_b16 v[20:21], v3 offset:1024
ds_read_b64_tr_b16 v[22:23], v3 offset:3072
s_waitcnt vmcnt(30)
s_waitcnt lgkmcnt(2)
v_mfma_f32_32x32x16_bf16 v[24:39], v[16:19], a[4:7], v[24:39]
ds_read_b64_tr_b16 v[8:9], v2 offset:4096
ds_read_b64_tr_b16 v[10:11], v2 offset:6144
s_waitcnt lgkmcnt(2)
v_mfma_f32_32x32x16_bf16 v[40:55], v[20:23], a[4:7], v[40:55]
ds_read_b64_tr_b16 v[12:13], v3 offset:4096
ds_read_b64_tr_b16 v[14:15], v3 offset:6144
s_waitcnt vmcnt(29)
s_waitcnt lgkmcnt(2)
v_mfma_f32_32x32x16_bf16 v[24:39], v[8:11], a[8:11], v[24:39]
ds_read_b64_tr_b16 v[16:17], v2 offset:5120
ds_read_b64_tr_b16 v[18:19], v2 offset:7168
s_waitcnt lgkmcnt(2)
v_mfma_f32_32x32x16_bf16 v[40:55], v[12:15], a[8:11], v[40:55]
ds_read_b64_tr_b16 v[20:21], v3 offset:5120
ds_read_b64_tr_b16 v[22:23], v3 offset:7168
s_waitcnt vmcnt(28)
s_waitcnt lgkmcnt(2)
v_mfma_f32_32x32x16_bf16 v[24:39], v[16:19], a[12:15], v[24:39]
ds_read_b64_tr_b16 v[8:9], v2 offset:8192
ds_read_b64_tr_b16 v[10:11], v2 offset:10240
s_waitcnt lgkmcnt(2)
v_mfma_f32_32x32x16_bf16 v[40:55], v[20:23], a[12:15], v[40:55]
ds_read_b64_tr_b16 v[12:13], v3 offset:8192
ds_read_b64_tr_b16 v[14:15], v3 offset:10240
s_waitcnt vmcnt(27)
s_waitcnt lgkmcnt(2)
v_mfma_f32_32x32x16_bf16 v[24:39], v[8:11], a[16:19], v[24:39]
ds_read_b64_tr_b16 v[16:17], v2 offset:9216
ds_read_b64_tr_b16 v[18:19], v2 offset:11264
s_waitcnt lgkmcnt(2)
v_mfma_f32_32x32x16_bf16 v[40:55], v[12:15], a[16:19], v[40:55]
ds_read_b64_tr_b16 v[20:21], v3 offset:9216
ds_read_b64_tr_b16 v[22:23], v3 offset:11264
s_waitcnt vmcnt(26)
s_waitcnt lgkmcnt(2)
v_mfma_f32_32x32x16_bf16 v[24:39], v[16:19], a[20:23], v[24:39]
ds_read_b64_tr_b16 v[8:9], v2 offset:12288
ds_read_b64_tr_b16 v[10:11], v2 offset:14336
s_waitcnt lgkmcnt(2)
v_mfma_f32_32x32x16_bf16 v[40:55], v[20:23], a[20:23], v[40:55]
ds_read_b64_tr_b16 v[12:13], v3 offset:12288
ds_read_b64_tr_b16 v[14:15], v3 offset:14336
s_waitcnt vmcnt(25)
s_waitcnt lgkmcnt(2)
v_mfma_f32_32x32x16_bf16 v[24:39], v[8:11], a[24:27], v[24:39]
ds_read_b64_tr_b16 v[16:17], v2 offset:13312
ds_read_b64_tr_b16 v[18:19], v2 offset:15360
s_waitcnt lgkmcnt(2)
v_mfma_f32_32x32x16_bf16 v[40:55], v[12:15], a[24:27], v[40:55]
ds_read_b64_tr_b16 v[20:21], v3 offset:13312
ds_read_b64_tr_b16 v[22:23], v3 offset:15360
s_waitcnt vmcnt(24)
s_waitcnt lgkmcnt(2)
v_mfma_f32_32x32x16_bf16 v[24:39], v[16:19], a[28:31], v[24:39]
ds_read_b64_tr_b16 v[8:9], v2 offset:16384
ds_read_b64_tr_b16 v[10:11], v2 offset:18432
s_waitcnt lgkmcnt(2)
v_mfma_f32_32x32x16_bf16 v[40:55], v[20:23], a[28:31], v[40:55]
ds_read_b64_tr_b16 v[12:13], v3 offset:16384
ds_read_b64_tr_b16 v[14:15], v3 offset:18432
s_waitcnt vmcnt(23)
s_waitcnt lgkmcnt(2)
v_mfma_f32_32x32x16_bf16 v[24:39], v[8:11], a[32:35], v[24:39]
ds_read_b64_tr_b16 v[16:17], v2 offset:17408
ds_read_b64_tr_b16 v[18:19], v2 offset:19456
s_waitcnt lgkmcnt(2)
v_mfma_f32_32x32x16_bf16 v[40:55], v[12:15], a[32:35], v[40:55]
ds_read_b64_tr_b16 v[20:21], v3 offset:17408
ds_read_b64_tr_b16 v[22:23], v3 offset:19456
s_waitcnt vmcnt(22)
s_waitcnt lgkmcnt(2)
v_mfma_f32_32x32x16_bf16 v[24:39], v[16:19], a[36:39], v[24:39]
ds_read_b64_tr_b16 v[8:9], v2 offset:20480
ds_read_b64_tr_b16 v[10:11], v2 offset:22528
s_waitcnt lgkmcnt(2)
v_mfma_f32_32x32x16_bf16 v[40:55], v[20:23], a[36:39], v[40:55]
ds_read_b64_tr_b16 v[12:13], v3 offset:20480
ds_read_b64_tr_b16 v[14:15], v3 offset:22528
s_waitcnt vmcnt(21)
s_waitcnt lgkmcnt(2)
v_mfma_f32_32x32x16_bf16 v[24:39], v[8:11], a[40:43], v[24:39]
ds_read_b64_tr_b16 v[16:17], v2 offset:21504
ds_read_b64_tr_b16 v[18:19], v2 offset:23552
s_waitcnt lgkmcnt(2)
v_mfma_f32_32x32x16_bf16 v[40:55], v[12:15], a[40:43], v[40:55]
ds_read_b64_tr_b16 v[20:21], v3 offset:21504
ds_read_b64_tr_b16 v[22:23], v3 offset:23552
s_waitcnt vmcnt(20)
s_waitcnt lgkmcnt(2)
v_mfma_f32_32x32x16_bf16 v[24:39], v[16:19], a[44:47], v[24:39]
ds_read_b64_tr_b16 v[8:9], v2 offset:24576
ds_read_b64_tr_b16 v[10:11], v2 offset:26624
s_waitcnt lgkmcnt(2)
v_mfma_f32_32x32x16_bf16 v[40:55], v[20:23], a[44:47], v[40:55]
ds_read_b64_tr_b16 v[12:13], v3 offset:24576
ds_read_b64_tr_b16 v[14:15], v3 offset:26624
s_waitcnt vmcnt(19)
s_waitcnt lgkmcnt(2)
v_mfma_f32_32x32x16_bf16 v[24:39], v[8:11], a[48:51], v[24:39]
ds_read_b64_tr_b16 v[16:17], v2 offset:25600
ds_read_b64_tr_b16 v[18:19], v2 offset:27648
s_waitcnt lgkmcnt(2)
v_mfma_f32_32x32x16_bf16 v[40:55], v[12:15], a[48:51], v[40:55]
ds_read_b64_tr_b16 v[20:21], v3 offset:25600
ds_read_b64_tr_b16 v[22:23], v3 offset:27648
s_waitcnt vmcnt(18)
s_waitcnt lgkmcnt(2)
v_mfma_f32_32x32x16_bf16 v[24:39], v[16:19], a[52:55], v[24:39]
ds_read_b64_tr_b16 v[8:9], v2 offset:28672
ds_read_b64_tr_b16 v[10:11], v2 offset:30720
s_waitcnt lgkmcnt(2)
v_mfma_f32_32x32x16_bf16 v[40:55], v[20:23], a[52:55], v[40:55]
ds_read_b64_tr_b16 v[12:13], v3 offset:28672
ds_read_b64_tr_b16 v[14:15], v3 offset:30720
s_waitcnt vmcnt(17)
s_waitcnt lgkmcnt(2)
v_mfma_f32_32x32x16_bf16 v[24:39], v[8:11], a[56:59], v[24:39]
ds_read_b64_tr_b16 v[16:17], v2 offset:29696
ds_read_b64_tr_b16 v[18:19], v2 offset:31744
s_waitcnt lgkmcnt(2)
v_mfma_f32_32x32x16_bf16 v[40:55], v[12:15], a[56:59], v[40:55]
ds_read_b64_tr_b16 v[20:21], v3 offset:29696
ds_read_b64_tr_b16 v[22:23], v3 offset:31744
s_waitcnt vmcnt(16)
s_waitcnt lgkmcnt(2)
v_mfma_f32_32x32x16_bf16 v[24:39], v[16:19], a[60:63], v[24:39]
ds_read_b64_tr_b16 v[8:9], v2 offset:32768
ds_read_b64_tr_b16 v[10:11], v2 offset:34816
s_waitcnt lgkmcnt(2)
v_mfma_f32_32x32x16_bf16 v[40:55], v[20:23], a[60:63], v[40:55]
ds_read_b64_tr_b16 v[12:13], v3 offset:32768
ds_read_b64_tr_b16 v[14:15], v3 offset:34816
s_waitcnt vmcnt(15)
s_waitcnt lgkmcnt(2)
v_mfma_f32_32x32x16_bf16 v[24:39], v[8:11], a[64:67], v[24:39]
ds_read_b64_tr_b16 v[16:17], v2 offset:33792
ds_read_b64_tr_b16 v[18:19], v2 offset:35840
s_waitcnt lgkmcnt(2)
v_mfma_f32_32x32x16_bf16 v[40:55], v[12:15], a[64:67], v[40:55]
ds_read_b64_tr_b16 v[20:21], v3 offset:33792
ds_read_b64_tr_b16 v[22:23], v3 offset:35840
s_waitcnt vmcnt(14)
s_waitcnt lgkmcnt(2)
v_mfma_f32_32x32x16_bf16 v[24:39], v[16:19], a[68:71], v[24:39]
ds_read_b64_tr_b16 v[8:9], v2 offset:36864
ds_read_b64_tr_b16 v[10:11], v2 offset:38912
s_waitcnt lgkmcnt(2)
v_mfma_f32_32x32x16_bf16 v[40:55], v[20:23], a[68:71], v[40:55]
ds_read_b64_tr_b16 v[12:13], v3 offset:36864
ds_read_b64_tr_b16 v[14:15], v3 offset:38912
s_waitcnt vmcnt(13)
s_waitcnt lgkmcnt(2)
v_mfma_f32_32x32x16_bf16 v[24:39], v[8:11], a[72:75], v[24:39]
ds_read_b64_tr_b16 v[16:17], v2 offset:37888
ds_read_b64_tr_b16 v[18:19], v2 offset:39936
s_waitcnt lgkmcnt(2)
v_mfma_f32_32x32x16_bf16 v[40:55], v[12:15], a[72:75], v[40:55]
ds_read_b64_tr_b16 v[20:21], v3 offset:37888
ds_read_b64_tr_b16 v[22:23], v3 offset:39936
s_waitcnt vmcnt(12)
s_waitcnt lgkmcnt(2)
v_mfma_f32_32x32x16_bf16 v[24:39], v[16:19], a[76:79], v[24:39]
ds_read_b64_tr_b16 v[8:9], v2 offset:40960
ds_read_b64_tr_b16 v[10:11], v2 offset:43008
s_waitcnt lgkmcnt(2)
v_mfma_f32_32x32x16_bf16 v[40:55], v[20:23], a[76:79], v[40:55]
ds_read_b64_tr_b16 v[12:13], v3 offset:40960
ds_read_b64_tr_b16 v[14:15], v3 offset:43008
s_waitcnt vmcnt(11)
s_waitcnt lgkmcnt(2)
v_mfma_f32_32x32x16_bf16 v[24:39], v[8:11], a[80:83], v[24:39]
ds_read_b64_tr_b16 v[16:17], v2 offset:41984
ds_read_b64_tr_b16 v[18:19], v2 offset:44032
s_waitcnt lgkmcnt(2)
v_mfma_f32_32x32x16_bf16 v[40:55], v[12:15], a[80:83], v[40:55]
ds_read_b64_tr_b16 v[20:21], v3 offset:41984
ds_read_b64_tr_b16 v[22:23], v3 offset:44032
s_waitcnt vmcnt(10)
s_waitcnt lgkmcnt(2)
v_mfma_f32_32x32x16_bf16 v[24:39], v[16:19], a[84:87], v[24:39]
ds_read_b64_tr_b16 v[8:9], v2 offset:45056
ds_read_b64_tr_b16 v[10:11], v2 offset:47104
s_waitcnt lgkmcnt(2)
v_mfma_f32_32x32x16_bf16 v[40:55], v[20:23], a[84:87], v[40:55]
ds_read_b64_tr_b16 v[12:13], v3 offset:45056
ds_read_b64_tr_b16 v[14:15], v3 offset:47104
s_waitcnt vmcnt(9)
s_waitcnt lgkmcnt(2)
v_mfma_f32_32x32x16_bf16 v[24:39], v[8:11], a[88:91], v[24:39]
ds_read_b64_tr_b16 v[16:17], v2 offset:46080
ds_read_b64_tr_b16 v[18:19], v2 offset:48128
s_waitcnt lgkmcnt(2)
v_mfma_f32_32x32x16_bf16 v[40:55], v[12:15], a[88:91], v[40:55]
ds_read_b64_tr_b16 v[20:21], v3 offset:46080
ds_read_b64_tr_b16 v[22:23], v3 offset:48128
s_waitcnt vmcnt(8)
s_waitcnt lgkmcnt(2)
v_mfma_f32_32x32x16_bf16 v[24:39], v[16:19], a[92:95], v[24:39]
ds_read_b64_tr_b16 v[8:9], v2 offset:49152
ds_read_b64_tr_b16 v[10:11], v2 offset:51200
s_waitcnt lgkmcnt(2)
v_mfma_f32_32x32x16_bf16 v[40:55], v[20:23], a[92:95], v[40:55]
ds_read_b64_tr_b16 v[12:13], v3 offset:49152
ds_read_b64_tr_b16 v[14:15], v3 offset:51200
s_waitcnt vmcnt(7)
s_waitcnt lgkmcnt(2)
v_mfma_f32_32x32x16_bf16 v[24:39], v[8:11], a[96:99], v[24:39]
ds_read_b64_tr_b16 v[16:17], v2 offset:50176
ds_read_b64_tr_b16 v[18:19], v2 offset:52224
s_waitcnt lgkmcnt(2)
v_mfma_f32_32x32x16_bf16 v[40:55], v[12:15], a[96:99], v[40:55]
ds_read_b64_tr_b16 v[20:21], v3 offset:50176
ds_read_b64_tr_b16 v[22:23], v3 offset:52224
s_waitcnt vmcnt(6)
s_waitcnt lgkmcnt(2)
v_mfma_f32_32x32x16_bf16 v[24:39], v[16:19], a[100:103], v[24:39]
ds_read_b64_tr_b16 v[8:9], v2 offset:53248
ds_read_b64_tr_b16 v[10:11], v2 offset:55296
s_waitcnt lgkmcnt(2)
v_mfma_f32_32x32x16_bf16 v[40:55], v[20:23], a[100:103], v[40:55]
ds_read_b64_tr_b16 v[12:13], v3 offset:53248
ds_read_b64_tr_b16 v[14:15], v3 offset:55296
s_waitcnt vmcnt(5)
s_waitcnt lgkmcnt(2)
v_mfma_f32_32x32x16_bf16 v[24:39], v[8:11], a[104:107], v[24:39]
ds_read_b64_tr_b16 v[16:17], v2 offset:54272
ds_read_b64_tr_b16 v[18:19], v2 offset:56320
s_waitcnt lgkmcnt(2)
v_mfma_f32_32x32x16_bf16 v[40:55], v[12:15], a[104:107], v[40:55]
ds_read_b64_tr_b16 v[20:21], v3 offset:54272
ds_read_b64_tr_b16 v[22:23], v3 offset:56320
s_waitcnt vmcnt(4)
s_waitcnt lgkmcnt(2)
v_mfma_f32_32x32x16_bf16 v[24:39], v[16:19], a[108:111], v[24:39]
ds_read_b64_tr_b16 v[8:9], v2 offset:57344
ds_read_b64_tr_b16 v[10:11], v2 offset:59392
s_waitcnt lgkmcnt(2)
v_mfma_f32_32x32x16_bf16 v[40:55], v[20:23], a[108:111], v[40:55]
ds_read_b64_tr_b16 v[12:13], v3 offset:57344
ds_read_b64_tr_b16 v[14:15], v3 offset:59392
s_waitcnt vmcnt(3)
s_waitcnt lgkmcnt(2)
v_mfma_f32_32x32x16_bf16 v[24:39], v[8:11], a[112:115], v[24:39]
ds_read_b64_tr_b16 v[16:17], v2 offset:58368
ds_read_b64_tr_b16 v[18:19], v2 offset:60416
s_waitcnt lgkmcnt(2)
v_mfma_f32_32x32x16_bf16 v[40:55], v[12:15], a[112:115], v[40:55]
ds_read_b64_tr_b16 v[20:21], v3 offset:58368
ds_read_b64_tr_b16 v[22:23], v3 offset:60416
s_waitcnt vmcnt(2)
s_waitcnt lgkmcnt(2)
v_mfma_f32_32x32x16_bf16 v[24:39], v[16:19], a[116:119], v[24:39]
ds_read_b64_tr_b16 v[8:9], v2 offset:61440
ds_read_b64_tr_b16 v[10:11], v2 offset:63488
s_waitcnt lgkmcnt(2)
v_mfma_f32_32x32x16_bf16 v[40:55], v[20:23], a[116:119], v[40:55]
ds_read_b64_tr_b16 v[12:13], v3 offset:61440
ds_read_b64_tr_b16 v[14:15], v3 offset:63488
s_waitcnt vmcnt(1)
s_waitcnt lgkmcnt(2)
v_mfma_f32_32x32x16_bf16 v[24:39], v[8:11], a[120:123], v[24:39]
ds_read_b64_tr_b16 v[16:17], v2 offset:62464
ds_read_b64_tr_b16 v[18:19], v2 offset:64512
s_waitcnt lgkmcnt(2)
v_mfma_f32_32x32x16_bf16 v[40:55], v[12:15], a[120:123], v[40:55]
ds_read_b64_tr_b16 v[20:21], v3 offset:62464
ds_read_b64_tr_b16 v[22:23], v3 offset:64512
s_waitcnt vmcnt(0)
s_waitcnt lgkmcnt(2)
v_mfma_f32_32x32x16_bf16 v[24:39], v[16:19], a[124:127], v[24:39]
s_waitcnt lgkmcnt(0)
v_mfma_f32_32x32x16_bf16 v[40:55], v[20:23], a[124:127], v[40:55]
s_nop 11
s_add_u32 s77, s82, 0
buffer_store_dwordx4 v[24:27], v0, s[8:11], s77 offen offset:0 sc1
buffer_store_dwordx4 v[28:31], v0, s[8:11], s77 offen offset:1024 sc1
buffer_store_dwordx4 v[32:35], v0, s[8:11], s77 offen offset:2048 sc1
buffer_store_dwordx4 v[36:39], v0, s[8:11], s77 offen offset:3072 sc1
s_add_u32 s77, s82, 4096
buffer_store_dwordx4 v[40:43], v0, s[8:11], s77 offen offset:0 sc1
buffer_store_dwordx4 v[44:47], v0, s[8:11], s77 offen offset:1024 sc1
buffer_store_dwordx4 v[48:51], v0, s[8:11], s77 offen offset:2048 sc1
buffer_store_dwordx4 v[52:55], v0, s[8:11], s77 offen offset:3072 sc1
s_waitcnt vmcnt(0) lgkmcnt(0)
s_barrier
s_cmp_eq_u32 s13, 0
s_cbranch_scc0 L_rs_19
s_lshl_b32 s25, s32, 7
s_add_u32 s25, s25, 70281216
v_mov_b32 v250, s25
v_mov_b32 v251, 1
s_mov_b64 exec, 1
buffer_atomic_add v251, v250, s[8:11], 0 offen
s_mov_b64 exec, -1
L_rs_19:
s_add_u32 s32, s32, 1
s_cmp_lt_u32 s32, 16
s_cbranch_scc1 RC2_g
s_branch K_end
K_rE4:
v_mbcnt_lo_u32_b32 v0, -1, 0
v_mbcnt_hi_u32_b32 v0, -1, v0
s_sub_u32 s25, s33, 160
s_lshr_b32 s28, s25, 3
s_lshl_b32 s28, s28, 2
s_and_b32 s23, s25, 7
v_lshrrev_b32 v10, 3, v0
v_and_b32 v11, 7, v0
v_bfe_u32 v12, v0, 4, 1
v_lshlrev_b32 v12, 2, v12
v_xor_b32 v11, v11, v12
s_mov_b32 s76, 1152
v_mul_lo_u32 v1, v10, s76
v_lshl_add_u32 v1, v11, 4, v1
v_lshrrev_b32 v10, 5, v0
v_bfe_u32 v11, v0, 2, 2
v_lshl_add_u32 v10, v10, 2, v11
v_lshlrev_b32 v10, 7, v10
v_bfe_u32 v12, v0, 4, 1
v_lshl_add_u32 v10, v12, 5, v10
v_and_b32 v12, 3, v0
v_lshl_add_u32 v10, v12, 3, v10
v_lshrrev_b32 v11, 1, v11
v_lshlrev_b32 v11, 6, v11
v_add_u32 v2, v10, v11
v_xor_b32 v11, 64, v11
v_add_u32 v3, v10, v11
v_add_u32 v4, 0x10000, v2
v_add_u32 v5, 0x10000, v3
v_add_u32 v6, 0x20000, v2
v_add_u32 v7, 0x20000, v3
v_lshlrev_b32 v0, 4, v0
s_mov_b32 s64, s98
s_and_b32 s65, s99, 0xffff
s_mov_b32 s66, 5308416
s_mov_b32 s67, 0x20000
s_mul_i32 s73, s23, 663552
s_lshl_b32 s76, s28, 6
s_add_u32 s73, s73, s76
s_mul_i32 s76, s13, 18432
s_add_u32 s73, s73, s76
s_lshl_b32 s83, s13, 11
s_add_u32 m0, s83, 0
s_add_u32 s76, s73, 0
buffer_load_dwordx4 v1, s[64:67], s76 offen lds
s_add_u32 m0, s83, 1024
s_add_u32 s76, s73, 9216
buffer_load_dwordx4 v1, s[64:67], s76 offen lds
s_add_u32 m0, s83, 8192
s_add_u32 s76, s73, 128
buffer_load_dwordx4 v1, s[64:67], s76 offen lds
s_add_u32 m0, s83, 9216
s_add_u32 s76, s73, 9344
buffer_load_dwordx4 v1, s[64:67], s76 offen lds
s_add_u32 m0, s83, 16384
s_add_u32 s76, s73, 73728
buffer_load_dwordx4 v1, s[64:67], s76 offen lds
s_add_u32 m0, s83, 17408
s_add_u32 s76, s73, 82944
buffer_load_dwordx4 v1, s[64:67], s76 offen lds
s_add_u32 m0, s83, 24576
s_add_u32 s76, s73, 73856
buffer_load_dwordx4 v1, s[64:67], s76 offen lds
s_add_u32 m0, s83, 25600
s_add_u32 s76, s73, 83072
buffer_load_dwordx4 v1, s[64:67], s76 offen lds
s_add_u32 m0, s83, 32768
s_add_u32 s76, s73, 147456
buffer_load_dwordx4 v1, s[64:67], s76 offen lds
s_add_u32 m0, s83, 33792
s_add_u32 s76, s73, 156672
buffer_load_dwordx4 v1, s[64:67], s76 offen lds
s_add_u32 m0, s83, 40960
s_add_u32 s76, s73, 147584
buffer_load_dwordx4 v1, s[64:67], s76 offen lds
s_add_u32 m0, s83, 41984
s_add_u32 s76, s73, 156800
buffer_load_dwordx4 v1, s[64:67], s76 offen lds
s_add_u32 m0, s83, 49152
s_add_u32 s76, s73, 221184
buffer_load_dwordx4 v1, s[64:67], s76 offen lds
s_add_u32 m0, s83, 50176
s_add_u32 s76, s73, 230400
buffer_load_dwordx4 v1, s[64:67], s76 offen lds
s_add_u32 m0, s83, 57344
s_add_u32 s76, s73, 221312
buffer_load_dwordx4 v1, s[64:67], s76 offen lds
s_add_u32 m0, s83, 58368
s_add_u32 s76, s73, 230528
buffer_load_dwordx4 v1, s[64:67], s76 offen lds
s_add_u32 m0, s83, 65536
s_add_u32 s76, s73, 294912
buffer_load_dwordx4 v1, s[64:67], s76 offen lds
s_add_u32 m0, s83, 66560
s_add_u32 s76, s73, 304128
buffer_load_dwordx4 v1, s[64:67], s76 offen lds
s_add_u32 m0, s83, 73728
s_add_u32 s76, s73, 295040
buffer_load_dwordx4 v1, s[64:67], s76 offen lds
s_add_u32 m0, s83, 74752
s_add_u32 s76, s73, 304256
buffer_load_dwordx4 v1, s[64:67], s76 offen lds
s_add_u32 m0, s83, 81920
s_add_u32 s76, s73, 368640
buffer_load_dwordx4 v1, s[64:67], s76 offen lds
s_add_u32 m0, s83, 82944
s_add_u32 s76, s73, 377856
buffer_load_dwordx4 v1, s[64:67], s76 offen lds
s_add_u32 m0, s83, 90112
s_add_u32 s76, s73, 368768
buffer_load_dwordx4 v1, s[64:67], s76 offen lds
s_add_u32 m0, s83, 91136
s_add_u32 s76, s73, 377984
buffer_load_dwordx4 v1, s[64:67], s76 offen lds
s_add_u32 m0, s83, 98304
s_add_u32 s76, s73, 442368
buffer_load_dwordx4 v1, s[64:67], s76 offen lds
s_add_u32 m0, s83, 99328
s_add_u32 s76, s73, 451584
buffer_load_dwordx4 v1, s[64:67], s76 offen lds
s_add_u32 m0, s83, 106496
s_add_u32 s76, s73, 442496
buffer_load_dwordx4 v1, s[64:67], s76 offen lds
s_add_u32 m0, s83, 107520
s_add_u32 s76, s73, 451712
buffer_load_dwordx4 v1, s[64:67], s76 offen lds
s_add_u32 m0, s83, 114688
s_add_u32 s76, s73, 516096
buffer_load_dwordx4 v1, s[64:67], s76 offen lds
s_add_u32 m0, s83, 115712
s_add_u32 s76, s73, 525312
buffer_load_dwordx4 v1, s[64:67], s76 offen lds
s_add_u32 m0, s83, 122880
s_add_u32 s76, s73, 516224
buffer_load_dwordx4 v1, s[64:67], s76 offen lds
s_add_u32 m0, s83, 123904
s_add_u32 s76, s73, 525440
buffer_load_dwordx4 v1, s[64:67], s76 offen lds
s_add_u32 m0, s83, 131072
s_add_u32 s76, s73, 589824
buffer_load_dwordx4 v1, s[64:67], s76 offen lds
s_add_u32 m0, s83, 132096
s_add_u32 s76, s73, 599040
buffer_load_dwordx4 v1, s[64:67], s76 offen lds
s_add_u32 m0, s83, 139264
s_add_u32 s76, s73, 589952
buffer_load_dwordx4 v1, s[64:67], s76 offen lds
s_add_u32 m0, s83, 140288
s_add_u32 s76, s73, 599168
buffer_load_dwordx4 v1, s[64:67], s76 offen lds
s_waitcnt vmcnt(0)
s_barrier
s_mov_b32 s32, 0
RE4_g:
s_cmp_eq_u32 s13, 0
s_cbranch_scc0 L_rd_20_b
s_lshl_b32 s25, s32, 7
s_add_u32 s25, s25, 70285312
v_mov_b32 v250, s25
s_mov_b32 s24, 0
L_rd_20:
buffer_load_dword v251, v250, s[8:11], 0 offen sc1
s_waitcnt vmcnt(0)
v_readfirstlane_b32 s25, v251
s_cmp_ge_u32 s25, 72
s_cbranch_scc1 L_rd_20_b
s_cmp_lt_u32 s32, 14
s_cbranch_scc0 L_rd_20_ns
s_sleep 8
L_rd_20_ns:
s_add_u32 s24, s24, 1
s_cmp_lt_u32 s24, 1200000
s_cbranch_scc1 L_rd_20
s_endpgm
L_rd_20_b:
s_barrier
s_lshl_b32 s29, s32, 2
s_add_u32 s29, s29, s13
s_mul_i32 s72, s29, 294912
s_mul_i32 s76, s23, 36864
s_add_u32 s72, s72, s76
s_add_u32 s72, s72, 100663296
s_lshl_b32 s82, s23, 6
s_add_u32 s82, s82, s29
s_mul_i32 s82, s82, 18
s_add_u32 s82, s82, s28
s_lshl_b32 s82, s82, 12
s_add_u32 s82, s82, 163577856
s_add_u32 s76, s72, 0
buffer_load_dwordx4 a[0:3], v0, s[8:11], s76 offen offset:0 sc1
buffer_load_dwordx4 a[4:7], v0, s[8:11], s76 offen offset:1024 sc1
buffer_load_dwordx4 a[8:11], v0, s[8:11], s76 offen offset:2048 sc1
buffer_load_dwordx4 a[12:15], v0, s[8:11], s76 offen offset:3072 sc1
s_add_u32 s76, s72, 4096
buffer_load_dwordx4 a[16:19], v0, s[8:11], s76 offen offset:0 sc1
buffer_load_dwordx4 a[20:23], v0, s[8:11], s76 offen offset:1024 sc1
buffer_load_dwordx4 a[24:27], v0, s[8:11], s76 offen offset:2048 sc1
buffer_load_dwordx4 a[28:31], v0, s[8:11], s76 offen offset:3072 sc1
s_add_u32 s76, s72, 8192
buffer_load_dwordx4 a[32:35], v0, s[8:11], s76 offen offset:0 sc1
buffer_load_dwordx4 a[36:39], v0, s[8:11], s76 offen offset:1024 sc1
buffer_load_dwordx4 a[40:43], v0, s[8:11], s76 offen offset:2048 sc1
buffer_load_dwordx4 a[44:47], v0, s[8:11], s76 offen offset:3072 sc1
s_add_u32 s76, s72, 12288
buffer_load_dwordx4 a[48:51], v0, s[8:11], s76 offen offset:0 sc1
buffer_load_dwordx4 a[52:55], v0, s[8:11], s76 offen offset:1024 sc1
buffer_load_dwordx4 a[56:59], v0, s[8:11], s76 offen offset:2048 sc1
buffer_load_dwordx4 a[60:63], v0, s[8:11], s76 offen offset:3072 sc1
s_add_u32 s76, s72, 16384
buffer_load_dwordx4 a[64:67], v0, s[8:11], s76 offen offset:0 sc1
buffer_load_dwordx4 a[68:71], v0, s[8:11], s76 offen offset:1024 sc1
buffer_load_dwordx4 a[72:75], v0, s[8:11], s76 offen offset:2048 sc1
buffer_load_dwordx4 a[76:79], v0, s[8:11], s76 offen offset:3072 sc1
s_add_u32 s76, s72, 20480
buffer_load_dwordx4 a[80:83], v0, s[8:11], s76 offen offset:0 sc1
buffer_load_dwordx4 a[84:87], v0, s[8:11], s76 offen offset:1024 sc1
buffer_load_dwordx4 a[88:91], v0, s[8:11], s76 offen offset:2048 sc1
buffer_load_dwordx4 a[92:95], v0, s[8:11], s76 offen offset:3072 sc1
s_add_u32 s76, s72, 24576
buffer_load_dwordx4 a[96:99], v0, s[8:11], s76 offen offset:0 sc1
buffer_load_dwordx4 a[100:103], v0, s[8:11], s76 offen offset:1024 sc1
buffer_load_dwordx4 a[104:107], v0, s[8:11], s76 offen offset:2048 sc1
buffer_load_dwordx4 a[108:111], v0, s[8:11], s76 offen offset:3072 sc1
s_add_u32 s76, s72, 28672
buffer_load_dwordx4 a[112:115], v0, s[8:11], s76 offen offset:0 sc1
buffer_load_dwordx4 a[116:119], v0, s[8:11], s76 offen offset:1024 sc1
buffer_load_dwordx4 a[120:123], v0, s[8:11], s76 offen offset:2048 sc1
buffer_load_dwordx4 a[124:127], v0, s[8:11], s76 offen offset:3072 sc1
s_add_u32 s76, s72, 32768
buffer_load_dwordx4 a[128:131], v0, s[8:11], s76 offen offset:0 sc1
buffer_load_dwordx4 a[132:135], v0, s[8:11], s76 offen offset:1024 sc1
buffer_load_dwordx4 a[136:139], v0, s[8:11], s76 offen offset:2048 sc1
buffer_load_dwordx4 a[140:143], v0, s[8:11], s76 offen offset:3072 sc1
ds_read_b64_tr_b16 v[8:9], v2 offset:0
ds_read_b64_tr_b16 v[10:11], v2 offset:2048
ds_read_b64_tr_b16 v[12:13], v3 offset:0
ds_read_b64_tr_b16 v[14:15], v3 offset:2048
ds_read_b64_tr_b16 v[16:17], v2 offset:8192
ds_read_b64_tr_b16 v[18:19], v2 offset:10240
ds_read_b64_tr_b16 v[20:21], v3 offset:8192
ds_read_b64_tr_b16 v[22:23], v3 offset:10240
s_waitcnt vmcnt(35)
s_waitcnt lgkmcnt(6)
v_mfma_f32_32x32x16_bf16 v[40:55], v[8:11], a[0:3], 0
ds_read_b64_tr_b16 v[24:25], v2 offset:1024
ds_read_b64_tr_b16 v[26:27], v2 offset:3072
s_waitcnt lgkmcnt(6)
v_mfma_f32_32x32x16_bf16 v[56:71], v[12:15], a[0:3], 0
ds_read_b64_tr_b16 v[28:29], v3 offset:1024
ds_read_b64_tr_b16 v[30:31], v3 offset:3072
s_waitcnt lgkmcnt(6)
v_mfma_f32_32x32x16_bf16 v[72:87], v[16:19], a[0:3], 0
ds_read_b64_tr_b16 v[32:33], v2 offset:9216
ds_read_b64_tr_b16 v[34:35], v2 offset:11264
s_waitcnt lgkmcnt(6)
v_mfma_f32_32x32x16_bf16 v[88:103], v[20:23], a[0:3], 0
ds_read_b64_tr_b16 v[36:37], v3 offset:9216
ds_read_b64_tr_b16 v[38:39], v3 offset:11264
s_waitcnt vmcnt(34)
s_waitcnt lgkmcnt(6)
v_mfma_f32_32x32x16_bf16 v[40:55], v[24:27], a[4:7], v[40:55]
ds_read_b64_tr_b16 v[8:9], v2 offset:4096
ds_read_b64_tr_b16 v[10:11], v2 offset:6144
s_waitcnt lgkmcnt(6)
v_mfma_f32_32x32x16_bf16 v[56:71], v[28:31], a[4:7], v[56:71]
ds_read_b64_tr_b16 v[12:13], v3 offset:4096
ds_read_b64_tr_b16 v[14:15], v3 offset:6144
s_waitcnt lgkmcnt(6)
v_mfma_f32_32x32x16_bf16 v[72:87], v[32:35], a[4:7], v[72:87]
ds_read_b64_tr_b16 v[16:17], v2 offset:12288
ds_read_b64_tr_b16 v[18:19], v2 offset:14336
s_waitcnt lgkmcnt(6)
v_mfma_f32_32x32x16_bf16 v[88:103], v[36:39], a[4:7], v[88:103]
ds_read_b64_tr_b16 v[20:21], v3 offset:12288
ds_read_b64_tr_b16 v[22:23], v3 offset:14336
s_waitcnt vmcnt(33)
s_waitcnt lgkmcnt(6)
v_mfma_f32_32x32x16_bf16 v[40:55], v[8:11], a[8:11], v[40:55]
ds_read_b64_tr_b16 v[24:25], v2 offset:5120
ds_read_b64_tr_b16 v[26:27], v2 offset:7168
s_waitcnt lgkmcnt(6)
v_mfma_f32_32x32x16_bf16 v[56:71], v[12:15], a[8:11], v[56:71]
ds_read_b64_tr_b16 v[28:29], v3 offset:5120
ds_read_b64_tr_b16 v[30:31], v3 offset:7168
s_waitcnt lgkmcnt(6)
v_mfma_f32_32x32x16_bf16 v[72:87], v[16:19], a[8:11], v[72:87]
ds_read_b64_tr_b16 v[32:33], v2 offset:13312
ds_read_b64_tr_b16 v[34:35], v2 offset:15360
s_waitcnt lgkmcnt(6)
v_mfma_f32_32x32x16_bf16 v[88:103], v[20:23], a[8:11], v[88:103]
ds_read_b64_tr_b16 v[36:37], v3 offset:13312
ds_read_b64_tr_b16 v[38:39], v3 offset:15360
s_waitcnt vmcnt(32)
s_waitcnt lgkmcnt(6)
v_mfma_f32_32x32x16_bf16 v[40:55], v[24:27], a[12:15], v[40:55]
ds_read_b64_tr_b16 v[8:9], v2 offset:16384
ds_read_b64_tr_b16 v[10:11], v2 offset:18432
s_waitcnt lgkmcnt(6)
v_mfma_f32_32x32x16_bf16 v[56:71], v[28:31], a[12:15], v[56:71]
ds_read_b64_tr_b16 v[12:13], v3 offset:16384
ds_read_b64_tr_b16 v[14:15], v3 offset:18432
s_waitcnt lgkmcnt(6)
v_mfma_f32_32x32x16_bf16 v[72:87], v[32:35], a[12:15], v[72:87]
ds_read_b64_tr_b16 v[16:17], v2 offset:24576
ds_read_b64_tr_b16 v[18:19], v2 offset:26624
s_waitcnt lgkmcnt(6)
v_mfma_f32_32x32x16_bf16 v[88:103], v[36:39], a[12:15], v[88:103]
ds_read_b64_tr_b16 v[20:21], v3 offset:24576
ds_read_b64_tr_b16 v[22:23], v3 offset:26624
s_waitcnt vmcnt(31)
s_waitcnt lgkmcnt(6)
v_mfma_f32_32x32x16_bf16 v[40:55], v[8:11], a[16:19], v[40:55]
ds_read_b64_tr_b16 v[24:25], v2 offset:17408
ds_read_b64_tr_b16 v[26:27], v2 offset:19456
s_waitcnt lgkmcnt(6)
v_mfma_f32_32x32x16_bf16 v[56:71], v[12:15], a[16:19], v[56:71]
ds_read_b64_tr_b16 v[28:29], v3 offset:17408
ds_read_b64_tr_b16 v[30:31], v3 offset:19456
s_waitcnt lgkmcnt(6)
v_mfma_f32_32x32x16_bf16 v[72:87], v[16:19], a[16:19], v[72:87]
ds_read_b64_tr_b16 v[32:33], v2 offset:25600
ds_read_b64_tr_b16 v[34:35], v2 offset:27648
s_waitcnt lgkmcnt(6)
v_mfma_f32_32x32x16_bf16 v[88:103], v[20:23], a[16:19], v[88:103]
ds_read_b64_tr_b16 v[36:37], v3 offset:25600
ds_read_b64_tr_b16 v[38:39], v3 offset:27648
s_waitcnt vmcnt(30)
s_waitcnt lgkmcnt(6)
v_mfma_f32_32x32x16_bf16 v[40:55], v[24:27], a[20:23], v[40:55]
ds_read_b64_tr_b16 v[8:9], v2 offset:20480
ds_read_b64_tr_b16 v[10:11], v2 offset:22528
s_waitcnt lgkmcnt(6)
v_mfma_f32_32x32x16_bf16 v[56:71], v[28:31], a[20:23], v[56:71]
ds_read_b64_tr_b16 v[12:13], v3 offset:20480
ds_read_b64_tr_b16 v[14:15], v3 offset:22528
s_waitcnt lgkmcnt(6)
v_mfma_f32_32x32x16_bf16 v[72:87], v[32:35], a[20:23], v[72:87]
ds_read_b64_tr_b16 v[16:17], v2 offset:28672
ds_read_b64_tr_b16 v[18:19], v2 offset:30720
s_waitcnt lgkmcnt(6)
v_mfma_f32_32x32x16_bf16 v[88:103], v[36:39], a[20:23], v[88:103]
ds_read_b64_tr_b16 v[20:21], v3 offset:28672
ds_read_b64_tr_b16 v[22:23], v3 offset:30720
s_waitcnt vmcnt(29)
s_waitcnt lgkmcnt(6)
v_mfma_f32_32x32x16_bf16 v[40:55], v[8:11], a[24:27], v[40:55]
ds_read_b64_tr_b16 v[24:25], v2 offset:21504
ds_read_b64_tr_b16 v[26:27], v2 offset:23552
s_waitcnt lgkmcnt(6)
v_mfma_f32_32x32x16_bf16 v[56:71], v[12:15], a[24:27], v[56:71]
ds_read_b64_tr_b16 v[28:29], v3 offset:21504
ds_read_b64_tr_b16 v[30:31], v3 offset:23552
s_waitcnt lgkmcnt(6)
v_mfma_f32_32x32x16_bf16 v[72:87], v[16:19], a[24:27], v[72:87]
ds_read_b64_tr_b16 v[32:33], v2 offset:29696
ds_read_b64_tr_b16 v[34:35], v2 offset:31744
s_waitcnt lgkmcnt(6)
v_mfma_f32_32x32x16_bf16 v[88:103], v[20:23], a[24:27], v[88:103]
ds_read_b64_tr_b16 v[36:37], v3 offset:29696
ds_read_b64_tr_b16 v[38:39], v3 offset:31744
s_waitcnt vmcnt(28)
s_waitcnt lgkmcnt(6)
v_mfma_f32_32x32x16_bf16 v[40:55], v[24:27], a[28:31], v[40:55]
ds_read_b64_tr_b16 v[8:9], v2 offset:32768
ds_read_b64_tr_b16 v[10:11], v2 offset:34816
s_waitcnt lgkmcnt(6)
v_mfma_f32_32x32x16_bf16 v[56:71], v[28:31], a[28:31], v[56:71]
ds_read_b64_tr_b16 v[12:13], v3 offset:32768
ds_read_b64_tr_b16 v[14:15], v3 offset:34816
s_waitcnt lgkmcnt(6)
v_mfma_f32_32x32x16_bf16 v[72:87], v[32:35], a[28:31], v[72:87]
ds_read_b64_tr_b16 v[16:17], v2 offset:40960
ds_read_b64_tr_b16 v[18:19], v2 offset:43008
s_waitcnt lgkmcnt(6)
v_mfma_f32_32x32x16_bf16 v[88:103], v[36:39], a[28:31], v[88:103]
ds_read_b64_tr_b16 v[20:21], v3 offset:40960
ds_read_b64_tr_b16 v[22:23], v3 offset:43008
s_waitcnt vmcnt(27)
s_waitcnt lgkmcnt(6)
v_mfma_f32_32x32x16_bf16 v[40:55], v[8:11], a[32:35], v[40:55]
ds_read_b64_tr_b16 v[24:25], v2 offset:33792
ds_read_b64_tr_b16 v[26:27], v2 offset:35840
s_waitcnt lgkmcnt(6)
v_mfma_f32_32x32x16_bf16 v[56:71], v[12:15], a[32:35], v[56:71]
ds_read_b64_tr_b16 v[28:29], v3 offset:33792
ds_read_b64_tr_b16 v[30:31], v3 offset:35840
s_waitcnt lgkmcnt(6)
v_mfma_f32_32x32x16_bf16 v[72:87], v[16:19], a[32:35], v[72:87]
ds_read_b64_tr_b16 v[32:33], v2 offset:41984
ds_read_b64_tr_b16 v[34:35], v2 offset:44032
s_waitcnt lgkmcnt(6)
v_mfma_f32_32x32x16_bf16 v[88:103], v[20:23], a[32:35], v[88:103]
ds_read_b64_tr_b16 v[36:37], v3 offset:41984
ds_read_b64_tr_b16 v[38:39], v3 offset:44032
s_waitcnt vmcnt(26)
s_waitcnt lgkmcnt(6)
v_mfma_f32_32x32x16_bf16 v[40:55], v[24:27], a[36:39], v[40:55]
ds_read_b64_tr_b16 v[8:9], v2 offset:36864
ds_read_b64_tr_b16 v[10:11], v2 offset:38912
s_waitcnt lgkmcnt(6)
v_mfma_f32_32x32x16_bf16 v[56:71], v[28:31], a[36:39], v[56:71]
ds_read_b64_tr_b16 v[12:13], v3 offset:36864
ds_read_b64_tr_b16 v[14:15], v3 offset:38912
s_waitcnt lgkmcnt(6)
v_mfma_f32_32x32x16_bf16 v[72:87], v[32:35], a[36:39], v[72:87]
ds_read_b64_tr_b16 v[16:17], v2 offset:45056
ds_read_b64_tr_b16 v[18:19], v2 offset:47104
s_waitcnt lgkmcnt(6)
v_mfma_f32_32x32x16_bf16 v[88:103], v[36:39], a[36:39], v[88:103]
ds_read_b64_tr_b16 v[20:21], v3 offset:45056
ds_read_b64_tr_b16 v[22:23], v3 offset:47104
s_waitcnt vmcnt(25)
s_waitcnt lgkmcnt(6)
v_mfma_f32_32x32x16_bf16 v[40:55], v[8:11], a[40:43], v[40:55]
ds_read_b64_tr_b16 v[24:25], v2 offset:37888
ds_read_b64_tr_b16 v[26:27], v2 offset:39936
s_waitcnt lgkmcnt(6)
v_mfma_f32_32x32x16_bf16 v[56:71], v[12:15], a[40:43], v[56:71]
ds_read_b64_tr_b16 v[28:29], v3 offset:37888
ds_read_b64_tr_b16 v[30:31], v3 offset:39936
s_waitcnt lgkmcnt(6)
v_mfma_f32_32x32x16_bf16 v[72:87], v[16:19], a[40:43], v[72:87]
ds_read_b64_tr_b16 v[32:33], v2 offset:46080
ds_read_b64_tr_b16 v[34:35], v2 offset:48128
s_waitcnt lgkmcnt(6)
v_mfma_f32_32x32x16_bf16 v[88:103], v[20:23], a[40:43], v[88:103]
ds_read_b64_tr_b16 v[36:37], v3 offset:46080
ds_read_b64_tr_b16 v[38:39], v3 offset:48128
s_waitcnt vmcnt(24)
s_waitcnt lgkmcnt(6)
v_mfma_f32_32x32x16_bf16 v[40:55], v[24:27], a[44:47], v[40:55]
ds_read_b64_tr_b16 v[8:9], v2 offset:49152
ds_read_b64_tr_b16 v[10:11], v2 offset:51200
s_waitcnt lgkmcnt(6)
v_mfma_f32_32x32x16_bf16 v[56:71], v[28:31], a[44:47], v[56:71]
ds_read_b64_tr_b16 v[12:13], v3 offset:49152
ds_read_b64_tr_b16 v[14:15], v3 offset:51200
s_waitcnt lgkmcnt(6)
v_mfma_f32_32x32x16_bf16 v[72:87], v[32:35], a[44:47], v[72:87]
ds_read_b64_tr_b16 v[16:17], v2 offset:57344
ds_read_b64_tr_b16 v[18:19], v2 offset:59392
s_waitcnt lgkmcnt(6)
v_mfma_f32_32x32x16_bf16 v[88:103], v[36:39], a[44:47], v[88:103]
ds_read_b64_tr_b16 v[20:21], v3 offset:57344
ds_read_b64_tr_b16 v[22:23], v3 offset:59392
s_waitcnt vmcnt(23)
s_waitcnt lgkmcnt(6)
v_mfma_f32_32x32x16_bf16 v[40:55], v[8:11], a[48:51], v[40:55]
ds_read_b64_tr_b16 v[24:25], v2 offset:50176
ds_read_b64_tr_b16 v[26:27], v2 offset:52224
s_waitcnt lgkmcnt(6)
v_mfma_f32_32x32x16_bf16 v[56:71], v[12:15], a[48:51], v[56:71]
ds_read_b64_tr_b16 v[28:29], v3 offset:50176
ds_read_b64_tr_b16 v[30:31], v3 offset:52224
s_waitcnt lgkmcnt(6)
v_mfma_f32_32x32x16_bf16 v[72:87], v[16:19], a[48:51], v[72:87]
ds_read_b64_tr_b16 v[32:33], v2 offset:58368
ds_read_b64_tr_b16 v[34:35], v2 offset:60416
s_waitcnt lgkmcnt(6)
v_mfma_f32_32x32x16_bf16 v[88:103], v[20:23], a[48:51], v[88:103]
ds_read_b64_tr_b16 v[36:37], v3 offset:58368
ds_read_b64_tr_b16 v[38:39], v3 offset:60416
s_waitcnt vmcnt(22)
s_waitcnt lgkmcnt(6)
v_mfma_f32_32x32x16_bf16 v[40:55], v[24:27], a[52:55], v[40:55]
ds_read_b64_tr_b16 v[8:9], v2 offset:53248
ds_read_b64_tr_b16 v[10:11], v2 offset:55296
s_waitcnt lgkmcnt(6)
v_mfma_f32_32x32x16_bf16 v[56:71], v[28:31], a[52:55], v[56:71]
ds_read_b64_tr_b16 v[12:13], v3 offset:53248
ds_read_b64_tr_b16 v[14:15], v3 offset:55296
s_waitcnt lgkmcnt(6)
v_mfma_f32_32x32x16_bf16 v[72:87], v[32:35], a[52:55], v[72:87]
ds_read_b64_tr_b16 v[16:17], v2 offset:61440
ds_read_b64_tr_b16 v[18:19], v2 offset:63488
s_waitcnt lgkmcnt(6)
v_mfma_f32_32x32x16_bf16 v[88:103], v[36:39], a[52:55], v[88:103]
ds_read_b64_tr_b16 v[20:21], v3 offset:61440
ds_read_b64_tr_b16 v[22:23], v3 offset:63488
s_waitcnt vmcnt(21)
s_waitcnt lgkmcnt(6)
v_mfma_f32_32x32x16_bf16 v[40:55], v[8:11], a[56:59], v[40:55]
ds_read_b64_tr_b16 v[24:25], v2 offset:54272
ds_read_b64_tr_b16 v[26:27], v2 offset:56320
s_waitcnt lgkmcnt(6)
v_mfma_f32_32x32x16_bf16 v[56:71], v[12:15], a[56:59], v[56:71]
ds_read_b64_tr_b16 v[28:29], v3 offset:54272
ds_read_b64_tr_b16 v[30:31], v3 offset:56320
s_waitcnt lgkmcnt(6)
v_mfma_f32_32x32x16_bf16 v[72:87], v[16:19], a[56:59], v[72:87]
ds_read_b64_tr_b16 v[32:33], v2 offset:62464
ds_read_b64_tr_b16 v[34:35], v2 offset:64512
s_waitcnt lgkmcnt(6)
v_mfma_f32_32x32x16_bf16 v[88:103], v[20:23], a[56:59], v[88:103]
ds_read_b64_tr_b16 v[36:37], v3 offset:62464
ds_read_b64_tr_b16 v[38:39], v3 offset:64512
s_waitcnt vmcnt(20)
s_waitcnt lgkmcnt(6)
v_mfma_f32_32x32x16_bf16 v[40:55], v[24:27], a[60:63], v[40:55]
ds_read_b64_tr_b16 v[8:9], v4 offset:0
ds_read_b64_tr_b16 v[10:11], v4 offset:2048
s_waitcnt lgkmcnt(6)
v_mfma_f32_32x32x16_bf16 v[56:71], v[28:31], a[60:63], v[56:71]
ds_read_b64_tr_b16 v[12:13], v5 offset:0
ds_read_b64_tr_b16 v[14:15], v5 offset:2048
s_waitcnt lgkmcnt(6)
v_mfma_f32_32x32x16_bf16 v[72:87], v[32:35], a[60:63], v[72:87]
ds_read_b64_tr_b16 v[16:17], v4 offset:8192
ds_read_b64_tr_b16 v[18:19], v4 offset:10240
s_waitcnt lgkmcnt(6)
v_mfma_f32_32x32x16_bf16 v[88:103], v[36:39], a[60:63], v[88:103]
ds_read_b64_tr_b16 v[20:21], v5 offset:8192
ds_read_b64_tr_b16 v[22:23], v5 offset:10240
s_waitcnt vmcnt(19)
s_waitcnt lgkmcnt(6)
v_mfma_f32_32x32x16_bf16 v[40:55], v[8:11], a[64:67], v[40:55]
ds_read_b64_tr_b16 v[24:25], v4 offset:1024
ds_read_b64_tr_b16 v[26:27], v4 offset:3072
s_waitcnt lgkmcnt(6)
v_mfma_f32_32x32x16_bf16 v[56:71], v[12:15], a[64:67], v[56:71]
ds_read_b64_tr_b16 v[28:29], v5 offset:1024
ds_read_b64_tr_b16 v[30:31], v5 offset:3072
s_waitcnt lgkmcnt(6)
v_mfma_f32_32x32x16_bf16 v[72:87], v[16:19], a[64:67], v[72:87]
ds_read_b64_tr_b16 v[32:33], v4 offset:9216
ds_read_b64_tr_b16 v[34:35], v4 offset:11264
s_waitcnt lgkmcnt(6)
v_mfma_f32_32x32x16_bf16 v[88:103], v[20:23], a[64:67], v[88:103]
ds_read_b64_tr_b16 v[36:37], v5 offset:9216
ds_read_b64_tr_b16 v[38:39], v5 offset:11264
s_waitcnt vmcnt(18)
s_waitcnt lgkmcnt(6)
v_mfma_f32_32x32x16_bf16 v[40:55], v[24:27], a[68:71], v[40:55]
ds_read_b64_tr_b16 v[8:9], v4 offset:4096
ds_read_b64_tr_b16 v[10:11], v4 offset:6144
s_waitcnt lgkmcnt(6)
v_mfma_f32_32x32x16_bf16 v[56:71], v[28:31], a[68:71], v[56:71]
ds_read_b64_tr_b16 v[12:13], v5 offset:4096
ds_read_b64_tr_b16 v[14:15], v5 offset:6144
s_waitcnt lgkmcnt(6)
v_mfma_f32_32x32x16_bf16 v[72:87], v[32:35], a[68:71], v[72:87]
ds_read_b64_tr_b16 v[16:17], v4 offset:12288
ds_read_b64_tr_b16 v[18:19], v4 offset:14336
s_waitcnt lgkmcnt(6)
v_mfma_f32_32x32x16_bf16 v[88:103], v[36:39], a[68:71], v[88:103]
ds_read_b64_tr_b16 v[20:21], v5 offset:12288
ds_read_b64_tr_b16 v[22:23], v5 offset:14336
s_waitcnt vmcnt(17)
s_waitcnt lgkmcnt(6)
v_mfma_f32_32x32x16_bf16 v[40:55], v[8:11], a[72:75], v[40:55]
ds_read_b64_tr_b16 v[24:25], v4 offset:5120
ds_read_b64_tr_b16 v[26:27], v4 offset:7168
s_waitcnt lgkmcnt(6)
v_mfma_f32_32x32x16_bf16 v[56:71], v[12:15], a[72:75], v[56:71]
ds_read_b64_tr_b16 v[28:29], v5 offset:5120
ds_read_b64_tr_b16 v[30:31], v5 offset:7168
s_waitcnt lgkmcnt(6)
v_mfma_f32_32x32x16_bf16 v[72:87], v[16:19], a[72:75], v[72:87]
ds_read_b64_tr_b16 v[32:33], v4 offset:13312
ds_read_b64_tr_b16 v[34:35], v4 offset:15360
s_waitcnt lgkmcnt(6)
v_mfma_f32_32x32x16_bf16 v[88:103], v[20:23], a[72:75], v[88:103]
ds_read_b64_tr_b16 v[36:37], v5 offset:13312
ds_read_b64_tr_b16 v[38:39], v5 offset:15360
s_waitcnt vmcnt(16)
s_waitcnt lgkmcnt(6)
v_mfma_f32_32x32x16_bf16 v[40:55], v[24:27], a[76:79], v[40:55]
ds_read_b64_tr_b16 v[8:9], v4 offset:16384
ds_read_b64_tr_b16 v[10:11], v4 offset:18432
s_waitcnt lgkmcnt(6)
v_mfma_f32_32x32x16_bf16 v[56:71], v[28:31], a[76:79], v[56:71]
ds_read_b64_tr_b16 v[12:13], v5 offset:16384
ds_read_b64_tr_b16 v[14:15], v5 offset:18432
s_waitcnt lgkmcnt(6)
v_mfma_f32_32x32x16_bf16 v[72:87], v[32:35], a[76:79], v[72:87]
ds_read_b64_tr_b16 v[16:17], v4 offset:24576
ds_read_b64_tr_b16 v[18:19], v4 offset:26624
s_waitcnt lgkmcnt(6)
v_mfma_f32_32x32x16_bf16 v[88:103], v[36:39], a[76:79], v[88:103]
ds_read_b64_tr_b16 v[20:21], v5 offset:24576
ds_read_b64_tr_b16 v[22:23], v5 offset:26624
s_waitcnt vmcnt(15)
s_waitcnt lgkmcnt(6)
v_mfma_f32_32x32x16_bf16 v[40:55], v[8:11], a[80:83], v[40:55]
ds_read_b64_tr_b16 v[24:25], v4 offset:17408
ds_read_b64_tr_b16 v[26:27], v4 offset:19456
s_waitcnt lgkmcnt(6)
v_mfma_f32_32x32x16_bf16 v[56:71], v[12:15], a[80:83], v[56:71]
ds_read_b64_tr_b16 v[28:29], v5 offset:17408
ds_read_b64_tr_b16 v[30:31], v5 offset:19456
s_waitcnt lgkmcnt(6)
v_mfma_f32_32x32x16_bf16 v[72:87], v[16:19], a[80:83], v[72:87]
ds_read_b64_tr_b16 v[32:33], v4 offset:25600
ds_read_b64_tr_b16 v[34:35], v4 offset:27648
s_waitcnt lgkmcnt(6)
v_mfma_f32_32x32x16_bf16 v[88:103], v[20:23], a[80:83], v[88:103]
ds_read_b64_tr_b16 v[36:37], v5 offset:25600
ds_read_b64_tr_b16 v[38:39], v5 offset:27648
s_waitcnt vmcnt(14)
s_waitcnt lgkmcnt(6)
v_mfma_f32_32x32x16_bf16 v[40:55], v[24:27], a[84:87], v[40:55]
ds_read_b64_tr_b16 v[8:9], v4 offset:20480
ds_read_b64_tr_b16 v[10:11], v4 offset:22528
s_waitcnt lgkmcnt(6)
v_mfma_f32_32x32x16_bf16 v[56:71], v[28:31], a[84:87], v[56:71]
ds_read_b64_tr_b16 v[12:13], v5 offset:20480
ds_read_b64_tr_b16 v[14:15], v5 offset:22528
s_waitcnt lgkmcnt(6)
v_mfma_f32_32x32x16_bf16 v[72:87], v[32:35], a[84:87], v[72:87]
ds_read_b64_tr_b16 v[16:17], v4 offset:28672
ds_read_b64_tr_b16 v[18:19], v4 offset:30720
s_waitcnt lgkmcnt(6)
v_mfma_f32_32x32x16_bf16 v[88:103], v[36:39], a[84:87], v[88:103]
ds_read_b64_tr_b16 v[20:21], v5 offset:28672
ds_read_b64_tr_b16 v[22:23], v5 offset:30720
s_waitcnt vmcnt(13)
s_waitcnt lgkmcnt(6)
v_mfma_f32_32x32x16_bf16 v[40:55], v[8:11], a[88:91], v[40:55]
ds_read_b64_tr_b16 v[24:25], v4 offset:21504
ds_read_b64_tr_b16 v[26:27], v4 offset:23552
s_waitcnt lgkmcnt(6)
v_mfma_f32_32x32x16_bf16 v[56:71], v[12:15], a[88:91], v[56:71]
ds_read_b64_tr_b16 v[28:29], v5 offset:21504
ds_read_b64_tr_b16 v[30:31], v5 offset:23552
s_waitcnt lgkmcnt(6)
v_mfma_f32_32x32x16_bf16 v[72:87], v[16:19], a[88:91], v[72:87]
ds_read_b64_tr_b16 v[32:33], v4 offset:29696
ds_read_b64_tr_b16 v[34:35], v4 offset:31744
s_waitcnt lgkmcnt(6)
v_mfma_f32_32x32x16_bf16 v[88:103], v[20:23], a[88:91], v[88:103]
ds_read_b64_tr_b16 v[36:37], v5 offset:29696
ds_read_b64_tr_b16 v[38:39], v5 offset:31744
s_waitcnt vmcnt(12)
s_waitcnt lgkmcnt(6)
v_mfma_f32_32x32x16_bf16 v[40:55], v[24:27], a[92:95], v[40:55]
ds_read_b64_tr_b16 v[8:9], v4 offset:32768
ds_read_b64_tr_b16 v[10:11], v4 offset:34816
s_waitcnt lgkmcnt(6)
v_mfma_f32_32x32x16_bf16 v[56:71], v[28:31], a[92:95], v[56:71]
ds_read_b64_tr_b16 v[12:13], v5 offset:32768
ds_read_b64_tr_b16 v[14:15], v5 offset:34816
s_waitcnt lgkmcnt(6)
v_mfma_f32_32x32x16_bf16 v[72:87], v[32:35], a[92:95], v[72:87]
ds_read_b64_tr_b16 v[16:17], v4 offset:40960
ds_read_b64_tr_b16 v[18:19], v4 offset:43008
s_waitcnt lgkmcnt(6)
v_mfma_f32_32x32x16_bf16 v[88:103], v[36:39], a[92:95], v[88:103]
ds_read_b64_tr_b16 v[20:21], v5 offset:40960
ds_read_b64_tr_b16 v[22:23], v5 offset:43008
s_waitcnt vmcnt(11)
s_waitcnt lgkmcnt(6)
v_mfma_f32_32x32x16_bf16 v[40:55], v[8:11], a[96:99], v[40:55]
ds_read_b64_tr_b16 v[24:25], v4 offset:33792
ds_read_b64_tr_b16 v[26:27], v4 offset:35840
s_waitcnt lgkmcnt(6)
v_mfma_f32_32x32x16_bf16 v[56:71], v[12:15], a[96:99], v[56:71]
ds_read_b64_tr_b16 v[28:29], v5 offset:33792
ds_read_b64_tr_b16 v[30:31], v5 offset:35840
s_waitcnt lgkmcnt(6)
v_mfma_f32_32x32x16_bf16 v[72:87], v[16:19], a[96:99], v[72:87]
ds_read_b64_tr_b16 v[32:33], v4 offset:41984
ds_read_b64_tr_b16 v[34:35], v4 offset:44032
s_waitcnt lgkmcnt(6)
v_mfma_f32_32x32x16_bf16 v[88:103], v[20:23], a[96:99], v[88:103]
ds_read_b64_tr_b16 v[36:37], v5 offset:41984
ds_read_b64_tr_b16 v[38:39], v5 offset:44032
s_waitcnt vmcnt(10)
s_waitcnt lgkmcnt(6)
v_mfma_f32_32x32x16_bf16 v[40:55], v[24:27], a[100:103], v[40:55]
ds_read_b64_tr_b16 v[8:9], v4 offset:36864
ds_read_b64_tr_b16 v[10:11], v4 offset:38912
s_waitcnt lgkmcnt(6)
v_mfma_f32_32x32x16_bf16 v[56:71], v[28:31], a[100:103], v[56:71]
ds_read_b64_tr_b16 v[12:13], v5 offset:36864
ds_read_b64_tr_b16 v[14:15], v5 offset:38912
s_waitcnt lgkmcnt(6)
v_mfma_f32_32x32x16_bf16 v[72:87], v[32:35], a[100:103], v[72:87]
ds_read_b64_tr_b16 v[16:17], v4 offset:45056
ds_read_b64_tr_b16 v[18:19], v4 offset:47104
s_waitcnt lgkmcnt(6)
v_mfma_f32_32x32x16_bf16 v[88:103], v[36:39], a[100:103], v[88:103]
ds_read_b64_tr_b16 v[20:21], v5 offset:45056
ds_read_b64_tr_b16 v[22:23], v5 offset:47104
s_waitcnt vmcnt(9)
s_waitcnt lgkmcnt(6)
v_mfma_f32_32x32x16_bf16 v[40:55], v[8:11], a[104:107], v[40:55]
ds_read_b64_tr_b16 v[24:25], v4 offset:37888
ds_read_b64_tr_b16 v[26:27], v4 offset:39936
s_waitcnt lgkmcnt(6)
v_mfma_f32_32x32x16_bf16 v[56:71], v[12:15], a[104:107], v[56:71]
ds_read_b64_tr_b16 v[28:29], v5 offset:37888
ds_read_b64_tr_b16 v[30:31], v5 offset:39936
s_waitcnt lgkmcnt(6)
v_mfma_f32_32x32x16_bf16 v[72:87], v[16:19], a[104:107], v[72:87]
ds_read_b64_tr_b16 v[32:33], v4 offset:46080
ds_read_b64_tr_b16 v[34:35], v4 offset:48128
s_waitcnt lgkmcnt(6)
v_mfma_f32_32x32x16_bf16 v[88:103], v[20:23], a[104:107], v[88:103]
ds_read_b64_tr_b16 v[36:37], v5 offset:46080
ds_read_b64_tr_b16 v[38:39], v5 offset:48128
s_waitcnt vmcnt(8)
s_waitcnt lgkmcnt(6)
v_mfma_f32_32x32x16_bf16 v[40:55], v[24:27], a[108:111], v[40:55]
ds_read_b64_tr_b16 v[8:9], v4 offset:49152
ds_read_b64_tr_b16 v[10:11], v4 offset:51200
s_waitcnt lgkmcnt(6)
v_mfma_f32_32x32x16_bf16 v[56:71], v[28:31], a[108:111], v[56:71]
ds_read_b64_tr_b16 v[12:13], v5 offset:49152
ds_read_b64_tr_b16 v[14:15], v5 offset:51200
s_waitcnt lgkmcnt(6)
v_mfma_f32_32x32x16_bf16 v[72:87], v[32:35], a[108:111], v[72:87]
ds_read_b64_tr_b16 v[16:17], v4 offset:57344
ds_read_b64_tr_b16 v[18:19], v4 offset:59392
s_waitcnt lgkmcnt(6)
v_mfma_f32_32x32x16_bf16 v[88:103], v[36:39], a[108:111], v[88:103]
ds_read_b64_tr_b16 v[20:21], v5 offset:57344
ds_read_b64_tr_b16 v[22:23], v5 offset:59392
s_waitcnt vmcnt(7)
s_waitcnt lgkmcnt(6)
v_mfma_f32_32x32x16_bf16 v[40:55], v[8:11], a[112:115], v[40:55]
ds_read_b64_tr_b16 v[24:25], v4 offset:50176
ds_read_b64_tr_b16 v[26:27], v4 offset:52224
s_waitcnt lgkmcnt(6)
v_mfma_f32_32x32x16_bf16 v[56:71], v[12:15], a[112:115], v[56:71]
ds_read_b64_tr_b16 v[28:29], v5 offset:50176
ds_read_b64_tr_b16 v[30:31], v5 offset:52224
s_waitcnt lgkmcnt(6)
v_mfma_f32_32x32x16_bf16 v[72:87], v[16:19], a[112:115], v[72:87]
ds_read_b64_tr_b16 v[32:33], v4 offset:58368
ds_read_b64_tr_b16 v[34:35], v4 offset:60416
s_waitcnt lgkmcnt(6)
v_mfma_f32_32x32x16_bf16 v[88:103], v[20:23], a[112:115], v[88:103]
ds_read_b64_tr_b16 v[36:37], v5 offset:58368
ds_read_b64_tr_b16 v[38:39], v5 offset:60416
s_waitcnt vmcnt(6)
s_waitcnt lgkmcnt(6)
v_mfma_f32_32x32x16_bf16 v[40:55], v[24:27], a[116:119], v[40:55]
ds_read_b64_tr_b16 v[8:9], v4 offset:53248
ds_read_b64_tr_b16 v[10:11], v4 offset:55296
s_waitcnt lgkmcnt(6)
v_mfma_f32_32x32x16_bf16 v[56:71], v[28:31], a[116:119], v[56:71]
ds_read_b64_tr_b16 v[12:13], v5 offset:53248
ds_read_b64_tr_b16 v[14:15], v5 offset:55296
s_waitcnt lgkmcnt(6)
v_mfma_f32_32x32x16_bf16 v[72:87], v[32:35], a[116:119], v[72:87]
ds_read_b64_tr_b16 v[16:17], v4 offset:61440
ds_read_b64_tr_b16 v[18:19], v4 offset:63488
s_waitcnt lgkmcnt(6)
v_mfma_f32_32x32x16_bf16 v[88:103], v[36:39], a[116:119], v[88:103]
ds_read_b64_tr_b16 v[20:21], v5 offset:61440
ds_read_b64_tr_b16 v[22:23], v5 offset:63488
s_waitcnt vmcnt(5)
s_waitcnt lgkmcnt(6)
v_mfma_f32_32x32x16_bf16 v[40:55], v[8:11], a[120:123], v[40:55]
ds_read_b64_tr_b16 v[24:25], v4 offset:54272
ds_read_b64_tr_b16 v[26:27], v4 offset:56320
s_waitcnt lgkmcnt(6)
v_mfma_f32_32x32x16_bf16 v[56:71], v[12:15], a[120:123], v[56:71]
ds_read_b64_tr_b16 v[28:29], v5 offset:54272
ds_read_b64_tr_b16 v[30:31], v5 offset:56320
s_waitcnt lgkmcnt(6)
v_mfma_f32_32x32x16_bf16 v[72:87], v[16:19], a[120:123], v[72:87]
ds_read_b64_tr_b16 v[32:33], v4 offset:62464
ds_read_b64_tr_b16 v[34:35], v4 offset:64512
s_waitcnt lgkmcnt(6)
v_mfma_f32_32x32x16_bf16 v[88:103], v[20:23], a[120:123], v[88:103]
ds_read_b64_tr_b16 v[36:37], v5 offset:62464
ds_read_b64_tr_b16 v[38:39], v5 offset:64512
s_waitcnt vmcnt(4)
s_waitcnt lgkmcnt(6)
v_mfma_f32_32x32x16_bf16 v[40:55], v[24:27], a[124:127], v[40:55]
ds_read_b64_tr_b16 v[8:9], v6 offset:0
ds_read_b64_tr_b16 v[10:11], v6 offset:2048
s_waitcnt lgkmcnt(6)
v_mfma_f32_32x32x16_bf16 v[56:71], v[28:31], a[124:127], v[56:71]
ds_read_b64_tr_b16 v[12:13], v7 offset:0
ds_read_b64_tr_b16 v[14:15], v7 offset:2048
s_waitcnt lgkmcnt(6)
v_mfma_f32_32x32x16_bf16 v[72:87], v[32:35], a[124:127], v[72:87]
ds_read_b64_tr_b16 v[16:17], v6 offset:8192
ds_read_b64_tr_b16 v[18:19], v6 offset:10240
s_waitcnt lgkmcnt(6)
v_mfma_f32_32x32x16_bf16 v[88:103], v[36:39], a[124:127], v[88:103]
ds_read_b64_tr_b16 v[20:21], v7 offset:8192
ds_read_b64_tr_b16 v[22:23], v7 offset:10240
s_waitcnt vmcnt(3)
s_waitcnt lgkmcnt(6)
v_mfma_f32_32x32x16_bf16 v[40:55], v[8:11], a[128:131], v[40:55]
ds_read_b64_tr_b16 v[24:25], v6 offset:1024
ds_read_b64_tr_b16 v[26:27], v6 offset:3072
s_waitcnt lgkmcnt(6)
v_mfma_f32_32x32x16_bf16 v[56:71], v[12:15], a[128:131], v[56:71]
ds_read_b64_tr_b16 v[28:29], v7 offset:1024
ds_read_b64_tr_b16 v[30:31], v7 offset:3072
s_waitcnt lgkmcnt(6)
v_mfma_f32_32x32x16_bf16 v[72:87], v[16:19], a[128:131], v[72:87]
ds_read_b64_tr_b16 v[32:33], v6 offset:9216
ds_read_b64_tr_b16 v[34:35], v6 offset:11264
s_waitcnt lgkmcnt(6)
v_mfma_f32_32x32x16_bf16 v[88:103], v[20:23], a[128:131], v[88:103]
ds_read_b64_tr_b16 v[36:37], v7 offset:9216
ds_read_b64_tr_b16 v[38:39], v7 offset:11264
s_waitcnt vmcnt(2)
s_waitcnt lgkmcnt(6)
v_mfma_f32_32x32x16_bf16 v[40:55], v[24:27], a[132:135], v[40:55]
ds_read_b64_tr_b16 v[8:9], v6 offset:4096
ds_read_b64_tr_b16 v[10:11], v6 offset:6144
s_waitcnt lgkmcnt(6)
v_mfma_f32_32x32x16_bf16 v[56:71], v[28:31], a[132:135], v[56:71]
ds_read_b64_tr_b16 v[12:13], v7 offset:4096
ds_read_b64_tr_b16 v[14:15], v7 offset:6144
s_waitcnt lgkmcnt(6)
v_mfma_f32_32x32x16_bf16 v[72:87], v[32:35], a[132:135], v[72:87]
ds_read_b64_tr_b16 v[16:17], v6 offset:12288
ds_read_b64_tr_b16 v[18:19], v6 offset:14336
s_waitcnt lgkmcnt(6)
v_mfma_f32_32x32x16_bf16 v[88:103], v[36:39], a[132:135], v[88:103]
ds_read_b64_tr_b16 v[20:21], v7 offset:12288
ds_read_b64_tr_b16 v[22:23], v7 offset:14336
s_waitcnt vmcnt(1)
s_waitcnt lgkmcnt(6)
v_mfma_f32_32x32x16_bf16 v[40:55], v[8:11], a[136:139], v[40:55]
ds_read_b64_tr_b16 v[24:25], v6 offset:5120
ds_read_b64_tr_b16 v[26:27], v6 offset:7168
s_waitcnt lgkmcnt(6)
v_mfma_f32_32x32x16_bf16 v[56:71], v[12:15], a[136:139], v[56:71]
ds_read_b64_tr_b16 v[28:29], v7 offset:5120
ds_read_b64_tr_b16 v[30:31], v7 offset:7168
s_waitcnt lgkmcnt(6)
v_mfma_f32_32x32x16_bf16 v[72:87], v[16:19], a[136:139], v[72:87]
ds_read_b64_tr_b16 v[32:33], v6 offset:13312
ds_read_b64_tr_b16 v[34:35], v6 offset:15360
s_waitcnt lgkmcnt(6)
v_mfma_f32_32x32x16_bf16 v[88:103], v[20:23], a[136:139], v[88:103]
ds_read_b64_tr_b16 v[36:37], v7 offset:13312
ds_read_b64_tr_b16 v[38:39], v7 offset:15360
s_waitcnt vmcnt(0)
s_waitcnt lgkmcnt(6)
v_mfma_f32_32x32x16_bf16 v[40:55], v[24:27], a[140:143], v[40:55]
s_waitcnt lgkmcnt(4)
v_mfma_f32_32x32x16_bf16 v[56:71], v[28:31], a[140:143], v[56:71]
s_waitcnt lgkmcnt(2)
v_mfma_f32_32x32x16_bf16 v[72:87], v[32:35], a[140:143], v[72:87]
s_waitcnt lgkmcnt(0)
v_mfma_f32_32x32x16_bf16 v[88:103], v[36:39], a[140:143], v[88:103]
s_nop 11
s_add_u32 s77, s82, 0
buffer_store_dwordx4 v[40:43], v0, s[8:11], s77 offen offset:0 sc1
buffer_store_dwordx4 v[44:47], v0, s[8:11], s77 offen offset:1024 sc1
buffer_store_dwordx4 v[48:51], v0, s[8:11], s77 offen offset:2048 sc1
buffer_store_dwordx4 v[52:55], v0, s[8:11], s77 offen offset:3072 sc1
s_add_u32 s77, s82, 4096
buffer_store_dwordx4 v[56:59], v0, s[8:11], s77 offen offset:0 sc1
buffer_store_dwordx4 v[60:63], v0, s[8:11], s77 offen offset:1024 sc1
buffer_store_dwordx4 v[64:67], v0, s[8:11], s77 offen offset:2048 sc1
buffer_store_dwordx4 v[68:71], v0, s[8:11], s77 offen offset:3072 sc1
s_add_u32 s77, s82, 8192
buffer_store_dwordx4 v[72:75], v0, s[8:11], s77 offen offset:0 sc1
buffer_store_dwordx4 v[76:79], v0, s[8:11], s77 offen offset:1024 sc1
buffer_store_dwordx4 v[80:83], v0, s[8:11], s77 offen offset:2048 sc1
buffer_store_dwordx4 v[84:87], v0, s[8:11], s77 offen offset:3072 sc1
s_add_u32 s77, s82, 12288
buffer_store_dwordx4 v[88:91], v0, s[8:11], s77 offen offset:0 sc1
buffer_store_dwordx4 v[92:95], v0, s[8:11], s77 offen offset:1024 sc1
buffer_store_dwordx4 v[96:99], v0, s[8:11], s77 offen offset:2048 sc1
buffer_store_dwordx4 v[100:103], v0, s[8:11], s77 offen offset:3072 sc1
s_waitcnt vmcnt(0) lgkmcnt(0)
s_barrier
s_cmp_eq_u32 s13, 0
s_cbranch_scc0 L_rs_21
s_lshl_b32 s25, s32, 7
s_add_u32 s25, s25, 70287360
v_mov_b32 v250, s25
v_mov_b32 v251, 1
s_mov_b64 exec, 1
buffer_atomic_add v251, v250, s[8:11], 0 offen
s_mov_b64 exec, -1
L_rs_21:
s_add_u32 s32, s32, 1
s_cmp_lt_u32 s32, 16
s_cbranch_scc1 RE4_g
s_branch K_end
K_rE2:
v_mbcnt_lo_u32_b32 v0, -1, 0
v_mbcnt_hi_u32_b32 v0, -1, v0
s_mov_b32 s28, 16
s_sub_u32 s23, s33, 192
v_lshrrev_b32 v10, 3, v0
v_and_b32 v11, 7, v0
v_bfe_u32 v12, v0, 4, 1
v_lshlrev_b32 v12, 2, v12
v_xor_b32 v11, v11, v12
s_mov_b32 s76, 1152
v_mul_lo_u32 v1, v10, s76
v_lshl_add_u32 v1, v11, 4, v1
v_lshrrev_b32 v10, 5, v0
v_bfe_u32 v11, v0, 2, 2
v_lshl_add_u32 v10, v10, 2, v11
v_lshlrev_b32 v10, 7, v10
v_bfe_u32 v12, v0, 4, 1
v_lshl_add_u32 v10, v12, 5, v10
v_and_b32 v12, 3, v0
v_lshl_add_u32 v10, v12, 3, v10
v_lshrrev_b32 v11, 1, v11
v_lshlrev_b32 v11, 6, v11
v_add_u32 v2, v10, v11
v_xor_b32 v11, 64, v11
v_add_u32 v3, v10, v11
v_add_u32 v4, 0x10000, v2
v_add_u32 v5, 0x10000, v3
v_add_u32 v6, 0x20000, v2
v_add_u32 v7, 0x20000, v3
v_lshlrev_b32 v0, 4, v0
s_mov_b32 s64, s98
s_and_b32 s65, s99, 0xffff
s_mov_b32 s66, 5308416
s_mov_b32 s67, 0x20000
s_mul_i32 s73, s23, 663552
s_lshl_b32 s76, s28, 6
s_add_u32 s73, s73, s76
s_mul_i32 s76, s13, 18432
s_add_u32 s73, s73, s76
s_lshl_b32 s83, s13, 11
s_add_u32 m0, s83, 0
s_add_u32 s76, s73, 0
buffer_load_dwordx4 v1, s[64:67], s76 offen lds
s_add_u32 m0, s83, 1024
s_add_u32 s76, s73, 9216
buffer_load_dwordx4 v1, s[64:67], s76 offen lds
s_add_u32 m0, s83, 8192
s_add_u32 s76, s73, 73728
buffer_load_dwordx4 v1, s[64:67], s76 offen lds
s_add_u32 m0, s83, 9216
s_add_u32 s76, s73, 82944
buffer_load_dwordx4 v1, s[64:67], s76 offen lds
s_add_u32 m0, s83, 16384
s_add_u32 s76, s73, 147456
buffer_load_dwordx4 v1, s[64:67], s76 offen lds
s_add_u32 m0, s83, 17408
s_add_u32 s76, s73, 156672
buffer_load_dwordx4 v1, s[64:67], s76 offen lds
s_add_u32 m0, s83, 24576
s_add_u32 s76, s73, 221184
buffer_load_dwordx4 v1, s[64:67], s76 offen lds
s_add_u32 m0, s83, 25600
s_add_u32 s76, s73, 230400
buffer_load_dwordx4 v1, s[64:67], s76 offen lds
s_add_u32 m0, s83, 32768
s_add_u32 s76, s73, 294912
buffer_load_dwordx4 v1, s[64:67], s76 offen lds
s_add_u32 m0, s83, 33792
s_add_u32 s76, s73, 304128
buffer_load_dwordx4 v1, s[64:67], s76 offen lds
s_add_u32 m0, s83, 40960
s_add_u32 s76, s73, 368640
buffer_load_dwordx4 v1, s[64:67], s76 offen lds
s_add_u32 m0, s83, 41984
s_add_u32 s76, s73, 377856
buffer_load_dwordx4 v1, s[64:67], s76 offen lds
s_add_u32 m0, s83, 49152
s_add_u32 s76, s73, 442368
buffer_load_dwordx4 v1, s[64:67], s76 offen lds
s_add_u32 m0, s83, 50176
s_add_u32 s76, s73, 451584
buffer_load_dwordx4 v1, s[64:67], s76 offen lds
s_add_u32 m0, s83, 57344
s_add_u32 s76, s73, 516096
buffer_load_dwordx4 v1, s[64:67], s76 offen lds
s_add_u32 m0, s83, 58368
s_add_u32 s76, s73, 525312
buffer_load_dwordx4 v1, s[64:67], s76 offen lds
s_add_u32 m0, s83, 65536
s_add_u32 s76, s73, 589824
buffer_load_dwordx4 v1, s[64:67], s76 offen lds
s_add_u32 m0, s83, 66560
s_add_u32 s76, s73, 599040
buffer_load_dwordx4 v1, s[64:67], s76 offen lds
s_waitcnt vmcnt(0)
s_barrier
s_mov_b32 s32, 0
RE2_g:
s_cmp_eq_u32 s13, 0
s_cbranch_scc0 L_rd_22_b
s_lshl_b32 s25, s32, 7
s_add_u32 s25, s25, 70285312
v_mov_b32 v250, s25
s_mov_b32 s24, 0
L_rd_22:
buffer_load_dword v251, v250, s[8:11], 0 offen sc1
s_waitcnt vmcnt(0)
v_readfirstlane_b32 s25, v251
s_cmp_ge_u32 s25, 72
s_cbranch_scc1 L_rd_22_b
s_cmp_lt_u32 s32, 14
s_cbranch_scc0 L_rd_22_ns
s_sleep 8
L_rd_22_ns:
s_add_u32 s24, s24, 1
s_cmp_lt_u32 s24, 1200000
s_cbranch_scc1 L_rd_22
s_endpgm
L_rd_22_b:
s_barrier
s_lshl_b32 s29, s32, 2
s_add_u32 s29, s29, s13
s_mul_i32 s72, s29, 294912
s_mul_i32 s76, s23, 36864
s_add_u32 s72, s72, s76
s_add_u32 s72, s72, 100663296
s_lshl_b32 s82, s23, 6
s_add_u32 s82, s82, s29
s_mul_i32 s82, s82, 18
s_add_u32 s82, s82, s28
s_lshl_b32 s82, s82, 12
s_add_u32 s82, s82, 163577856
s_add_u32 s76, s72, 0
buffer_load_dwordx4 a[0:3], v0, s[8:11], s76 offen offset:0 sc1
buffer_load_dwordx4 a[4:7], v0, s[8:11], s76 offen offset:1024 sc1
buffer_load_dwordx4 a[8:11], v0, s[8:11], s76 offen offset:2048 sc1
buffer_load_dwordx4 a[12:15], v0, s[8:11], s76 offen offset:3072 sc1
s_add_u32 s76, s72, 4096
buffer_load_dwordx4 a[16:19], v0, s[8:11], s76 offen offset:0 sc1
buffer_load_dwordx4 a[20:23], v0, s[8:11], s76 offen offset:1024 sc1
buffer_load_dwordx4 a[24:27], v0, s[8:11], s76 offen offset:2048 sc1
buffer_load_dwordx4 a[28:31], v0, s[8:11], s76 offen offset:3072 sc1
s_add_u32 s76, s72, 8192
buffer_load_dwordx4 a[32:35], v0, s[8:11], s76 offen offset:0 sc1
buffer_load_dwordx4 a[36:39], v0, s[8:11], s76 offen offset:1024 sc1
buffer_load_dwordx4 a[40:43], v0, s[8:11], s76 offen offset:2048 sc1
buffer_load_dwordx4 a[44:47], v0, s[8:11], s76 offen offset:3072 sc1
s_add_u32 s76, s72, 12288
buffer_load_dwordx4 a[48:51], v0, s[8:11], s76 offen offset:0 sc1
buffer_load_dwordx4 a[52:55], v0, s[8:11], s76 offen offset:1024 sc1
buffer_load_dwordx4 a[56:59], v0, s[8:11], s76 offen offset:2048 sc1
buffer_load_dwordx4 a[60:63], v0, s[8:11], s76 offen offset:3072 sc1
s_add_u32 s76, s72, 16384
buffer_load_dwordx4 a[64:67], v0, s[8:11], s76 offen offset:0 sc1
buffer_load_dwordx4 a[68:71], v0, s[8:11], s76 offen offset:1024 sc1
buffer_load_dwordx4 a[72:75], v0, s[8:11], s76 offen offset:2048 sc1
buffer_load_dwordx4 a[76:79], v0, s[8:11], s76 offen offset:3072 sc1
s_add_u32 s76, s72, 20480
buffer_load_dwordx4 a[80:83], v0, s[8:11], s76 offen offset:0 sc1
buffer_load_dwordx4 a[84:87], v0, s[8:11], s76 offen offset:1024 sc1
buffer_load_dwordx4 a[88:91], v0, s[8:11], s76 offen offset:2048 sc1
buffer_load_dwordx4 a[92:95], v0, s[8:11], s76 offen offset:3072 sc1
s_add_u32 s76, s72, 24576
buffer_load_dwordx4 a[96:99], v0, s[8:11], s76 offen offset:0 sc1
buffer_load_dwordx4 a[100:103], v0, s[8:11], s76 offen offset:1024 sc1
buffer_load_dwordx4 a[104:107], v0, s[8:11], s76 offen offset:2048 sc1
buffer_load_dwordx4 a[108:111], v0, s[8:11], s76 offen offset:3072 sc1
s_add_u32 s76, s72, 28672
buffer_load_dwordx4 a[112:115], v0, s[8:11], s76 offen offset:0 sc1
buffer_load_dwordx4 a[116:119], v0, s[8:11], s76 offen offset:1024 sc1
buffer_load_dwordx4 a[120:123], v0, s[8:11], s76 offen offset:2048 sc1
buffer_load_dwordx4 a[124:127], v0, s[8:11], s76 offen offset:3072 sc1
s_add_u32 s76, s72, 32768
buffer_load_dwordx4 a[128:131], v0, s[8:11], s76 offen offset:0 sc1
buffer_load_dwordx4 a[132:135], v0, s[8:11], s76 offen offset:1024 sc1
buffer_load_dwordx4 a[136:139], v0, s[8:11], s76 offen offset:2048 sc1
buffer_load_dwordx4 a[140:143], v0, s[8:11], s76 offen offset:3072 sc1
ds_read_b64_tr_b16 v[8:9], v2 offset:0
ds_read_b64_tr_b16 v[10:11], v2 offset:2048
ds_read_b64_tr_b16 v[12:13], v3 offset:0
ds_read_b64_tr_b16 v[14:15], v3 offset:2048
s_waitcnt vmcnt(35)
s_waitcnt lgkmcnt(2)
v_mfma_f32_32x32x16_bf16 v[24:39], v[8:11], a[0:3], 0
ds_read_b64_tr_b16 v[16:17], v2 offset:1024
ds_read_b64_tr_b16 v[18:19], v2 offset:3072
s_waitcnt lgkmcnt(2)
v_mfma_f32_32x32x16_bf16 v[40:55], v[12:15], a[0:3], 0
ds_read_b64_tr_b16 v[20:21], v3 offset:1024
ds_read_b64_tr_b16 v[22:23], v3 offset:3072
s_waitcnt vmcnt(34)
s_waitcnt lgkmcnt(2)
v_mfma_f32_32x32x16_bf16 v[24:39], v[16:19], a[4:7], v[24:39]
ds_read_b64_tr_b16 v[8:9], v2 offset:4096
ds_read_b64_tr_b16 v[10:11], v2 offset:6144
s_waitcnt lgkmcnt(2)
v_mfma_f32_32x32x16_bf16 v[40:55], v[20:23], a[4:7], v[40:55]
ds_read_b64_tr_b16 v[12:13], v3 offset:4096
ds_read_b64_tr_b16 v[14:15], v3 offset:6144
s_waitcnt vmcnt(33)
s_waitcnt lgkmcnt(2)
v_mfma_f32_32x32x16_bf16 v[24:39], v[8:11], a[8:11], v[24:39]
ds_read_b64_tr_b16 v[16:17], v2 offset:5120
ds_read_b64_tr_b16 v[18:19], v2 offset:7168
s_waitcnt lgkmcnt(2)
v_mfma_f32_32x32x16_bf16 v[40:55], v[12:15], a[8:11], v[40:55]
ds_read_b64_tr_b16 v[20:21], v3 offset:5120
ds_read_b64_tr_b16 v[22:23], v3 offset:7168
s_waitcnt vmcnt(32)
s_waitcnt lgkmcnt(2)
v_mfma_f32_32x32x16_bf16 v[24:39], v[16:19], a[12:15], v[24:39]
ds_read_b64_tr_b16 v[8:9], v2 offset:8192
ds_read_b64_tr_b16 v[10:11], v2 offset:10240
s_waitcnt lgkmcnt(2)
v_mfma_f32_32x32x16_bf16 v[40:55], v[20:23], a[12:15], v[40:55]
ds_read_b64_tr_b16 v[12:13], v3 offset:8192
ds_read_b64_tr_b16 v[14:15], v3 offset:10240
s_waitcnt vmcnt(31)
s_waitcnt lgkmcnt(2)
v_mfma_f32_32x32x16_bf16 v[24:39], v[8:11], a[16:19], v[24:39]
ds_read_b64_tr_b16 v[16:17], v2 offset:9216
ds_read_b64_tr_b16 v[18:19], v2 offset:11264
s_waitcnt lgkmcnt(2)
v_mfma_f32_32x32x16_bf16 v[40:55], v[12:15], a[16:19], v[40:55]
ds_read_b64_tr_b16 v[20:21], v3 offset:9216
ds_read_b64_tr_b16 v[22:23], v3 offset:11264
s_waitcnt vmcnt(30)
s_waitcnt lgkmcnt(2)
v_mfma_f32_32x32x16_bf16 v[24:39], v[16:19], a[20:23], v[24:39]
ds_read_b64_tr_b16 v[8:9], v2 offset:12288
ds_read_b64_tr_b16 v[10:11], v2 offset:14336
s_waitcnt lgkmcnt(2)
v_mfma_f32_32x32x16_bf16 v[40:55], v[20:23], a[20:23], v[40:55]
ds_read_b64_tr_b16 v[12:13], v3 offset:12288
ds_read_b64_tr_b16 v[14:15], v3 offset:14336
s_waitcnt vmcnt(29)
s_waitcnt lgkmcnt(2)
v_mfma_f32_32x32x16_bf16 v[24:39], v[8:11], a[24:27], v[24:39]
ds_read_b64_tr_b16 v[16:17], v2 offset:13312
ds_read_b64_tr_b16 v[18:19], v2 offset:15360
s_waitcnt lgkmcnt(2)
v_mfma_f32_32x32x16_bf16 v[40:55], v[12:15], a[24:27], v[40:55]
ds_read_b64_tr_b16 v[20:21], v3 offset:13312
ds_read_b64_tr_b16 v[22:23], v3 offset:15360
s_waitcnt vmcnt(28)
s_waitcnt lgkmcnt(2)
v_mfma_f32_32x32x16_bf16 v[24:39], v[16:19], a[28:31], v[24:39]
ds_read_b64_tr_b16 v[8:9], v2 offset:16384
ds_read_b64_tr_b16 v[10:11], v2 offset:18432
s_waitcnt lgkmcnt(2)
v_mfma_f32_32x32x16_bf16 v[40:55], v[20:23], a[28:31], v[40:55]
ds_read_b64_tr_b16 v[12:13], v3 offset:16384
ds_read_b64_tr_b16 v[14:15], v3 offset:18432
s_waitcnt vmcnt(27)
s_waitcnt lgkmcnt(2)
v_mfma_f32_32x32x16_bf16 v[24:39], v[8:11], a[32:35], v[24:39]
ds_read_b64_tr_b16 v[16:17], v2 offset:17408
ds_read_b64_tr_b16 v[18:19], v2 offset:19456
s_waitcnt lgkmcnt(2)
v_mfma_f32_32x32x16_bf16 v[40:55], v[12:15], a[32:35], v[40:55]
ds_read_b64_tr_b16 v[20:21], v3 offset:17408
ds_read_b64_tr_b16 v[22:23], v3 offset:19456
s_waitcnt vmcnt(26)
s_waitcnt lgkmcnt(2)
v_mfma_f32_32x32x16_bf16 v[24:39], v[16:19], a[36:39], v[24:39]
ds_read_b64_tr_b16 v[8:9], v2 offset:20480
ds_read_b64_tr_b16 v[10:11], v2 offset:22528
s_waitcnt lgkmcnt(2)
v_mfma_f32_32x32x16_bf16 v[40:55], v[20:23], a[36:39], v[40:55]
ds_read_b64_tr_b16 v[12:13], v3 offset:20480
ds_read_b64_tr_b16 v[14:15], v3 offset:22528
s_waitcnt vmcnt(25)
s_waitcnt lgkmcnt(2)
v_mfma_f32_32x32x16_bf16 v[24:39], v[8:11], a[40:43], v[24:39]
ds_read_b64_tr_b16 v[16:17], v2 offset:21504
ds_read_b64_tr_b16 v[18:19], v2 offset:23552
s_waitcnt lgkmcnt(2)
v_mfma_f32_32x32x16_bf16 v[40:55], v[12:15], a[40:43], v[40:55]
ds_read_b64_tr_b16 v[20:21], v3 offset:21504
ds_read_b64_tr_b16 v[22:23], v3 offset:23552
s_waitcnt vmcnt(24)
s_waitcnt lgkmcnt(2)
v_mfma_f32_32x32x16_bf16 v[24:39], v[16:19], a[44:47], v[24:39]
ds_read_b64_tr_b16 v[8:9], v2 offset:24576
ds_read_b64_tr_b16 v[10:11], v2 offset:26624
s_waitcnt lgkmcnt(2)
v_mfma_f32_32x32x16_bf16 v[40:55], v[20:23], a[44:47], v[40:55]
ds_read_b64_tr_b16 v[12:13], v3 offset:24576
ds_read_b64_tr_b16 v[14:15], v3 offset:26624
s_waitcnt vmcnt(23)
s_waitcnt lgkmcnt(2)
v_mfma_f32_32x32x16_bf16 v[24:39], v[8:11], a[48:51], v[24:39]
ds_read_b64_tr_b16 v[16:17], v2 offset:25600
ds_read_b64_tr_b16 v[18:19], v2 offset:27648
s_waitcnt lgkmcnt(2)
v_mfma_f32_32x32x16_bf16 v[40:55], v[12:15], a[48:51], v[40:55]
ds_read_b64_tr_b16 v[20:21], v3 offset:25600
ds_read_b64_tr_b16 v[22:23], v3 offset:27648
s_waitcnt vmcnt(22)
s_waitcnt lgkmcnt(2)
v_mfma_f32_32x32x16_bf16 v[24:39], v[16:19], a[52:55], v[24:39]
ds_read_b64_tr_b16 v[8:9], v2 offset:28672
ds_read_b64_tr_b16 v[10:11], v2 offset:30720
s_waitcnt lgkmcnt(2)
v_mfma_f32_32x32x16_bf16 v[40:55], v[20:23], a[52:55], v[40:55]
ds_read_b64_tr_b16 v[12:13], v3 offset:28672
ds_read_b64_tr_b16 v[14:15], v3 offset:30720
s_waitcnt vmcnt(21)
s_waitcnt lgkmcnt(2)
v_mfma_f32_32x32x16_bf16 v[24:39], v[8:11], a[56:59], v[24:39]
ds_read_b64_tr_b16 v[16:17], v2 offset:29696
ds_read_b64_tr_b16 v[18:19], v2 offset:31744
s_waitcnt lgkmcnt(2)
v_mfma_f32_32x32x16_bf16 v[40:55], v[12:15], a[56:59], v[40:55]
ds_read_b64_tr_b16 v[20:21], v3 offset:29696
ds_read_b64_tr_b16 v[22:23], v3 offset:31744
s_waitcnt vmcnt(20)
s_waitcnt lgkmcnt(2)
v_mfma_f32_32x32x16_bf16 v[24:39], v[16:19], a[60:63], v[24:39]
ds_read_b64_tr_b16 v[8:9], v2 offset:32768
ds_read_b64_tr_b16 v[10:11], v2 offset:34816
s_waitcnt lgkmcnt(2)
v_mfma_f32_32x32x16_bf16 v[40:55], v[20:23], a[60:63], v[40:55]
ds_read_b64_tr_b16 v[12:13], v3 offset:32768
ds_read_b64_tr_b16 v[14:15], v3 offset:34816
s_waitcnt vmcnt(19)
s_waitcnt lgkmcnt(2)
v_mfma_f32_32x32x16_bf16 v[24:39], v[8:11], a[64:67], v[24:39]
ds_read_b64_tr_b16 v[16:17], v2 offset:33792
ds_read_b64_tr_b16 v[18:19], v2 offset:35840
s_waitcnt lgkmcnt(2)
v_mfma_f32_32x32x16_bf16 v[40:55], v[12:15], a[64:67], v[40:55]
ds_read_b64_tr_b16 v[20:21], v3 offset:33792
ds_read_b64_tr_b16 v[22:23], v3 offset:35840
s_waitcnt vmcnt(18)
s_waitcnt lgkmcnt(2)
v_mfma_f32_32x32x16_bf16 v[24:39], v[16:19], a[68:71], v[24:39]
ds_read_b64_tr_b16 v[8:9], v2 offset:36864
ds_read_b64_tr_b16 v[10:11], v2 offset:38912
s_waitcnt lgkmcnt(2)
v_mfma_f32_32x32x16_bf16 v[40:55], v[20:23], a[68:71], v[40:55]
ds_read_b64_tr_b16 v[12:13], v3 offset:36864
ds_read_b64_tr_b16 v[14:15], v3 offset:38912
s_waitcnt vmcnt(17)
s_waitcnt lgkmcnt(2)
v_mfma_f32_32x32x16_bf16 v[24:39], v[8:11], a[72:75], v[24:39]
ds_read_b64_tr_b16 v[16:17], v2 offset:37888
ds_read_b64_tr_b16 v[18:19], v2 offset:39936
s_waitcnt lgkmcnt(2)
v_mfma_f32_32x32x16_bf16 v[40:55], v[12:15], a[72:75], v[40:55]
ds_read_b64_tr_b16 v[20:21], v3 offset:37888
ds_read_b64_tr_b16 v[22:23], v3 offset:39936
s_waitcnt vmcnt(16)
s_waitcnt lgkmcnt(2)
v_mfma_f32_32x32x16_bf16 v[24:39], v[16:19], a[76:79], v[24:39]
ds_read_b64_tr_b16 v[8:9], v2 offset:40960
ds_read_b64_tr_b16 v[10:11], v2 offset:43008
s_waitcnt lgkmcnt(2)
v_mfma_f32_32x32x16_bf16 v[40:55], v[20:23], a[76:79], v[40:55]
ds_read_b64_tr_b16 v[12:13], v3 offset:40960
ds_read_b64_tr_b16 v[14:15], v3 offset:43008
s_waitcnt vmcnt(15)
s_waitcnt lgkmcnt(2)
v_mfma_f32_32x32x16_bf16 v[24:39], v[8:11], a[80:83], v[24:39]
ds_read_b64_tr_b16 v[16:17], v2 offset:41984
ds_read_b64_tr_b16 v[18:19], v2 offset:44032
s_waitcnt lgkmcnt(2)
v_mfma_f32_32x32x16_bf16 v[40:55], v[12:15], a[80:83], v[40:55]
ds_read_b64_tr_b16 v[20:21], v3 offset:41984
ds_read_b64_tr_b16 v[22:23], v3 offset:44032
s_waitcnt vmcnt(14)
s_waitcnt lgkmcnt(2)
v_mfma_f32_32x32x16_bf16 v[24:39], v[16:19], a[84:87], v[24:39]
ds_read_b64_tr_b16 v[8:9], v2 offset:45056
ds_read_b64_tr_b16 v[10:11], v2 offset:47104
s_waitcnt lgkmcnt(2)
v_mfma_f32_32x32x16_bf16 v[40:55], v[20:23], a[84:87], v[40:55]
ds_read_b64_tr_b16 v[12:13], v3 offset:45056
ds_read_b64_tr_b16 v[14:15], v3 offset:47104
s_waitcnt vmcnt(13)
s_waitcnt lgkmcnt(2)
v_mfma_f32_32x32x16_bf16 v[24:39], v[8:11], a[88:91], v[24:39]
ds_read_b64_tr_b16 v[16:17], v2 offset:46080
ds_read_b64_tr_b16 v[18:19], v2 offset:48128
s_waitcnt lgkmcnt(2)
v_mfma_f32_32x32x16_bf16 v[40:55], v[12:15], a[88:91], v[40:55]
ds_read_b64_tr_b16 v[20:21], v3 offset:46080
ds_read_b64_tr_b16 v[22:23], v3 offset:48128
s_waitcnt vmcnt(12)
s_waitcnt lgkmcnt(2)
v_mfma_f32_32x32x16_bf16 v[24:39], v[16:19], a[92:95], v[24:39]
ds_read_b64_tr_b16 v[8:9], v2 offset:49152
ds_read_b64_tr_b16 v[10:11], v2 offset:51200
s_waitcnt lgkmcnt(2)
v_mfma_f32_32x32x16_bf16 v[40:55], v[20:23], a[92:95], v[40:55]
ds_read_b64_tr_b16 v[12:13], v3 offset:49152
ds_read_b64_tr_b16 v[14:15], v3 offset:51200
s_waitcnt vmcnt(11)
s_waitcnt lgkmcnt(2)
v_mfma_f32_32x32x16_bf16 v[24:39], v[8:11], a[96:99], v[24:39]
ds_read_b64_tr_b16 v[16:17], v2 offset:50176
ds_read_b64_tr_b16 v[18:19], v2 offset:52224
s_waitcnt lgkmcnt(2)
v_mfma_f32_32x32x16_bf16 v[40:55], v[12:15], a[96:99], v[40:55]
ds_read_b64_tr_b16 v[20:21], v3 offset:50176
ds_read_b64_tr_b16 v[22:23], v3 offset:52224
s_waitcnt vmcnt(10)
s_waitcnt lgkmcnt(2)
v_mfma_f32_32x32x16_bf16 v[24:39], v[16:19], a[100:103], v[24:39]
ds_read_b64_tr_b16 v[8:9], v2 offset:53248
ds_read_b64_tr_b16 v[10:11], v2 offset:55296
s_waitcnt lgkmcnt(2)
v_mfma_f32_32x32x16_bf16 v[40:55], v[20:23], a[100:103], v[40:55]
ds_read_b64_tr_b16 v[12:13], v3 offset:53248
ds_read_b64_tr_b16 v[14:15], v3 offset:55296
s_waitcnt vmcnt(9)
s_waitcnt lgkmcnt(2)
v_mfma_f32_32x32x16_bf16 v[24:39], v[8:11], a[104:107], v[24:39]
ds_read_b64_tr_b16 v[16:17], v2 offset:54272
ds_read_b64_tr_b16 v[18:19], v2 offset:56320
s_waitcnt lgkmcnt(2)
v_mfma_f32_32x32x16_bf16 v[40:55], v[12:15], a[104:107], v[40:55]
ds_read_b64_tr_b16 v[20:21], v3 offset:54272
ds_read_b64_tr_b16 v[22:23], v3 offset:56320
s_waitcnt vmcnt(8)
s_waitcnt lgkmcnt(2)
v_mfma_f32_32x32x16_bf16 v[24:39], v[16:19], a[108:111], v[24:39]
ds_read_b64_tr_b16 v[8:9], v2 offset:57344
ds_read_b64_tr_b16 v[10:11], v2 offset:59392
s_waitcnt lgkmcnt(2)
v_mfma_f32_32x32x16_bf16 v[40:55], v[20:23], a[108:111], v[40:55]
ds_read_b64_tr_b16 v[12:13], v3 offset:57344
ds_read_b64_tr_b16 v[14:15], v3 offset:59392
s_waitcnt vmcnt(7)
s_waitcnt lgkmcnt(2)
v_mfma_f32_32x32x16_bf16 v[24:39], v[8:11], a[112:115], v[24:39]
ds_read_b64_tr_b16 v[16:17], v2 offset:58368
ds_read_b64_tr_b16 v[18:19], v2 offset:60416
s_waitcnt lgkmcnt(2)
v_mfma_f32_32x32x16_bf16 v[40:55], v[12:15], a[112:115], v[40:55]
ds_read_b64_tr_b16 v[20:21], v3 offset:58368
ds_read_b64_tr_b16 v[22:23], v3 offset:60416
s_waitcnt vmcnt(6)
s_waitcnt lgkmcnt(2)
v_mfma_f32_32x32x16_bf16 v[24:39], v[16:19], a[116:119], v[24:39]
ds_read_b64_tr_b16 v[8:9], v2 offset:61440
ds_read_b64_tr_b16 v[10:11], v2 offset:63488
s_waitcnt lgkmcnt(2)
v_mfma_f32_32x32x16_bf16 v[40:55], v[20:23], a[116:119], v[40:55]
ds_read_b64_tr_b16 v[12:13], v3 offset:61440
ds_read_b64_tr_b16 v[14:15], v3 offset:63488
s_waitcnt vmcnt(5)
s_waitcnt lgkmcnt(2)
v_mfma_f32_32x32x16_bf16 v[24:39], v[8:11], a[120:123], v[24:39]
ds_read_b64_tr_b16 v[16:17], v2 offset:62464
ds_read_b64_tr_b16 v[18:19], v2 offset:64512
s_waitcnt lgkmcnt(2)
v_mfma_f32_32x32x16_bf16 v[40:55], v[12:15], a[120:123], v[40:55]
ds_read_b64_tr_b16 v[20:21], v3 offset:62464
ds_read_b64_tr_b16 v[22:23], v3 offset:64512
s_waitcnt vmcnt(4)
s_waitcnt lgkmcnt(2)
v_mfma_f32_32x32x16_bf16 v[24:39], v[16:19], a[124:127], v[24:39]
ds_read_b64_tr_b16 v[8:9], v4 offset:0
ds_read_b64_tr_b16 v[10:11], v4 offset:2048
s_waitcnt lgkmcnt(2)
v_mfma_f32_32x32x16_bf16 v[40:55], v[20:23], a[124:127], v[40:55]
ds_read_b64_tr_b16 v[12:13], v5 offset:0
ds_read_b64_tr_b16 v[14:15], v5 offset:2048
s_waitcnt vmcnt(3)
s_waitcnt lgkmcnt(2)
v_mfma_f32_32x32x16_bf16 v[24:39], v[8:11], a[128:131], v[24:39]
ds_read_b64_tr_b16 v[16:17], v4 offset:1024
ds_read_b64_tr_b16 v[18:19], v4 offset:3072
s_waitcnt lgkmcnt(2)
v_mfma_f32_32x32x16_bf16 v[40:55], v[12:15], a[128:131], v[40:55]
ds_read_b64_tr_b16 v[20:21], v5 offset:1024
ds_read_b64_tr_b16 v[22:23], v5 offset:3072
s_waitcnt vmcnt(2)
s_waitcnt lgkmcnt(2)
v_mfma_f32_32x32x16_bf16 v[24:39], v[16:19], a[132:135], v[24:39]
ds_read_b64_tr_b16 v[8:9], v4 offset:4096
ds_read_b64_tr_b16 v[10:11], v4 offset:6144
s_waitcnt lgkmcnt(2)
v_mfma_f32_32x32x16_bf16 v[40:55], v[20:23], a[132:135], v[40:55]
ds_read_b64_tr_b16 v[12:13], v5 offset:4096
ds_read_b64_tr_b16 v[14:15], v5 offset:6144
s_waitcnt vmcnt(1)
s_waitcnt lgkmcnt(2)
v_mfma_f32_32x32x16_bf16 v[24:39], v[8:11], a[136:139], v[24:39]
ds_read_b64_tr_b16 v[16:17], v4 offset:5120
ds_read_b64_tr_b16 v[18:19], v4 offset:7168
s_waitcnt lgkmcnt(2)
v_mfma_f32_32x32x16_bf16 v[40:55], v[12:15], a[136:139], v[40:55]
ds_read_b64_tr_b16 v[20:21], v5 offset:5120
ds_read_b64_tr_b16 v[22:23], v5 offset:7168
s_waitcnt vmcnt(0)
s_waitcnt lgkmcnt(2)
v_mfma_f32_32x32x16_bf16 v[24:39], v[16:19], a[140:143], v[24:39]
s_waitcnt lgkmcnt(0)
v_mfma_f32_32x32x16_bf16 v[40:55], v[20:23], a[140:143], v[40:55]
s_nop 11
s_add_u32 s77, s82, 0
buffer_store_dwordx4 v[24:27], v0, s[8:11], s77 offen offset:0 sc1
buffer_store_dwordx4 v[28:31], v0, s[8:11], s77 offen offset:1024 sc1
buffer_store_dwordx4 v[32:35], v0, s[8:11], s77 offen offset:2048 sc1
buffer_store_dwordx4 v[36:39], v0, s[8:11], s77 offen offset:3072 sc1
s_add_u32 s77, s82, 4096
buffer_store_dwordx4 v[40:43], v0, s[8:11], s77 offen offset:0 sc1
buffer_store_dwordx4 v[44:47], v0, s[8:11], s77 offen offset:1024 sc1
buffer_store_dwordx4 v[48:51], v0, s[8:11], s77 offen offset:2048 sc1
buffer_store_dwordx4 v[52:55], v0, s[8:11], s77 offen offset:3072 sc1
s_waitcnt vmcnt(0) lgkmcnt(0)
s_barrier
s_cmp_eq_u32 s13, 0
s_cbranch_scc0 L_rs_23
s_lshl_b32 s25, s32, 7
s_add_u32 s25, s25, 70287360
v_mov_b32 v250, s25
v_mov_b32 v251, 1
s_mov_b64 exec, 1
buffer_atomic_add v251, v250, s[8:11], 0 offen
s_mov_b64 exec, -1
L_rs_23:
s_add_u32 s32, s32, 1
s_cmp_lt_u32 s32, 16
s_cbranch_scc1 RE2_g
s_branch K_end
K_rL:
s_mov_b32 s32, 0
RL_g:
s_cmp_eq_u32 s13, 0
s_cbranch_scc0 L_rd_24_b
s_lshl_b32 s25, s32, 7
s_add_u32 s25, s25, 70281216
v_mov_b32 v250, s25
s_mov_b32 s24, 0
L_rd_24:
buffer_load_dword v251, v250, s[8:11], 0 offen sc1
s_waitcnt vmcnt(0)
v_readfirstlane_b32 s25, v251
s_cmp_ge_u32 s25, 40
s_cbranch_scc1 L_rd_24_b
s_cmp_lt_u32 s32, 14
s_cbranch_scc0 L_rd_24_ns
s_sleep 8
L_rd_24_ns:
s_add_u32 s24, s24, 1
s_cmp_lt_u32 s24, 1200000
s_cbranch_scc1 L_rd_24
s_endpgm
L_rd_24_b:
s_barrier
v_mbcnt_lo_u32_b32 v0, -1, 0
v_mbcnt_hi_u32_b32 v0, -1, v0
s_sub_u32 s25, s33, 72
s_lshr_b32 s20, s25, 2
s_lshl_b32 s26, s32, 2
s_add_u32 s20, s20, s26
s_and_b32 s21, s25, 3
v_and_b32 v1, 7, v0
v_bfe_u32 v2, v0, 3, 1
v_lshrrev_b32 v3, 4, v0
s_lshl_b32 s76, s21, 3
v_add_u32 v4, s76, v1
v_lshl_add_u32 v4, v2, 5, v4
v_lshlrev_b32 v5, 4, v4
v_lshl_add_u32 v6, v3, 10, v5
v_and_b32 v7, 1, v3
v_lshl_add_u32 v7, v7, 10, v5
v_lshrrev_b32 v8, 1, v3
v_lshl_add_u32 v7, v8, 3, v7
s_cmp_lt_u32 s13, 2
s_cselect_b32 s78, 0, 0x80000000
v_or_b32 v9, s78, v6
v_or_b32 v10, s78, v7
s_mul_i32 s79, s20, 36864
s_lshl_b32 s80, s13, 11
s_add_u32 s79, s79, s80
s_mul_i32 s81, s20, 73728
s_lshl_b32 s80, s13, 12
s_add_u32 s81, s81, s80
s_add_u32 s81, s81, 121634816
s_add_u32 s80, s79, 73924608
buffer_load_dwordx2 v[200:201], v7, s[8:11], s80 offen sc1
s_add_u32 s80, s79, 73932800
buffer_load_dwordx2 v[202:203], v7, s[8:11], s80 offen sc1
s_add_u32 s80, s79, 73940992
buffer_load_dwordx2 v[204:205], v7, s[8:11], s80 offen sc1
s_add_u32 s80, s79, 73949184
buffer_load_dwordx2 v[206:207], v7, s[8:11], s80 offen sc1
s_add_u32 s80, s79, 73957376
buffer_load_dwordx2 v[208:209], v10, s[8:11], s80 offen sc1
s_add_u32 s80, s81, 0
buffer_load_dwordx4 v[40:43], v6, s[8:11], s80 offen sc1
s_add_u32 s80, s81, 4718592
buffer_load_dwordx4 v[44:47], v6, s[8:11], s80 offen sc1
s_add_u32 s80, s81, 9437184
buffer_load_dwordx4 v[48:51], v6, s[8:11], s80 offen sc1
s_add_u32 s80, s81, 14155776
buffer_load_dwordx4 v[52:55], v6, s[8:11], s80 offen sc1
s_add_u32 s80, s81, 18874368
buffer_load_dwordx4 v[56:59], v6, s[8:11], s80 offen sc1
s_add_u32 s80, s81, 23592960
buffer_load_dwordx4 v[60:63], v6, s[8:11], s80 offen sc1
s_add_u32 s80, s81, 28311552
buffer_load_dwordx4 v[64:67], v6, s[8:11], s80 offen sc1
s_add_u32 s80, s81, 33030144
buffer_load_dwordx4 v[68:71], v6, s[8:11], s80 offen sc1
s_add_u32 s80, s81, 16384
buffer_load_dwordx4 v[72:75], v6, s[8:11], s80 offen sc1
s_add_u32 s80, s81, 4734976
buffer_load_dwordx4 v[76:79], v6, s[8:11], s80 offen sc1
s_add_u32 s80, s81, 9453568
buffer_load_dwordx4 v[80:83], v6, s[8:11], s80 offen sc1
s_add_u32 s80, s81, 14172160
buffer_load_dwordx4 v[84:87], v6, s[8:11], s80 offen sc1
s_add_u32 s80, s81, 18890752
buffer_load_dwordx4 v[88:91], v6, s[8:11], s80 offen sc1
s_add_u32 s80, s81, 23609344
buffer_load_dwordx4 v[92:95], v6, s[8:11], s80 offen sc1
s_add_u32 s80, s81, 28327936
buffer_load_dwordx4 v[96:99], v6, s[8:11], s80 offen sc1
s_add_u32 s80, s81, 33046528
buffer_load_dwordx4 v[100:103], v6, s[8:11], s80 offen sc1
s_add_u32 s80, s81, 32768
buffer_load_dwordx4 v[104:107], v6, s[8:11], s80 offen sc1
s_add_u32 s80, s81, 4751360
buffer_load_dwordx4 v[108:111], v6, s[8:11], s80 offen sc1
s_add_u32 s80, s81, 9469952
buffer_load_dwordx4 v[112:115], v6, s[8:11], s80 offen sc1
s_add_u32 s80, s81, 14188544
buffer_load_dwordx4 v[116:119], v6, s[8:11], s80 offen sc1
s_add_u32 s80, s81, 18907136
buffer_load_dwordx4 v[120:123], v6, s[8:11], s80 offen sc1
s_add_u32 s80, s81, 23625728
buffer_load_dwordx4 v[124:127], v6, s[8:11], s80 offen sc1
s_add_u32 s80, s81, 28344320
buffer_load_dwordx4 v[128:131], v6, s[8:11], s80 offen sc1
s_add_u32 s80, s81, 33062912
buffer_load_dwordx4 v[132:135], v6, s[8:11], s80 offen sc1
s_add_u32 s80, s81, 49152
buffer_load_dwordx4 v[136:139], v6, s[8:11], s80 offen sc1
s_add_u32 s80, s81, 4767744
buffer_load_dwordx4 v[140:143], v6, s[8:11], s80 offen sc1
s_add_u32 s80, s81, 9486336
buffer_load_dwordx4 v[144:147], v6, s[8:11], s80 offen sc1
s_add_u32 s80, s81, 14204928
buffer_load_dwordx4 v[148:151], v6, s[8:11], s80 offen sc1
s_add_u32 s80, s81, 18923520
buffer_load_dwordx4 v[152:155], v6, s[8:11], s80 offen sc1
s_add_u32 s80, s81, 23642112
buffer_load_dwordx4 v[156:159], v6, s[8:11], s80 offen sc1
s_add_u32 s80, s81, 28360704
buffer_load_dwordx4 v[160:163], v6, s[8:11], s80 offen sc1
s_add_u32 s80, s81, 33079296
buffer_load_dwordx4 v[164:167], v6, s[8:11], s80 offen sc1
s_add_u32 s80, s81, 65536
buffer_load_dwordx4 v[168:171], v9, s[8:11], s80 offen sc1
s_add_u32 s80, s81, 4784128
buffer_load_dwordx4 v[172:175], v9, s[8:11], s80 offen sc1
s_add_u32 s80, s81, 9502720
buffer_load_dwordx4 v[176:179], v9, s[8:11], s80 offen sc1
s_add_u32 s80, s81, 14221312
buffer_load_dwordx4 v[180:183], v9, s[8:11], s80 offen sc1
s_add_u32 s80, s81, 18939904
buffer_load_dwordx4 v[184:187], v9, s[8:11], s80 offen sc1
s_add_u32 s80, s81, 23658496
buffer_load_dwordx4 v[188:191], v9, s[8:11], s80 offen sc1
s_add_u32 s80, s81, 28377088
buffer_load_dwordx4 v[192:195], v9, s[8:11], s80 offen sc1
s_add_u32 s80, s81, 33095680
buffer_load_dwordx4 v[196:199], v9, s[8:11], s80 offen sc1
s_waitcnt vmcnt(32)
v_pk_add_f32 v[40:41], v[40:41], v[44:45]
v_pk_add_f32 v[48:49], v[48:49], v[52:53]
v_pk_add_f32 v[56:57], v[56:57], v[60:61]
v_pk_add_f32 v[64:65], v[64:65], v[68:69]
v_pk_add_f32 v[40:41], v[40:41], v[48:49]
v_pk_add_f32 v[56:57], v[56:57], v[64:65]
v_pk_add_f32 v[40:41], v[40:41], v[56:57]
v_pk_add_f32 v[42:43], v[42:43], v[46:47]
v_pk_add_f32 v[50:51], v[50:51], v[54:55]
v_pk_add_f32 v[58:59], v[58:59], v[62:63]
v_pk_add_f32 v[66:67], v[66:67], v[70:71]
v_pk_add_f32 v[42:43], v[42:43], v[50:51]
v_pk_add_f32 v[58:59], v[58:59], v[66:67]
v_pk_add_f32 v[42:43], v[42:43], v[58:59]
v_lshlrev_b32 v12, 16, v200
v_and_b32 v13, 0xffff0000, v200
v_add_f32 v16, v40, v12
v_add_f32 v17, v41, v13
v_lshlrev_b32 v12, 16, v201
v_and_b32 v13, 0xffff0000, v201
v_add_f32 v18, v42, v12
v_add_f32 v19, v43, v13
s_waitcnt vmcnt(24)
v_pk_add_f32 v[72:73], v[72:73], v[76:77]
v_pk_add_f32 v[80:81], v[80:81], v[84:85]
v_pk_add_f32 v[88:89], v[88:89], v[92:93]
v_pk_add_f32 v[96:97], v[96:97], v[100:101]
v_pk_add_f32 v[72:73], v[72:73], v[80:81]
v_pk_add_f32 v[88:89], v[88:89], v[96:97]
v_pk_add_f32 v[72:73], v[72:73], v[88:89]
v_pk_add_f32 v[74:75], v[74:75], v[78:79]
v_pk_add_f32 v[82:83], v[82:83], v[86:87]
v_pk_add_f32 v[90:91], v[90:91], v[94:95]
v_pk_add_f32 v[98:99], v[98:99], v[102:103]
v_pk_add_f32 v[74:75], v[74:75], v[82:83]
v_pk_add_f32 v[90:91], v[90:91], v[98:99]
v_pk_add_f32 v[74:75], v[74:75], v[90:91]
v_lshlrev_b32 v12, 16, v202
v_and_b32 v13, 0xffff0000, v202
v_add_f32 v20, v72, v12
v_add_f32 v21, v73, v13
v_lshlrev_b32 v12, 16, v203
v_and_b32 v13, 0xffff0000, v203
v_add_f32 v22, v74, v12
v_add_f32 v23, v75, v13
s_waitcnt vmcnt(16)
v_pk_add_f32 v[104:105], v[104:105], v[108:109]
v_pk_add_f32 v[112:113], v[112:113], v[116:117]
v_pk_add_f32 v[120:121], v[120:121], v[124:125]
v_pk_add_f32 v[128:129], v[128:129], v[132:133]
v_pk_add_f32 v[104:105], v[104:105], v[112:113]
v_pk_add_f32 v[120:121], v[120:121], v[128:129]
v_pk_add_f32 v[104:105], v[104:105], v[120:121]
v_pk_add_f32 v[106:107], v[106:107], v[110:111]
v_pk_add_f32 v[114:115], v[114:115], v[118:119]
v_pk_add_f32 v[122:123], v[122:123], v[126:127]
v_pk_add_f32 v[130:131], v[130:131], v[134:135]
v_pk_add_f32 v[106:107], v[106:107], v[114:115]
v_pk_add_f32 v[122:123], v[122:123], v[130:131]
v_pk_add_f32 v[106:107], v[106:107], v[122:123]
v_lshlrev_b32 v12, 16, v204
v_and_b32 v13, 0xffff0000, v204
v_add_f32 v24, v104, v12
v_add_f32 v25, v105, v13
v_lshlrev_b32 v12, 16, v205
v_and_b32 v13, 0xffff0000, v205
v_add_f32 v26, v106, v12
v_add_f32 v27, v107, v13
s_waitcnt vmcnt(8)
v_pk_add_f32 v[136:137], v[136:137], v[140:141]
v_pk_add_f32 v[144:145], v[144:145], v[148:149]
v_pk_add_f32 v[152:153], v[152:153], v[156:157]
v_pk_add_f32 v[160:161], v[160:161], v[164:165]
v_pk_add_f32 v[136:137], v[136:137], v[144:145]
v_pk_add_f32 v[152:153], v[152:153], v[160:161]
v_pk_add_f32 v[136:137], v[136:137], v[152:153]
v_pk_add_f32 v[138:139], v[138:139], v[142:143]
v_pk_add_f32 v[146:147], v[146:147], v[150:151]
v_pk_add_f32 v[154:155], v[154:155], v[158:159]
v_pk_add_f32 v[162:163], v[162:163], v[166:167]
v_pk_add_f32 v[138:139], v[138:139], v[146:147]
v_pk_add_f32 v[154:155], v[154:155], v[162:163]
v_pk_add_f32 v[138:139], v[138:139], v[154:155]
v_lshlrev_b32 v12, 16, v206
v_and_b32 v13, 0xffff0000, v206
v_add_f32 v28, v136, v12
v_add_f32 v29, v137, v13
v_lshlrev_b32 v12, 16, v207
v_and_b32 v13, 0xffff0000, v207
v_add_f32 v30, v138, v12
v_add_f32 v31, v139, v13
s_waitcnt vmcnt(0)
v_pk_add_f32 v[168:169], v[168:169], v[172:173]
v_pk_add_f32 v[176:177], v[176:177], v[180:181]
v_pk_add_f32 v[184:185], v[184:185], v[188:189]
v_pk_add_f32 v[192:193], v[192:193], v[196:197]
v_pk_add_f32 v[168:169], v[168:169], v[176:177]
v_pk_add_f32 v[184:185], v[184:185], v[192:193]
v_pk_add_f32 v[168:169], v[168:169], v[184:185]
v_pk_add_f32 v[170:171], v[170:171], v[174:175]
v_pk_add_f32 v[178:179], v[178:179], v[182:183]
v_pk_add_f32 v[186:187], v[186:187], v[190:191]
v_pk_add_f32 v[194:195], v[194:195], v[198:199]
v_pk_add_f32 v[170:171], v[170:171], v[178:179]
v_pk_add_f32 v[186:187], v[186:187], v[194:195]
v_pk_add_f32 v[170:171], v[170:171], v[186:187]
v_lshlrev_b32 v12, 16, v208
v_and_b32 v13, 0xffff0000, v208
v_add_f32 v32, v168, v12
v_add_f32 v33, v169, v13
v_lshlrev_b32 v12, 16, v209
v_and_b32 v13, 0xffff0000, v209
v_add_f32 v34, v170, v12
v_add_f32 v35, v171, v13
v_cvt_pk_bf16_f32 v200, v16, v17
v_cvt_pk_bf16_f32 v201, v18, v19
v_cvt_pk_bf16_f32 v202, v20, v21
v_cvt_pk_bf16_f32 v203, v22, v23
v_cvt_pk_bf16_f32 v204, v24, v25
v_cvt_pk_bf16_f32 v205, v26, v27
v_cvt_pk_bf16_f32 v206, v28, v29
v_cvt_pk_bf16_f32 v207, v30, v31
v_cvt_pk_bf16_f32 v208, v32, v33
v_cvt_pk_bf16_f32 v209, v34, v35
s_add_u32 s80, s79, 93323264
buffer_store_dwordx2 v[200:201], v7, s[8:11], s80 offen sc1
s_add_u32 s80, s79, 93331456
buffer_store_dwordx2 v[202:203], v7, s[8:11], s80 offen sc1
s_add_u32 s80, s79, 93339648
buffer_store_dwordx2 v[204:205], v7, s[8:11], s80 offen sc1
s_add_u32 s80, s79, 93347840
buffer_store_dwordx2 v[206:207], v7, s[8:11], s80 offen sc1
s_add_u32 s80, s79, 93356032
buffer_store_dwordx2 v[208:209], v10, s[8:11], s80 offen sc1
v_lshlrev_b32 v16, 16, v200
v_and_b32 v17, 0xffff0000, v200
v_lshlrev_b32 v18, 16, v201
v_and_b32 v19, 0xffff0000, v201
v_lshlrev_b32 v20, 16, v202
v_and_b32 v21, 0xffff0000, v202
v_lshlrev_b32 v22, 16, v203
v_and_b32 v23, 0xffff0000, v203
v_lshlrev_b32 v24, 16, v204
v_and_b32 v25, 0xffff0000, v204
v_lshlrev_b32 v26, 16, v205
v_and_b32 v27, 0xffff0000, v205
v_lshlrev_b32 v28, 16, v206
v_and_b32 v29, 0xffff0000, v206
v_lshlrev_b32 v30, 16, v207
v_and_b32 v31, 0xffff0000, v207
v_lshlrev_b32 v32, 16, v208
v_and_b32 v33, 0xffff0000, v208
v_lshlrev_b32 v34, 16, v209
v_and_b32 v35, 0xffff0000, v209
v_add_f32 v14, v16, v17
v_add_f32 v14, v14, v18
v_add_f32 v14, v14, v19
v_add_f32 v14, v14, v20
v_add_f32 v14, v14, v21
v_add_f32 v14, v14, v22
v_add_f32 v14, v14, v23
v_add_f32 v14, v14, v24
v_add_f32 v14, v14, v25
v_add_f32 v14, v14, v26
v_add_f32 v14, v14, v27
v_add_f32 v14, v14, v28
v_add_f32 v14, v14, v29
v_add_f32 v14, v14, v30
v_add_f32 v14, v14, v31
v_add_f32 v14, v14, v32
v_add_f32 v14, v14, v33
v_add_f32 v14, v14, v34
v_add_f32 v14, v14, v35
s_nop 1
v_add_f32_dpp v14, v14, v14 row_ror:8 row_mask:0xf bank_mask:0xf
v_mov_b32 v12, v14
s_nop 1
v_permlane16_swap_b32 v14, v12
v_add_f32 v14, v14, v12
v_mov_b32 v12, v14
s_nop 1
v_permlane32_swap_b32 v14, v12
v_add_f32 v14, v14, v12
v_lshlrev_b32 v12, 2, v1
s_lshl_b32 s82, s13, 5
v_add_u32 v13, s82, v12
ds_write_b32 v13, v14 offset:0
s_waitcnt lgkmcnt(0)
s_barrier
ds_read_b32 v36, v12 offset:0
ds_read_b32 v37, v12 offset:32
ds_read_b32 v38, v12 offset:64
ds_read_b32 v39, v12 offset:96
s_waitcnt lgkmcnt(0)
v_add_f32 v36, v36, v37
v_add_f32 v38, v38, v39
v_add_f32 v14, v36, v38
v_mul_f32 v14, 0x3ae38e39, v14
v_sub_f32 v16, v16, v14
v_sub_f32 v17, v17, v14
v_sub_f32 v18, v18, v14
v_sub_f32 v19, v19, v14
v_sub_f32 v20, v20, v14
v_sub_f32 v21, v21, v14
v_sub_f32 v22, v22, v14
v_sub_f32 v23, v23, v14
v_sub_f32 v24, v24, v14
v_sub_f32 v25, v25, v14
v_sub_f32 v26, v26, v14
v_sub_f32 v27, v27, v14
v_sub_f32 v28, v28, v14
v_sub_f32 v29, v29, v14
v_sub_f32 v30, v30, v14
v_sub_f32 v31, v31, v14
v_sub_f32 v32, v32, v14
v_sub_f32 v33, v33, v14
v_sub_f32 v34, v34, v14
v_sub_f32 v35, v35, v14
s_cmp_lt_u32 s13, 2
s_cselect_b32 s82, 1.0, 0
v_mul_f32 v32, s82, v32
v_mul_f32 v33, s82, v33
v_mul_f32 v34, s82, v34
v_mul_f32 v35, s82, v35
v_mul_f32 v15, v16, v16
v_fmac_f32 v15, v17, v17
v_fmac_f32 v15, v18, v18
v_fmac_f32 v15, v19, v19
v_fmac_f32 v15, v20, v20
v_fmac_f32 v15, v21, v21
v_fmac_f32 v15, v22, v22
v_fmac_f32 v15, v23, v23
v_fmac_f32 v15, v24, v24
v_fmac_f32 v15, v25, v25
v_fmac_f32 v15, v26, v26
v_fmac_f32 v15, v27, v27
v_fmac_f32 v15, v28, v28
v_fmac_f32 v15, v29, v29
v_fmac_f32 v15, v30, v30
v_fmac_f32 v15, v31, v31
v_fmac_f32 v15, v32, v32
v_fmac_f32 v15, v33, v33
v_fmac_f32 v15, v34, v34
v_fmac_f32 v15, v35, v35
s_nop 1
v_add_f32_dpp v15, v15, v15 row_ror:8 row_mask:0xf bank_mask:0xf
v_mov_b32 v12, v15
s_nop 1
v_permlane16_swap_b32 v15, v12
v_add_f32 v15, v15, v12
v_mov_b32 v12, v15
s_nop 1
v_permlane32_swap_b32 v15, v12
v_add_f32 v15, v15, v12
v_lshlrev_b32 v12, 2, v1
s_lshl_b32 s82, s13, 5
v_add_u32 v13, s82, v12
ds_write_b32 v13, v15 offset:128
s_waitcnt lgkmcnt(0)
s_barrier
ds_read_b32 v36, v12 offset:128
ds_read_b32 v37, v12 offset:160
ds_read_b32 v38, v12 offset:192
ds_read_b32 v39, v12 offset:224
s_waitcnt lgkmcnt(0)
v_add_f32 v36, v36, v37
v_add_f32 v38, v38, v39
v_add_f32 v15, v36, v38
v_mov_b32 v12, 0x3727c5ac
v_fmac_f32 v12, 0x3ae38e39, v15
v_rsq_f32 v15, v12
s_nop 0
v_mul_f32 v16, v15, v16
v_mul_f32 v17, v15, v17
v_mul_f32 v18, v15, v18
v_mul_f32 v19, v15, v19
v_mul_f32 v20, v15, v20
v_mul_f32 v21, v15, v21
v_mul_f32 v22, v15, v22
v_mul_f32 v23, v15, v23
v_mul_f32 v24, v15, v24
v_mul_f32 v25, v15, v25
v_mul_f32 v26, v15, v26
v_mul_f32 v27, v15, v27
v_mul_f32 v28, v15, v28
v_mul_f32 v29, v15, v29
v_mul_f32 v30, v15, v30
v_mul_f32 v31, v15, v31
v_mul_f32 v32, v15, v32
v_mul_f32 v33, v15, v33
v_mul_f32 v34, v15, v34
v_mul_f32 v35, v15, v35
v_cvt_pk_bf16_f32 v210, v16, v17
v_cvt_pk_bf16_f32 v211, v18, v19
v_cvt_pk_bf16_f32 v212, v20, v21
v_cvt_pk_bf16_f32 v213, v22, v23
v_cvt_pk_bf16_f32 v214, v24, v25
v_cvt_pk_bf16_f32 v215, v26, v27
v_cvt_pk_bf16_f32 v216, v28, v29
v_cvt_pk_bf16_f32 v217, v30, v31
v_cvt_pk_bf16_f32 v218, v32, v33
v_cvt_pk_bf16_f32 v219, v34, v35
s_add_u32 s80, s79, 96468992
buffer_store_dwordx2 v[210:211], v7, s[8:11], s80 offen sc1
s_add_u32 s80, s79, 96477184
buffer_store_dwordx2 v[212:213], v7, s[8:11], s80 offen sc1
s_add_u32 s80, s79, 96485376
buffer_store_dwordx2 v[214:215], v7, s[8:11], s80 offen sc1
s_add_u32 s80, s79, 96493568
buffer_store_dwordx2 v[216:217], v7, s[8:11], s80 offen sc1
s_add_u32 s80, s79, 96501760
buffer_store_dwordx2 v[218:219], v10, s[8:11], s80 offen sc1
s_waitcnt vmcnt(0) lgkmcnt(0)
s_barrier
s_cmp_eq_u32 s13, 0
s_cbranch_scc0 L_rs_25
s_lshl_b32 s25, s32, 7
s_add_u32 s25, s25, 70283264
v_mov_b32 v250, s25
v_mov_b32 v251, 1
s_mov_b64 exec, 1
buffer_atomic_add v251, v250, s[8:11], 0 offen
s_mov_b64 exec, -1
L_rs_25:
s_add_u32 s32, s32, 1
s_cmp_lt_u32 s32, 16
s_cbranch_scc1 RL_g
s_branch K_end
K_rF:
s_mov_b32 s32, 0
RF_g:
s_cmp_eq_u32 s13, 0
s_cbranch_scc0 L_rd_26_b
s_lshl_b32 s25, s32, 7
s_add_u32 s25, s25, 70287360
v_mov_b32 v250, s25
s_mov_b32 s24, 0
L_rd_26:
buffer_load_dword v251, v250, s[8:11], 0 offen sc1
s_waitcnt vmcnt(0)
v_readfirstlane_b32 s25, v251
s_cmp_ge_u32 s25, 40
s_cbranch_scc1 L_rd_26_b
s_cmp_lt_u32 s32, 14
s_cbranch_scc0 L_rd_26_ns
s_sleep 8
L_rd_26_ns:
s_add_u32 s24, s24, 1
s_cmp_lt_u32 s24, 1200000
s_cbranch_scc1 L_rd_26
s_endpgm
L_rd_26_b:
s_barrier
v_mbcnt_lo_u32_b32 v0, -1, 0
v_mbcnt_hi_u32_b32 v0, -1, v0
s_sub_u32 s25, s33, 200
s_lshr_b32 s20, s25, 2
s_lshl_b32 s26, s32, 2
s_add_u32 s20, s20, s26
s_and_b32 s21, s25, 3
v_and_b32 v1, 7, v0
v_bfe_u32 v2, v0, 3, 1
v_lshrrev_b32 v3, 4, v0
s_lshl_b32 s76, s21, 3
v_add_u32 v4, s76, v1
v_lshl_add_u32 v4, v2, 5, v4
v_lshlrev_b32 v5, 4, v4
v_lshl_add_u32 v6, v3, 10, v5
v_and_b32 v7, 1, v3
v_lshl_add_u32 v7, v7, 10, v5
v_lshrrev_b32 v8, 1, v3
v_lshl_add_u32 v7, v8, 3, v7
s_cmp_lt_u32 s13, 2
s_cselect_b32 s78, 0, 0x80000000
v_or_b32 v9, s78, v6
v_or_b32 v10, s78, v7
s_mul_i32 s79, s20, 36864
s_lshl_b32 s80, s13, 11
s_add_u32 s79, s79, s80
s_mul_i32 s81, s20, 73728
s_lshl_b32 s80, s13, 12
s_add_u32 s81, s81, s80
s_add_u32 s81, s81, 163577856
s_add_u32 s80, s79, 93323264
buffer_load_dwordx2 v[200:201], v7, s[8:11], s80 offen sc1
s_add_u32 s80, s79, 93331456
buffer_load_dwordx2 v[202:203], v7, s[8:11], s80 offen sc1
s_add_u32 s80, s79, 93339648
buffer_load_dwordx2 v[204:205], v7, s[8:11], s80 offen sc1
s_add_u32 s80, s79, 93347840
buffer_load_dwordx2 v[206:207], v7, s[8:11], s80 offen sc1
s_add_u32 s80, s79, 93356032
buffer_load_dwordx2 v[208:209], v10, s[8:11], s80 offen sc1
s_add_u32 s80, s81, 0
buffer_load_dwordx4 v[40:43], v6, s[8:11], s80 offen sc1
s_add_u32 s80, s81, 4718592
buffer_load_dwordx4 v[44:47], v6, s[8:11], s80 offen sc1
s_add_u32 s80, s81, 9437184
buffer_load_dwordx4 v[48:51], v6, s[8:11], s80 offen sc1
s_add_u32 s80, s81, 14155776
buffer_load_dwordx4 v[52:55], v6, s[8:11], s80 offen sc1
s_add_u32 s80, s81, 18874368
buffer_load_dwordx4 v[56:59], v6, s[8:11], s80 offen sc1
s_add_u32 s80, s81, 23592960
buffer_load_dwordx4 v[60:63], v6, s[8:11], s80 offen sc1
s_add_u32 s80, s81, 28311552
buffer_load_dwordx4 v[64:67], v6, s[8:11], s80 offen sc1
s_add_u32 s80, s81, 33030144
buffer_load_dwordx4 v[68:71], v6, s[8:11], s80 offen sc1
s_add_u32 s80, s81, 16384
buffer_load_dwordx4 v[72:75], v6, s[8:11], s80 offen sc1
s_add_u32 s80, s81, 4734976
buffer_load_dwordx4 v[76:79], v6, s[8:11], s80 offen sc1
s_add_u32 s80, s81, 9453568
buffer_load_dwordx4 v[80:83], v6, s[8:11], s80 offen sc1
s_add_u32 s80, s81, 14172160
buffer_load_dwordx4 v[84:87], v6, s[8:11], s80 offen sc1
s_add_u32 s80, s81, 18890752
buffer_load_dwordx4 v[88:91], v6, s[8:11], s80 offen sc1
s_add_u32 s80, s81, 23609344
buffer_load_dwordx4 v[92:95], v6, s[8:11], s80 offen sc1
s_add_u32 s80, s81, 28327936
buffer_load_dwordx4 v[96:99], v6, s[8:11], s80 offen sc1
s_add_u32 s80, s81, 33046528
buffer_load_dwordx4 v[100:103], v6, s[8:11], s80 offen sc1
s_add_u32 s80, s81, 32768
buffer_load_dwordx4 v[104:107], v6, s[8:11], s80 offen sc1
s_add_u32 s80, s81, 4751360
buffer_load_dwordx4 v[108:111], v6, s[8:11], s80 offen sc1
s_add_u32 s80, s81, 9469952
buffer_load_dwordx4 v[112:115], v6, s[8:11], s80 offen sc1
s_add_u32 s80, s81, 14188544
buffer_load_dwordx4 v[116:119], v6, s[8:11], s80 offen sc1
s_add_u32 s80, s81, 18907136
buffer_load_dwordx4 v[120:123], v6, s[8:11], s80 offen sc1
s_add_u32 s80, s81, 23625728
buffer_load_dwordx4 v[124:127], v6, s[8:11], s80 offen sc1
s_add_u32 s80, s81, 28344320
buffer_load_dwordx4 v[128:131], v6, s[8:11], s80 offen sc1
s_add_u32 s80, s81, 33062912
buffer_load_dwordx4 v[132:135], v6, s[8:11], s80 offen sc1
s_add_u32 s80, s81, 49152
buffer_load_dwordx4 v[136:139], v6, s[8:11], s80 offen sc1
s_add_u32 s80, s81, 4767744
buffer_load_dwordx4 v[140:143], v6, s[8:11], s80 offen sc1
s_add_u32 s80, s81, 9486336
buffer_load_dwordx4 v[144:147], v6, s[8:11], s80 offen sc1
s_add_u32 s80, s81, 14204928
buffer_load_dwordx4 v[148:151], v6, s[8:11], s80 offen sc1
s_add_u32 s80, s81, 18923520
buffer_load_dwordx4 v[152:155], v6, s[8:11], s80 offen sc1
s_add_u32 s80, s81, 23642112
buffer_load_dwordx4 v[156:159], v6, s[8:11], s80 offen sc1
s_add_u32 s80, s81, 28360704
buffer_load_dwordx4 v[160:163], v6, s[8:11], s80 offen sc1
s_add_u32 s80, s81, 33079296
buffer_load_dwordx4 v[164:167], v6, s[8:11], s80 offen sc1
s_add_u32 s80, s81, 65536
buffer_load_dwordx4 v[168:171], v9, s[8:11], s80 offen sc1
s_add_u32 s80, s81, 4784128
buffer_load_dwordx4 v[172:175], v9, s[8:11], s80 offen sc1
s_add_u32 s80, s81, 9502720
buffer_load_dwordx4 v[176:179], v9, s[8:11], s80 offen sc1
s_add_u32 s80, s81, 14221312
buffer_load_dwordx4 v[180:183], v9, s[8:11], s80 offen sc1
s_add_u32 s80, s81, 18939904
buffer_load_dwordx4 v[184:187], v9, s[8:11], s80 offen sc1
s_add_u32 s80, s81, 23658496
buffer_load_dwordx4 v[188:191], v9, s[8:11], s80 offen sc1
s_add_u32 s80, s81, 28377088
buffer_load_dwordx4 v[192:195], v9, s[8:11], s80 offen sc1
s_add_u32 s80, s81, 33095680
buffer_load_dwordx4 v[196:199], v9, s[8:11], s80 offen sc1
s_waitcnt vmcnt(32)
v_pk_add_f32 v[40:41], v[40:41], v[44:45]
v_pk_add_f32 v[48:49], v[48:49], v[52:53]
v_pk_add_f32 v[56:57], v[56:57], v[60:61]
v_pk_add_f32 v[64:65], v[64:65], v[68:69]
v_pk_add_f32 v[40:41], v[40:41], v[48:49]
v_pk_add_f32 v[56:57], v[56:57], v[64:65]
v_pk_add_f32 v[40:41], v[40:41], v[56:57]
v_pk_add_f32 v[42:43], v[42:43], v[46:47]
v_pk_add_f32 v[50:51], v[50:51], v[54:55]
v_pk_add_f32 v[58:59], v[58:59], v[62:63]
v_pk_add_f32 v[66:67], v[66:67], v[70:71]
v_pk_add_f32 v[42:43], v[42:43], v[50:51]
v_pk_add_f32 v[58:59], v[58:59], v[66:67]
v_pk_add_f32 v[42:43], v[42:43], v[58:59]
v_lshlrev_b32 v12, 16, v200
v_and_b32 v13, 0xffff0000, v200
v_add_f32 v16, v40, v12
v_add_f32 v17, v41, v13
v_lshlrev_b32 v12, 16, v201
v_and_b32 v13, 0xffff0000, v201
v_add_f32 v18, v42, v12
v_add_f32 v19, v43, v13
s_waitcnt vmcnt(24)
v_pk_add_f32 v[72:73], v[72:73], v[76:77]
v_pk_add_f32 v[80:81], v[80:81], v[84:85]
v_pk_add_f32 v[88:89], v[88:89], v[92:93]
v_pk_add_f32 v[96:97], v[96:97], v[100:101]
v_pk_add_f32 v[72:73], v[72:73], v[80:81]
v_pk_add_f32 v[88:89], v[88:89], v[96:97]
v_pk_add_f32 v[72:73], v[72:73], v[88:89]
v_pk_add_f32 v[74:75], v[74:75], v[78:79]
v_pk_add_f32 v[82:83], v[82:83], v[86:87]
v_pk_add_f32 v[90:91], v[90:91], v[94:95]
v_pk_add_f32 v[98:99], v[98:99], v[102:103]
v_pk_add_f32 v[74:75], v[74:75], v[82:83]
v_pk_add_f32 v[90:91], v[90:91], v[98:99]
v_pk_add_f32 v[74:75], v[74:75], v[90:91]
v_lshlrev_b32 v12, 16, v202
v_and_b32 v13, 0xffff0000, v202
v_add_f32 v20, v72, v12
v_add_f32 v21, v73, v13
v_lshlrev_b32 v12, 16, v203
v_and_b32 v13, 0xffff0000, v203
v_add_f32 v22, v74, v12
v_add_f32 v23, v75, v13
s_waitcnt vmcnt(16)
v_pk_add_f32 v[104:105], v[104:105], v[108:109]
v_pk_add_f32 v[112:113], v[112:113], v[116:117]
v_pk_add_f32 v[120:121], v[120:121], v[124:125]
v_pk_add_f32 v[128:129], v[128:129], v[132:133]
v_pk_add_f32 v[104:105], v[104:105], v[112:113]
v_pk_add_f32 v[120:121], v[120:121], v[128:129]
v_pk_add_f32 v[104:105], v[104:105], v[120:121]
v_pk_add_f32 v[106:107], v[106:107], v[110:111]
v_pk_add_f32 v[114:115], v[114:115], v[118:119]
v_pk_add_f32 v[122:123], v[122:123], v[126:127]
v_pk_add_f32 v[130:131], v[130:131], v[134:135]
v_pk_add_f32 v[106:107], v[106:107], v[114:115]
v_pk_add_f32 v[122:123], v[122:123], v[130:131]
v_pk_add_f32 v[106:107], v[106:107], v[122:123]
v_lshlrev_b32 v12, 16, v204
v_and_b32 v13, 0xffff0000, v204
v_add_f32 v24, v104, v12
v_add_f32 v25, v105, v13
v_lshlrev_b32 v12, 16, v205
v_and_b32 v13, 0xffff0000, v205
v_add_f32 v26, v106, v12
v_add_f32 v27, v107, v13
s_waitcnt vmcnt(8)
v_pk_add_f32 v[136:137], v[136:137], v[140:141]
v_pk_add_f32 v[144:145], v[144:145], v[148:149]
v_pk_add_f32 v[152:153], v[152:153], v[156:157]
v_pk_add_f32 v[160:161], v[160:161], v[164:165]
v_pk_add_f32 v[136:137], v[136:137], v[144:145]
v_pk_add_f32 v[152:153], v[152:153], v[160:161]
v_pk_add_f32 v[136:137], v[136:137], v[152:153]
v_pk_add_f32 v[138:139], v[138:139], v[142:143]
v_pk_add_f32 v[146:147], v[146:147], v[150:151]
v_pk_add_f32 v[154:155], v[154:155], v[158:159]
v_pk_add_f32 v[162:163], v[162:163], v[166:167]
v_pk_add_f32 v[138:139], v[138:139], v[146:147]
v_pk_add_f32 v[154:155], v[154:155], v[162:163]
v_pk_add_f32 v[138:139], v[138:139], v[154:155]
v_lshlrev_b32 v12, 16, v206
v_and_b32 v13, 0xffff0000, v206
v_add_f32 v28, v136, v12
v_add_f32 v29, v137, v13
v_lshlrev_b32 v12, 16, v207
v_and_b32 v13, 0xffff0000, v207
v_add_f32 v30, v138, v12
v_add_f32 v31, v139, v13
s_waitcnt vmcnt(0)
v_pk_add_f32 v[168:169], v[168:169], v[172:173]
v_pk_add_f32 v[176:177], v[176:177], v[180:181]
v_pk_add_f32 v[184:185], v[184:185], v[188:189]
v_pk_add_f32 v[192:193], v[192:193], v[196:197]
v_pk_add_f32 v[168:169], v[168:169], v[176:177]
v_pk_add_f32 v[184:185], v[184:185], v[192:193]
v_pk_add_f32 v[168:169], v[168:169], v[184:185]
v_pk_add_f32 v[170:171], v[170:171], v[174:175]
v_pk_add_f32 v[178:179], v[178:179], v[182:183]
v_pk_add_f32 v[186:187], v[186:187], v[190:191]
v_pk_add_f32 v[194:195], v[194:195], v[198:199]
v_pk_add_f32 v[170:171], v[170:171], v[178:179]
v_pk_add_f32 v[186:187], v[186:187], v[194:195]
v_pk_add_f32 v[170:171], v[170:171], v[186:187]
v_lshlrev_b32 v12, 16, v208
v_and_b32 v13, 0xffff0000, v208
v_add_f32 v32, v168, v12
v_add_f32 v33, v169, v13
v_lshlrev_b32 v12, 16, v209
v_and_b32 v13, 0xffff0000, v209
v_add_f32 v34, v170, v12
v_add_f32 v35, v171, v13
s_mov_b32 s64, s100
s_and_b32 s65, s101, 0xffff
s_mov_b32 s66, 2359296
s_mov_b32 s67, 0x20000
s_lshl_b32 s76, s20, 5
s_lshl_b32 s77, s21, 3
s_add_u32 s76, s76, s77
s_mul_i32 s76, s76, 1152
s_lshl_b32 s77, s13, 6
s_add_u32 s76, s76, s77
v_mul_u32_u24 v11, 1152, v1
v_lshl_add_u32 v11, v3, 4, v11
v_lshl_add_u32 v11, v2, 3, v11
v_or_b32 v12, s78, v11
v_cvt_pk_bf16_f32 v200, v16, v17
v_cvt_pk_bf16_f32 v201, v18, v19
v_cvt_pk_bf16_f32 v202, v20, v21
v_cvt_pk_bf16_f32 v203, v22, v23
v_cvt_pk_bf16_f32 v204, v24, v25
v_cvt_pk_bf16_f32 v205, v26, v27
v_cvt_pk_bf16_f32 v206, v28, v29
v_cvt_pk_bf16_f32 v207, v30, v31
v_cvt_pk_bf16_f32 v208, v32, v33
v_cvt_pk_bf16_f32 v209, v34, v35
buffer_store_dwordx2 v[200:201], v11, s[64:67], s76 offen offset:0 nt
buffer_store_dwordx2 v[202:203], v11, s[64:67], s76 offen offset:256 nt
buffer_store_dwordx2 v[204:205], v11, s[64:67], s76 offen offset:512 nt
buffer_store_dwordx2 v[206:207], v11, s[64:67], s76 offen offset:768 nt
buffer_store_dwordx2 v[208:209], v12, s[64:67], s76 offen offset:1024 nt
s_waitcnt vmcnt(0) lgkmcnt(0)
s_barrier
s_cmp_eq_u32 s13, 0
s_cbranch_scc0 L_rs_27
L_rs_27:
s_add_u32 s32, s32, 1
s_cmp_lt_u32 s32, 16
s_cbranch_scc1 RF_g
s_branch K_end
K_rD:
v_mbcnt_lo_u32_b32 v0, -1, 0
v_mbcnt_hi_u32_b32 v0, -1, v0
s_sub_u32 s28, s33, 88
v_lshrrev_b32 v10, 3, v0
v_and_b32 v11, 7, v0
v_bfe_u32 v12, v0, 4, 1
v_lshlrev_b32 v12, 2, v12
v_xor_b32 v11, v11, v12
s_mov_b32 s76, 9216
v_mul_lo_u32 v1, v10, s76
v_lshl_add_u32 v1, v11, 4, v1
v_lshrrev_b32 v10, 5, v0
v_bfe_u32 v11, v0, 2, 2
v_lshl_add_u32 v10, v10, 2, v11
v_lshlrev_b32 v10, 7, v10
v_bfe_u32 v12, v0, 4, 1
v_lshl_add_u32 v10, v12, 5, v10
v_and_b32 v12, 3, v0
v_lshl_add_u32 v10, v12, 3, v10
v_lshrrev_b32 v11, 1, v11
v_lshlrev_b32 v11, 6, v11
v_add_u32 v2, v10, v11
v_xor_b32 v11, 64, v11
v_add_u32 v3, v10, v11
v_add_u32 v4, 0x10000, v2
v_add_u32 v5, 0x10000, v3
v_add_u32 v6, 0x20000, v2
v_add_u32 v7, 0x20000, v3
v_lshlrev_b32 v0, 4, v0
s_mov_b32 s64, s94
s_and_b32 s65, s95, 0xffff
s_mov_b32 s66, 5308416
s_mov_b32 s67, 0x20000
s_mov_b32 s68, s96
s_and_b32 s69, s97, 0xffff
s_mov_b32 s70, 5308416
s_mov_b32 s71, 0x20000
s_lshl_b32 s73, s28, 7
s_mul_i32 s76, s13, 147456
s_add_u32 s73, s73, s76
s_mov_b32 s74, s73
s_lshl_b32 s83, s13, 11
s_add_u32 m0, s83, 0
s_add_u32 s76, s73, 0
buffer_load_dwordx4 v1, s[64:67], s76 offen lds
s_add_u32 m0, s83, 1024
s_add_u32 s76, s73, 73728
buffer_load_dwordx4 v1, s[64:67], s76 offen lds
s_add_u32 m0, s83, 8192
s_add_u32 s76, s74, 0
buffer_load_dwordx4 v1, s[68:71], s76 offen lds
s_add_u32 m0, s83, 9216
s_add_u32 s76, s74, 73728
buffer_load_dwordx4 v1, s[68:71], s76 offen lds
s_add_u32 m0, s83, 16384
s_add_u32 s76, s73, 589824
buffer_load_dwordx4 v1, s[64:67], s76 offen lds
s_add_u32 m0, s83, 17408
s_add_u32 s76, s73, 663552
buffer_load_dwordx4 v1, s[64:67], s76 offen lds
s_add_u32 m0, s83, 24576
s_add_u32 s76, s74, 589824
buffer_load_dwordx4 v1, s[68:71], s76 offen lds
s_add_u32 m0, s83, 25600
s_add_u32 s76, s74, 663552
buffer_load_dwordx4 v1, s[68:71], s76 offen lds
s_add_u32 m0, s83, 32768
s_add_u32 s76, s73, 1179648
buffer_load_dwordx4 v1, s[64:67], s76 offen lds
s_add_u32 m0, s83, 33792
s_add_u32 s76, s73, 1253376
buffer_load_dwordx4 v1, s[64:67], s76 offen lds
s_add_u32 m0, s83, 40960
s_add_u32 s76, s74, 1179648
buffer_load_dwordx4 v1, s[68:71], s76 offen lds
s_add_u32 m0, s83, 41984
s_add_u32 s76, s74, 1253376
buffer_load_dwordx4 v1, s[68:71], s76 offen lds
s_add_u32 m0, s83, 49152
s_add_u32 s76, s73, 1769472
buffer_load_dwordx4 v1, s[64:67], s76 offen lds
s_add_u32 m0, s83, 50176
s_add_u32 s76, s73, 1843200
buffer_load_dwordx4 v1, s[64:67], s76 offen lds
s_add_u32 m0, s83, 57344
s_add_u32 s76, s74, 1769472
buffer_load_dwordx4 v1, s[68:71], s76 offen lds
s_add_u32 m0, s83, 58368
s_add_u32 s76, s74, 1843200
buffer_load_dwordx4 v1, s[68:71], s76 offen lds
s_add_u32 m0, s83, 65536
s_add_u32 s76, s73, 2359296
buffer_load_dwordx4 v1, s[64:67], s76 offen lds
s_add_u32 m0, s83, 66560
s_add_u32 s76, s73, 2433024
buffer_load_dwordx4 v1, s[64:67], s76 offen lds
s_add_u32 m0, s83, 73728
s_add_u32 s76, s74, 2359296
buffer_load_dwordx4 v1, s[68:71], s76 offen lds
s_add_u32 m0, s83, 74752
s_add_u32 s76, s74, 2433024
buffer_load_dwordx4 v1, s[68:71], s76 offen lds
s_add_u32 m0, s83, 81920
s_add_u32 s76, s73, 2949120
buffer_load_dwordx4 v1, s[64:67], s76 offen lds
s_add_u32 m0, s83, 82944
s_add_u32 s76, s73, 3022848
buffer_load_dwordx4 v1, s[64:67], s76 offen lds
s_add_u32 m0, s83, 90112
s_add_u32 s76, s74, 2949120
buffer_load_dwordx4 v1, s[68:71], s76 offen lds
s_add_u32 m0, s83, 91136
s_add_u32 s76, s74, 3022848
buffer_load_dwordx4 v1, s[68:71], s76 offen lds
s_add_u32 m0, s83, 98304
s_add_u32 s76, s73, 3538944
buffer_load_dwordx4 v1, s[64:67], s76 offen lds
s_add_u32 m0, s83, 99328
s_add_u32 s76, s73, 3612672
buffer_load_dwordx4 v1, s[64:67], s76 offen lds
s_add_u32 m0, s83, 106496
s_add_u32 s76, s74, 3538944
buffer_load_dwordx4 v1, s[68:71], s76 offen lds
s_add_u32 m0, s83, 107520
s_add_u32 s76, s74, 3612672
buffer_load_dwordx4 v1, s[68:71], s76 offen lds
s_add_u32 m0, s83, 114688
s_add_u32 s76, s73, 4128768
buffer_load_dwordx4 v1, s[64:67], s76 offen lds
s_add_u32 m0, s83, 115712
s_add_u32 s76, s73, 4202496
buffer_load_dwordx4 v1, s[64:67], s76 offen lds
s_add_u32 m0, s83, 122880
s_add_u32 s76, s74, 4128768
buffer_load_dwordx4 v1, s[68:71], s76 offen lds
s_add_u32 m0, s83, 123904
s_add_u32 s76, s74, 4202496
buffer_load_dwordx4 v1, s[68:71], s76 offen lds
s_add_u32 m0, s83, 131072
s_add_u32 s76, s73, 4718592
buffer_load_dwordx4 v1, s[64:67], s76 offen lds
s_add_u32 m0, s83, 132096
s_add_u32 s76, s73, 4792320
buffer_load_dwordx4 v1, s[64:67], s76 offen lds
s_add_u32 m0, s83, 139264
s_add_u32 s76, s74, 4718592
buffer_load_dwordx4 v1, s[68:71], s76 offen lds
s_add_u32 m0, s83, 140288
s_add_u32 s76, s74, 4792320
buffer_load_dwordx4 v1, s[68:71], s76 offen lds
s_waitcnt vmcnt(0)
s_barrier
s_mov_b32 s32, 0
RD_g:
s_cmp_eq_u32 s13, 0
s_cbranch_scc0 L_rd_28_b
s_lshl_b32 s25, s32, 7
s_add_u32 s25, s25, 70283264
v_mov_b32 v250, s25
s_mov_b32 s24, 0
L_rd_28:
buffer_load_dword v251, v250, s[8:11], 0 offen sc1
s_waitcnt vmcnt(0)
v_readfirstlane_b32 s25, v251
s_cmp_ge_u32 s25, 16
s_cbranch_scc1 L_rd_28_b
s_cmp_lt_u32 s32, 14
s_cbranch_scc0 L_rd_28_ns
s_sleep 8
L_rd_28_ns:
s_add_u32 s24, s24, 1
s_cmp_lt_u32 s24, 1200000
s_cbranch_scc1 L_rd_28
s_endpgm
L_rd_28_b:
s_barrier
s_lshl_b32 s29, s32, 2
s_add_u32 s29, s29, s13
s_mul_i32 s72, s29, 36864
s_add_u32 s72, s72, 96468992
s_mul_i32 s82, s29, 294912
s_lshl_b32 s81, s28, 12
s_add_u32 s82, s82, s81
s_add_u32 s82, s82, 100663296
s_mov_b32 s78, 0xbfb8aa3b
s_add_u32 s76, s72, 0
buffer_load_dwordx4 a[0:3], v0, s[8:11], s76 offen offset:0 sc1
buffer_load_dwordx4 a[4:7], v0, s[8:11], s76 offen offset:1024 sc1
buffer_load_dwordx4 a[8:11], v0, s[8:11], s76 offen offset:2048 sc1
buffer_load_dwordx4 a[12:15], v0, s[8:11], s76 offen offset:3072 sc1
s_add_u32 s76, s72, 4096
buffer_load_dwordx4 a[16:19], v0, s[8:11], s76 offen offset:0 sc1
buffer_load_dwordx4 a[20:23], v0, s[8:11], s76 offen offset:1024 sc1
buffer_load_dwordx4 a[24:27], v0, s[8:11], s76 offen offset:2048 sc1
buffer_load_dwordx4 a[28:31], v0, s[8:11], s76 offen offset:3072 sc1
s_add_u32 s76, s72, 8192
buffer_load_dwordx4 a[32:35], v0, s[8:11], s76 offen offset:0 sc1
buffer_load_dwordx4 a[36:39], v0, s[8:11], s76 offen offset:1024 sc1
buffer_load_dwordx4 a[40:43], v0, s[8:11], s76 offen offset:2048 sc1
buffer_load_dwordx4 a[44:47], v0, s[8:11], s76 offen offset:3072 sc1
s_add_u32 s76, s72, 12288
buffer_load_dwordx4 a[48:51], v0, s[8:11], s76 offen offset:0 sc1
buffer_load_dwordx4 a[52:55], v0, s[8:11], s76 offen offset:1024 sc1
buffer_load_dwordx4 a[56:59], v0, s[8:11], s76 offen offset:2048 sc1
buffer_load_dwordx4 a[60:63], v0, s[8:11], s76 offen offset:3072 sc1
s_add_u32 s76, s72, 16384
buffer_load_dwordx4 a[64:67], v0, s[8:11], s76 offen offset:0 sc1
buffer_load_dwordx4 a[68:71], v0, s[8:11], s76 offen offset:1024 sc1
buffer_load_dwordx4 a[72:75], v0, s[8:11], s76 offen offset:2048 sc1
buffer_load_dwordx4 a[76:79], v0, s[8:11], s76 offen offset:3072 sc1
s_add_u32 s76, s72, 20480
buffer_load_dwordx4 a[80:83], v0, s[8:11], s76 offen offset:0 sc1
buffer_load_dwordx4 a[84:87], v0, s[8:11], s76 offen offset:1024 sc1
buffer_load_dwordx4 a[88:91], v0, s[8:11], s76 offen offset:2048 sc1
buffer_load_dwordx4 a[92:95], v0, s[8:11], s76 offen offset:3072 sc1
s_add_u32 s76, s72, 24576
buffer_load_dwordx4 a[96:99], v0, s[8:11], s76 offen offset:0 sc1
buffer_load_dwordx4 a[100:103], v0, s[8:11], s76 offen offset:1024 sc1
buffer_load_dwordx4 a[104:107], v0, s[8:11], s76 offen offset:2048 sc1
buffer_load_dwordx4 a[108:111], v0, s[8:11], s76 offen offset:3072 sc1
s_add_u32 s76, s72, 28672
buffer_load_dwordx4 a[112:115], v0, s[8:11], s76 offen offset:0 sc1
buffer_load_dwordx4 a[116:119], v0, s[8:11], s76 offen offset:1024 sc1
buffer_load_dwordx4 a[120:123], v0, s[8:11], s76 offen offset:2048 sc1
buffer_load_dwordx4 a[124:127], v0, s[8:11], s76 offen offset:3072 sc1
s_add_u32 s76, s72, 32768
buffer_load_dwordx4 a[128:131], v0, s[8:11], s76 offen offset:0 sc1
buffer_load_dwordx4 a[132:135], v0, s[8:11], s76 offen offset:1024 sc1
buffer_load_dwordx4 a[136:139], v0, s[8:11], s76 offen offset:2048 sc1
buffer_load_dwordx4 a[140:143], v0, s[8:11], s76 offen offset:3072 sc1
ds_read_b64_tr_b16 v[8:9], v2 offset:0
ds_read_b64_tr_b16 v[10:11], v2 offset:2048
ds_read_b64_tr_b16 v[12:13], v3 offset:0
ds_read_b64_tr_b16 v[14:15], v3 offset:2048
ds_read_b64_tr_b16 v[16:17], v2 offset:8192
ds_read_b64_tr_b16 v[18:19], v2 offset:10240
ds_read_b64_tr_b16 v[20:21], v3 offset:8192
ds_read_b64_tr_b16 v[22:23], v3 offset:10240
s_waitcnt vmcnt(35)
s_waitcnt lgkmcnt(6)
v_mfma_f32_32x32x16_bf16 v[40:55], v[8:11], a[0:3], 0
ds_read_b64_tr_b16 v[24:25], v2 offset:1024
ds_read_b64_tr_b16 v[26:27], v2 offset:3072
s_waitcnt lgkmcnt(6)
v_mfma_f32_32x32x16_bf16 v[56:71], v[12:15], a[0:3], 0
ds_read_b64_tr_b16 v[28:29], v3 offset:1024
ds_read_b64_tr_b16 v[30:31], v3 offset:3072
s_waitcnt lgkmcnt(6)
v_mfma_f32_32x32x16_bf16 v[72:87], v[16:19], a[0:3], 0
ds_read_b64_tr_b16 v[32:33], v2 offset:9216
ds_read_b64_tr_b16 v[34:35], v2 offset:11264
s_waitcnt lgkmcnt(6)
v_mfma_f32_32x32x16_bf16 v[88:103], v[20:23], a[0:3], 0
ds_read_b64_tr_b16 v[36:37], v3 offset:9216
ds_read_b64_tr_b16 v[38:39], v3 offset:11264
s_waitcnt vmcnt(34)
s_waitcnt lgkmcnt(6)
v_mfma_f32_32x32x16_bf16 v[40:55], v[24:27], a[4:7], v[40:55]
ds_read_b64_tr_b16 v[8:9], v2 offset:4096
ds_read_b64_tr_b16 v[10:11], v2 offset:6144
s_waitcnt lgkmcnt(6)
v_mfma_f32_32x32x16_bf16 v[56:71], v[28:31], a[4:7], v[56:71]
ds_read_b64_tr_b16 v[12:13], v3 offset:4096
ds_read_b64_tr_b16 v[14:15], v3 offset:6144
s_waitcnt lgkmcnt(6)
v_mfma_f32_32x32x16_bf16 v[72:87], v[32:35], a[4:7], v[72:87]
ds_read_b64_tr_b16 v[16:17], v2 offset:12288
ds_read_b64_tr_b16 v[18:19], v2 offset:14336
s_waitcnt lgkmcnt(6)
v_mfma_f32_32x32x16_bf16 v[88:103], v[36:39], a[4:7], v[88:103]
ds_read_b64_tr_b16 v[20:21], v3 offset:12288
ds_read_b64_tr_b16 v[22:23], v3 offset:14336
s_waitcnt vmcnt(33)
s_waitcnt lgkmcnt(6)
v_mfma_f32_32x32x16_bf16 v[40:55], v[8:11], a[8:11], v[40:55]
ds_read_b64_tr_b16 v[24:25], v2 offset:5120
ds_read_b64_tr_b16 v[26:27], v2 offset:7168
s_waitcnt lgkmcnt(6)
v_mfma_f32_32x32x16_bf16 v[56:71], v[12:15], a[8:11], v[56:71]
ds_read_b64_tr_b16 v[28:29], v3 offset:5120
ds_read_b64_tr_b16 v[30:31], v3 offset:7168
s_waitcnt lgkmcnt(6)
v_mfma_f32_32x32x16_bf16 v[72:87], v[16:19], a[8:11], v[72:87]
ds_read_b64_tr_b16 v[32:33], v2 offset:13312
ds_read_b64_tr_b16 v[34:35], v2 offset:15360
s_waitcnt lgkmcnt(6)
v_mfma_f32_32x32x16_bf16 v[88:103], v[20:23], a[8:11], v[88:103]
ds_read_b64_tr_b16 v[36:37], v3 offset:13312
ds_read_b64_tr_b16 v[38:39], v3 offset:15360
s_waitcnt vmcnt(32)
s_waitcnt lgkmcnt(6)
v_mfma_f32_32x32x16_bf16 v[40:55], v[24:27], a[12:15], v[40:55]
ds_read_b64_tr_b16 v[8:9], v2 offset:16384
ds_read_b64_tr_b16 v[10:11], v2 offset:18432
s_waitcnt lgkmcnt(6)
v_mfma_f32_32x32x16_bf16 v[56:71], v[28:31], a[12:15], v[56:71]
ds_read_b64_tr_b16 v[12:13], v3 offset:16384
ds_read_b64_tr_b16 v[14:15], v3 offset:18432
s_waitcnt lgkmcnt(6)
v_mfma_f32_32x32x16_bf16 v[72:87], v[32:35], a[12:15], v[72:87]
ds_read_b64_tr_b16 v[16:17], v2 offset:24576
ds_read_b64_tr_b16 v[18:19], v2 offset:26624
s_waitcnt lgkmcnt(6)
v_mfma_f32_32x32x16_bf16 v[88:103], v[36:39], a[12:15], v[88:103]
ds_read_b64_tr_b16 v[20:21], v3 offset:24576
ds_read_b64_tr_b16 v[22:23], v3 offset:26624
s_waitcnt vmcnt(31)
s_waitcnt lgkmcnt(6)
v_mfma_f32_32x32x16_bf16 v[40:55], v[8:11], a[16:19], v[40:55]
ds_read_b64_tr_b16 v[24:25], v2 offset:17408
ds_read_b64_tr_b16 v[26:27], v2 offset:19456
s_waitcnt lgkmcnt(6)
v_mfma_f32_32x32x16_bf16 v[56:71], v[12:15], a[16:19], v[56:71]
ds_read_b64_tr_b16 v[28:29], v3 offset:17408
ds_read_b64_tr_b16 v[30:31], v3 offset:19456
s_waitcnt lgkmcnt(6)
v_mfma_f32_32x32x16_bf16 v[72:87], v[16:19], a[16:19], v[72:87]
ds_read_b64_tr_b16 v[32:33], v2 offset:25600
ds_read_b64_tr_b16 v[34:35], v2 offset:27648
s_waitcnt lgkmcnt(6)
v_mfma_f32_32x32x16_bf16 v[88:103], v[20:23], a[16:19], v[88:103]
ds_read_b64_tr_b16 v[36:37], v3 offset:25600
ds_read_b64_tr_b16 v[38:39], v3 offset:27648
s_waitcnt vmcnt(30)
s_waitcnt lgkmcnt(6)
v_mfma_f32_32x32x16_bf16 v[40:55], v[24:27], a[20:23], v[40:55]
ds_read_b64_tr_b16 v[8:9], v2 offset:20480
ds_read_b64_tr_b16 v[10:11], v2 offset:22528
s_waitcnt lgkmcnt(6)
v_mfma_f32_32x32x16_bf16 v[56:71], v[28:31], a[20:23], v[56:71]
ds_read_b64_tr_b16 v[12:13], v3 offset:20480
ds_read_b64_tr_b16 v[14:15], v3 offset:22528
s_waitcnt lgkmcnt(6)
v_mfma_f32_32x32x16_bf16 v[72:87], v[32:35], a[20:23], v[72:87]
ds_read_b64_tr_b16 v[16:17], v2 offset:28672
ds_read_b64_tr_b16 v[18:19], v2 offset:30720
s_waitcnt lgkmcnt(6)
v_mfma_f32_32x32x16_bf16 v[88:103], v[36:39], a[20:23], v[88:103]
ds_read_b64_tr_b16 v[20:21], v3 offset:28672
ds_read_b64_tr_b16 v[22:23], v3 offset:30720
s_waitcnt vmcnt(29)
s_waitcnt lgkmcnt(6)
v_mfma_f32_32x32x16_bf16 v[40:55], v[8:11], a[24:27], v[40:55]
ds_read_b64_tr_b16 v[24:25], v2 offset:21504
ds_read_b64_tr_b16 v[26:27], v2 offset:23552
s_waitcnt lgkmcnt(6)
v_mfma_f32_32x32x16_bf16 v[56:71], v[12:15], a[24:27], v[56:71]
ds_read_b64_tr_b16 v[28:29], v3 offset:21504
ds_read_b64_tr_b16 v[30:31], v3 offset:23552
s_waitcnt lgkmcnt(6)
v_mfma_f32_32x32x16_bf16 v[72:87], v[16:19], a[24:27], v[72:87]
ds_read_b64_tr_b16 v[32:33], v2 offset:29696
ds_read_b64_tr_b16 v[34:35], v2 offset:31744
s_waitcnt lgkmcnt(6)
v_mfma_f32_32x32x16_bf16 v[88:103], v[20:23], a[24:27], v[88:103]
ds_read_b64_tr_b16 v[36:37], v3 offset:29696
ds_read_b64_tr_b16 v[38:39], v3 offset:31744
s_waitcnt vmcnt(28)
s_waitcnt lgkmcnt(6)
v_mfma_f32_32x32x16_bf16 v[40:55], v[24:27], a[28:31], v[40:55]
ds_read_b64_tr_b16 v[8:9], v2 offset:32768
ds_read_b64_tr_b16 v[10:11], v2 offset:34816
s_waitcnt lgkmcnt(6)
v_mfma_f32_32x32x16_bf16 v[56:71], v[28:31], a[28:31], v[56:71]
ds_read_b64_tr_b16 v[12:13], v3 offset:32768
ds_read_b64_tr_b16 v[14:15], v3 offset:34816
s_waitcnt lgkmcnt(6)
v_mfma_f32_32x32x16_bf16 v[72:87], v[32:35], a[28:31], v[72:87]
ds_read_b64_tr_b16 v[16:17], v2 offset:40960
ds_read_b64_tr_b16 v[18:19], v2 offset:43008
s_waitcnt lgkmcnt(6)
v_mfma_f32_32x32x16_bf16 v[88:103], v[36:39], a[28:31], v[88:103]
ds_read_b64_tr_b16 v[20:21], v3 offset:40960
ds_read_b64_tr_b16 v[22:23], v3 offset:43008
s_waitcnt vmcnt(27)
s_waitcnt lgkmcnt(6)
v_mfma_f32_32x32x16_bf16 v[40:55], v[8:11], a[32:35], v[40:55]
ds_read_b64_tr_b16 v[24:25], v2 offset:33792
ds_read_b64_tr_b16 v[26:27], v2 offset:35840
s_waitcnt lgkmcnt(6)
v_mfma_f32_32x32x16_bf16 v[56:71], v[12:15], a[32:35], v[56:71]
ds_read_b64_tr_b16 v[28:29], v3 offset:33792
ds_read_b64_tr_b16 v[30:31], v3 offset:35840
s_waitcnt lgkmcnt(6)
v_mfma_f32_32x32x16_bf16 v[72:87], v[16:19], a[32:35], v[72:87]
ds_read_b64_tr_b16 v[32:33], v2 offset:41984
ds_read_b64_tr_b16 v[34:35], v2 offset:44032
s_waitcnt lgkmcnt(6)
v_mfma_f32_32x32x16_bf16 v[88:103], v[20:23], a[32:35], v[88:103]
ds_read_b64_tr_b16 v[36:37], v3 offset:41984
ds_read_b64_tr_b16 v[38:39], v3 offset:44032
s_waitcnt vmcnt(26)
s_waitcnt lgkmcnt(6)
v_mfma_f32_32x32x16_bf16 v[40:55], v[24:27], a[36:39], v[40:55]
ds_read_b64_tr_b16 v[8:9], v2 offset:36864
ds_read_b64_tr_b16 v[10:11], v2 offset:38912
s_waitcnt lgkmcnt(6)
v_mfma_f32_32x32x16_bf16 v[56:71], v[28:31], a[36:39], v[56:71]
ds_read_b64_tr_b16 v[12:13], v3 offset:36864
ds_read_b64_tr_b16 v[14:15], v3 offset:38912
s_waitcnt lgkmcnt(6)
v_mfma_f32_32x32x16_bf16 v[72:87], v[32:35], a[36:39], v[72:87]
ds_read_b64_tr_b16 v[16:17], v2 offset:45056
ds_read_b64_tr_b16 v[18:19], v2 offset:47104
s_waitcnt lgkmcnt(6)
v_mfma_f32_32x32x16_bf16 v[88:103], v[36:39], a[36:39], v[88:103]
ds_read_b64_tr_b16 v[20:21], v3 offset:45056
ds_read_b64_tr_b16 v[22:23], v3 offset:47104
s_waitcnt vmcnt(25)
s_waitcnt lgkmcnt(6)
v_mfma_f32_32x32x16_bf16 v[40:55], v[8:11], a[40:43], v[40:55]
ds_read_b64_tr_b16 v[24:25], v2 offset:37888
ds_read_b64_tr_b16 v[26:27], v2 offset:39936
s_waitcnt lgkmcnt(6)
v_mfma_f32_32x32x16_bf16 v[56:71], v[12:15], a[40:43], v[56:71]
ds_read_b64_tr_b16 v[28:29], v3 offset:37888
ds_read_b64_tr_b16 v[30:31], v3 offset:39936
s_waitcnt lgkmcnt(6)
v_mfma_f32_32x32x16_bf16 v[72:87], v[16:19], a[40:43], v[72:87]
ds_read_b64_tr_b16 v[32:33], v2 offset:46080
ds_read_b64_tr_b16 v[34:35], v2 offset:48128
s_waitcnt lgkmcnt(6)
v_mfma_f32_32x32x16_bf16 v[88:103], v[20:23], a[40:43], v[88:103]
ds_read_b64_tr_b16 v[36:37], v3 offset:46080
ds_read_b64_tr_b16 v[38:39], v3 offset:48128
s_waitcnt vmcnt(24)
s_waitcnt lgkmcnt(6)
v_mfma_f32_32x32x16_bf16 v[40:55], v[24:27], a[44:47], v[40:55]
ds_read_b64_tr_b16 v[8:9], v2 offset:49152
ds_read_b64_tr_b16 v[10:11], v2 offset:51200
s_waitcnt lgkmcnt(6)
v_mfma_f32_32x32x16_bf16 v[56:71], v[28:31], a[44:47], v[56:71]
ds_read_b64_tr_b16 v[12:13], v3 offset:49152
ds_read_b64_tr_b16 v[14:15], v3 offset:51200
s_waitcnt lgkmcnt(6)
v_mfma_f32_32x32x16_bf16 v[72:87], v[32:35], a[44:47], v[72:87]
ds_read_b64_tr_b16 v[16:17], v2 offset:57344
ds_read_b64_tr_b16 v[18:19], v2 offset:59392
s_waitcnt lgkmcnt(6)
v_mfma_f32_32x32x16_bf16 v[88:103], v[36:39], a[44:47], v[88:103]
ds_read_b64_tr_b16 v[20:21], v3 offset:57344
ds_read_b64_tr_b16 v[22:23], v3 offset:59392
s_waitcnt vmcnt(23)
s_waitcnt lgkmcnt(6)
v_mfma_f32_32x32x16_bf16 v[40:55], v[8:11], a[48:51], v[40:55]
ds_read_b64_tr_b16 v[24:25], v2 offset:50176
ds_read_b64_tr_b16 v[26:27], v2 offset:52224
s_waitcnt lgkmcnt(6)
v_mfma_f32_32x32x16_bf16 v[56:71], v[12:15], a[48:51], v[56:71]
ds_read_b64_tr_b16 v[28:29], v3 offset:50176
ds_read_b64_tr_b16 v[30:31], v3 offset:52224
s_waitcnt lgkmcnt(6)
v_mfma_f32_32x32x16_bf16 v[72:87], v[16:19], a[48:51], v[72:87]
ds_read_b64_tr_b16 v[32:33], v2 offset:58368
ds_read_b64_tr_b16 v[34:35], v2 offset:60416
s_waitcnt lgkmcnt(6)
v_mfma_f32_32x32x16_bf16 v[88:103], v[20:23], a[48:51], v[88:103]
ds_read_b64_tr_b16 v[36:37], v3 offset:58368
ds_read_b64_tr_b16 v[38:39], v3 offset:60416
s_waitcnt vmcnt(22)
s_waitcnt lgkmcnt(6)
v_mfma_f32_32x32x16_bf16 v[40:55], v[24:27], a[52:55], v[40:55]
ds_read_b64_tr_b16 v[8:9], v2 offset:53248
ds_read_b64_tr_b16 v[10:11], v2 offset:55296
s_waitcnt lgkmcnt(6)
v_mfma_f32_32x32x16_bf16 v[56:71], v[28:31], a[52:55], v[56:71]
ds_read_b64_tr_b16 v[12:13], v3 offset:53248
ds_read_b64_tr_b16 v[14:15], v3 offset:55296
s_waitcnt lgkmcnt(6)
v_mfma_f32_32x32x16_bf16 v[72:87], v[32:35], a[52:55], v[72:87]
ds_read_b64_tr_b16 v[16:17], v2 offset:61440
ds_read_b64_tr_b16 v[18:19], v2 offset:63488
s_waitcnt lgkmcnt(6)
v_mfma_f32_32x32x16_bf16 v[88:103], v[36:39], a[52:55], v[88:103]
ds_read_b64_tr_b16 v[20:21], v3 offset:61440
ds_read_b64_tr_b16 v[22:23], v3 offset:63488
s_waitcnt vmcnt(21)
s_waitcnt lgkmcnt(6)
v_mfma_f32_32x32x16_bf16 v[40:55], v[8:11], a[56:59], v[40:55]
ds_read_b64_tr_b16 v[24:25], v2 offset:54272
ds_read_b64_tr_b16 v[26:27], v2 offset:56320
s_waitcnt lgkmcnt(6)
v_mfma_f32_32x32x16_bf16 v[56:71], v[12:15], a[56:59], v[56:71]
ds_read_b64_tr_b16 v[28:29], v3 offset:54272
ds_read_b64_tr_b16 v[30:31], v3 offset:56320
s_waitcnt lgkmcnt(6)
v_mfma_f32_32x32x16_bf16 v[72:87], v[16:19], a[56:59], v[72:87]
ds_read_b64_tr_b16 v[32:33], v2 offset:62464
ds_read_b64_tr_b16 v[34:35], v2 offset:64512
s_waitcnt lgkmcnt(6)
v_mfma_f32_32x32x16_bf16 v[88:103], v[20:23], a[56:59], v[88:103]
ds_read_b64_tr_b16 v[36:37], v3 offset:62464
ds_read_b64_tr_b16 v[38:39], v3 offset:64512
s_waitcnt vmcnt(20)
s_waitcnt lgkmcnt(6)
v_mfma_f32_32x32x16_bf16 v[40:55], v[24:27], a[60:63], v[40:55]
ds_read_b64_tr_b16 v[8:9], v4 offset:0
ds_read_b64_tr_b16 v[10:11], v4 offset:2048
s_waitcnt lgkmcnt(6)
v_mfma_f32_32x32x16_bf16 v[56:71], v[28:31], a[60:63], v[56:71]
ds_read_b64_tr_b16 v[12:13], v5 offset:0
ds_read_b64_tr_b16 v[14:15], v5 offset:2048
s_waitcnt lgkmcnt(6)
v_mfma_f32_32x32x16_bf16 v[72:87], v[32:35], a[60:63], v[72:87]
ds_read_b64_tr_b16 v[16:17], v4 offset:8192
ds_read_b64_tr_b16 v[18:19], v4 offset:10240
s_waitcnt lgkmcnt(6)
v_mfma_f32_32x32x16_bf16 v[88:103], v[36:39], a[60:63], v[88:103]
ds_read_b64_tr_b16 v[20:21], v5 offset:8192
ds_read_b64_tr_b16 v[22:23], v5 offset:10240
s_waitcnt vmcnt(19)
s_waitcnt lgkmcnt(6)
v_mfma_f32_32x32x16_bf16 v[40:55], v[8:11], a[64:67], v[40:55]
ds_read_b64_tr_b16 v[24:25], v4 offset:1024
ds_read_b64_tr_b16 v[26:27], v4 offset:3072
s_waitcnt lgkmcnt(6)
v_mfma_f32_32x32x16_bf16 v[56:71], v[12:15], a[64:67], v[56:71]
ds_read_b64_tr_b16 v[28:29], v5 offset:1024
ds_read_b64_tr_b16 v[30:31], v5 offset:3072
s_waitcnt lgkmcnt(6)
v_mfma_f32_32x32x16_bf16 v[72:87], v[16:19], a[64:67], v[72:87]
ds_read_b64_tr_b16 v[32:33], v4 offset:9216
ds_read_b64_tr_b16 v[34:35], v4 offset:11264
s_waitcnt lgkmcnt(6)
v_mfma_f32_32x32x16_bf16 v[88:103], v[20:23], a[64:67], v[88:103]
ds_read_b64_tr_b16 v[36:37], v5 offset:9216
ds_read_b64_tr_b16 v[38:39], v5 offset:11264
s_waitcnt vmcnt(18)
s_waitcnt lgkmcnt(6)
v_mfma_f32_32x32x16_bf16 v[40:55], v[24:27], a[68:71], v[40:55]
ds_read_b64_tr_b16 v[8:9], v4 offset:4096
ds_read_b64_tr_b16 v[10:11], v4 offset:6144
s_waitcnt lgkmcnt(6)
v_mfma_f32_32x32x16_bf16 v[56:71], v[28:31], a[68:71], v[56:71]
ds_read_b64_tr_b16 v[12:13], v5 offset:4096
ds_read_b64_tr_b16 v[14:15], v5 offset:6144
s_waitcnt lgkmcnt(6)
v_mfma_f32_32x32x16_bf16 v[72:87], v[32:35], a[68:71], v[72:87]
ds_read_b64_tr_b16 v[16:17], v4 offset:12288
ds_read_b64_tr_b16 v[18:19], v4 offset:14336
s_waitcnt lgkmcnt(6)
v_mfma_f32_32x32x16_bf16 v[88:103], v[36:39], a[68:71], v[88:103]
ds_read_b64_tr_b16 v[20:21], v5 offset:12288
ds_read_b64_tr_b16 v[22:23], v5 offset:14336
s_waitcnt vmcnt(17)
s_waitcnt lgkmcnt(6)
v_mfma_f32_32x32x16_bf16 v[40:55], v[8:11], a[72:75], v[40:55]
ds_read_b64_tr_b16 v[24:25], v4 offset:5120
ds_read_b64_tr_b16 v[26:27], v4 offset:7168
s_waitcnt lgkmcnt(6)
v_mfma_f32_32x32x16_bf16 v[56:71], v[12:15], a[72:75], v[56:71]
ds_read_b64_tr_b16 v[28:29], v5 offset:5120
ds_read_b64_tr_b16 v[30:31], v5 offset:7168
s_waitcnt lgkmcnt(6)
v_mfma_f32_32x32x16_bf16 v[72:87], v[16:19], a[72:75], v[72:87]
ds_read_b64_tr_b16 v[32:33], v4 offset:13312
ds_read_b64_tr_b16 v[34:35], v4 offset:15360
s_waitcnt lgkmcnt(6)
v_mfma_f32_32x32x16_bf16 v[88:103], v[20:23], a[72:75], v[88:103]
ds_read_b64_tr_b16 v[36:37], v5 offset:13312
ds_read_b64_tr_b16 v[38:39], v5 offset:15360
s_waitcnt vmcnt(16)
s_waitcnt lgkmcnt(6)
v_mfma_f32_32x32x16_bf16 v[40:55], v[24:27], a[76:79], v[40:55]
ds_read_b64_tr_b16 v[8:9], v4 offset:16384
ds_read_b64_tr_b16 v[10:11], v4 offset:18432
s_waitcnt lgkmcnt(6)
v_mfma_f32_32x32x16_bf16 v[56:71], v[28:31], a[76:79], v[56:71]
ds_read_b64_tr_b16 v[12:13], v5 offset:16384
ds_read_b64_tr_b16 v[14:15], v5 offset:18432
s_waitcnt lgkmcnt(6)
v_mfma_f32_32x32x16_bf16 v[72:87], v[32:35], a[76:79], v[72:87]
ds_read_b64_tr_b16 v[16:17], v4 offset:24576
ds_read_b64_tr_b16 v[18:19], v4 offset:26624
s_waitcnt lgkmcnt(6)
v_mfma_f32_32x32x16_bf16 v[88:103], v[36:39], a[76:79], v[88:103]
ds_read_b64_tr_b16 v[20:21], v5 offset:24576
ds_read_b64_tr_b16 v[22:23], v5 offset:26624
s_waitcnt vmcnt(15)
s_waitcnt lgkmcnt(6)
v_mfma_f32_32x32x16_bf16 v[40:55], v[8:11], a[80:83], v[40:55]
ds_read_b64_tr_b16 v[24:25], v4 offset:17408
ds_read_b64_tr_b16 v[26:27], v4 offset:19456
s_waitcnt lgkmcnt(6)
v_mfma_f32_32x32x16_bf16 v[56:71], v[12:15], a[80:83], v[56:71]
ds_read_b64_tr_b16 v[28:29], v5 offset:17408
ds_read_b64_tr_b16 v[30:31], v5 offset:19456
s_waitcnt lgkmcnt(6)
v_mfma_f32_32x32x16_bf16 v[72:87], v[16:19], a[80:83], v[72:87]
ds_read_b64_tr_b16 v[32:33], v4 offset:25600
ds_read_b64_tr_b16 v[34:35], v4 offset:27648
s_waitcnt lgkmcnt(6)
v_mfma_f32_32x32x16_bf16 v[88:103], v[20:23], a[80:83], v[88:103]
ds_read_b64_tr_b16 v[36:37], v5 offset:25600
ds_read_b64_tr_b16 v[38:39], v5 offset:27648
s_waitcnt vmcnt(14)
s_waitcnt lgkmcnt(6)
v_mfma_f32_32x32x16_bf16 v[40:55], v[24:27], a[84:87], v[40:55]
ds_read_b64_tr_b16 v[8:9], v4 offset:20480
ds_read_b64_tr_b16 v[10:11], v4 offset:22528
s_waitcnt lgkmcnt(6)
v_mfma_f32_32x32x16_bf16 v[56:71], v[28:31], a[84:87], v[56:71]
ds_read_b64_tr_b16 v[12:13], v5 offset:20480
ds_read_b64_tr_b16 v[14:15], v5 offset:22528
s_waitcnt lgkmcnt(6)
v_mfma_f32_32x32x16_bf16 v[72:87], v[32:35], a[84:87], v[72:87]
ds_read_b64_tr_b16 v[16:17], v4 offset:28672
ds_read_b64_tr_b16 v[18:19], v4 offset:30720
s_waitcnt lgkmcnt(6)
v_mfma_f32_32x32x16_bf16 v[88:103], v[36:39], a[84:87], v[88:103]
ds_read_b64_tr_b16 v[20:21], v5 offset:28672
ds_read_b64_tr_b16 v[22:23], v5 offset:30720
s_waitcnt vmcnt(13)
s_waitcnt lgkmcnt(6)
v_mfma_f32_32x32x16_bf16 v[40:55], v[8:11], a[88:91], v[40:55]
ds_read_b64_tr_b16 v[24:25], v4 offset:21504
ds_read_b64_tr_b16 v[26:27], v4 offset:23552
s_waitcnt lgkmcnt(6)
v_mfma_f32_32x32x16_bf16 v[56:71], v[12:15], a[88:91], v[56:71]
ds_read_b64_tr_b16 v[28:29], v5 offset:21504
ds_read_b64_tr_b16 v[30:31], v5 offset:23552
s_waitcnt lgkmcnt(6)
v_mfma_f32_32x32x16_bf16 v[72:87], v[16:19], a[88:91], v[72:87]
ds_read_b64_tr_b16 v[32:33], v4 offset:29696
ds_read_b64_tr_b16 v[34:35], v4 offset:31744
s_waitcnt lgkmcnt(6)
v_mfma_f32_32x32x16_bf16 v[88:103], v[20:23], a[88:91], v[88:103]
ds_read_b64_tr_b16 v[36:37], v5 offset:29696
ds_read_b64_tr_b16 v[38:39], v5 offset:31744
s_waitcnt vmcnt(12)
s_waitcnt lgkmcnt(6)
v_mfma_f32_32x32x16_bf16 v[40:55], v[24:27], a[92:95], v[40:55]
ds_read_b64_tr_b16 v[8:9], v4 offset:32768
ds_read_b64_tr_b16 v[10:11], v4 offset:34816
s_waitcnt lgkmcnt(6)
v_mfma_f32_32x32x16_bf16 v[56:71], v[28:31], a[92:95], v[56:71]
ds_read_b64_tr_b16 v[12:13], v5 offset:32768
ds_read_b64_tr_b16 v[14:15], v5 offset:34816
s_waitcnt lgkmcnt(6)
v_mfma_f32_32x32x16_bf16 v[72:87], v[32:35], a[92:95], v[72:87]
ds_read_b64_tr_b16 v[16:17], v4 offset:40960
ds_read_b64_tr_b16 v[18:19], v4 offset:43008
s_waitcnt lgkmcnt(6)
v_mfma_f32_32x32x16_bf16 v[88:103], v[36:39], a[92:95], v[88:103]
ds_read_b64_tr_b16 v[20:21], v5 offset:40960
ds_read_b64_tr_b16 v[22:23], v5 offset:43008
s_waitcnt vmcnt(11)
s_waitcnt lgkmcnt(6)
v_mfma_f32_32x32x16_bf16 v[40:55], v[8:11], a[96:99], v[40:55]
ds_read_b64_tr_b16 v[24:25], v4 offset:33792
ds_read_b64_tr_b16 v[26:27], v4 offset:35840
s_waitcnt lgkmcnt(6)
v_mfma_f32_32x32x16_bf16 v[56:71], v[12:15], a[96:99], v[56:71]
ds_read_b64_tr_b16 v[28:29], v5 offset:33792
ds_read_b64_tr_b16 v[30:31], v5 offset:35840
s_waitcnt lgkmcnt(6)
v_mfma_f32_32x32x16_bf16 v[72:87], v[16:19], a[96:99], v[72:87]
ds_read_b64_tr_b16 v[32:33], v4 offset:41984
ds_read_b64_tr_b16 v[34:35], v4 offset:44032
s_waitcnt lgkmcnt(6)
v_mfma_f32_32x32x16_bf16 v[88:103], v[20:23], a[96:99], v[88:103]
ds_read_b64_tr_b16 v[36:37], v5 offset:41984
ds_read_b64_tr_b16 v[38:39], v5 offset:44032
s_waitcnt vmcnt(10)
s_waitcnt lgkmcnt(6)
v_mfma_f32_32x32x16_bf16 v[40:55], v[24:27], a[100:103], v[40:55]
ds_read_b64_tr_b16 v[8:9], v4 offset:36864
ds_read_b64_tr_b16 v[10:11], v4 offset:38912
s_waitcnt lgkmcnt(6)
v_mfma_f32_32x32x16_bf16 v[56:71], v[28:31], a[100:103], v[56:71]
ds_read_b64_tr_b16 v[12:13], v5 offset:36864
ds_read_b64_tr_b16 v[14:15], v5 offset:38912
s_waitcnt lgkmcnt(6)
v_mfma_f32_32x32x16_bf16 v[72:87], v[32:35], a[100:103], v[72:87]
ds_read_b64_tr_b16 v[16:17], v4 offset:45056
ds_read_b64_tr_b16 v[18:19], v4 offset:47104
s_waitcnt lgkmcnt(6)
v_mfma_f32_32x32x16_bf16 v[88:103], v[36:39], a[100:103], v[88:103]
ds_read_b64_tr_b16 v[20:21], v5 offset:45056
ds_read_b64_tr_b16 v[22:23], v5 offset:47104
s_waitcnt vmcnt(9)
s_waitcnt lgkmcnt(6)
v_mfma_f32_32x32x16_bf16 v[40:55], v[8:11], a[104:107], v[40:55]
ds_read_b64_tr_b16 v[24:25], v4 offset:37888
ds_read_b64_tr_b16 v[26:27], v4 offset:39936
s_waitcnt lgkmcnt(6)
v_mfma_f32_32x32x16_bf16 v[56:71], v[12:15], a[104:107], v[56:71]
ds_read_b64_tr_b16 v[28:29], v5 offset:37888
ds_read_b64_tr_b16 v[30:31], v5 offset:39936
s_waitcnt lgkmcnt(6)
v_mfma_f32_32x32x16_bf16 v[72:87], v[16:19], a[104:107], v[72:87]
ds_read_b64_tr_b16 v[32:33], v4 offset:46080
ds_read_b64_tr_b16 v[34:35], v4 offset:48128
s_waitcnt lgkmcnt(6)
v_mfma_f32_32x32x16_bf16 v[88:103], v[20:23], a[104:107], v[88:103]
ds_read_b64_tr_b16 v[36:37], v5 offset:46080
ds_read_b64_tr_b16 v[38:39], v5 offset:48128
s_waitcnt vmcnt(8)
s_waitcnt lgkmcnt(6)
v_mfma_f32_32x32x16_bf16 v[40:55], v[24:27], a[108:111], v[40:55]
ds_read_b64_tr_b16 v[8:9], v4 offset:49152
ds_read_b64_tr_b16 v[10:11], v4 offset:51200
s_waitcnt lgkmcnt(6)
v_mfma_f32_32x32x16_bf16 v[56:71], v[28:31], a[108:111], v[56:71]
ds_read_b64_tr_b16 v[12:13], v5 offset:49152
ds_read_b64_tr_b16 v[14:15], v5 offset:51200
s_waitcnt lgkmcnt(6)
v_mfma_f32_32x32x16_bf16 v[72:87], v[32:35], a[108:111], v[72:87]
ds_read_b64_tr_b16 v[16:17], v4 offset:57344
ds_read_b64_tr_b16 v[18:19], v4 offset:59392
s_waitcnt lgkmcnt(6)
v_mfma_f32_32x32x16_bf16 v[88:103], v[36:39], a[108:111], v[88:103]
ds_read_b64_tr_b16 v[20:21], v5 offset:57344
ds_read_b64_tr_b16 v[22:23], v5 offset:59392
s_waitcnt vmcnt(7)
s_waitcnt lgkmcnt(6)
v_mfma_f32_32x32x16_bf16 v[40:55], v[8:11], a[112:115], v[40:55]
ds_read_b64_tr_b16 v[24:25], v4 offset:50176
ds_read_b64_tr_b16 v[26:27], v4 offset:52224
s_waitcnt lgkmcnt(6)
v_mfma_f32_32x32x16_bf16 v[56:71], v[12:15], a[112:115], v[56:71]
ds_read_b64_tr_b16 v[28:29], v5 offset:50176
ds_read_b64_tr_b16 v[30:31], v5 offset:52224
s_waitcnt lgkmcnt(6)
v_mfma_f32_32x32x16_bf16 v[72:87], v[16:19], a[112:115], v[72:87]
ds_read_b64_tr_b16 v[32:33], v4 offset:58368
ds_read_b64_tr_b16 v[34:35], v4 offset:60416
s_waitcnt lgkmcnt(6)
v_mfma_f32_32x32x16_bf16 v[88:103], v[20:23], a[112:115], v[88:103]
ds_read_b64_tr_b16 v[36:37], v5 offset:58368
ds_read_b64_tr_b16 v[38:39], v5 offset:60416
s_waitcnt vmcnt(6)
s_waitcnt lgkmcnt(6)
v_mfma_f32_32x32x16_bf16 v[40:55], v[24:27], a[116:119], v[40:55]
ds_read_b64_tr_b16 v[8:9], v4 offset:53248
ds_read_b64_tr_b16 v[10:11], v4 offset:55296
s_waitcnt lgkmcnt(6)
v_mfma_f32_32x32x16_bf16 v[56:71], v[28:31], a[116:119], v[56:71]
ds_read_b64_tr_b16 v[12:13], v5 offset:53248
ds_read_b64_tr_b16 v[14:15], v5 offset:55296
s_waitcnt lgkmcnt(6)
v_mfma_f32_32x32x16_bf16 v[72:87], v[32:35], a[116:119], v[72:87]
ds_read_b64_tr_b16 v[16:17], v4 offset:61440
ds_read_b64_tr_b16 v[18:19], v4 offset:63488
s_waitcnt lgkmcnt(6)
v_mfma_f32_32x32x16_bf16 v[88:103], v[36:39], a[116:119], v[88:103]
ds_read_b64_tr_b16 v[20:21], v5 offset:61440
ds_read_b64_tr_b16 v[22:23], v5 offset:63488
s_waitcnt vmcnt(5)
s_waitcnt lgkmcnt(6)
v_mfma_f32_32x32x16_bf16 v[40:55], v[8:11], a[120:123], v[40:55]
ds_read_b64_tr_b16 v[24:25], v4 offset:54272
ds_read_b64_tr_b16 v[26:27], v4 offset:56320
s_waitcnt lgkmcnt(6)
v_mfma_f32_32x32x16_bf16 v[56:71], v[12:15], a[120:123], v[56:71]
ds_read_b64_tr_b16 v[28:29], v5 offset:54272
ds_read_b64_tr_b16 v[30:31], v5 offset:56320
s_waitcnt lgkmcnt(6)
v_mfma_f32_32x32x16_bf16 v[72:87], v[16:19], a[120:123], v[72:87]
ds_read_b64_tr_b16 v[32:33], v4 offset:62464
ds_read_b64_tr_b16 v[34:35], v4 offset:64512
s_waitcnt lgkmcnt(6)
v_mfma_f32_32x32x16_bf16 v[88:103], v[20:23], a[120:123], v[88:103]
ds_read_b64_tr_b16 v[36:37], v5 offset:62464
ds_read_b64_tr_b16 v[38:39], v5 offset:64512
s_waitcnt vmcnt(4)
s_waitcnt lgkmcnt(6)
v_mfma_f32_32x32x16_bf16 v[40:55], v[24:27], a[124:127], v[40:55]
ds_read_b64_tr_b16 v[8:9], v6 offset:0
ds_read_b64_tr_b16 v[10:11], v6 offset:2048
s_waitcnt lgkmcnt(6)
v_mfma_f32_32x32x16_bf16 v[56:71], v[28:31], a[124:127], v[56:71]
ds_read_b64_tr_b16 v[12:13], v7 offset:0
ds_read_b64_tr_b16 v[14:15], v7 offset:2048
s_waitcnt lgkmcnt(6)
v_mfma_f32_32x32x16_bf16 v[72:87], v[32:35], a[124:127], v[72:87]
ds_read_b64_tr_b16 v[16:17], v6 offset:8192
ds_read_b64_tr_b16 v[18:19], v6 offset:10240
s_waitcnt lgkmcnt(6)
v_mfma_f32_32x32x16_bf16 v[88:103], v[36:39], a[124:127], v[88:103]
ds_read_b64_tr_b16 v[20:21], v7 offset:8192
ds_read_b64_tr_b16 v[22:23], v7 offset:10240
s_waitcnt vmcnt(3)
s_waitcnt lgkmcnt(6)
v_mfma_f32_32x32x16_bf16 v[40:55], v[8:11], a[128:131], v[40:55]
ds_read_b64_tr_b16 v[24:25], v6 offset:1024
ds_read_b64_tr_b16 v[26:27], v6 offset:3072
s_waitcnt lgkmcnt(6)
v_mfma_f32_32x32x16_bf16 v[56:71], v[12:15], a[128:131], v[56:71]
ds_read_b64_tr_b16 v[28:29], v7 offset:1024
ds_read_b64_tr_b16 v[30:31], v7 offset:3072
s_waitcnt lgkmcnt(6)
v_mfma_f32_32x32x16_bf16 v[72:87], v[16:19], a[128:131], v[72:87]
ds_read_b64_tr_b16 v[32:33], v6 offset:9216
ds_read_b64_tr_b16 v[34:35], v6 offset:11264
s_waitcnt lgkmcnt(6)
v_mfma_f32_32x32x16_bf16 v[88:103], v[20:23], a[128:131], v[88:103]
ds_read_b64_tr_b16 v[36:37], v7 offset:9216
ds_read_b64_tr_b16 v[38:39], v7 offset:11264
s_waitcnt vmcnt(2)
s_waitcnt lgkmcnt(6)
v_mfma_f32_32x32x16_bf16 v[40:55], v[24:27], a[132:135], v[40:55]
ds_read_b64_tr_b16 v[8:9], v6 offset:4096
ds_read_b64_tr_b16 v[10:11], v6 offset:6144
s_waitcnt lgkmcnt(6)
v_mfma_f32_32x32x16_bf16 v[56:71], v[28:31], a[132:135], v[56:71]
ds_read_b64_tr_b16 v[12:13], v7 offset:4096
ds_read_b64_tr_b16 v[14:15], v7 offset:6144
s_waitcnt lgkmcnt(6)
v_mfma_f32_32x32x16_bf16 v[72:87], v[32:35], a[132:135], v[72:87]
ds_read_b64_tr_b16 v[16:17], v6 offset:12288
ds_read_b64_tr_b16 v[18:19], v6 offset:14336
s_waitcnt lgkmcnt(6)
v_mfma_f32_32x32x16_bf16 v[88:103], v[36:39], a[132:135], v[88:103]
ds_read_b64_tr_b16 v[20:21], v7 offset:12288
ds_read_b64_tr_b16 v[22:23], v7 offset:14336
s_waitcnt vmcnt(1)
s_waitcnt lgkmcnt(6)
v_mfma_f32_32x32x16_bf16 v[40:55], v[8:11], a[136:139], v[40:55]
ds_read_b64_tr_b16 v[24:25], v6 offset:5120
ds_read_b64_tr_b16 v[26:27], v6 offset:7168
s_waitcnt lgkmcnt(6)
v_mfma_f32_32x32x16_bf16 v[56:71], v[12:15], a[136:139], v[56:71]
ds_read_b64_tr_b16 v[28:29], v7 offset:5120
ds_read_b64_tr_b16 v[30:31], v7 offset:7168
s_waitcnt lgkmcnt(6)
v_mfma_f32_32x32x16_bf16 v[72:87], v[16:19], a[136:139], v[72:87]
ds_read_b64_tr_b16 v[32:33], v6 offset:13312
ds_read_b64_tr_b16 v[34:35], v6 offset:15360
s_waitcnt lgkmcnt(6)
v_mfma_f32_32x32x16_bf16 v[88:103], v[20:23], a[136:139], v[88:103]
ds_read_b64_tr_b16 v[36:37], v7 offset:13312
ds_read_b64_tr_b16 v[38:39], v7 offset:15360
s_waitcnt vmcnt(0)
s_waitcnt lgkmcnt(6)
v_mfma_f32_32x32x16_bf16 v[40:55], v[24:27], a[140:143], v[40:55]
s_waitcnt lgkmcnt(4)
v_mfma_f32_32x32x16_bf16 v[56:71], v[28:31], a[140:143], v[56:71]
s_waitcnt lgkmcnt(2)
v_mfma_f32_32x32x16_bf16 v[72:87], v[32:35], a[140:143], v[72:87]
s_waitcnt lgkmcnt(0)
v_mfma_f32_32x32x16_bf16 v[88:103], v[36:39], a[140:143], v[88:103]
s_nop 11
v_mul_f32 v104, s78, v40
v_mul_f32 v105, s78, v41
v_mul_f32 v106, s78, v42
v_mul_f32 v107, s78, v43
v_mul_f32 v108, s78, v44
v_mul_f32 v109, s78, v45
v_mul_f32 v110, s78, v46
v_mul_f32 v111, s78, v47
v_mul_f32 v112, s78, v48
v_mul_f32 v113, s78, v49
v_mul_f32 v114, s78, v50
v_mul_f32 v115, s78, v51
v_mul_f32 v116, s78, v52
v_mul_f32 v117, s78, v53
v_mul_f32 v118, s78, v54
v_mul_f32 v119, s78, v55
v_exp_f32 v104, v104
v_exp_f32 v105, v105
v_exp_f32 v106, v106
v_exp_f32 v107, v107
v_exp_f32 v108, v108
v_exp_f32 v109, v109
v_exp_f32 v110, v110
v_exp_f32 v111, v111
v_exp_f32 v112, v112
v_exp_f32 v113, v113
v_exp_f32 v114, v114
v_exp_f32 v115, v115
v_exp_f32 v116, v116
v_exp_f32 v117, v117
v_exp_f32 v118, v118
v_exp_f32 v119, v119
v_add_f32 v104, 1.0, v104
v_add_f32 v105, 1.0, v105
v_add_f32 v106, 1.0, v106
v_add_f32 v107, 1.0, v107
v_add_f32 v108, 1.0, v108
v_add_f32 v109, 1.0, v109
v_add_f32 v110, 1.0, v110
v_add_f32 v111, 1.0, v111
v_add_f32 v112, 1.0, v112
v_add_f32 v113, 1.0, v113
v_add_f32 v114, 1.0, v114
v_add_f32 v115, 1.0, v115
v_add_f32 v116, 1.0, v116
v_add_f32 v117, 1.0, v117
v_add_f32 v118, 1.0, v118
v_add_f32 v119, 1.0, v119
v_rcp_f32 v104, v104
v_rcp_f32 v105, v105
v_rcp_f32 v106, v106
v_rcp_f32 v107, v107
v_rcp_f32 v108, v108
v_rcp_f32 v109, v109
v_rcp_f32 v110, v110
v_rcp_f32 v111, v111
v_rcp_f32 v112, v112
v_rcp_f32 v113, v113
v_rcp_f32 v114, v114
v_rcp_f32 v115, v115
v_rcp_f32 v116, v116
v_rcp_f32 v117, v117
v_rcp_f32 v118, v118
v_rcp_f32 v119, v119
v_mul_f32 v40, v40, v72
v_mul_f32 v41, v41, v73
v_mul_f32 v42, v42, v74
v_mul_f32 v43, v43, v75
v_mul_f32 v44, v44, v76
v_mul_f32 v45, v45, v77
v_mul_f32 v46, v46, v78
v_mul_f32 v47, v47, v79
v_mul_f32 v48, v48, v80
v_mul_f32 v49, v49, v81
v_mul_f32 v50, v50, v82
v_mul_f32 v51, v51, v83
v_mul_f32 v52, v52, v84
v_mul_f32 v53, v53, v85
v_mul_f32 v54, v54, v86
v_mul_f32 v55, v55, v87
v_mul_f32 v40, v40, v104
v_mul_f32 v41, v41, v105
v_mul_f32 v42, v42, v106
v_mul_f32 v43, v43, v107
v_mul_f32 v44, v44, v108
v_mul_f32 v45, v45, v109
v_mul_f32 v46, v46, v110
v_mul_f32 v47, v47, v111
v_mul_f32 v48, v48, v112
v_mul_f32 v49, v49, v113
v_mul_f32 v50, v50, v114
v_mul_f32 v51, v51, v115
v_mul_f32 v52, v52, v116
v_mul_f32 v53, v53, v117
v_mul_f32 v54, v54, v118
v_mul_f32 v55, v55, v119
v_cvt_pk_bf16_f32 v120, v40, v41
v_cvt_pk_bf16_f32 v121, v42, v43
v_cvt_pk_bf16_f32 v122, v48, v49
v_cvt_pk_bf16_f32 v123, v50, v51
buffer_store_dwordx4 v[120:123], v0, s[8:11], s82 offen offset:0 sc1
v_cvt_pk_bf16_f32 v124, v44, v45
v_cvt_pk_bf16_f32 v125, v46, v47
v_cvt_pk_bf16_f32 v126, v52, v53
v_cvt_pk_bf16_f32 v127, v54, v55
buffer_store_dwordx4 v[124:127], v0, s[8:11], s82 offen offset:1024 sc1
v_mul_f32 v104, s78, v56
v_mul_f32 v105, s78, v57
v_mul_f32 v106, s78, v58
v_mul_f32 v107, s78, v59
v_mul_f32 v108, s78, v60
v_mul_f32 v109, s78, v61
v_mul_f32 v110, s78, v62
v_mul_f32 v111, s78, v63
v_mul_f32 v112, s78, v64
v_mul_f32 v113, s78, v65
v_mul_f32 v114, s78, v66
v_mul_f32 v115, s78, v67
v_mul_f32 v116, s78, v68
v_mul_f32 v117, s78, v69
v_mul_f32 v118, s78, v70
v_mul_f32 v119, s78, v71
v_exp_f32 v104, v104
v_exp_f32 v105, v105
v_exp_f32 v106, v106
v_exp_f32 v107, v107
v_exp_f32 v108, v108
v_exp_f32 v109, v109
v_exp_f32 v110, v110
v_exp_f32 v111, v111
v_exp_f32 v112, v112
v_exp_f32 v113, v113
v_exp_f32 v114, v114
v_exp_f32 v115, v115
v_exp_f32 v116, v116
v_exp_f32 v117, v117
v_exp_f32 v118, v118
v_exp_f32 v119, v119
v_add_f32 v104, 1.0, v104
v_add_f32 v105, 1.0, v105
v_add_f32 v106, 1.0, v106
v_add_f32 v107, 1.0, v107
v_add_f32 v108, 1.0, v108
v_add_f32 v109, 1.0, v109
v_add_f32 v110, 1.0, v110
v_add_f32 v111, 1.0, v111
v_add_f32 v112, 1.0, v112
v_add_f32 v113, 1.0, v113
v_add_f32 v114, 1.0, v114
v_add_f32 v115, 1.0, v115
v_add_f32 v116, 1.0, v116
v_add_f32 v117, 1.0, v117
v_add_f32 v118, 1.0, v118
v_add_f32 v119, 1.0, v119
v_rcp_f32 v104, v104
v_rcp_f32 v105, v105
v_rcp_f32 v106, v106
v_rcp_f32 v107, v107
v_rcp_f32 v108, v108
v_rcp_f32 v109, v109
v_rcp_f32 v110, v110
v_rcp_f32 v111, v111
v_rcp_f32 v112, v112
v_rcp_f32 v113, v113
v_rcp_f32 v114, v114
v_rcp_f32 v115, v115
v_rcp_f32 v116, v116
v_rcp_f32 v117, v117
v_rcp_f32 v118, v118
v_rcp_f32 v119, v119
v_mul_f32 v56, v56, v88
v_mul_f32 v57, v57, v89
v_mul_f32 v58, v58, v90
v_mul_f32 v59, v59, v91
v_mul_f32 v60, v60, v92
v_mul_f32 v61, v61, v93
v_mul_f32 v62, v62, v94
v_mul_f32 v63, v63, v95
v_mul_f32 v64, v64, v96
v_mul_f32 v65, v65, v97
v_mul_f32 v66, v66, v98
v_mul_f32 v67, v67, v99
v_mul_f32 v68, v68, v100
v_mul_f32 v69, v69, v101
v_mul_f32 v70, v70, v102
v_mul_f32 v71, v71, v103
v_mul_f32 v56, v56, v104
v_mul_f32 v57, v57, v105
v_mul_f32 v58, v58, v106
v_mul_f32 v59, v59, v107
v_mul_f32 v60, v60, v108
v_mul_f32 v61, v61, v109
v_mul_f32 v62, v62, v110
v_mul_f32 v63, v63, v111
v_mul_f32 v64, v64, v112
v_mul_f32 v65, v65, v113
v_mul_f32 v66, v66, v114
v_mul_f32 v67, v67, v115
v_mul_f32 v68, v68, v116
v_mul_f32 v69, v69, v117
v_mul_f32 v70, v70, v118
v_mul_f32 v71, v71, v119
v_cvt_pk_bf16_f32 v128, v56, v57
v_cvt_pk_bf16_f32 v129, v58, v59
v_cvt_pk_bf16_f32 v130, v64, v65
v_cvt_pk_bf16_f32 v131, v66, v67
buffer_store_dwordx4 v[128:131], v0, s[8:11], s82 offen offset:2048 sc1
v_cvt_pk_bf16_f32 v132, v60, v61
v_cvt_pk_bf16_f32 v133, v62, v63
v_cvt_pk_bf16_f32 v134, v68, v69
v_cvt_pk_bf16_f32 v135, v70, v71
buffer_store_dwordx4 v[132:135], v0, s[8:11], s82 offen offset:3072 sc1
s_waitcnt vmcnt(0) lgkmcnt(0)
s_barrier
s_cmp_eq_u32 s13, 0
s_cbranch_scc0 L_rs_29
s_lshl_b32 s25, s32, 7
s_add_u32 s25, s25, 70285312
v_mov_b32 v250, s25
v_mov_b32 v251, 1
s_mov_b64 exec, 1
buffer_atomic_add v251, v250, s[8:11], 0 offen
s_mov_b64 exec, -1
L_rs_29:
s_add_u32 s32, s32, 1
s_cmp_lt_u32 s32, 16
s_cbranch_scc1 RD_g
K_end:
s_waitcnt vmcnt(0) lgkmcnt(0)
s_endpgm
.p2align 6
K_items:
.long 0, 109
.long 109, 109
.long 218, 97
.long 315, 81
.long 396, 80
.long 476, 80
.long 556, 80
.long 0, 0
.long 0xc, 0x4, 0xffff0000, 0x10
.long 0x100000c, 0x4, 0xffff0000, 0x10
.long 0x200000c, 0x4, 0xffff0000, 0x10
.long 0x300000c, 0x4, 0xffff0000, 0x10
.long 0x1c00000c, 0x4, 0xffff0000, 0x10
.long 0x1d00000c, 0x4, 0xffff0000, 0x10
.long 0x1e00000c, 0x4, 0xffff0000, 0x10
.long 0x1f00000c, 0x4, 0xffff0000, 0x10
.long 0x1801000c, 0x4, 0xffff0000, 0x10
.long 0x1901000c, 0x4, 0xffff0000, 0x10
.long 0x1a01000c, 0x4, 0xffff0000, 0x10
.long 0x1b01000c, 0x4, 0xffff0000, 0x10
.long 0x5020002, 0x4, 0xffff0000, 0x40020
.long 0x401, 0xffff0000, 0x310020, 0x100011
.long 0x10c, 0x10004, 0x310020, 0x11
.long 0x100010c, 0x10004, 0x310020, 0x11
.long 0x200010c, 0x10004, 0x310020, 0x11
.long 0x300010c, 0x10004, 0x310020, 0x11
.long 0x1c00010c, 0x10004, 0x310020, 0x11
.long 0x1d00010c, 0x10004, 0x310020, 0x11
.long 0x1e00010c, 0x10004, 0x310020, 0x11
.long 0x1f00010c, 0x10004, 0x310020, 0x11
.long 0x1801010c, 0x10004, 0x310020, 0x11
.long 0x1901010c, 0x10004, 0x310020, 0x11
.long 0x1a01010c, 0x10004, 0x310020, 0x11
.long 0x1b01010c, 0x10004, 0x310020, 0x11
.long 0x5020102, 0x10004, 0x310020, 0x40021
.long 0xb01, 0xffff0000, 0x310020, 0x100012
.long 0x20c, 0x20004, 0x310020, 0x12
.long 0x100020c, 0x20004, 0x310020, 0x12
.long 0x200020c, 0x20004, 0x310020, 0x12
.long 0x300020c, 0x20004, 0x310020, 0x12
.long 0x1c00020c, 0x20004, 0x310020, 0x12
.long 0x1d00020c, 0x20004, 0x310020, 0x12
.long 0x1e00020c, 0x20004, 0x310020, 0x12
.long 0x1f00020c, 0x20004, 0x310020, 0x12
.long 0x1801020c, 0x20004, 0x310020, 0x12
.long 0x1901020c, 0x20004, 0x310020, 0x12
.long 0x1a01020c, 0x20004, 0x310020, 0x12
.long 0x1b01020c, 0x20004, 0x310020, 0x12
.long 0x5020202, 0x20004, 0x310020, 0x40022
.long 0x30c, 0x30004, 0x310020, 0x13
.long 0x100030c, 0x30004, 0x310020, 0x13
.long 0x200030c, 0x30004, 0x310020, 0x13
.long 0x300030c, 0x30004, 0x310020, 0x13
.long 0x1c00030c, 0x30004, 0x310020, 0x13
.long 0x1d00030c, 0x30004, 0x310020, 0x13
.long 0x1e00030c, 0x30004, 0x310020, 0x13
.long 0x1f00030c, 0x30004, 0x310020, 0x13
.long 0x1801030c, 0x30004, 0x310020, 0x13
.long 0x1901030c, 0x30004, 0x310020, 0x13
.long 0x1a01030c, 0x30004, 0x310020, 0x13
.long 0x1b01030c, 0x30004, 0x310020, 0x13
.long 0x5020302, 0x30004, 0x310020, 0x40023
.long 0x1201, 0xffff0000, 0x310020, 0x100014
.long 0x402, 0x40004, 0x310020, 0x40014
.long 0x7000402, 0x40004, 0x310020, 0x40014
.long 0x6010402, 0x40004, 0x310020, 0x40014
.long 0x5020402, 0x40004, 0x310020, 0x40024
.long 0x502, 0x50004, 0x310020, 0x40015
.long 0x7000502, 0x50004, 0x310020, 0x40015
.long 0x6010502, 0x50004, 0x310020, 0x40015
.long 0x5020502, 0x50004, 0x310020, 0x40025
.long 0x1901, 0xffff0000, 0x310020, 0x100016
.long 0x602, 0x60004, 0x310020, 0x40016
.long 0x7000602, 0x60004, 0x310020, 0x40016
.long 0x6010602, 0x60004, 0x310020, 0x40016
.long 0x5020602, 0x60004, 0x310020, 0x40026
.long 0x702, 0x70004, 0x310020, 0x40017
.long 0x7000702, 0x70004, 0x310020, 0x40017
.long 0x6010702, 0x70004, 0x310020, 0x40017
.long 0x5020702, 0x70004, 0x310020, 0x40027
.long 0x2001, 0xffff0000, 0x310020, 0x100018
.long 0x802, 0x80004, 0x310020, 0x40018
.long 0x7000802, 0x80004, 0x310020, 0x40018
.long 0x6010802, 0x80004, 0x310020, 0x40018
.long 0x5020802, 0x80004, 0x310020, 0x40028
.long 0x2701, 0xffff0000, 0x310020, 0x100019
.long 0x902, 0x90004, 0x310020, 0x40019
.long 0x7000902, 0x90004, 0x310020, 0x40019
.long 0x6010902, 0x90004, 0x310020, 0x40019
.long 0x5020902, 0x90004, 0x310020, 0x40029
.long 0xa02, 0xa0004, 0x310020, 0x4001a
.long 0x7000a02, 0xa0004, 0x310020, 0x4001a
.long 0x6010a02, 0xa0004, 0x310020, 0x4001a
.long 0x5020a02, 0xa0004, 0x310020, 0x4002a
.long 0x2e01, 0xffff0000, 0x310020, 0x10001b
.long 0xb02, 0xb0004, 0x310020, 0x4001b
.long 0x7000b02, 0xb0004, 0x310020, 0x4001b
.long 0x6010b02, 0xb0004, 0x310020, 0x4001b
.long 0x5020b02, 0xb0004, 0x310020, 0x4002b
.long 0xc02, 0xc0004, 0x310020, 0x4001c
.long 0x7000c02, 0xc0004, 0x310020, 0x4001c
.long 0x6010c02, 0xc0004, 0x310020, 0x4001c
.long 0x5020c02, 0xc0004, 0x310020, 0x4002c
.long 0x3501, 0xffff0000, 0x310020, 0x10001d
.long 0xd02, 0xd0004, 0x310020, 0x4001d
.long 0x7000d02, 0xd0004, 0x310020, 0x4001d
.long 0x6010d02, 0xd0004, 0x310020, 0x4001d
.long 0x5020d02, 0xd0004, 0x310020, 0x4002d
.long 0xe02, 0xe0004, 0x310020, 0x4001e
.long 0x7000e02, 0xe0004, 0x310020, 0x4001e
.long 0x6010e02, 0xe0004, 0x310020, 0x4001e
.long 0x5020e02, 0xe0004, 0x310020, 0x4002e
.long 0x3c01, 0xffff0000, 0x310020, 0x10001f
.long 0xf02, 0xf0004, 0x310020, 0x4001f
.long 0x7000f02, 0xf0004, 0x310020, 0x4001f
.long 0x6010f02, 0xf0004, 0x310020, 0x4001f
.long 0x5020f02, 0xf0004, 0x310020, 0x4002f
.long 0x400000c, 0x4, 0xffff0000, 0x10
.long 0x500000c, 0x4, 0xffff0000, 0x10
.long 0x600000c, 0x4, 0xffff0000, 0x10
.long 0x700000c, 0x4, 0xffff0000, 0x10
.long 0x1000c, 0x4, 0xffff0000, 0x10
.long 0x101000c, 0x4, 0xffff0000, 0x10
.long 0x201000c, 0x4, 0xffff0000, 0x10
.long 0x301000c, 0x4, 0xffff0000, 0x10
.long 0x1c01000c, 0x4, 0xffff0000, 0x10
.long 0x1d01000c, 0x4, 0xffff0000, 0x10
.long 0x1e01000c, 0x4, 0xffff0000, 0x10
.long 0x1f01000c, 0x4, 0xffff0000, 0x10
.long 0x6020002, 0x4, 0xffff0000, 0x40020
.long 0x501, 0xffff0000, 0x310020, 0x100011
.long 0x400010c, 0x10004, 0x310020, 0x11
.long 0x500010c, 0x10004, 0x310020, 0x11
.long 0x600010c, 0x10004, 0x310020, 0x11
.long 0x700010c, 0x10004, 0x310020, 0x11
.long 0x1010c, 0x10004, 0x310020, 0x11
.long 0x101010c, 0x10004, 0x310020, 0x11
.long 0x201010c, 0x10004, 0x310020, 0x11
.long 0x301010c, 0x10004, 0x310020, 0x11
.long 0x1c01010c, 0x10004, 0x310020, 0x11
.long 0x1d01010c, 0x10004, 0x310020, 0x11
.long 0x1e01010c, 0x10004, 0x310020, 0x11
.long 0x1f01010c, 0x10004, 0x310020, 0x11
.long 0x6020102, 0x10004, 0x310020, 0x40021
.long 0x400020c, 0x20004, 0x310020, 0x12
.long 0x500020c, 0x20004, 0x310020, 0x12
.long 0x600020c, 0x20004, 0x310020, 0x12
.long 0x700020c, 0x20004, 0x310020, 0x12
.long 0x1020c, 0x20004, 0x310020, 0x12
.long 0x101020c, 0x20004, 0x310020, 0x12
.long 0x201020c, 0x20004, 0x310020, 0x12
.long 0x301020c, 0x20004, 0x310020, 0x12
.long 0x1c01020c, 0x20004, 0x310020, 0x12
.long 0x1d01020c, 0x20004, 0x310020, 0x12
.long 0x1e01020c, 0x20004, 0x310020, 0x12
.long 0x1f01020c, 0x20004, 0x310020, 0x12
.long 0x6020202, 0x20004, 0x310020, 0x40022
.long 0xc01, 0xffff0000, 0x310020, 0x100013
.long 0x400030c, 0x30004, 0x310020, 0x13
.long 0x500030c, 0x30004, 0x310020, 0x13
.long 0x600030c, 0x30004, 0x310020, 0x13
.long 0x700030c, 0x30004, 0x310020, 0x13
.long 0x1030c, 0x30004, 0x310020, 0x13
.long 0x101030c, 0x30004, 0x310020, 0x13
.long 0x201030c, 0x30004, 0x310020, 0x13
.long 0x301030c, 0x30004, 0x310020, 0x13
.long 0x1c01030c, 0x30004, 0x310020, 0x13
.long 0x1d01030c, 0x30004, 0x310020, 0x13
.long 0x1e01030c, 0x30004, 0x310020, 0x13
.long 0x1f01030c, 0x30004, 0x310020, 0x13
.long 0x6020302, 0x30004, 0x310020, 0x40023
.long 0x1301, 0xffff0000, 0x310020, 0x100014
.long 0x1000402, 0x40004, 0x310020, 0x40014
.long 0x10402, 0x40004, 0x310020, 0x40014
.long 0x7010402, 0x40004, 0x310020, 0x40014
.long 0x6020402, 0x40004, 0x310020, 0x40024
.long 0x1000502, 0x50004, 0x310020, 0x40015
.long 0x10502, 0x50004, 0x310020, 0x40015
.long 0x7010502, 0x50004, 0x310020, 0x40015
.long 0x6020502, 0x50004, 0x310020, 0x40025
.long 0x1a01, 0xffff0000, 0x310020, 0x100016
.long 0x1000602, 0x60004, 0x310020, 0x40016
.long 0x10602, 0x60004, 0x310020, 0x40016
.long 0x7010602, 0x60004, 0x310020, 0x40016
.long 0x6020602, 0x60004, 0x310020, 0x40026
.long 0x1000702, 0x70004, 0x310020, 0x40017
.long 0x10702, 0x70004, 0x310020, 0x40017
.long 0x7010702, 0x70004, 0x310020, 0x40017
.long 0x6020702, 0x70004, 0x310020, 0x40027
.long 0x2101, 0xffff0000, 0x310020, 0x100018
.long 0x1000802, 0x80004, 0x310020, 0x40018
.long 0x10802, 0x80004, 0x310020, 0x40018
.long 0x7010802, 0x80004, 0x310020, 0x40018
.long 0x6020802, 0x80004, 0x310020, 0x40028
.long 0x1000902, 0x90004, 0x310020, 0x40019
.long 0x10902, 0x90004, 0x310020, 0x40019
.long 0x7010902, 0x90004, 0x310020, 0x40019
.long 0x6020902, 0x90004, 0x310020, 0x40029
.long 0x2801, 0xffff0000, 0x310020, 0x10001a
.long 0x1000a02, 0xa0004, 0x310020, 0x4001a
.long 0x10a02, 0xa0004, 0x310020, 0x4001a
.long 0x7010a02, 0xa0004, 0x310020, 0x4001a
.long 0x6020a02, 0xa0004, 0x310020, 0x4002a
.long 0x2f01, 0xffff0000, 0x310020, 0x10001b
.long 0x1000b02, 0xb0004, 0x310020, 0x4001b
.long 0x10b02, 0xb0004, 0x310020, 0x4001b
.long 0x7010b02, 0xb0004, 0x310020, 0x4001b
.long 0x6020b02, 0xb0004, 0x310020, 0x4002b
.long 0x1000c02, 0xc0004, 0x310020, 0x4001c
.long 0x10c02, 0xc0004, 0x310020, 0x4001c
.long 0x7010c02, 0xc0004, 0x310020, 0x4001c
.long 0x6020c02, 0xc0004, 0x310020, 0x4002c
.long 0x3601, 0xffff0000, 0x310020, 0x10001d
.long 0x1000d02, 0xd0004, 0x310020, 0x4001d
.long 0x10d02, 0xd0004, 0x310020, 0x4001d
.long 0x7010d02, 0xd0004, 0x310020, 0x4001d
.long 0x6020d02, 0xd0004, 0x310020, 0x4002d
.long 0x1000e02, 0xe0004, 0x310020, 0x4001e
.long 0x10e02, 0xe0004, 0x310020, 0x4001e
.long 0x7010e02, 0xe0004, 0x310020, 0x4001e
.long 0x6020e02, 0xe0004, 0x310020, 0x4002e
.long 0x3d01, 0xffff0000, 0x310020, 0x10001f
.long 0x1000f02, 0xf0004, 0x310020, 0x4001f
.long 0x10f02, 0xf0004, 0x310020, 0x4001f
.long 0x7010f02, 0xf0004, 0x310020, 0x4001f
.long 0x6020f02, 0xf0004, 0x310020, 0x4002f
.long 0x800000c, 0x4, 0xffff0000, 0x10
.long 0x900000c, 0x4, 0xffff0000, 0x10
.long 0xa00000c, 0x4, 0xffff0000, 0x10
.long 0xb00000c, 0x4, 0xffff0000, 0x10
.long 0x401000c, 0x4, 0xffff0000, 0x10
.long 0x501000c, 0x4, 0xffff0000, 0x10
.long 0x601000c, 0x4, 0xffff0000, 0x10
.long 0x701000c, 0x4, 0xffff0000, 0x10
.long 0x20002, 0x4, 0xffff0000, 0x40020
.long 0x7020002, 0x4, 0xffff0000, 0x40020
.long 0x601, 0xffff0000, 0x310020, 0x100011
.long 0x800010c, 0x10004, 0x310020, 0x11
.long 0x900010c, 0x10004, 0x310020, 0x11
.long 0xa00010c, 0x10004, 0x310020, 0x11
.long 0xb00010c, 0x10004, 0x310020, 0x11
.long 0x401010c, 0x10004, 0x310020, 0x11
.long 0x501010c, 0x10004, 0x310020, 0x11
.long 0x601010c, 0x10004, 0x310020, 0x11
.long 0x701010c, 0x10004, 0x310020, 0x11
.long 0x20102, 0x10004, 0x310020, 0x40021
.long 0x7020102, 0x10004, 0x310020, 0x40021
.long 0x800020c, 0x20004, 0x310020, 0x12
.long 0x900020c, 0x20004, 0x310020, 0x12
.long 0xa00020c, 0x20004, 0x310020, 0x12
.long 0xb00020c, 0x20004, 0x310020, 0x12
.long 0x401020c, 0x20004, 0x310020, 0x12
.long 0x501020c, 0x20004, 0x310020, 0x12
.long 0x601020c, 0x20004, 0x310020, 0x12
.long 0x701020c, 0x20004, 0x310020, 0x12
.long 0x20202, 0x20004, 0x310020, 0x40022
.long 0x7020202, 0x20004, 0x310020, 0x40022
.long 0xd01, 0xffff0000, 0x310020, 0x100013
.long 0x800030c, 0x30004, 0x310020, 0x13
.long 0x900030c, 0x30004, 0x310020, 0x13
.long 0xa00030c, 0x30004, 0x310020, 0x13
.long 0xb00030c, 0x30004, 0x310020, 0x13
.long 0x401030c, 0x30004, 0x310020, 0x13
.long 0x501030c, 0x30004, 0x310020, 0x13
.long 0x601030c, 0x30004, 0x310020, 0x13
.long 0x701030c, 0x30004, 0x310020, 0x13
.long 0x20302, 0x30004, 0x310020, 0x40023
.long 0x7020302, 0x30004, 0x310020, 0x40023
.long 0x2000402, 0x40004, 0x310020, 0x40014
.long 0x1010402, 0x40004, 0x310020, 0x40014
.long 0x20402, 0x40004, 0x310020, 0x40024
.long 0x7020402, 0x40004, 0x310020, 0x40024
.long 0x1401, 0xffff0000, 0x310020, 0x100015
.long 0x2000502, 0x50004, 0x310020, 0x40015
.long 0x1010502, 0x50004, 0x310020, 0x40015
.long 0x20502, 0x50004, 0x310020, 0x40025
.long 0x7020502, 0x50004, 0x310020, 0x40025
.long 0x1b01, 0xffff0000, 0x310020, 0x100016
.long 0x2000602, 0x60004, 0x310020, 0x40016
.long 0x1010602, 0x60004, 0x310020, 0x40016
.long 0x20602, 0x60004, 0x310020, 0x40026
.long 0x7020602, 0x60004, 0x310020, 0x40026
.long 0x2000702, 0x70004, 0x310020, 0x40017
.long 0x1010702, 0x70004, 0x310020, 0x40017
.long 0x20702, 0x70004, 0x310020, 0x40027
.long 0x7020702, 0x70004, 0x310020, 0x40027
.long 0x2201, 0xffff0000, 0x310020, 0x100018
.long 0x2000802, 0x80004, 0x310020, 0x40018
.long 0x1010802, 0x80004, 0x310020, 0x40018
.long 0x20802, 0x80004, 0x310020, 0x40028
.long 0x7020802, 0x80004, 0x310020, 0x40028
.long 0x2000902, 0x90004, 0x310020, 0x40019
.long 0x1010902, 0x90004, 0x310020, 0x40019
.long 0x20902, 0x90004, 0x310020, 0x40029
.long 0x7020902, 0x90004, 0x310020, 0x40029
.long 0x2901, 0xffff0000, 0x310020, 0x10001a
.long 0x2000a02, 0xa0004, 0x310020, 0x4001a
.long 0x1010a02, 0xa0004, 0x310020, 0x4001a
.long 0x20a02, 0xa0004, 0x310020, 0x4002a
.long 0x7020a02, 0xa0004, 0x310020, 0x4002a
.long 0x2000b02, 0xb0004, 0x310020, 0x4001b
.long 0x1010b02, 0xb0004, 0x310020, 0x4001b
.long 0x20b02, 0xb0004, 0x310020, 0x4002b
.long 0x7020b02, 0xb0004, 0x310020, 0x4002b
.long 0x3001, 0xffff0000, 0x310020, 0x10001c
.long 0x2000c02, 0xc0004, 0x310020, 0x4001c
.long 0x1010c02, 0xc0004, 0x310020, 0x4001c
.long 0x20c02, 0xc0004, 0x310020, 0x4002c
.long 0x7020c02, 0xc0004, 0x310020, 0x4002c
.long 0x3701, 0xffff0000, 0x310020, 0x10001d
.long 0x2000d02, 0xd0004, 0x310020, 0x4001d
.long 0x1010d02, 0xd0004, 0x310020, 0x4001d
.long 0x20d02, 0xd0004, 0x310020, 0x4002d
.long 0x7020d02, 0xd0004, 0x310020, 0x4002d
.long 0x2000e02, 0xe0004, 0x310020, 0x4001e
.long 0x1010e02, 0xe0004, 0x310020, 0x4001e
.long 0x20e02, 0xe0004, 0x310020, 0x4002e
.long 0x7020e02, 0xe0004, 0x310020, 0x4002e
.long 0x3e01, 0xffff0000, 0x310020, 0x10001f
.long 0x2000f02, 0xf0004, 0x310020, 0x4001f
.long 0x1010f02, 0xf0004, 0x310020, 0x4001f
.long 0x20f02, 0xf0004, 0x310020, 0x4002f
.long 0x7020f02, 0xf0004, 0x310020, 0x4002f
.long 0xc00000c, 0x4, 0xffff0000, 0x10
.long 0xd00000c, 0x4, 0xffff0000, 0x10
.long 0xe00000c, 0x4, 0xffff0000, 0x10
.long 0xf00000c, 0x4, 0xffff0000, 0x10
.long 0x801000c, 0x4, 0xffff0000, 0x10
.long 0x901000c, 0x4, 0xffff0000, 0x10
.long 0xa01000c, 0x4, 0xffff0000, 0x10
.long 0xb01000c, 0x4, 0xffff0000, 0x10
.long 0x1020002, 0x4, 0xffff0000, 0x40020
.long 0x701, 0xffff0000, 0x310020, 0x100011
.long 0xc00010c, 0x10004, 0x310020, 0x11
.long 0xd00010c, 0x10004, 0x310020, 0x11
.long 0xe00010c, 0x10004, 0x310020, 0x11
.long 0xf00010c, 0x10004, 0x310020, 0x11
.long 0x801010c, 0x10004, 0x310020, 0x11
.long 0x901010c, 0x10004, 0x310020, 0x11
.long 0xa01010c, 0x10004, 0x310020, 0x11
.long 0xb01010c, 0x10004, 0x310020, 0x11
.long 0x1020102, 0x10004, 0x310020, 0x40021
.long 0xc00020c, 0x20004, 0x310020, 0x12
.long 0xd00020c, 0x20004, 0x310020, 0x12
.long 0xe00020c, 0x20004, 0x310020, 0x12
.long 0xf00020c, 0x20004, 0x310020, 0x12
.long 0x801020c, 0x20004, 0x310020, 0x12
.long 0x901020c, 0x20004, 0x310020, 0x12
.long 0xa01020c, 0x20004, 0x310020, 0x12
.long 0xb01020c, 0x20004, 0x310020, 0x12
.long 0x1020202, 0x20004, 0x310020, 0x40022
.long 0xe01, 0xffff0000, 0x310020, 0x100013
.long 0xc00030c, 0x30004, 0x310020, 0x13
.long 0xd00030c, 0x30004, 0x310020, 0x13
.long 0xe00030c, 0x30004, 0x310020, 0x13
.long 0xf00030c, 0x30004, 0x310020, 0x13
.long 0x801030c, 0x30004, 0x310020, 0x13
.long 0x901030c, 0x30004, 0x310020, 0x13
.long 0xa01030c, 0x30004, 0x310020, 0x13
.long 0xb01030c, 0x30004, 0x310020, 0x13
.long 0x1020302, 0x30004, 0x310020, 0x40023
.long 0x3000402, 0x40004, 0x310020, 0x40014
.long 0x2010402, 0x40004, 0x310020, 0x40014
.long 0x1020402, 0x40004, 0x310020, 0x40024
.long 0x1501, 0xffff0000, 0x310020, 0x100015
.long 0x3000502, 0x50004, 0x310020, 0x40015
.long 0x2010502, 0x50004, 0x310020, 0x40015
.long 0x1020502, 0x50004, 0x310020, 0x40025
.long 0x3000602, 0x60004, 0x310020, 0x40016
.long 0x2010602, 0x60004, 0x310020, 0x40016
.long 0x1020602, 0x60004, 0x310020, 0x40026
.long 0x1c01, 0xffff0000, 0x310020, 0x100017
.long 0x3000702, 0x70004, 0x310020, 0x40017
.long 0x2010702, 0x70004, 0x310020, 0x40017
.long 0x1020702, 0x70004, 0x310020, 0x40027
.long 0x2301, 0xffff0000, 0x310020, 0x100018
.long 0x3000802, 0x80004, 0x310020, 0x40018
.long 0x2010802, 0x80004, 0x310020, 0x40018
.long 0x1020802, 0x80004, 0x310020, 0x40028
.long 0x3000902, 0x90004, 0x310020, 0x40019
.long 0x2010902, 0x90004, 0x310020, 0x40019
.long 0x1020902, 0x90004, 0x310020, 0x40029
.long 0x2a01, 0xffff0000, 0x310020, 0x10001a
.long 0x3000a02, 0xa0004, 0x310020, 0x4001a
.long 0x2010a02, 0xa0004, 0x310020, 0x4001a
.long 0x1020a02, 0xa0004, 0x310020, 0x4002a
.long 0x3000b02, 0xb0004, 0x310020, 0x4001b
.long 0x2010b02, 0xb0004, 0x310020, 0x4001b
.long 0x1020b02, 0xb0004, 0x310020, 0x4002b
.long 0x3101, 0xffff0000, 0x310020, 0x10001c
.long 0x3000c02, 0xc0004, 0x310020, 0x4001c
.long 0x2010c02, 0xc0004, 0x310020, 0x4001c
.long 0x1020c02, 0xc0004, 0x310020, 0x4002c
.long 0x3000d02, 0xd0004, 0x310020, 0x4001d
.long 0x2010d02, 0xd0004, 0x310020, 0x4001d
.long 0x1020d02, 0xd0004, 0x310020, 0x4002d
.long 0x3801, 0xffff0000, 0x310020, 0x10001e
.long 0x3000e02, 0xe0004, 0x310020, 0x4001e
.long 0x2010e02, 0xe0004, 0x310020, 0x4001e
.long 0x1020e02, 0xe0004, 0x310020, 0x4002e
.long 0x3f01, 0xffff0000, 0x310020, 0x10001f
.long 0x3000f02, 0xf0004, 0x310020, 0x4001f
.long 0x2010f02, 0xf0004, 0x310020, 0x4001f
.long 0x1020f02, 0xf0004, 0x310020, 0x4002f
.long 0x1000000c, 0x4, 0xffff0000, 0x10
.long 0x1100000c, 0x4, 0xffff0000, 0x10
.long 0x1200000c, 0x4, 0xffff0000, 0x10
.long 0x1300000c, 0x4, 0xffff0000, 0x10
.long 0xc01000c, 0x4, 0xffff0000, 0x10
.long 0xd01000c, 0x4, 0xffff0000, 0x10
.long 0xe01000c, 0x4, 0xffff0000, 0x10
.long 0xf01000c, 0x4, 0xffff0000, 0x10
.long 0x2020002, 0x4, 0xffff0000, 0x40020
.long 0x1000010c, 0x10004, 0x310020, 0x11
.long 0x1100010c, 0x10004, 0x310020, 0x11
.long 0x1200010c, 0x10004, 0x310020, 0x11
.long 0x1300010c, 0x10004, 0x310020, 0x11
.long 0xc01010c, 0x10004, 0x310020, 0x11
.long 0xd01010c, 0x10004, 0x310020, 0x11
.long 0xe01010c, 0x10004, 0x310020, 0x11
.long 0xf01010c, 0x10004, 0x310020, 0x11
.long 0x2020102, 0x10004, 0x310020, 0x40021
.long 0x801, 0xffff0000, 0x310020, 0x100012
.long 0x1000020c, 0x20004, 0x310020, 0x12
.long 0x1100020c, 0x20004, 0x310020, 0x12
.long 0x1200020c, 0x20004, 0x310020, 0x12
.long 0x1300020c, 0x20004, 0x310020, 0x12
.long 0xc01020c, 0x20004, 0x310020, 0x12
.long 0xd01020c, 0x20004, 0x310020, 0x12
.long 0xe01020c, 0x20004, 0x310020, 0x12
.long 0xf01020c, 0x20004, 0x310020, 0x12
.long 0x2020202, 0x20004, 0x310020, 0x40022
.long 0xf01, 0xffff0000, 0x310020, 0x100013
.long 0x1000030c, 0x30004, 0x310020, 0x13
.long 0x1100030c, 0x30004, 0x310020, 0x13
.long 0x1200030c, 0x30004, 0x310020, 0x13
.long 0x1300030c, 0x30004, 0x310020, 0x13
.long 0xc01030c, 0x30004, 0x310020, 0x13
.long 0xd01030c, 0x30004, 0x310020, 0x13
.long 0xe01030c, 0x30004, 0x310020, 0x13
.long 0xf01030c, 0x30004, 0x310020, 0x13
.long 0x2020302, 0x30004, 0x310020, 0x40023
.long 0x4000402, 0x40004, 0x310020, 0x40014
.long 0x3010402, 0x40004, 0x310020, 0x40014
.long 0x2020402, 0x40004, 0x310020, 0x40024
.long 0x1601, 0xffff0000, 0x310020, 0x100015
.long 0x4000502, 0x50004, 0x310020, 0x40015
.long 0x3010502, 0x50004, 0x310020, 0x40015
.long 0x2020502, 0x50004, 0x310020, 0x40025
.long 0x4000602, 0x60004, 0x310020, 0x40016
.long 0x3010602, 0x60004, 0x310020, 0x40016
.long 0x2020602, 0x60004, 0x310020, 0x40026
.long 0x1d01, 0xffff0000, 0x310020, 0x100017
.long 0x4000702, 0x70004, 0x310020, 0x40017
.long 0x3010702, 0x70004, 0x310020, 0x40017
.long 0x2020702, 0x70004, 0x310020, 0x40027
.long 0x4000802, 0x80004, 0x310020, 0x40018
.long 0x3010802, 0x80004, 0x310020, 0x40018
.long 0x2020802, 0x80004, 0x310020, 0x40028
.long 0x2401, 0xffff0000, 0x310020, 0x100019
.long 0x4000902, 0x90004, 0x310020, 0x40019
.long 0x3010902, 0x90004, 0x310020, 0x40019
.long 0x2020902, 0x90004, 0x310020, 0x40029
.long 0x2b01, 0xffff0000, 0x310020, 0x10001a
.long 0x4000a02, 0xa0004, 0x310020, 0x4001a
.long 0x3010a02, 0xa0004, 0x310020, 0x4001a
.long 0x2020a02, 0xa0004, 0x310020, 0x4002a
.long 0x4000b02, 0xb0004, 0x310020, 0x4001b
.long 0x3010b02, 0xb0004, 0x310020, 0x4001b
.long 0x2020b02, 0xb0004, 0x310020, 0x4002b
.long 0x3201, 0xffff0000, 0x310020, 0x10001c
.long 0x4000c02, 0xc0004, 0x310020, 0x4001c
.long 0x3010c02, 0xc0004, 0x310020, 0x4001c
.long 0x2020c02, 0xc0004, 0x310020, 0x4002c
.long 0x4000d02, 0xd0004, 0x310020, 0x4001d
.long 0x3010d02, 0xd0004, 0x310020, 0x4001d
.long 0x2020d02, 0xd0004, 0x310020, 0x4002d
.long 0x3901, 0xffff0000, 0x310020, 0x10001e
.long 0x4000e02, 0xe0004, 0x310020, 0x4001e
.long 0x3010e02, 0xe0004, 0x310020, 0x4001e
.long 0x2020e02, 0xe0004, 0x310020, 0x4002e
.long 0x4000f02, 0xf0004, 0x310020, 0x4001f
.long 0x3010f02, 0xf0004, 0x310020, 0x4001f
.long 0x2020f02, 0xf0004, 0x310020, 0x4002f
.long 0x1400000c, 0x4, 0xffff0000, 0x10
.long 0x1500000c, 0x4, 0xffff0000, 0x10
.long 0x1600000c, 0x4, 0xffff0000, 0x10
.long 0x1700000c, 0x4, 0xffff0000, 0x10
.long 0x1001000c, 0x4, 0xffff0000, 0x10
.long 0x1101000c, 0x4, 0xffff0000, 0x10
.long 0x1201000c, 0x4, 0xffff0000, 0x10
.long 0x1301000c, 0x4, 0xffff0000, 0x10
.long 0x3020002, 0x4, 0xffff0000, 0x40020
.long 0x1400010c, 0x10004, 0x310020, 0x11
.long 0x1500010c, 0x10004, 0x310020, 0x11
.long 0x1600010c, 0x10004, 0x310020, 0x11
.long 0x1700010c, 0x10004, 0x310020, 0x11
.long 0x1001010c, 0x10004, 0x310020, 0x11
.long 0x1101010c, 0x10004, 0x310020, 0x11
.long 0x1201010c, 0x10004, 0x310020, 0x11
.long 0x1301010c, 0x10004, 0x310020, 0x11
.long 0x3020102, 0x10004, 0x310020, 0x40021
.long 0x901, 0xffff0000, 0x310020, 0x100012
.long 0x1400020c, 0x20004, 0x310020, 0x12
.long 0x1500020c, 0x20004, 0x310020, 0x12
.long 0x1600020c, 0x20004, 0x310020, 0x12
.long 0x1700020c, 0x20004, 0x310020, 0x12
.long 0x1001020c, 0x20004, 0x310020, 0x12
.long 0x1101020c, 0x20004, 0x310020, 0x12
.long 0x1201020c, 0x20004, 0x310020, 0x12
.long 0x1301020c, 0x20004, 0x310020, 0x12
.long 0x3020202, 0x20004, 0x310020, 0x40022
.long 0x1400030c, 0x30004, 0x310020, 0x13
.long 0x1500030c, 0x30004, 0x310020, 0x13
.long 0x1600030c, 0x30004, 0x310020, 0x13
.long 0x1700030c, 0x30004, 0x310020, 0x13
.long 0x1001030c, 0x30004, 0x310020, 0x13
.long 0x1101030c, 0x30004, 0x310020, 0x13
.long 0x1201030c, 0x30004, 0x310020, 0x13
.long 0x1301030c, 0x30004, 0x310020, 0x13
.long 0x3020302, 0x30004, 0x310020, 0x40023
.long 0x1001, 0xffff0000, 0x310020, 0x100014
.long 0x5000402, 0x40004, 0x310020, 0x40014
.long 0x4010402, 0x40004, 0x310020, 0x40014
.long 0x3020402, 0x40004, 0x310020, 0x40024
.long 0x1701, 0xffff0000, 0x310020, 0x100015
.long 0x5000502, 0x50004, 0x310020, 0x40015
.long 0x4010502, 0x50004, 0x310020, 0x40015
.long 0x3020502, 0x50004, 0x310020, 0x40025
.long 0x5000602, 0x60004, 0x310020, 0x40016
.long 0x4010602, 0x60004, 0x310020, 0x40016
.long 0x3020602, 0x60004, 0x310020, 0x40026
.long 0x1e01, 0xffff0000, 0x310020, 0x100017
.long 0x5000702, 0x70004, 0x310020, 0x40017
.long 0x4010702, 0x70004, 0x310020, 0x40017
.long 0x3020702, 0x70004, 0x310020, 0x40027
.long 0x5000802, 0x80004, 0x310020, 0x40018
.long 0x4010802, 0x80004, 0x310020, 0x40018
.long 0x3020802, 0x80004, 0x310020, 0x40028
.long 0x2501, 0xffff0000, 0x310020, 0x100019
.long 0x5000902, 0x90004, 0x310020, 0x40019
.long 0x4010902, 0x90004, 0x310020, 0x40019
.long 0x3020902, 0x90004, 0x310020, 0x40029
.long 0x5000a02, 0xa0004, 0x310020, 0x4001a
.long 0x4010a02, 0xa0004, 0x310020, 0x4001a
.long 0x3020a02, 0xa0004, 0x310020, 0x4002a
.long 0x2c01, 0xffff0000, 0x310020, 0x10001b
.long 0x5000b02, 0xb0004, 0x310020, 0x4001b
.long 0x4010b02, 0xb0004, 0x310020, 0x4001b
.long 0x3020b02, 0xb0004, 0x310020, 0x4002b
.long 0x3301, 0xffff0000, 0x310020, 0x10001c
.long 0x5000c02, 0xc0004, 0x310020, 0x4001c
.long 0x4010c02, 0xc0004, 0x310020, 0x4001c
.long 0x3020c02, 0xc0004, 0x310020, 0x4002c
.long 0x5000d02, 0xd0004, 0x310020, 0x4001d
.long 0x4010d02, 0xd0004, 0x310020, 0x4001d
.long 0x3020d02, 0xd0004, 0x310020, 0x4002d
.long 0x3a01, 0xffff0000, 0x310020, 0x10001e
.long 0x5000e02, 0xe0004, 0x310020, 0x4001e
.long 0x4010e02, 0xe0004, 0x310020, 0x4001e
.long 0x3020e02, 0xe0004, 0x310020, 0x4002e
.long 0x5000f02, 0xf0004, 0x310020, 0x4001f
.long 0x4010f02, 0xf0004, 0x310020, 0x4001f
.long 0x3020f02, 0xf0004, 0x310020, 0x4002f
.long 0x1800000c, 0x4, 0xffff0000, 0x10
.long 0x1900000c, 0x4, 0xffff0000, 0x10
.long 0x1a00000c, 0x4, 0xffff0000, 0x10
.long 0x1b00000c, 0x4, 0xffff0000, 0x10
.long 0x1401000c, 0x4, 0xffff0000, 0x10
.long 0x1501000c, 0x4, 0xffff0000, 0x10
.long 0x1601000c, 0x4, 0xffff0000, 0x10
.long 0x1701000c, 0x4, 0xffff0000, 0x10
.long 0x4020002, 0x4, 0xffff0000, 0x40020
.long 0x1800010c, 0x10004, 0x310020, 0x11
.long 0x1900010c, 0x10004, 0x310020, 0x11
.long 0x1a00010c, 0x10004, 0x310020, 0x11
.long 0x1b00010c, 0x10004, 0x310020, 0x11
.long 0x1401010c, 0x10004, 0x310020, 0x11
.long 0x1501010c, 0x10004, 0x310020, 0x11
.long 0x1601010c, 0x10004, 0x310020, 0x11
.long 0x1701010c, 0x10004, 0x310020, 0x11
.long 0x4020102, 0x10004, 0x310020, 0x40021
.long 0xa01, 0xffff0000, 0x310020, 0x100012
.long 0x1800020c, 0x20004, 0x310020, 0x12
.long 0x1900020c, 0x20004, 0x310020, 0x12
.long 0x1a00020c, 0x20004, 0x310020, 0x12
.long 0x1b00020c, 0x20004, 0x310020, 0x12
.long 0x1401020c, 0x20004, 0x310020, 0x12
.long 0x1501020c, 0x20004, 0x310020, 0x12
.long 0x1601020c, 0x20004, 0x310020, 0x12
.long 0x1701020c, 0x20004, 0x310020, 0x12
.long 0x4020202, 0x20004, 0x310020, 0x40022
.long 0x1800030c, 0x30004, 0x310020, 0x13
.long 0x1900030c, 0x30004, 0x310020, 0x13
.long 0x1a00030c, 0x30004, 0x310020, 0x13
.long 0x1b00030c, 0x30004, 0x310020, 0x13
.long 0x1401030c, 0x30004, 0x310020, 0x13
.long 0x1501030c, 0x30004, 0x310020, 0x13
.long 0x1601030c, 0x30004, 0x310020, 0x13
.long 0x1701030c, 0x30004, 0x310020, 0x13
.long 0x4020302, 0x30004, 0x310020, 0x40023
.long 0x1101, 0xffff0000, 0x310020, 0x100014
.long 0x6000402, 0x40004, 0x310020, 0x40014
.long 0x5010402, 0x40004, 0x310020, 0x40014
.long 0x4020402, 0x40004, 0x310020, 0x40024
.long 0x6000502, 0x50004, 0x310020, 0x40015
.long 0x5010502, 0x50004, 0x310020, 0x40015
.long 0x4020502, 0x50004, 0x310020, 0x40025
.long 0x1801, 0xffff0000, 0x310020, 0x100016
.long 0x6000602, 0x60004, 0x310020, 0x40016
.long 0x5010602, 0x60004, 0x310020, 0x40016
.long 0x4020602, 0x60004, 0x310020, 0x40026
.long 0x1f01, 0xffff0000, 0x310020, 0x100017
.long 0x6000702, 0x70004, 0x310020, 0x40017
.long 0x5010702, 0x70004, 0x310020, 0x40017
.long 0x4020702, 0x70004, 0x310020, 0x40027
.long 0x6000802, 0x80004, 0x310020, 0x40018
.long 0x5010802, 0x80004, 0x310020, 0x40018
.long 0x4020802, 0x80004, 0x310020, 0x40028
.long 0x2601, 0xffff0000, 0x310020, 0x100019
.long 0x6000902, 0x90004, 0x310020, 0x40019
.long 0x5010902, 0x90004, 0x310020, 0x40019
.long 0x4020902, 0x90004, 0x310020, 0x40029
.long 0x6000a02, 0xa0004, 0x310020, 0x4001a
.long 0x5010a02, 0xa0004, 0x310020, 0x4001a
.long 0x4020a02, 0xa0004, 0x310020, 0x4002a
.long 0x2d01, 0xffff0000, 0x310020, 0x10001b
.long 0x6000b02, 0xb0004, 0x310020, 0x4001b
.long 0x5010b02, 0xb0004, 0x310020, 0x4001b
.long 0x4020b02, 0xb0004, 0x310020, 0x4002b
.long 0x6000c02, 0xc0004, 0x310020, 0x4001c
.long 0x5010c02, 0xc0004, 0x310020, 0x4001c
.long 0x4020c02, 0xc0004, 0x310020, 0x4002c
.long 0x3401, 0xffff0000, 0x310020, 0x10001d
.long 0x6000d02, 0xd0004, 0x310020, 0x4001d
.long 0x5010d02, 0xd0004, 0x310020, 0x4001d
.long 0x4020d02, 0xd0004, 0x310020, 0x4002d
.long 0x3b01, 0xffff0000, 0x310020, 0x10001e
.long 0x6000e02, 0xe0004, 0x310020, 0x4001e
.long 0x5010e02, 0xe0004, 0x310020, 0x4001e
.long 0x4020e02, 0xe0004, 0x310020, 0x4002e
.long 0x6000f02, 0xf0004, 0x310020, 0x4001f
.long 0x5010f02, 0xf0004, 0x310020, 0x4001f
.long 0x4020f02, 0xf0004, 0x310020, 0x4002f

.section .rodata,"a"
.p2align 6
.amdhsa_kernel sequential_preLN__memory_aug_recurrent_mem_tr__glu_gated_swiglu__prompt_kernel
  .amdhsa_next_free_vgpr 512
  .amdhsa_next_free_sgpr 102
  .amdhsa_accum_offset 256
  .amdhsa_group_segment_fixed_size 0
  .amdhsa_kernarg_size 112
  .amdhsa_user_sgpr_count 2
  .amdhsa_user_sgpr_kernarg_segment_ptr 1
  .amdhsa_system_sgpr_workgroup_id_x 1
.end_amdhsa_kernel
```
